```python
import torch

def _softmax(x, axis=-1):
    return torch.softmax(x, dim=axis)
def _gelu(x):
    return torch.nn.functional.gelu(x, approximate="tanh")
def _silu(x):
    return torch.nn.functional.silu(x)
def _sigmoid(x):
    return torch.sigmoid(x)
def _layernorm(x, axis=-1, eps=1e-5):
    m = x.mean(dim=axis, keepdim=True)
    v = x.var(dim=axis, keepdim=True, unbiased=False)
    return (x - m) / torch.sqrt(v + eps)
def _scatter_add(tgt, idx, src, axis=0):
    return tgt.clone().index_add_(axis, idx, src)
def _segment_sum(src, seg, n):
    out = torch.zeros((n,) + src.shape[1:], dtype=src.dtype)
    return out.index_add_(0, seg, src)
def _pad(x, pw):
    flat = tuple(v for pair in reversed(pw) for v in pair)
    return torch.nn.functional.pad(x, flat)

kernel_name = 'gated_mix__ssm_conv_h3__swiglu_ffn__prompt'

def setup_inputs():

    _w = (lambda a: (lambda t: t.to(torch.bfloat16) if t.is_floating_point() else t)(torch.as_tensor(a)))
    def _A_setup():
        B, S, D = 1, 2048, 1024
        ks = 4
        return {
            "q": _w((lambda *s: torch.randn(*s, dtype=torch.bfloat16) * 0.05)(B, S, D)),
            "k": _w((lambda *s: torch.randn(*s, dtype=torch.bfloat16) * 0.4)(B, S, D)),
            "v": _w((lambda *s: torch.randn(*s, dtype=torch.bfloat16) * 0.4)(B, S, D)),
            "shift_k": _w((lambda *s: torch.randn(*s, dtype=torch.bfloat16) * 0.4)(D, ks) * 0.5),
            "ssm_k": _w((lambda *s: torch.randn(*s, dtype=torch.bfloat16) * 0.4)(D, S) * (1.0 / S ** 0.5)),
            "ssm_D": _w((lambda *s: torch.randn(*s, dtype=torch.bfloat16) * 0.4)(D)),
        }
    _A_in = _A_setup()

    def _B_setup():
        B, S, D, F = 1, 2048, 1024, 3584
        return {
            "x": _w((lambda *s: torch.randn(*s, dtype=torch.bfloat16) * 0.05)(B, S, D)),
            "w_gate": _w((lambda *s: torch.randn(*s, dtype=torch.bfloat16) * 0.05)(D, F)),
            "w_up": _w((lambda *s: torch.randn(*s, dtype=torch.bfloat16) * 0.05)(D, F)),
            "w_down": _w((lambda *s: torch.randn(*s, dtype=torch.bfloat16) * 0.05)(F, D)),
        }
    _B_in = _B_setup()

    return {
        "A_q": _A_in["q"],
        "A_k": _A_in["k"],
        "A_v": _A_in["v"],
        "A_shift_k": _A_in["shift_k"],
        "A_ssm_k": _A_in["ssm_k"],
        "A_ssm_D": _A_in["ssm_D"],
        "B_x": _B_in["x"],
        "B_w_gate": _B_in["w_gate"],
        "B_w_up": _B_in["w_up"],
        "B_w_down": _B_in["w_down"],
        "gate_w": _w((lambda *s: torch.randn(*s, dtype=torch.bfloat16) * 0.05)(1024) * 16.0),
    }

def reference(A_q, A_k, A_v, A_shift_k, A_ssm_k, A_ssm_D, B_x, B_w_gate, B_w_up, B_w_down, gate_w):
    def _A_ref(q, k, v, shift_k, ssm_k, ssm_D):
        B, S, D = q.shape
        ks = shift_k.shape[-1]
        k_pad = _pad(k, ((0, 0), (ks - 1, 0), (0, 0)))
        k_shift = torch.zeros_like(k)
        for t in range(ks):
            k_shift = k_shift + k_pad[:, t:t + S, :] * shift_k[:, ks - 1 - t][None, None, :]
        kv = k_shift * v
        L = 2 * S
        kv_pad = _pad(kv, ((0, 0), (0, S), (0, 0)))
        kf_pad = _pad(ssm_k, ((0, 0), (0, S)))
        kv_f = (lambda x, axes=(-2,-1): torch.fft.rfft2(x.float(), dim=axes))(kv_pad[:, None, :, :], axes=(1, 2))
        kf_f = (lambda x, axes=(-2,-1): torch.fft.rfft2(x.float(), dim=axes))(kf_pad[:, None, :], axes=(1, 2))
        kf_f = (lambda x, *d: x.permute(*d))(kf_f, 1, 2, 0)
        y_f = kv_f * kf_f[None, :, :, :]
        y = (lambda x, s, axes=(-2,-1): torch.fft.irfft2(x, s=s, dim=axes).to(torch.bfloat16))(y_f, (1, L), axes=(1, 2))[:, 0, :S, :]
        y = y + kv * ssm_D[None, None, :]
        return q * y

    def _B_ref(x, w_gate, w_up, w_down):
        g = _silu(x @ w_gate)
        u = x @ w_up
        return (g * u) @ w_down

    x = A_q
    g = _sigmoid((x * gate_w).sum(-1, keepdims=True))
    a = _A_ref(x, A_k, A_v, A_shift_k, A_ssm_k, A_ssm_D)
    b = _B_ref(x, B_w_gate, B_w_up, B_w_down)
    return g * a + (1 - g) * b
```

```asm
; @launch grid=(256,1,1) block=(256,1,1) lds=163840
.amdgcn_target "amdgcn-amd-amdhsa--gfx950"
.text
.globl gated_mix__ssm_conv_h3__swiglu_ffn__prompt_kernel
.p2align 8
.type gated_mix__ssm_conv_h3__swiglu_ffn__prompt_kernel,@function
gated_mix__ssm_conv_h3__swiglu_ffn__prompt_kernel:
    s_cmp_ge_u32 s2, 256
    s_cbranch_scc1 L_done
    s_load_dwordx2 s[4:5], s[0:1], 0
    s_load_dwordx8 s[16:23], s[0:1], 56
    s_load_dwordx4 s[24:27], s[0:1], 88
    s_load_dwordx2 s[28:29], s[0:1], 104
    s_load_dwordx2 s[6:7], s[0:1], 8
    s_load_dwordx8 s[8:15], s[0:1], 16
    s_getpc_b64 s[96:97]
L_pc:
    v_min_u32 v1, 31, v0
    v_lshlrev_b32 v1, 7, v1
    global_load_dword v236, v1, s[96:97]
    v_lshrrev_b32 v1, 6, v0
    v_and_b32 v244, 63, v0
    v_readfirstlane_b32 s30, v1
    s_cmp_ge_u32 s2, 224
    s_cbranch_scc1 L_helper
    s_lshr_b32 s74, s2, 3
    s_and_b32 s71, s74, 3
    s_and_b32 s75, s2, 1
    s_lshl2_add_u32 s71, s75, s71
    s_lshr_b32 s72, s74, 2
    s_bfe_u32 s75, s2, 0x20001
    s_mul_i32 s75, s75, 7
    s_add_u32 s72, s72, s75
    s_lshl2_add_u32 s73, s71, s30
    s_lshl_b32 s73, s73, 17
    v_lshrrev_b32 v3, 3, v244
    v_lshlrev_b32 v3, 11, v3
    v_add_u32 v3, s73, v3
    v_and_b32 v4, 7, v244
    v_lshrrev_b32 v5, 4, v244
    v_xor_b32 v4, v4, v5
    v_xor_b32 v6, 4, v4
    v_lshl_add_u32 v208, v4, 4, v3
    v_lshl_add_u32 v6, v6, 4, v3
    v_add_u32 v209, 15360, v6
    v_add_u32 v210, 30720, v208
    v_add_u32 v211, 46080, v6
    v_add_u32 v212, 65536, v208
    v_add_u32 v213, 80896, v6
    v_add_u32 v214, 96256, v208
    v_add_u32 v215, 111616, v6
    s_lshl_b32 s66, s30, 14
    s_mov_b32 s64, 0
    s_mov_b32 s65, 0
    s_and_b32 s73, s30, 1
    s_mul_i32 s73, s73, 229376
    s_lshl_b32 s76, s72, 8
    s_add_u32 s73, s73, s76
    v_and_b32 v3, 15, v244
    v_lshlrev_b32 v4, 1, v5
    v_xor_b32 v3, v3, v4
    v_mul_u32_u24 v4, 7168, v5
    v_add_u32 v4, s73, v4
    v_xor_b32 v6, 8, v3
    v_lshl_add_u32 v216, v3, 4, v4
    v_lshl_add_u32 v6, v6, 4, v4
    v_add_u32 v217, 27648, v216
    v_add_u32 v218, 55296, v6
    v_add_u32 v219, 82944, v6
    v_add_u32 v220, 114688, v216
    v_add_u32 v221, 142336, v216
    v_add_u32 v222, 169984, v6
    v_add_u32 v223, 197632, v6
    s_lshl_b32 s67, s30, 13
    s_add_u32 s67, s67, 65536
    s_waitcnt lgkmcnt(0)
    s_mov_b32 s32, s4
    s_and_b32 s33, s5, 0xffff
    s_mov_b32 s34, 4194304
    s_mov_b32 s35, 0x20000
    s_cmp_ge_u32 s30, 2
    s_cselect_b32 s36, s18, s16
    s_cselect_b32 s37, s19, s17
    s_and_b32 s37, s37, 0xffff
    s_mov_b32 s38, 7340032
    s_mov_b32 s39, 0x20000
    s_mov_b32 m0, s66
    s_nop 0
    buffer_load_dwordx4 v208, s[32:35], s64 offen offset:0  lds
    buffer_load_dwordx4 v209, s[32:35], s64 offen offset:1024  lds
    buffer_load_dwordx4 v210, s[32:35], s64 offen offset:2048  lds
    buffer_load_dwordx4 v211, s[32:35], s64 offen offset:3072  lds
    s_add_u32 m0, s66, 4096
    s_nop 0
    buffer_load_dwordx4 v212, s[32:35], s64 offen offset:0  lds
    buffer_load_dwordx4 v213, s[32:35], s64 offen offset:1024  lds
    buffer_load_dwordx4 v214, s[32:35], s64 offen offset:2048  lds
    buffer_load_dwordx4 v215, s[32:35], s64 offen offset:3072  lds
    s_add_u32 s64, s64, 128
    s_xor_b32 s66, s66, 8192
    s_mov_b32 m0, s67
    s_nop 0
    buffer_load_dwordx4 v216, s[36:39], s65 offen offset:0  lds
    buffer_load_dwordx4 v217, s[36:39], s65 offen offset:1024  lds
    buffer_load_dwordx4 v218, s[36:39], s65 offen offset:2048  lds
    buffer_load_dwordx4 v219, s[36:39], s65 offen offset:3072  lds
    s_add_u32 m0, s67, 4096
    s_nop 0
    buffer_load_dwordx4 v220, s[36:39], s65 offen offset:0  lds
    buffer_load_dwordx4 v221, s[36:39], s65 offen offset:1024  lds
    buffer_load_dwordx4 v222, s[36:39], s65 offen offset:2048  lds
    buffer_load_dwordx4 v223, s[36:39], s65 offen offset:3072  lds
    s_add_u32 s65, s65, 458752
    s_xor_b32 s67, s67, 32768
    s_mov_b32 s40, s18
    s_and_b32 s41, s19, 0xffff
    s_mov_b32 s42, 7340032
    s_mov_b32 s43, 0x20000
    s_lshl2_add_u32 s73, s2, s30
    s_lshl_b32 s73, s73, 9
    s_add_u32 s68, s73, 458752
    v_and_b32 v3, 3, v244
    v_lshlrev_b32 v3, 7, v3
    v_lshrrev_b32 v4, 2, v244
    s_mov_b32 s75, 458752
    v_mul_lo_u32 v5, v4, s75
    v_add_u32 v5, v5, v3
    v_cmp_le_u32 vcc, 3, v4
    v_mov_b32 v6, 0x80000000
    s_nop 0
    v_cndmask_b32 v5, v5, v6, vcc
    buffer_load_dword v237, v5, s[40:43], s68 offen
    s_add_u32 s68, s68, 1376256
    v_min_u32 v4, 1, v4
    v_lshl_add_u32 v234, v4, 31, v3
    s_mul_i32 s73, s2, 9363
    s_lshr_b32 s73, s73, 10
    s_mul_i32 s75, s30, 3
    s_add_u32 s73, s73, s75
    s_lshl_b32 s73, s73, 11
    s_add_u32 s88, s73, 128
    v_lshlrev_b32 v5, 4, v3
    v_cmp_eq_u32 vcc, 6144, v5
    s_nop 1
    v_cndmask_b32 v5, v5, v6, vcc
    v_lshrrev_b32 v4, 2, v244
    v_lshl_add_u32 v7, v4, 7, v5
    v_cmp_le_u32 vcc, 4, v4
    s_nop 1
    v_cndmask_b32 v7, v7, v6, vcc
    buffer_load_dword v238, v7, s[32:35], s88 offen
    s_add_u32 s88, s88, 512
    v_cmp_le_u32 vcc, 1, v4
    s_nop 1
    v_cndmask_b32 v207, v5, v6, vcc
    s_lshl2_add_u32 s73, s74, s30
    s_lshl_b32 s73, s73, 9
    s_add_u32 s73, s73, 4096
    v_add_u32 v3, s73, v3
    v_min_u32 v3, L_done-L_pc2, v3
    s_getpc_b64 s[98:99]
L_pc2:
    global_load_dword v239, v3, s[98:99]
    s_lshl2_add_u32 s73, s2, s30
    s_lshl_b32 s75, s73, 12
    s_load_dword s96, s[12:13], s75
    s_lshr_b32 s75, s73, 1
    s_lshl_b32 s75, s75, 2
    s_load_dword s31, s[14:15], s75
    v_lshlrev_b32 v245, 4, v244
    s_mov_b32 s60, s26
    s_and_b32 s61, s27, 0xffff
    s_mov_b32 s62, 256
    s_mov_b32 s63, 0x20000
    v_and_b32 v3, 15, v244
    v_lshrrev_b32 v4, 4, v244
    v_lshrrev_b32 v5, 1, v3
    v_xor_b32 v4, v4, v5
    v_lshlrev_b32 v4, 4, v4
    v_lshl_add_u32 v4, v3, 7, v4
    s_lshl_b32 s73, s30, 14
    v_add_u32 v224, s73, v4
    v_xor_b32 v225, 64, v224
    v_lshrrev_b32 v3, 4, v244
    v_bfe_u32 v4, v244, 2, 2
    v_lshl_add_u32 v5, v3, 3, v4
    v_and_b32 v3, 1, v3
    v_lshl_add_u32 v4, v3, 2, v4
    v_and_b32 v3, 3, v244
    v_lshlrev_b32 v3, 3, v3
    v_lshl_add_u32 v3, v5, 8, v3
    v_add_u32 v3, 65536, v3
    v_xor_b32 v5, 0, v4
    v_lshl_add_u32 v226, v5, 5, v3
    v_xor_b32 v5, 1, v4
    v_lshl_add_u32 v227, v5, 5, v3
    v_xor_b32 v5, 2, v4
    v_lshl_add_u32 v228, v5, 5, v3
    v_xor_b32 v5, 3, v4
    v_lshl_add_u32 v229, v5, 5, v3
    v_xor_b32 v5, 4, v4
    v_lshl_add_u32 v230, v5, 5, v3
    v_xor_b32 v5, 5, v4
    v_lshl_add_u32 v231, v5, 5, v3
    v_xor_b32 v5, 6, v4
    v_lshl_add_u32 v232, v5, 5, v3
    v_xor_b32 v5, 7, v4
    v_lshl_add_u32 v233, v5, 5, v3
    s_waitcnt vmcnt(3)
    s_barrier
    ds_read_b64_tr_b16 a[64:65], v226 offset:0
    ds_read_b64_tr_b16 a[66:67], v226 offset:1024
    ds_read_b64_tr_b16 a[68:69], v226 offset:8192
    ds_read_b64_tr_b16 a[70:71], v226 offset:9216
    ds_read_b128 a[0:3], v224 offset:0
    ds_read_b128 a[4:7], v225 offset:0
    ds_read_b128 a[8:11], v224 offset:2048
    ds_read_b128 a[12:15], v225 offset:2048
    ds_read_b128 a[16:19], v224 offset:4096
    ds_read_b128 a[20:23], v225 offset:4096
    ds_read_b128 a[24:27], v224 offset:6144
    ds_read_b128 a[28:31], v225 offset:6144
    ds_read_b64_tr_b16 a[72:73], v226 offset:16384
    ds_read_b64_tr_b16 a[74:75], v226 offset:17408
    ds_read_b64_tr_b16 a[76:77], v226 offset:24576
    ds_read_b64_tr_b16 a[78:79], v226 offset:25600
    s_waitcnt lgkmcnt(0)
    v_mfma_f32_16x16x32_bf16 v[0:3], a[64:67], a[0:3], 0
    ds_read_b64_tr_b16 a[80:81], v227 offset:0
    v_mfma_f32_16x16x32_bf16 v[0:3], a[68:71], a[4:7], v[0:3]
    ds_read_b64_tr_b16 a[82:83], v227 offset:1024
    v_mfma_f32_16x16x32_bf16 v[4:7], a[64:67], a[8:11], 0
    ds_read_b64_tr_b16 a[84:85], v227 offset:8192
    v_mfma_f32_16x16x32_bf16 v[4:7], a[68:71], a[12:15], v[4:7]
    ds_read_b64_tr_b16 a[86:87], v227 offset:9216
    s_mov_b32 m0, s66
    v_mfma_f32_16x16x32_bf16 v[8:11], a[64:67], a[16:19], 0
    buffer_load_dwordx4 v208, s[32:35], s64 offen offset:0  lds
    v_mfma_f32_16x16x32_bf16 v[8:11], a[68:71], a[20:23], v[8:11]
    v_mfma_f32_16x16x32_bf16 v[12:15], a[64:67], a[24:27], 0
    buffer_load_dwordx4 v209, s[32:35], s64 offen offset:1024  lds
    v_mfma_f32_16x16x32_bf16 v[12:15], a[68:71], a[28:31], v[12:15]
    v_mfma_f32_16x16x32_bf16 v[16:19], a[72:75], a[0:3], 0
    ds_read_b64_tr_b16 a[88:89], v227 offset:16384
    buffer_load_dwordx4 v210, s[32:35], s64 offen offset:2048  lds
    v_mfma_f32_16x16x32_bf16 v[16:19], a[76:79], a[4:7], v[16:19]
    ds_read_b64_tr_b16 a[90:91], v227 offset:17408
    v_mfma_f32_16x16x32_bf16 v[20:23], a[72:75], a[8:11], 0
    ds_read_b64_tr_b16 a[92:93], v227 offset:24576
    buffer_load_dwordx4 v211, s[32:35], s64 offen offset:3072  lds
    v_mfma_f32_16x16x32_bf16 v[20:23], a[76:79], a[12:15], v[20:23]
    ds_read_b64_tr_b16 a[94:95], v227 offset:25600
    s_add_u32 m0, s66, 4096
    v_mfma_f32_16x16x32_bf16 v[24:27], a[72:75], a[16:19], 0
    buffer_load_dwordx4 v212, s[32:35], s64 offen offset:0  lds
    v_mfma_f32_16x16x32_bf16 v[24:27], a[76:79], a[20:23], v[24:27]
    v_mfma_f32_16x16x32_bf16 v[28:31], a[72:75], a[24:27], 0
    buffer_load_dwordx4 v213, s[32:35], s64 offen offset:1024  lds
    v_mfma_f32_16x16x32_bf16 v[28:31], a[76:79], a[28:31], v[28:31]
    s_waitcnt lgkmcnt(4)
    v_mfma_f32_16x16x32_bf16 v[32:35], a[80:83], a[0:3], 0
    ds_read_b64_tr_b16 a[64:65], v228 offset:0
    buffer_load_dwordx4 v214, s[32:35], s64 offen offset:2048  lds
    v_mfma_f32_16x16x32_bf16 v[32:35], a[84:87], a[4:7], v[32:35]
    ds_read_b64_tr_b16 a[66:67], v228 offset:1024
    s_xor_b32 s66, s66, 8192
    v_mfma_f32_16x16x32_bf16 v[36:39], a[80:83], a[8:11], 0
    ds_read_b64_tr_b16 a[68:69], v228 offset:8192
    buffer_load_dwordx4 v215, s[32:35], s64 offen offset:3072  lds
    s_add_u32 s64, s64, 128
    v_mfma_f32_16x16x32_bf16 v[36:39], a[84:87], a[12:15], v[36:39]
    ds_read_b64_tr_b16 a[70:71], v228 offset:9216
    s_mov_b32 m0, s67
    v_mfma_f32_16x16x32_bf16 v[40:43], a[80:83], a[16:19], 0
    buffer_load_dwordx4 v216, s[36:39], s65 offen offset:0  lds
    v_mfma_f32_16x16x32_bf16 v[40:43], a[84:87], a[20:23], v[40:43]
    v_mfma_f32_16x16x32_bf16 v[44:47], a[80:83], a[24:27], 0
    v_mfma_f32_16x16x32_bf16 v[44:47], a[84:87], a[28:31], v[44:47]
    buffer_load_dwordx4 v217, s[36:39], s65 offen offset:1024  lds
    s_waitcnt lgkmcnt(4)
    v_mfma_f32_16x16x32_bf16 v[48:51], a[88:91], a[0:3], 0
    ds_read_b64_tr_b16 a[72:73], v228 offset:16384
    v_mfma_f32_16x16x32_bf16 v[48:51], a[92:95], a[4:7], v[48:51]
    ds_read_b64_tr_b16 a[74:75], v228 offset:17408
    v_mfma_f32_16x16x32_bf16 v[52:55], a[88:91], a[8:11], 0
    ds_read_b64_tr_b16 a[76:77], v228 offset:24576
    buffer_load_dwordx4 v218, s[36:39], s65 offen offset:2048  lds
    v_mfma_f32_16x16x32_bf16 v[52:55], a[92:95], a[12:15], v[52:55]
    ds_read_b64_tr_b16 a[78:79], v228 offset:25600
    v_mfma_f32_16x16x32_bf16 v[56:59], a[88:91], a[16:19], 0
    v_mfma_f32_16x16x32_bf16 v[56:59], a[92:95], a[20:23], v[56:59]
    buffer_load_dwordx4 v219, s[36:39], s65 offen offset:3072  lds
    v_mfma_f32_16x16x32_bf16 v[60:63], a[88:91], a[24:27], 0
    v_mfma_f32_16x16x32_bf16 v[60:63], a[92:95], a[28:31], v[60:63]
    s_waitcnt lgkmcnt(4)
    s_add_u32 m0, s67, 4096
    v_mfma_f32_16x16x32_bf16 v[64:67], a[64:67], a[0:3], 0
    ds_read_b64_tr_b16 a[80:81], v229 offset:0
    buffer_load_dwordx4 v220, s[36:39], s65 offen offset:0  lds
    v_mfma_f32_16x16x32_bf16 v[64:67], a[68:71], a[4:7], v[64:67]
    ds_read_b64_tr_b16 a[82:83], v229 offset:1024
    v_mfma_f32_16x16x32_bf16 v[68:71], a[64:67], a[8:11], 0
    ds_read_b64_tr_b16 a[84:85], v229 offset:8192
    v_mfma_f32_16x16x32_bf16 v[68:71], a[68:71], a[12:15], v[68:71]
    ds_read_b64_tr_b16 a[86:87], v229 offset:9216
    buffer_load_dwordx4 v221, s[36:39], s65 offen offset:1024  lds
    v_mfma_f32_16x16x32_bf16 v[72:75], a[64:67], a[16:19], 0
    v_mfma_f32_16x16x32_bf16 v[72:75], a[68:71], a[20:23], v[72:75]
    v_mfma_f32_16x16x32_bf16 v[76:79], a[64:67], a[24:27], 0
    buffer_load_dwordx4 v222, s[36:39], s65 offen offset:2048  lds
    v_mfma_f32_16x16x32_bf16 v[76:79], a[68:71], a[28:31], v[76:79]
    s_waitcnt lgkmcnt(4)
    v_mfma_f32_16x16x32_bf16 v[80:83], a[72:75], a[0:3], 0
    ds_read_b64_tr_b16 a[88:89], v229 offset:16384
    s_xor_b32 s67, s67, 32768
    v_mfma_f32_16x16x32_bf16 v[80:83], a[76:79], a[4:7], v[80:83]
    ds_read_b64_tr_b16 a[90:91], v229 offset:17408
    buffer_load_dwordx4 v223, s[36:39], s65 offen offset:3072  lds
    s_add_u32 s65, s65, 458752
    v_mfma_f32_16x16x32_bf16 v[84:87], a[72:75], a[8:11], 0
    ds_read_b64_tr_b16 a[92:93], v229 offset:24576
    v_mfma_f32_16x16x32_bf16 v[84:87], a[76:79], a[12:15], v[84:87]
    ds_read_b64_tr_b16 a[94:95], v229 offset:25600
    v_mfma_f32_16x16x32_bf16 v[88:91], a[72:75], a[16:19], 0
    v_mfma_f32_16x16x32_bf16 v[88:91], a[76:79], a[20:23], v[88:91]
    v_mfma_f32_16x16x32_bf16 v[92:95], a[72:75], a[24:27], 0
    v_mfma_f32_16x16x32_bf16 v[92:95], a[76:79], a[28:31], v[92:95]
    s_waitcnt lgkmcnt(4)
    v_mfma_f32_16x16x32_bf16 v[96:99], a[80:83], a[0:3], 0
    ds_read_b64_tr_b16 a[64:65], v230 offset:0
    v_mfma_f32_16x16x32_bf16 v[96:99], a[84:87], a[4:7], v[96:99]
    ds_read_b64_tr_b16 a[66:67], v230 offset:1024
    v_mfma_f32_16x16x32_bf16 v[100:103], a[80:83], a[8:11], 0
    ds_read_b64_tr_b16 a[68:69], v230 offset:8192
    buffer_load_dword v240, v234, s[40:43], s68 offen
    s_add_u32 s68, s68, 458752
    buffer_load_dword v241, v207, s[32:35], s88 offen
    s_add_u32 s88, s88, 128
    v_mfma_f32_16x16x32_bf16 v[100:103], a[84:87], a[12:15], v[100:103]
    ds_read_b64_tr_b16 a[70:71], v230 offset:9216
    v_mfma_f32_16x16x32_bf16 v[104:107], a[80:83], a[16:19], 0
    v_mfma_f32_16x16x32_bf16 v[104:107], a[84:87], a[20:23], v[104:107]
    s_mov_b32 m0, s66
    v_mfma_f32_16x16x32_bf16 v[108:111], a[80:83], a[24:27], 0
    buffer_load_dwordx4 v208, s[32:35], s64 offen offset:0  lds
    v_mfma_f32_16x16x32_bf16 v[108:111], a[84:87], a[28:31], v[108:111]
    s_waitcnt lgkmcnt(4)
    v_mfma_f32_16x16x32_bf16 v[112:115], a[88:91], a[0:3], 0
    ds_read_b64_tr_b16 a[72:73], v230 offset:16384
    v_mfma_f32_16x16x32_bf16 v[112:115], a[92:95], a[4:7], v[112:115]
    ds_read_b64_tr_b16 a[74:75], v230 offset:17408
    v_mfma_f32_16x16x32_bf16 v[116:119], a[88:91], a[8:11], 0
    ds_read_b64_tr_b16 a[76:77], v230 offset:24576
    v_mfma_f32_16x16x32_bf16 v[116:119], a[92:95], a[12:15], v[116:119]
    ds_read_b64_tr_b16 a[78:79], v230 offset:25600
    v_mfma_f32_16x16x32_bf16 v[120:123], a[88:91], a[16:19], 0
    buffer_load_dwordx4 v209, s[32:35], s64 offen offset:1024  lds
    v_mfma_f32_16x16x32_bf16 v[120:123], a[92:95], a[20:23], v[120:123]
    v_mfma_f32_16x16x32_bf16 v[124:127], a[88:91], a[24:27], 0
    v_mfma_f32_16x16x32_bf16 v[124:127], a[92:95], a[28:31], v[124:127]
    s_waitcnt lgkmcnt(4)
    v_mfma_f32_16x16x32_bf16 v[128:131], a[64:67], a[0:3], 0
    ds_read_b64_tr_b16 a[80:81], v231 offset:0
    v_mfma_f32_16x16x32_bf16 v[128:131], a[68:71], a[4:7], v[128:131]
    ds_read_b64_tr_b16 a[82:83], v231 offset:1024
    v_mfma_f32_16x16x32_bf16 v[132:135], a[64:67], a[8:11], 0
    ds_read_b64_tr_b16 a[84:85], v231 offset:8192
    buffer_load_dwordx4 v210, s[32:35], s64 offen offset:2048  lds
    v_mfma_f32_16x16x32_bf16 v[132:135], a[68:71], a[12:15], v[132:135]
    ds_read_b64_tr_b16 a[86:87], v231 offset:9216
    v_mfma_f32_16x16x32_bf16 v[136:139], a[64:67], a[16:19], 0
    v_mfma_f32_16x16x32_bf16 v[136:139], a[68:71], a[20:23], v[136:139]
    v_mfma_f32_16x16x32_bf16 v[140:143], a[64:67], a[24:27], 0
    v_mfma_f32_16x16x32_bf16 v[140:143], a[68:71], a[28:31], v[140:143]
    s_waitcnt lgkmcnt(4)
    v_mfma_f32_16x16x32_bf16 v[144:147], a[72:75], a[0:3], 0
    ds_read_b64_tr_b16 a[88:89], v231 offset:16384
    buffer_load_dwordx4 v211, s[32:35], s64 offen offset:3072  lds
    v_mfma_f32_16x16x32_bf16 v[144:147], a[76:79], a[4:7], v[144:147]
    ds_read_b64_tr_b16 a[90:91], v231 offset:17408
    v_mfma_f32_16x16x32_bf16 v[148:151], a[72:75], a[8:11], 0
    ds_read_b64_tr_b16 a[92:93], v231 offset:24576
    v_mfma_f32_16x16x32_bf16 v[148:151], a[76:79], a[12:15], v[148:151]
    ds_read_b64_tr_b16 a[94:95], v231 offset:25600
    v_mfma_f32_16x16x32_bf16 v[152:155], a[72:75], a[16:19], 0
    v_mfma_f32_16x16x32_bf16 v[152:155], a[76:79], a[20:23], v[152:155]
    s_add_u32 m0, s66, 4096
    v_mfma_f32_16x16x32_bf16 v[156:159], a[72:75], a[24:27], 0
    buffer_load_dwordx4 v212, s[32:35], s64 offen offset:0  lds
    v_mfma_f32_16x16x32_bf16 v[156:159], a[76:79], a[28:31], v[156:159]
    s_waitcnt lgkmcnt(4)
    v_mfma_f32_16x16x32_bf16 v[160:163], a[80:83], a[0:3], 0
    ds_read_b64_tr_b16 a[64:65], v232 offset:0
    v_mfma_f32_16x16x32_bf16 v[160:163], a[84:87], a[4:7], v[160:163]
    ds_read_b64_tr_b16 a[66:67], v232 offset:1024
    v_mfma_f32_16x16x32_bf16 v[164:167], a[80:83], a[8:11], 0
    ds_read_b64_tr_b16 a[68:69], v232 offset:8192
    v_mfma_f32_16x16x32_bf16 v[164:167], a[84:87], a[12:15], v[164:167]
    ds_read_b64_tr_b16 a[70:71], v232 offset:9216
    v_mfma_f32_16x16x32_bf16 v[168:171], a[80:83], a[16:19], 0
    buffer_load_dwordx4 v213, s[32:35], s64 offen offset:1024  lds
    v_mfma_f32_16x16x32_bf16 v[168:171], a[84:87], a[20:23], v[168:171]
    v_mfma_f32_16x16x32_bf16 v[172:175], a[80:83], a[24:27], 0
    v_mfma_f32_16x16x32_bf16 v[172:175], a[84:87], a[28:31], v[172:175]
    s_waitcnt lgkmcnt(4)
    v_mfma_f32_16x16x32_bf16 v[176:179], a[88:91], a[0:3], 0
    ds_read_b64_tr_b16 a[72:73], v232 offset:16384
    v_mfma_f32_16x16x32_bf16 v[176:179], a[92:95], a[4:7], v[176:179]
    ds_read_b64_tr_b16 a[74:75], v232 offset:17408
    v_mfma_f32_16x16x32_bf16 v[180:183], a[88:91], a[8:11], 0
    ds_read_b64_tr_b16 a[76:77], v232 offset:24576
    buffer_load_dwordx4 v214, s[32:35], s64 offen offset:2048  lds
    v_mfma_f32_16x16x32_bf16 v[180:183], a[92:95], a[12:15], v[180:183]
    ds_read_b64_tr_b16 a[78:79], v232 offset:25600
    v_mfma_f32_16x16x32_bf16 v[184:187], a[88:91], a[16:19], 0
    v_mfma_f32_16x16x32_bf16 v[184:187], a[92:95], a[20:23], v[184:187]
    v_mfma_f32_16x16x32_bf16 v[188:191], a[88:91], a[24:27], 0
    v_mfma_f32_16x16x32_bf16 v[188:191], a[92:95], a[28:31], v[188:191]
    s_waitcnt lgkmcnt(4)
    s_xor_b32 s66, s66, 8192
    v_mfma_f32_16x16x32_bf16 a[96:99], a[64:67], a[0:3], 0
    ds_read_b64_tr_b16 a[80:81], v233 offset:0
    buffer_load_dwordx4 v215, s[32:35], s64 offen offset:3072  lds
    s_add_u32 s64, s64, 128
    v_mfma_f32_16x16x32_bf16 a[96:99], a[68:71], a[4:7], a[96:99]
    ds_read_b64_tr_b16 a[82:83], v233 offset:1024
    v_mfma_f32_16x16x32_bf16 a[100:103], a[64:67], a[8:11], 0
    ds_read_b64_tr_b16 a[84:85], v233 offset:8192
    v_mfma_f32_16x16x32_bf16 a[100:103], a[68:71], a[12:15], a[100:103]
    ds_read_b64_tr_b16 a[86:87], v233 offset:9216
    v_mfma_f32_16x16x32_bf16 a[104:107], a[64:67], a[16:19], 0
    ds_read_b64_tr_b16 a[88:89], v233 offset:16384
    v_mfma_f32_16x16x32_bf16 a[104:107], a[68:71], a[20:23], a[104:107]
    ds_read_b64_tr_b16 a[90:91], v233 offset:17408
    v_mfma_f32_16x16x32_bf16 a[108:111], a[64:67], a[24:27], 0
    ds_read_b64_tr_b16 a[92:93], v233 offset:24576
    v_mfma_f32_16x16x32_bf16 a[108:111], a[68:71], a[28:31], a[108:111]
    ds_read_b64_tr_b16 a[94:95], v233 offset:25600
    s_waitcnt vmcnt(18) lgkmcnt(8)
    v_mfma_f32_16x16x32_bf16 a[112:115], a[72:75], a[0:3], 0
    ds_read_b128 a[32:35], v224 offset:8192
    v_mfma_f32_16x16x32_bf16 a[112:115], a[76:79], a[4:7], a[112:115]
    ds_read_b128 a[36:39], v225 offset:8192
    v_mfma_f32_16x16x32_bf16 a[116:119], a[72:75], a[8:11], 0
    ds_read_b128 a[40:43], v224 offset:10240
    v_mfma_f32_16x16x32_bf16 a[116:119], a[76:79], a[12:15], a[116:119]
    ds_read_b128 a[44:47], v225 offset:10240
    v_mfma_f32_16x16x32_bf16 a[120:123], a[72:75], a[16:19], 0
    ds_read_b128 a[48:51], v224 offset:12288
    v_mfma_f32_16x16x32_bf16 a[120:123], a[76:79], a[20:23], a[120:123]
    ds_read_b128 a[52:55], v225 offset:12288
    v_mfma_f32_16x16x32_bf16 a[124:127], a[72:75], a[24:27], 0
    ds_read_b128 a[56:59], v224 offset:14336
    ds_read_b128 a[60:63], v225 offset:14336
    v_mfma_f32_16x16x32_bf16 a[124:127], a[76:79], a[28:31], a[124:127]
    s_waitcnt vmcnt(10) lgkmcnt(0)
    v_mfma_f32_16x16x32_bf16 a[128:131], a[80:83], a[0:3], 0
    s_barrier
    v_mfma_f32_16x16x32_bf16 a[128:131], a[84:87], a[4:7], a[128:131]
    ds_read_b64_tr_b16 a[64:65], v226 offset:32768
    v_mfma_f32_16x16x32_bf16 a[132:135], a[80:83], a[8:11], 0
    ds_read_b64_tr_b16 a[66:67], v226 offset:33792
    v_mfma_f32_16x16x32_bf16 a[132:135], a[84:87], a[12:15], a[132:135]
    ds_read_b64_tr_b16 a[68:69], v226 offset:40960
    v_mfma_f32_16x16x32_bf16 a[136:139], a[80:83], a[16:19], 0
    ds_read_b64_tr_b16 a[70:71], v226 offset:41984
    v_mfma_f32_16x16x32_bf16 a[136:139], a[84:87], a[20:23], a[136:139]
    s_mov_b32 m0, s67
    v_mfma_f32_16x16x32_bf16 a[140:143], a[80:83], a[24:27], 0
    buffer_load_dwordx4 v216, s[36:39], s65 offen offset:0  lds
    v_mfma_f32_16x16x32_bf16 a[140:143], a[84:87], a[28:31], a[140:143]
    v_mfma_f32_16x16x32_bf16 a[144:147], a[88:91], a[0:3], 0
    v_mfma_f32_16x16x32_bf16 a[144:147], a[92:95], a[4:7], a[144:147]
    ds_read_b64_tr_b16 a[72:73], v226 offset:49152
    v_mfma_f32_16x16x32_bf16 a[148:151], a[88:91], a[8:11], 0
    ds_read_b64_tr_b16 a[74:75], v226 offset:50176
    v_mfma_f32_16x16x32_bf16 a[148:151], a[92:95], a[12:15], a[148:151]
    ds_read_b64_tr_b16 a[76:77], v226 offset:57344
    v_mfma_f32_16x16x32_bf16 a[152:155], a[88:91], a[16:19], 0
    ds_read_b64_tr_b16 a[78:79], v226 offset:58368
    v_mfma_f32_16x16x32_bf16 a[152:155], a[92:95], a[20:23], a[152:155]
    v_mfma_f32_16x16x32_bf16 a[156:159], a[88:91], a[24:27], 0
    buffer_load_dwordx4 v217, s[36:39], s65 offen offset:1024  lds
    v_mfma_f32_16x16x32_bf16 a[156:159], a[92:95], a[28:31], a[156:159]
    s_waitcnt lgkmcnt(4)
    v_mfma_f32_16x16x32_bf16 v[0:3], a[64:67], a[32:35], v[0:3]
    ds_read_b64_tr_b16 a[80:81], v227 offset:32768
    s_bfe_u32 s80, s2, 0x30003
    v_mfma_f32_16x16x32_bf16 v[0:3], a[68:71], a[36:39], v[0:3]
    ds_read_b64_tr_b16 a[82:83], v227 offset:33792
    s_bfe_u32 s94, s2, 0x10001
    v_mfma_f32_16x16x32_bf16 v[4:7], a[64:67], a[40:43], v[4:7]
    ds_read_b64_tr_b16 a[84:85], v227 offset:40960
    s_lshl3_add_u32 s80, s94, s80
    v_mfma_f32_16x16x32_bf16 v[4:7], a[68:71], a[44:47], v[4:7]
    ds_read_b64_tr_b16 a[86:87], v227 offset:41984
    s_lshr_b32 s81, s2, 6
    v_mfma_f32_16x16x32_bf16 v[8:11], a[64:67], a[48:51], v[8:11]
    s_bfe_u32 s94, s2, 0x10002
    s_lshl2_add_u32 s81, s94, s81
    v_mfma_f32_16x16x32_bf16 v[8:11], a[68:71], a[52:55], v[8:11]
    s_lshr_b32 s94, s30, 1
    v_mfma_f32_16x16x32_bf16 v[12:15], a[64:67], a[56:59], v[12:15]
    buffer_load_dwordx4 v218, s[36:39], s65 offen offset:2048  lds
    s_lshl1_add_u32 s81, s81, s94
    v_mfma_f32_16x16x32_bf16 v[12:15], a[68:71], a[60:63], v[12:15]
    s_waitcnt lgkmcnt(4)
    s_and_b32 s92, s2, 1
    v_mfma_f32_16x16x32_bf16 v[16:19], a[72:75], a[32:35], v[16:19]
    ds_read_b64_tr_b16 a[88:89], v227 offset:49152
    s_and_b32 s93, s30, 1
    v_mfma_f32_16x16x32_bf16 v[16:19], a[76:79], a[36:39], v[16:19]
    ds_read_b64_tr_b16 a[90:91], v227 offset:50176
    s_lshl1_add_u32 s82, s92, s93
    v_mfma_f32_16x16x32_bf16 v[20:23], a[72:75], a[40:43], v[20:23]
    ds_read_b64_tr_b16 a[92:93], v227 offset:57344
    s_mov_b32 s44, s20
    v_mfma_f32_16x16x32_bf16 v[20:23], a[76:79], a[44:47], v[20:23]
    ds_read_b64_tr_b16 a[94:95], v227 offset:58368
    s_and_b32 s45, s21, 0xffff
    v_mfma_f32_16x16x32_bf16 v[24:27], a[72:75], a[48:51], v[24:27]
    s_mov_b32 s46, 7340032
    s_mov_b32 s47, 0x20000
    v_mfma_f32_16x16x32_bf16 v[24:27], a[76:79], a[52:55], v[24:27]
    s_lshl2_add_u32 s92, s80, s82
    v_mfma_f32_16x16x32_bf16 v[28:31], a[72:75], a[56:59], v[28:31]
    buffer_load_dwordx4 v219, s[36:39], s65 offen offset:3072  lds
    s_mul_i32 s84, s92, 229376
    v_mfma_f32_16x16x32_bf16 v[28:31], a[76:79], a[60:63], v[28:31]
    s_waitcnt lgkmcnt(4)
    s_lshl_b32 s92, s94, 13
    v_mfma_f32_16x16x32_bf16 v[32:35], a[80:83], a[32:35], v[32:35]
    ds_read_b64_tr_b16 a[64:65], v228 offset:32768
    s_add_u32 s84, s84, s92
    v_mfma_f32_16x16x32_bf16 v[32:35], a[84:87], a[36:39], v[32:35]
    ds_read_b64_tr_b16 a[66:67], v228 offset:33792
    s_lshl_b32 s85, s93, 14
    v_mfma_f32_16x16x32_bf16 v[36:39], a[80:83], a[40:43], v[36:39]
    ds_read_b64_tr_b16 a[68:69], v228 offset:40960
    s_add_u32 s85, s85, s92
    v_mfma_f32_16x16x32_bf16 v[36:39], a[84:87], a[44:47], v[36:39]
    ds_read_b64_tr_b16 a[70:71], v228 offset:41984
    s_mul_i32 s69, s30, 1835008
    v_mfma_f32_16x16x32_bf16 v[40:43], a[80:83], a[48:51], v[40:43]
    s_lshl_b32 s92, s2, 11
    s_add_u32 s69, s69, s92
    v_mfma_f32_16x16x32_bf16 v[40:43], a[84:87], a[52:55], v[40:43]
    s_mul_i32 s77, s82, 1835008
    s_add_u32 m0, s67, 4096
    v_mfma_f32_16x16x32_bf16 v[44:47], a[80:83], a[56:59], v[44:47]
    buffer_load_dwordx4 v220, s[36:39], s65 offen offset:0  lds
    s_lshl_b32 s92, s81, 7
    v_mfma_f32_16x16x32_bf16 v[44:47], a[84:87], a[60:63], v[44:47]
    s_waitcnt lgkmcnt(4)
    s_add_u32 s77, s77, s92
    v_mfma_f32_16x16x32_bf16 v[48:51], a[88:91], a[32:35], v[48:51]
    ds_read_b64_tr_b16 a[72:73], v228 offset:49152
    s_lshl_b32 s79, s30, 13
    v_mfma_f32_16x16x32_bf16 v[48:51], a[92:95], a[36:39], v[48:51]
    ds_read_b64_tr_b16 a[74:75], v228 offset:50176
    s_add_u32 s79, s79, 98304
    v_mfma_f32_16x16x32_bf16 v[52:55], a[88:91], a[40:43], v[52:55]
    ds_read_b64_tr_b16 a[76:77], v228 offset:57344
    v_lshrrev_b32 v192, 2, v244
    v_mfma_f32_16x16x32_bf16 v[52:55], a[92:95], a[44:47], v[52:55]
    ds_read_b64_tr_b16 a[78:79], v228 offset:58368
    v_min_u32 v192, 1, v192
    v_mfma_f32_16x16x32_bf16 v[56:59], a[88:91], a[48:51], v[56:59]
    v_lshlrev_b32 v192, 31, v192
    v_mfma_f32_16x16x32_bf16 v[56:59], a[92:95], a[52:55], v[56:59]
    v_lshl_add_u32 v235, v244, 7, v192
    v_mfma_f32_16x16x32_bf16 v[60:63], a[88:91], a[56:59], v[60:63]
    buffer_load_dwordx4 v221, s[36:39], s65 offen offset:1024  lds
    v_lshrrev_b32 v192, 3, v244
    v_mfma_f32_16x16x32_bf16 v[60:63], a[92:95], a[60:63], v[60:63]
    s_waitcnt lgkmcnt(4)
    v_and_b32 v193, 6, v192
    v_mfma_f32_16x16x32_bf16 v[64:67], a[64:67], a[32:35], v[64:67]
    ds_read_b64_tr_b16 a[80:81], v229 offset:32768
    v_and_b32 v194, 7, v244
    v_mfma_f32_16x16x32_bf16 v[64:67], a[68:71], a[36:39], v[64:67]
    ds_read_b64_tr_b16 a[82:83], v229 offset:33792
    v_xor_b32 v193, v193, v194
    v_mfma_f32_16x16x32_bf16 v[68:71], a[64:67], a[40:43], v[68:71]
    ds_read_b64_tr_b16 a[84:85], v229 offset:40960
    v_lshlrev_b32 v192, 11, v192
    v_mfma_f32_16x16x32_bf16 v[68:71], a[68:71], a[44:47], v[68:71]
    ds_read_b64_tr_b16 a[86:87], v229 offset:41984
    v_lshl_add_u32 v246, v193, 4, v192
    v_mfma_f32_16x16x32_bf16 v[72:75], a[64:67], a[48:51], v[72:75]
    v_add_u32 v247, 15360, v246
    v_mfma_f32_16x16x32_bf16 v[72:75], a[68:71], a[52:55], v[72:75]
    v_add_u32 v248, 30720, v246
    v_mfma_f32_16x16x32_bf16 v[76:79], a[64:67], a[56:59], v[76:79]
    buffer_load_dwordx4 v222, s[36:39], s65 offen offset:2048  lds
    v_add_u32 v249, 46080, v246
    v_mfma_f32_16x16x32_bf16 v[76:79], a[68:71], a[60:63], v[76:79]
    s_waitcnt lgkmcnt(4)
    v_lshrrev_b32 v192, 2, v244
    v_mfma_f32_16x16x32_bf16 v[80:83], a[72:75], a[32:35], v[80:83]
    ds_read_b64_tr_b16 a[88:89], v229 offset:49152
    v_bfe_u32 v193, v244, 3, 2
    v_mfma_f32_16x16x32_bf16 v[80:83], a[76:79], a[36:39], v[80:83]
    ds_read_b64_tr_b16 a[90:91], v229 offset:50176
    v_and_b32 v194, 3, v244
    v_mfma_f32_16x16x32_bf16 v[84:87], a[72:75], a[40:43], v[84:87]
    ds_read_b64_tr_b16 a[92:93], v229 offset:57344
    v_lshlrev_b32 v192, 7, v192
    v_mfma_f32_16x16x32_bf16 v[84:87], a[76:79], a[44:47], v[84:87]
    ds_read_b64_tr_b16 a[94:95], v229 offset:58368
    v_lshl_add_u32 v192, v194, 3, v192
    v_mfma_f32_16x16x32_bf16 v[88:91], a[72:75], a[48:51], v[88:91]
    v_add_u32 v192, s79, v192
    s_xor_b32 s67, s67, 32768
    v_mfma_f32_16x16x32_bf16 v[88:91], a[76:79], a[52:55], v[88:91]
    v_xor_b32 v194, 0, v193
    v_lshl_add_u32 v250, v194, 5, v192
    v_mfma_f32_16x16x32_bf16 v[92:95], a[72:75], a[56:59], v[92:95]
    buffer_load_dwordx4 v223, s[36:39], s65 offen offset:3072  lds
    s_add_u32 s65, s65, 458752
    v_mfma_f32_16x16x32_bf16 v[92:95], a[76:79], a[60:63], v[92:95]
    s_waitcnt lgkmcnt(4)
    v_xor_b32 v194, 1, v193
    v_mfma_f32_16x16x32_bf16 v[96:99], a[80:83], a[32:35], v[96:99]
    ds_read_b64_tr_b16 a[64:65], v230 offset:32768
    v_lshl_add_u32 v251, v194, 5, v192
    v_mfma_f32_16x16x32_bf16 v[96:99], a[84:87], a[36:39], v[96:99]
    ds_read_b64_tr_b16 a[66:67], v230 offset:33792
    v_xor_b32 v194, 2, v193
    v_lshl_add_u32 v252, v194, 5, v192
    v_xor_b32 v194, 3, v193
    v_lshl_add_u32 v253, v194, 5, v192
    v_mfma_f32_16x16x32_bf16 v[100:103], a[80:83], a[40:43], v[100:103]
    ds_read_b64_tr_b16 a[68:69], v230 offset:40960
    buffer_load_dword v242, v234, s[40:43], s68 offen
    s_add_u32 s68, s68, 458752
    buffer_load_dword v243, v207, s[32:35], s88 offen
    s_add_u32 s88, s88, 128
    buffer_load_dword v236, v234, s[40:43], s68 offen
    s_add_u32 s68, s68, 458752
    buffer_load_dword v237, v207, s[32:35], s88 offen
    s_add_u32 s88, s88, 128
    v_mfma_f32_16x16x32_bf16 v[100:103], a[84:87], a[44:47], v[100:103]
    ds_read_b64_tr_b16 a[70:71], v230 offset:41984
    buffer_load_dword v238, v235, s[44:47], s69 offen
    s_add_u32 s69, s69, 512
    v_mfma_f32_16x16x32_bf16 v[104:107], a[80:83], a[48:51], v[104:107]
    v_mfma_f32_16x16x32_bf16 v[104:107], a[84:87], a[52:55], v[104:107]
    s_mov_b32 m0, s66
    v_mfma_f32_16x16x32_bf16 v[108:111], a[80:83], a[56:59], v[108:111]
    buffer_load_dwordx4 v208, s[32:35], s64 offen offset:0  lds
    v_mfma_f32_16x16x32_bf16 v[108:111], a[84:87], a[60:63], v[108:111]
    s_waitcnt lgkmcnt(4)
    v_mfma_f32_16x16x32_bf16 v[112:115], a[88:91], a[32:35], v[112:115]
    ds_read_b64_tr_b16 a[72:73], v230 offset:49152
    v_mfma_f32_16x16x32_bf16 v[112:115], a[92:95], a[36:39], v[112:115]
    ds_read_b64_tr_b16 a[74:75], v230 offset:50176
    v_mfma_f32_16x16x32_bf16 v[116:119], a[88:91], a[40:43], v[116:119]
    ds_read_b64_tr_b16 a[76:77], v230 offset:57344
    v_mfma_f32_16x16x32_bf16 v[116:119], a[92:95], a[44:47], v[116:119]
    ds_read_b64_tr_b16 a[78:79], v230 offset:58368
    v_mfma_f32_16x16x32_bf16 v[120:123], a[88:91], a[48:51], v[120:123]
    v_mfma_f32_16x16x32_bf16 v[120:123], a[92:95], a[52:55], v[120:123]
    v_mfma_f32_16x16x32_bf16 v[124:127], a[88:91], a[56:59], v[124:127]
    buffer_load_dwordx4 v209, s[32:35], s64 offen offset:1024  lds
    v_mfma_f32_16x16x32_bf16 v[124:127], a[92:95], a[60:63], v[124:127]
    s_waitcnt lgkmcnt(4)
    v_mfma_f32_16x16x32_bf16 v[128:131], a[64:67], a[32:35], v[128:131]
    ds_read_b64_tr_b16 a[80:81], v231 offset:32768
    v_mfma_f32_16x16x32_bf16 v[128:131], a[68:71], a[36:39], v[128:131]
    ds_read_b64_tr_b16 a[82:83], v231 offset:33792
    v_mfma_f32_16x16x32_bf16 v[132:135], a[64:67], a[40:43], v[132:135]
    ds_read_b64_tr_b16 a[84:85], v231 offset:40960
    v_mfma_f32_16x16x32_bf16 v[132:135], a[68:71], a[44:47], v[132:135]
    ds_read_b64_tr_b16 a[86:87], v231 offset:41984
    s_waitcnt vmcnt(15)
    v_mfma_f32_16x16x32_bf16 v[136:139], a[64:67], a[48:51], v[136:139]
    ds_read_b128 a[0:3], v224 offset:0
    v_mfma_f32_16x16x32_bf16 v[136:139], a[68:71], a[52:55], v[136:139]
    ds_read_b128 a[4:7], v225 offset:0
    v_mfma_f32_16x16x32_bf16 v[140:143], a[64:67], a[56:59], v[140:143]
    buffer_load_dwordx4 v210, s[32:35], s64 offen offset:2048  lds
    v_mfma_f32_16x16x32_bf16 v[140:143], a[68:71], a[60:63], v[140:143]
    s_waitcnt lgkmcnt(6)
    v_mfma_f32_16x16x32_bf16 v[144:147], a[72:75], a[32:35], v[144:147]
    ds_read_b64_tr_b16 a[88:89], v231 offset:49152
    v_mfma_f32_16x16x32_bf16 v[144:147], a[76:79], a[36:39], v[144:147]
    ds_read_b64_tr_b16 a[90:91], v231 offset:50176
    v_mfma_f32_16x16x32_bf16 v[148:151], a[72:75], a[40:43], v[148:151]
    ds_read_b64_tr_b16 a[92:93], v231 offset:57344
    v_mfma_f32_16x16x32_bf16 v[148:151], a[76:79], a[44:47], v[148:151]
    ds_read_b64_tr_b16 a[94:95], v231 offset:58368
    v_mfma_f32_16x16x32_bf16 v[152:155], a[72:75], a[48:51], v[152:155]
    ds_read_b128 a[8:11], v224 offset:2048
    v_mfma_f32_16x16x32_bf16 v[152:155], a[76:79], a[52:55], v[152:155]
    ds_read_b128 a[12:15], v225 offset:2048
    v_mfma_f32_16x16x32_bf16 v[156:159], a[72:75], a[56:59], v[156:159]
    buffer_load_dwordx4 v211, s[32:35], s64 offen offset:3072  lds
    v_mfma_f32_16x16x32_bf16 v[156:159], a[76:79], a[60:63], v[156:159]
    s_waitcnt lgkmcnt(8)
    v_mfma_f32_16x16x32_bf16 v[160:163], a[80:83], a[32:35], v[160:163]
    ds_read_b64_tr_b16 a[64:65], v232 offset:32768
    v_mfma_f32_16x16x32_bf16 v[160:163], a[84:87], a[36:39], v[160:163]
    ds_read_b64_tr_b16 a[66:67], v232 offset:33792
    v_mfma_f32_16x16x32_bf16 v[164:167], a[80:83], a[40:43], v[164:167]
    ds_read_b64_tr_b16 a[68:69], v232 offset:40960
    v_mfma_f32_16x16x32_bf16 v[164:167], a[84:87], a[44:47], v[164:167]
    ds_read_b64_tr_b16 a[70:71], v232 offset:41984
    v_mfma_f32_16x16x32_bf16 v[168:171], a[80:83], a[48:51], v[168:171]
    ds_read_b128 a[16:19], v224 offset:4096
    v_mfma_f32_16x16x32_bf16 v[168:171], a[84:87], a[52:55], v[168:171]
    ds_read_b128 a[20:23], v225 offset:4096
    s_add_u32 m0, s66, 4096
    v_mfma_f32_16x16x32_bf16 v[172:175], a[80:83], a[56:59], v[172:175]
    buffer_load_dwordx4 v212, s[32:35], s64 offen offset:0  lds
    v_mfma_f32_16x16x32_bf16 v[172:175], a[84:87], a[60:63], v[172:175]
    s_waitcnt lgkmcnt(8)
    v_mfma_f32_16x16x32_bf16 v[176:179], a[88:91], a[32:35], v[176:179]
    ds_read_b64_tr_b16 a[72:73], v232 offset:49152
    v_mfma_f32_16x16x32_bf16 v[176:179], a[92:95], a[36:39], v[176:179]
    ds_read_b64_tr_b16 a[74:75], v232 offset:50176
    v_mfma_f32_16x16x32_bf16 v[180:183], a[88:91], a[40:43], v[180:183]
    ds_read_b64_tr_b16 a[76:77], v232 offset:57344
    v_mfma_f32_16x16x32_bf16 v[180:183], a[92:95], a[44:47], v[180:183]
    ds_read_b64_tr_b16 a[78:79], v232 offset:58368
    v_mfma_f32_16x16x32_bf16 v[184:187], a[88:91], a[48:51], v[184:187]
    ds_read_b128 a[24:27], v224 offset:6144
    v_mfma_f32_16x16x32_bf16 v[184:187], a[92:95], a[52:55], v[184:187]
    ds_read_b128 a[28:31], v225 offset:6144
    v_mfma_f32_16x16x32_bf16 v[188:191], a[88:91], a[56:59], v[188:191]
    buffer_load_dwordx4 v213, s[32:35], s64 offen offset:1024  lds
    v_mfma_f32_16x16x32_bf16 v[188:191], a[92:95], a[60:63], v[188:191]
    s_waitcnt lgkmcnt(8)
    v_mfma_f32_16x16x32_bf16 a[96:99], a[64:67], a[32:35], a[96:99]
    ds_read_b64_tr_b16 a[80:81], v233 offset:32768
    v_mfma_f32_16x16x32_bf16 a[96:99], a[68:71], a[36:39], a[96:99]
    ds_read_b64_tr_b16 a[82:83], v233 offset:33792
    v_mfma_f32_16x16x32_bf16 a[100:103], a[64:67], a[40:43], a[100:103]
    ds_read_b64_tr_b16 a[84:85], v233 offset:40960
    v_mfma_f32_16x16x32_bf16 a[100:103], a[68:71], a[44:47], a[100:103]
    ds_read_b64_tr_b16 a[86:87], v233 offset:41984
    v_mfma_f32_16x16x32_bf16 a[104:107], a[64:67], a[48:51], a[104:107]
    ds_read_b64_tr_b16 a[88:89], v233 offset:49152
    v_mfma_f32_16x16x32_bf16 a[104:107], a[68:71], a[52:55], a[104:107]
    ds_read_b64_tr_b16 a[90:91], v233 offset:50176
    v_mfma_f32_16x16x32_bf16 a[108:111], a[64:67], a[56:59], a[108:111]
    ds_read_b64_tr_b16 a[92:93], v233 offset:57344
    buffer_load_dwordx4 v214, s[32:35], s64 offen offset:2048  lds
    v_mfma_f32_16x16x32_bf16 a[108:111], a[68:71], a[60:63], a[108:111]
    ds_read_b64_tr_b16 a[94:95], v233 offset:58368
    s_waitcnt lgkmcnt(10)
    v_mfma_f32_16x16x32_bf16 a[112:115], a[72:75], a[32:35], a[112:115]
    v_mfma_f32_16x16x32_bf16 a[112:115], a[76:79], a[36:39], a[112:115]
    v_mfma_f32_16x16x32_bf16 a[116:119], a[72:75], a[40:43], a[116:119]
    v_mfma_f32_16x16x32_bf16 a[116:119], a[76:79], a[44:47], a[116:119]
    v_mfma_f32_16x16x32_bf16 a[120:123], a[72:75], a[48:51], a[120:123]
    v_mfma_f32_16x16x32_bf16 a[120:123], a[76:79], a[52:55], a[120:123]
    s_xor_b32 s66, s66, 8192
    v_mfma_f32_16x16x32_bf16 a[124:127], a[72:75], a[56:59], a[124:127]
    buffer_load_dwordx4 v215, s[32:35], s64 offen offset:3072  lds
    s_add_u32 s64, s64, 128
    v_mfma_f32_16x16x32_bf16 a[124:127], a[76:79], a[60:63], a[124:127]
    s_waitcnt vmcnt(13) lgkmcnt(0)
    v_mfma_f32_16x16x32_bf16 a[128:131], a[80:83], a[32:35], a[128:131]
    s_barrier
    v_mfma_f32_16x16x32_bf16 a[128:131], a[84:87], a[36:39], a[128:131]
    ds_read_b64_tr_b16 a[64:65], v226 offset:0
    v_mfma_f32_16x16x32_bf16 a[132:135], a[80:83], a[40:43], a[132:135]
    ds_read_b64_tr_b16 a[66:67], v226 offset:1024
    v_mfma_f32_16x16x32_bf16 a[132:135], a[84:87], a[44:47], a[132:135]
    ds_read_b64_tr_b16 a[68:69], v226 offset:8192
    v_mfma_f32_16x16x32_bf16 a[136:139], a[80:83], a[48:51], a[136:139]
    ds_read_b64_tr_b16 a[70:71], v226 offset:9216
    v_mfma_f32_16x16x32_bf16 a[136:139], a[84:87], a[52:55], a[136:139]
    s_mov_b32 m0, s67
    v_mfma_f32_16x16x32_bf16 a[140:143], a[80:83], a[56:59], a[140:143]
    buffer_load_dwordx4 v216, s[36:39], s65 offen offset:0  lds
    v_mfma_f32_16x16x32_bf16 a[140:143], a[84:87], a[60:63], a[140:143]
    v_mfma_f32_16x16x32_bf16 a[144:147], a[88:91], a[32:35], a[144:147]
    v_mfma_f32_16x16x32_bf16 a[144:147], a[92:95], a[36:39], a[144:147]
    ds_read_b64_tr_b16 a[72:73], v226 offset:16384
    v_mfma_f32_16x16x32_bf16 a[148:151], a[88:91], a[40:43], a[148:151]
    ds_read_b64_tr_b16 a[74:75], v226 offset:17408
    v_mfma_f32_16x16x32_bf16 a[148:151], a[92:95], a[44:47], a[148:151]
    ds_read_b64_tr_b16 a[76:77], v226 offset:24576
    v_mfma_f32_16x16x32_bf16 a[152:155], a[88:91], a[48:51], a[152:155]
    ds_read_b64_tr_b16 a[78:79], v226 offset:25600
    v_mfma_f32_16x16x32_bf16 a[152:155], a[92:95], a[52:55], a[152:155]
    v_mfma_f32_16x16x32_bf16 a[156:159], a[88:91], a[56:59], a[156:159]
    buffer_load_dwordx4 v217, s[36:39], s65 offen offset:1024  lds
    v_mfma_f32_16x16x32_bf16 a[156:159], a[92:95], a[60:63], a[156:159]
    s_waitcnt lgkmcnt(4)
    v_mfma_f32_16x16x32_bf16 v[0:3], a[64:67], a[0:3], v[0:3]
    ds_read_b64_tr_b16 a[80:81], v227 offset:0
    v_mfma_f32_16x16x32_bf16 v[0:3], a[68:71], a[4:7], v[0:3]
    ds_read_b64_tr_b16 a[82:83], v227 offset:1024
    v_mfma_f32_16x16x32_bf16 v[4:7], a[64:67], a[8:11], v[4:7]
    ds_read_b64_tr_b16 a[84:85], v227 offset:8192
    v_mfma_f32_16x16x32_bf16 v[4:7], a[68:71], a[12:15], v[4:7]
    ds_read_b64_tr_b16 a[86:87], v227 offset:9216
    v_mfma_f32_16x16x32_bf16 v[8:11], a[64:67], a[16:19], v[8:11]
    v_mfma_f32_16x16x32_bf16 v[8:11], a[68:71], a[20:23], v[8:11]
    v_mfma_f32_16x16x32_bf16 v[12:15], a[64:67], a[24:27], v[12:15]
    buffer_load_dwordx4 v218, s[36:39], s65 offen offset:2048  lds
    v_mfma_f32_16x16x32_bf16 v[12:15], a[68:71], a[28:31], v[12:15]
    s_waitcnt lgkmcnt(4)
    v_mfma_f32_16x16x32_bf16 v[16:19], a[72:75], a[0:3], v[16:19]
    ds_read_b64_tr_b16 a[88:89], v227 offset:16384
    v_mfma_f32_16x16x32_bf16 v[16:19], a[76:79], a[4:7], v[16:19]
    ds_read_b64_tr_b16 a[90:91], v227 offset:17408
    v_mfma_f32_16x16x32_bf16 v[20:23], a[72:75], a[8:11], v[20:23]
    ds_read_b64_tr_b16 a[92:93], v227 offset:24576
    v_mfma_f32_16x16x32_bf16 v[20:23], a[76:79], a[12:15], v[20:23]
    ds_read_b64_tr_b16 a[94:95], v227 offset:25600
    v_mfma_f32_16x16x32_bf16 v[24:27], a[72:75], a[16:19], v[24:27]
    v_mfma_f32_16x16x32_bf16 v[24:27], a[76:79], a[20:23], v[24:27]
    v_mfma_f32_16x16x32_bf16 v[28:31], a[72:75], a[24:27], v[28:31]
    buffer_load_dwordx4 v219, s[36:39], s65 offen offset:3072  lds
    v_mfma_f32_16x16x32_bf16 v[28:31], a[76:79], a[28:31], v[28:31]
    s_waitcnt lgkmcnt(4)
    v_mfma_f32_16x16x32_bf16 v[32:35], a[80:83], a[0:3], v[32:35]
    ds_read_b64_tr_b16 a[64:65], v228 offset:0
    v_mfma_f32_16x16x32_bf16 v[32:35], a[84:87], a[4:7], v[32:35]
    ds_read_b64_tr_b16 a[66:67], v228 offset:1024
    v_mfma_f32_16x16x32_bf16 v[36:39], a[80:83], a[8:11], v[36:39]
    ds_read_b64_tr_b16 a[68:69], v228 offset:8192
    v_mfma_f32_16x16x32_bf16 v[36:39], a[84:87], a[12:15], v[36:39]
    ds_read_b64_tr_b16 a[70:71], v228 offset:9216
    v_mfma_f32_16x16x32_bf16 v[40:43], a[80:83], a[16:19], v[40:43]
    v_mfma_f32_16x16x32_bf16 v[40:43], a[84:87], a[20:23], v[40:43]
    s_add_u32 m0, s67, 4096
    v_mfma_f32_16x16x32_bf16 v[44:47], a[80:83], a[24:27], v[44:47]
    buffer_load_dwordx4 v220, s[36:39], s65 offen offset:0  lds
    v_mfma_f32_16x16x32_bf16 v[44:47], a[84:87], a[28:31], v[44:47]
    s_waitcnt lgkmcnt(4)
    v_mfma_f32_16x16x32_bf16 v[48:51], a[88:91], a[0:3], v[48:51]
    ds_read_b64_tr_b16 a[72:73], v228 offset:16384
    v_mfma_f32_16x16x32_bf16 v[48:51], a[92:95], a[4:7], v[48:51]
    ds_read_b64_tr_b16 a[74:75], v228 offset:17408
    v_mfma_f32_16x16x32_bf16 v[52:55], a[88:91], a[8:11], v[52:55]
    ds_read_b64_tr_b16 a[76:77], v228 offset:24576
    v_mfma_f32_16x16x32_bf16 v[52:55], a[92:95], a[12:15], v[52:55]
    ds_read_b64_tr_b16 a[78:79], v228 offset:25600
    v_mfma_f32_16x16x32_bf16 v[56:59], a[88:91], a[16:19], v[56:59]
    v_mfma_f32_16x16x32_bf16 v[56:59], a[92:95], a[20:23], v[56:59]
    v_mfma_f32_16x16x32_bf16 v[60:63], a[88:91], a[24:27], v[60:63]
    buffer_load_dwordx4 v221, s[36:39], s65 offen offset:1024  lds
    v_mfma_f32_16x16x32_bf16 v[60:63], a[92:95], a[28:31], v[60:63]
    s_waitcnt lgkmcnt(4)
    v_mfma_f32_16x16x32_bf16 v[64:67], a[64:67], a[0:3], v[64:67]
    ds_read_b64_tr_b16 a[80:81], v229 offset:0
    v_mfma_f32_16x16x32_bf16 v[64:67], a[68:71], a[4:7], v[64:67]
    ds_read_b64_tr_b16 a[82:83], v229 offset:1024
    v_mfma_f32_16x16x32_bf16 v[68:71], a[64:67], a[8:11], v[68:71]
    ds_read_b64_tr_b16 a[84:85], v229 offset:8192
    v_mfma_f32_16x16x32_bf16 v[68:71], a[68:71], a[12:15], v[68:71]
    ds_read_b64_tr_b16 a[86:87], v229 offset:9216
    v_mfma_f32_16x16x32_bf16 v[72:75], a[64:67], a[16:19], v[72:75]
    v_mfma_f32_16x16x32_bf16 v[72:75], a[68:71], a[20:23], v[72:75]
    v_mfma_f32_16x16x32_bf16 v[76:79], a[64:67], a[24:27], v[76:79]
    buffer_load_dwordx4 v222, s[36:39], s65 offen offset:2048  lds
    v_mfma_f32_16x16x32_bf16 v[76:79], a[68:71], a[28:31], v[76:79]
    s_waitcnt lgkmcnt(4)
    v_mfma_f32_16x16x32_bf16 v[80:83], a[72:75], a[0:3], v[80:83]
    ds_read_b64_tr_b16 a[88:89], v229 offset:16384
    v_mfma_f32_16x16x32_bf16 v[80:83], a[76:79], a[4:7], v[80:83]
    ds_read_b64_tr_b16 a[90:91], v229 offset:17408
    v_mfma_f32_16x16x32_bf16 v[84:87], a[72:75], a[8:11], v[84:87]
    ds_read_b64_tr_b16 a[92:93], v229 offset:24576
    v_mfma_f32_16x16x32_bf16 v[84:87], a[76:79], a[12:15], v[84:87]
    ds_read_b64_tr_b16 a[94:95], v229 offset:25600
    v_mfma_f32_16x16x32_bf16 v[88:91], a[72:75], a[16:19], v[88:91]
    v_mfma_f32_16x16x32_bf16 v[88:91], a[76:79], a[20:23], v[88:91]
    s_xor_b32 s67, s67, 32768
    v_mfma_f32_16x16x32_bf16 v[92:95], a[72:75], a[24:27], v[92:95]
    buffer_load_dwordx4 v223, s[36:39], s65 offen offset:3072  lds
    s_add_u32 s65, s65, 458752
    v_mfma_f32_16x16x32_bf16 v[92:95], a[76:79], a[28:31], v[92:95]
    s_waitcnt lgkmcnt(4)
    v_mfma_f32_16x16x32_bf16 v[96:99], a[80:83], a[0:3], v[96:99]
    ds_read_b64_tr_b16 a[64:65], v230 offset:0
    v_mfma_f32_16x16x32_bf16 v[96:99], a[84:87], a[4:7], v[96:99]
    ds_read_b64_tr_b16 a[66:67], v230 offset:1024
    v_mfma_f32_16x16x32_bf16 v[100:103], a[80:83], a[8:11], v[100:103]
    ds_read_b64_tr_b16 a[68:69], v230 offset:8192
    buffer_load_dword v239, v234, s[40:43], s68 offen
    s_add_u32 s68, s68, 458752
    buffer_load_dword v240, v207, s[32:35], s88 offen
    s_add_u32 s88, s88, 128
    v_mfma_f32_16x16x32_bf16 v[100:103], a[84:87], a[12:15], v[100:103]
    ds_read_b64_tr_b16 a[70:71], v230 offset:9216
    buffer_load_dword v241, v235, s[44:47], s69 offen
    s_add_u32 s69, s69, 512
    s_waitcnt vmcnt(23)
    buffer_load_dword v242, v235, s[44:47], s69 offen
    s_add_u32 s69, s69, 512
    v_mfma_f32_16x16x32_bf16 v[104:107], a[80:83], a[16:19], v[104:107]
    v_mfma_f32_16x16x32_bf16 v[104:107], a[84:87], a[20:23], v[104:107]
    s_mov_b32 m0, s66
    v_mfma_f32_16x16x32_bf16 v[108:111], a[80:83], a[24:27], v[108:111]
    buffer_load_dwordx4 v208, s[32:35], s64 offen offset:0  lds
    v_mfma_f32_16x16x32_bf16 v[108:111], a[84:87], a[28:31], v[108:111]
    s_waitcnt lgkmcnt(4)
    v_mfma_f32_16x16x32_bf16 v[112:115], a[88:91], a[0:3], v[112:115]
    ds_read_b64_tr_b16 a[72:73], v230 offset:16384
    v_mfma_f32_16x16x32_bf16 v[112:115], a[92:95], a[4:7], v[112:115]
    ds_read_b64_tr_b16 a[74:75], v230 offset:17408
    v_mfma_f32_16x16x32_bf16 v[116:119], a[88:91], a[8:11], v[116:119]
    ds_read_b64_tr_b16 a[76:77], v230 offset:24576
    v_mfma_f32_16x16x32_bf16 v[116:119], a[92:95], a[12:15], v[116:119]
    ds_read_b64_tr_b16 a[78:79], v230 offset:25600
    v_mfma_f32_16x16x32_bf16 v[120:123], a[88:91], a[16:19], v[120:123]
    v_mfma_f32_16x16x32_bf16 v[120:123], a[92:95], a[20:23], v[120:123]
    v_mfma_f32_16x16x32_bf16 v[124:127], a[88:91], a[24:27], v[124:127]
    buffer_load_dwordx4 v209, s[32:35], s64 offen offset:1024  lds
    v_mfma_f32_16x16x32_bf16 v[124:127], a[92:95], a[28:31], v[124:127]
    s_waitcnt lgkmcnt(4)
    v_mfma_f32_16x16x32_bf16 v[128:131], a[64:67], a[0:3], v[128:131]
    ds_read_b64_tr_b16 a[80:81], v231 offset:0
    v_mfma_f32_16x16x32_bf16 v[128:131], a[68:71], a[4:7], v[128:131]
    ds_read_b64_tr_b16 a[82:83], v231 offset:1024
    v_mfma_f32_16x16x32_bf16 v[132:135], a[64:67], a[8:11], v[132:135]
    ds_read_b64_tr_b16 a[84:85], v231 offset:8192
    v_mfma_f32_16x16x32_bf16 v[132:135], a[68:71], a[12:15], v[132:135]
    ds_read_b64_tr_b16 a[86:87], v231 offset:9216
    s_waitcnt vmcnt(14)
    v_mfma_f32_16x16x32_bf16 v[136:139], a[64:67], a[16:19], v[136:139]
    ds_read_b128 a[32:35], v224 offset:8192
    v_mfma_f32_16x16x32_bf16 v[136:139], a[68:71], a[20:23], v[136:139]
    ds_read_b128 a[36:39], v225 offset:8192
    v_mfma_f32_16x16x32_bf16 v[140:143], a[64:67], a[24:27], v[140:143]
    buffer_load_dwordx4 v210, s[32:35], s64 offen offset:2048  lds
    v_mfma_f32_16x16x32_bf16 v[140:143], a[68:71], a[28:31], v[140:143]
    s_waitcnt lgkmcnt(6)
    v_mfma_f32_16x16x32_bf16 v[144:147], a[72:75], a[0:3], v[144:147]
    ds_read_b64_tr_b16 a[88:89], v231 offset:16384
    v_mfma_f32_16x16x32_bf16 v[144:147], a[76:79], a[4:7], v[144:147]
    ds_read_b64_tr_b16 a[90:91], v231 offset:17408
    v_mfma_f32_16x16x32_bf16 v[148:151], a[72:75], a[8:11], v[148:151]
    ds_read_b64_tr_b16 a[92:93], v231 offset:24576
    v_mfma_f32_16x16x32_bf16 v[148:151], a[76:79], a[12:15], v[148:151]
    ds_read_b64_tr_b16 a[94:95], v231 offset:25600
    v_mfma_f32_16x16x32_bf16 v[152:155], a[72:75], a[16:19], v[152:155]
    ds_read_b128 a[40:43], v224 offset:10240
    v_mfma_f32_16x16x32_bf16 v[152:155], a[76:79], a[20:23], v[152:155]
    ds_read_b128 a[44:47], v225 offset:10240
    v_mfma_f32_16x16x32_bf16 v[156:159], a[72:75], a[24:27], v[156:159]
    buffer_load_dwordx4 v211, s[32:35], s64 offen offset:3072  lds
    v_mfma_f32_16x16x32_bf16 v[156:159], a[76:79], a[28:31], v[156:159]
    s_waitcnt lgkmcnt(8)
    v_mfma_f32_16x16x32_bf16 v[160:163], a[80:83], a[0:3], v[160:163]
    ds_read_b64_tr_b16 a[64:65], v232 offset:0
    v_mfma_f32_16x16x32_bf16 v[160:163], a[84:87], a[4:7], v[160:163]
    ds_read_b64_tr_b16 a[66:67], v232 offset:1024
    v_mfma_f32_16x16x32_bf16 v[164:167], a[80:83], a[8:11], v[164:167]
    ds_read_b64_tr_b16 a[68:69], v232 offset:8192
    v_mfma_f32_16x16x32_bf16 v[164:167], a[84:87], a[12:15], v[164:167]
    ds_read_b64_tr_b16 a[70:71], v232 offset:9216
    v_mfma_f32_16x16x32_bf16 v[168:171], a[80:83], a[16:19], v[168:171]
    ds_read_b128 a[48:51], v224 offset:12288
    v_mfma_f32_16x16x32_bf16 v[168:171], a[84:87], a[20:23], v[168:171]
    ds_read_b128 a[52:55], v225 offset:12288
    s_add_u32 m0, s66, 4096
    v_mfma_f32_16x16x32_bf16 v[172:175], a[80:83], a[24:27], v[172:175]
    buffer_load_dwordx4 v212, s[32:35], s64 offen offset:0  lds
    v_mfma_f32_16x16x32_bf16 v[172:175], a[84:87], a[28:31], v[172:175]
    s_waitcnt lgkmcnt(8)
    v_mfma_f32_16x16x32_bf16 v[176:179], a[88:91], a[0:3], v[176:179]
    ds_read_b64_tr_b16 a[72:73], v232 offset:16384
    v_mfma_f32_16x16x32_bf16 v[176:179], a[92:95], a[4:7], v[176:179]
    ds_read_b64_tr_b16 a[74:75], v232 offset:17408
    v_mfma_f32_16x16x32_bf16 v[180:183], a[88:91], a[8:11], v[180:183]
    ds_read_b64_tr_b16 a[76:77], v232 offset:24576
    v_mfma_f32_16x16x32_bf16 v[180:183], a[92:95], a[12:15], v[180:183]
    ds_read_b64_tr_b16 a[78:79], v232 offset:25600
    v_mfma_f32_16x16x32_bf16 v[184:187], a[88:91], a[16:19], v[184:187]
    ds_read_b128 a[56:59], v224 offset:14336
    v_mfma_f32_16x16x32_bf16 v[184:187], a[92:95], a[20:23], v[184:187]
    ds_read_b128 a[60:63], v225 offset:14336
    v_mfma_f32_16x16x32_bf16 v[188:191], a[88:91], a[24:27], v[188:191]
    buffer_load_dwordx4 v213, s[32:35], s64 offen offset:1024  lds
    v_mfma_f32_16x16x32_bf16 v[188:191], a[92:95], a[28:31], v[188:191]
    s_waitcnt lgkmcnt(8)
    v_mfma_f32_16x16x32_bf16 a[96:99], a[64:67], a[0:3], a[96:99]
    ds_read_b64_tr_b16 a[80:81], v233 offset:0
    v_mfma_f32_16x16x32_bf16 a[96:99], a[68:71], a[4:7], a[96:99]
    ds_read_b64_tr_b16 a[82:83], v233 offset:1024
    v_mfma_f32_16x16x32_bf16 a[100:103], a[64:67], a[8:11], a[100:103]
    ds_read_b64_tr_b16 a[84:85], v233 offset:8192
    v_mfma_f32_16x16x32_bf16 a[100:103], a[68:71], a[12:15], a[100:103]
    ds_read_b64_tr_b16 a[86:87], v233 offset:9216
    v_mfma_f32_16x16x32_bf16 a[104:107], a[64:67], a[16:19], a[104:107]
    ds_read_b64_tr_b16 a[88:89], v233 offset:16384
    v_mfma_f32_16x16x32_bf16 a[104:107], a[68:71], a[20:23], a[104:107]
    ds_read_b64_tr_b16 a[90:91], v233 offset:17408
    v_mfma_f32_16x16x32_bf16 a[108:111], a[64:67], a[24:27], a[108:111]
    ds_read_b64_tr_b16 a[92:93], v233 offset:24576
    buffer_load_dwordx4 v214, s[32:35], s64 offen offset:2048  lds
    v_mfma_f32_16x16x32_bf16 a[108:111], a[68:71], a[28:31], a[108:111]
    ds_read_b64_tr_b16 a[94:95], v233 offset:25600
    s_waitcnt lgkmcnt(10)
    v_mfma_f32_16x16x32_bf16 a[112:115], a[72:75], a[0:3], a[112:115]
    v_mfma_f32_16x16x32_bf16 a[112:115], a[76:79], a[4:7], a[112:115]
    v_mfma_f32_16x16x32_bf16 a[116:119], a[72:75], a[8:11], a[116:119]
    v_mfma_f32_16x16x32_bf16 a[116:119], a[76:79], a[12:15], a[116:119]
    v_mfma_f32_16x16x32_bf16 a[120:123], a[72:75], a[16:19], a[120:123]
    v_mfma_f32_16x16x32_bf16 a[120:123], a[76:79], a[20:23], a[120:123]
    s_xor_b32 s66, s66, 8192
    v_mfma_f32_16x16x32_bf16 a[124:127], a[72:75], a[24:27], a[124:127]
    buffer_load_dwordx4 v215, s[32:35], s64 offen offset:3072  lds
    s_add_u32 s64, s64, 128
    v_mfma_f32_16x16x32_bf16 a[124:127], a[76:79], a[28:31], a[124:127]
    s_waitcnt vmcnt(12) lgkmcnt(0)
    v_mfma_f32_16x16x32_bf16 a[128:131], a[80:83], a[0:3], a[128:131]
    s_barrier
    v_mfma_f32_16x16x32_bf16 a[128:131], a[84:87], a[4:7], a[128:131]
    ds_read_b64_tr_b16 a[64:65], v226 offset:32768
    v_mfma_f32_16x16x32_bf16 a[132:135], a[80:83], a[8:11], a[132:135]
    ds_read_b64_tr_b16 a[66:67], v226 offset:33792
    v_mfma_f32_16x16x32_bf16 a[132:135], a[84:87], a[12:15], a[132:135]
    ds_read_b64_tr_b16 a[68:69], v226 offset:40960
    v_mfma_f32_16x16x32_bf16 a[136:139], a[80:83], a[16:19], a[136:139]
    ds_read_b64_tr_b16 a[70:71], v226 offset:41984
    v_mfma_f32_16x16x32_bf16 a[136:139], a[84:87], a[20:23], a[136:139]
    s_mov_b32 m0, s67
    v_mfma_f32_16x16x32_bf16 a[140:143], a[80:83], a[24:27], a[140:143]
    buffer_load_dwordx4 v216, s[36:39], s65 offen offset:0  lds
    v_mfma_f32_16x16x32_bf16 a[140:143], a[84:87], a[28:31], a[140:143]
    v_mfma_f32_16x16x32_bf16 a[144:147], a[88:91], a[0:3], a[144:147]
    v_mfma_f32_16x16x32_bf16 a[144:147], a[92:95], a[4:7], a[144:147]
    ds_read_b64_tr_b16 a[72:73], v226 offset:49152
    v_mfma_f32_16x16x32_bf16 a[148:151], a[88:91], a[8:11], a[148:151]
    ds_read_b64_tr_b16 a[74:75], v226 offset:50176
    v_mfma_f32_16x16x32_bf16 a[148:151], a[92:95], a[12:15], a[148:151]
    ds_read_b64_tr_b16 a[76:77], v226 offset:57344
    v_mfma_f32_16x16x32_bf16 a[152:155], a[88:91], a[16:19], a[152:155]
    ds_read_b64_tr_b16 a[78:79], v226 offset:58368
    v_mfma_f32_16x16x32_bf16 a[152:155], a[92:95], a[20:23], a[152:155]
    v_mfma_f32_16x16x32_bf16 a[156:159], a[88:91], a[24:27], a[156:159]
    buffer_load_dwordx4 v217, s[36:39], s65 offen offset:1024  lds
    v_mfma_f32_16x16x32_bf16 a[156:159], a[92:95], a[28:31], a[156:159]
    s_waitcnt lgkmcnt(4)
    v_mfma_f32_16x16x32_bf16 v[0:3], a[64:67], a[32:35], v[0:3]
    ds_read_b64_tr_b16 a[80:81], v227 offset:32768
    v_mfma_f32_16x16x32_bf16 v[0:3], a[68:71], a[36:39], v[0:3]
    ds_read_b64_tr_b16 a[82:83], v227 offset:33792
    v_mfma_f32_16x16x32_bf16 v[4:7], a[64:67], a[40:43], v[4:7]
    ds_read_b64_tr_b16 a[84:85], v227 offset:40960
    v_mfma_f32_16x16x32_bf16 v[4:7], a[68:71], a[44:47], v[4:7]
    ds_read_b64_tr_b16 a[86:87], v227 offset:41984
    v_mfma_f32_16x16x32_bf16 v[8:11], a[64:67], a[48:51], v[8:11]
    v_mfma_f32_16x16x32_bf16 v[8:11], a[68:71], a[52:55], v[8:11]
    v_mfma_f32_16x16x32_bf16 v[12:15], a[64:67], a[56:59], v[12:15]
    buffer_load_dwordx4 v218, s[36:39], s65 offen offset:2048  lds
    v_mfma_f32_16x16x32_bf16 v[12:15], a[68:71], a[60:63], v[12:15]
    s_waitcnt lgkmcnt(4)
    v_mfma_f32_16x16x32_bf16 v[16:19], a[72:75], a[32:35], v[16:19]
    ds_read_b64_tr_b16 a[88:89], v227 offset:49152
    v_mov_b32 v192, 0
    v_mfma_f32_16x16x32_bf16 v[16:19], a[76:79], a[36:39], v[16:19]
    ds_read_b64_tr_b16 a[90:91], v227 offset:50176
    v_mfma_f32_16x16x32_bf16 v[20:23], a[72:75], a[40:43], v[20:23]
    ds_read_b64_tr_b16 a[92:93], v227 offset:57344
    v_mfma_f32_16x16x32_bf16 v[20:23], a[76:79], a[44:47], v[20:23]
    ds_read_b64_tr_b16 a[94:95], v227 offset:58368
    v_mfma_f32_16x16x32_bf16 v[24:27], a[72:75], a[48:51], v[24:27]
    v_mfma_f32_16x16x32_bf16 v[24:27], a[76:79], a[52:55], v[24:27]
    v_mfma_f32_16x16x32_bf16 v[28:31], a[72:75], a[56:59], v[28:31]
    buffer_load_dwordx4 v219, s[36:39], s65 offen offset:3072  lds
    v_mfma_f32_16x16x32_bf16 v[28:31], a[76:79], a[60:63], v[28:31]
    s_waitcnt lgkmcnt(4)
    v_mfma_f32_16x16x32_bf16 v[32:35], a[80:83], a[32:35], v[32:35]
    ds_read_b64_tr_b16 a[64:65], v228 offset:32768
    v_mfma_f32_16x16x32_bf16 v[32:35], a[84:87], a[36:39], v[32:35]
    ds_read_b64_tr_b16 a[66:67], v228 offset:33792
    v_mfma_f32_16x16x32_bf16 v[36:39], a[80:83], a[40:43], v[36:39]
    ds_read_b64_tr_b16 a[68:69], v228 offset:40960
    v_mfma_f32_16x16x32_bf16 v[36:39], a[84:87], a[44:47], v[36:39]
    ds_read_b64_tr_b16 a[70:71], v228 offset:41984
    v_mfma_f32_16x16x32_bf16 v[40:43], a[80:83], a[48:51], v[40:43]
    v_mfma_f32_16x16x32_bf16 v[40:43], a[84:87], a[52:55], v[40:43]
    s_add_u32 m0, s67, 4096
    v_mfma_f32_16x16x32_bf16 v[44:47], a[80:83], a[56:59], v[44:47]
    buffer_load_dwordx4 v220, s[36:39], s65 offen offset:0  lds
    v_mfma_f32_16x16x32_bf16 v[44:47], a[84:87], a[60:63], v[44:47]
    s_waitcnt lgkmcnt(4)
    v_mfma_f32_16x16x32_bf16 v[48:51], a[88:91], a[32:35], v[48:51]
    ds_read_b64_tr_b16 a[72:73], v228 offset:49152
    v_mfma_f32_16x16x32_bf16 v[48:51], a[92:95], a[36:39], v[48:51]
    ds_read_b64_tr_b16 a[74:75], v228 offset:50176
    v_mfma_f32_16x16x32_bf16 v[52:55], a[88:91], a[40:43], v[52:55]
    ds_read_b64_tr_b16 a[76:77], v228 offset:57344
    v_mfma_f32_16x16x32_bf16 v[52:55], a[92:95], a[44:47], v[52:55]
    ds_read_b64_tr_b16 a[78:79], v228 offset:58368
    v_mfma_f32_16x16x32_bf16 v[56:59], a[88:91], a[48:51], v[56:59]
    v_mfma_f32_16x16x32_bf16 v[56:59], a[92:95], a[52:55], v[56:59]
    v_mfma_f32_16x16x32_bf16 v[60:63], a[88:91], a[56:59], v[60:63]
    buffer_load_dwordx4 v221, s[36:39], s65 offen offset:1024  lds
    v_mfma_f32_16x16x32_bf16 v[60:63], a[92:95], a[60:63], v[60:63]
    s_waitcnt lgkmcnt(4)
    v_mfma_f32_16x16x32_bf16 v[64:67], a[64:67], a[32:35], v[64:67]
    ds_read_b64_tr_b16 a[80:81], v229 offset:32768
    v_mfma_f32_16x16x32_bf16 v[64:67], a[68:71], a[36:39], v[64:67]
    ds_read_b64_tr_b16 a[82:83], v229 offset:33792
    v_mfma_f32_16x16x32_bf16 v[68:71], a[64:67], a[40:43], v[68:71]
    ds_read_b64_tr_b16 a[84:85], v229 offset:40960
    v_mfma_f32_16x16x32_bf16 v[68:71], a[68:71], a[44:47], v[68:71]
    ds_read_b64_tr_b16 a[86:87], v229 offset:41984
    v_mfma_f32_16x16x32_bf16 v[72:75], a[64:67], a[48:51], v[72:75]
    v_mfma_f32_16x16x32_bf16 v[72:75], a[68:71], a[52:55], v[72:75]
    v_mfma_f32_16x16x32_bf16 v[76:79], a[64:67], a[56:59], v[76:79]
    buffer_load_dwordx4 v222, s[36:39], s65 offen offset:2048  lds
    v_mfma_f32_16x16x32_bf16 v[76:79], a[68:71], a[60:63], v[76:79]
    s_waitcnt lgkmcnt(4)
    v_mfma_f32_16x16x32_bf16 v[80:83], a[72:75], a[32:35], v[80:83]
    ds_read_b64_tr_b16 a[88:89], v229 offset:49152
    v_mfma_f32_16x16x32_bf16 v[80:83], a[76:79], a[36:39], v[80:83]
    ds_read_b64_tr_b16 a[90:91], v229 offset:50176
    v_mfma_f32_16x16x32_bf16 v[84:87], a[72:75], a[40:43], v[84:87]
    ds_read_b64_tr_b16 a[92:93], v229 offset:57344
    v_mfma_f32_16x16x32_bf16 v[84:87], a[76:79], a[44:47], v[84:87]
    ds_read_b64_tr_b16 a[94:95], v229 offset:58368
    v_mfma_f32_16x16x32_bf16 v[88:91], a[72:75], a[48:51], v[88:91]
    v_mfma_f32_16x16x32_bf16 v[88:91], a[76:79], a[52:55], v[88:91]
    s_xor_b32 s67, s67, 32768
    v_mfma_f32_16x16x32_bf16 v[92:95], a[72:75], a[56:59], v[92:95]
    buffer_load_dwordx4 v223, s[36:39], s65 offen offset:3072  lds
    s_add_u32 s65, s65, 458752
    v_mfma_f32_16x16x32_bf16 v[92:95], a[76:79], a[60:63], v[92:95]
    s_waitcnt lgkmcnt(4)
    v_mfma_f32_16x16x32_bf16 v[96:99], a[80:83], a[32:35], v[96:99]
    ds_read_b64_tr_b16 a[64:65], v230 offset:32768
    v_mfma_f32_16x16x32_bf16 v[96:99], a[84:87], a[36:39], v[96:99]
    ds_read_b64_tr_b16 a[66:67], v230 offset:33792
    v_mfma_f32_16x16x32_bf16 v[100:103], a[80:83], a[40:43], v[100:103]
    ds_read_b64_tr_b16 a[68:69], v230 offset:40960
    buffer_load_dword v243, v234, s[40:43], s68 offen
    s_add_u32 s68, s68, 458752
    buffer_load_dword v236, v207, s[32:35], s88 offen
    s_add_u32 s88, s88, 128
    v_mfma_f32_16x16x32_bf16 v[100:103], a[84:87], a[44:47], v[100:103]
    ds_read_b64_tr_b16 a[70:71], v230 offset:41984
    buffer_load_dword v237, v235, s[44:47], s69 offen
    s_add_u32 s69, s69, 457216
    v_mfma_f32_16x16x32_bf16 v[104:107], a[80:83], a[48:51], v[104:107]
    buffer_load_dwordx2 v[194:195], v192, s[60:63], 0 offen sc1
    v_mfma_f32_16x16x32_bf16 v[104:107], a[84:87], a[52:55], v[104:107]
    s_mov_b32 m0, s66
    v_mfma_f32_16x16x32_bf16 v[108:111], a[80:83], a[56:59], v[108:111]
    buffer_load_dwordx4 v208, s[32:35], s64 offen offset:0  lds
    v_mfma_f32_16x16x32_bf16 v[108:111], a[84:87], a[60:63], v[108:111]
    s_waitcnt lgkmcnt(4)
    v_mfma_f32_16x16x32_bf16 v[112:115], a[88:91], a[32:35], v[112:115]
    ds_read_b64_tr_b16 a[72:73], v230 offset:49152
    v_mfma_f32_16x16x32_bf16 v[112:115], a[92:95], a[36:39], v[112:115]
    ds_read_b64_tr_b16 a[74:75], v230 offset:50176
    v_mfma_f32_16x16x32_bf16 v[116:119], a[88:91], a[40:43], v[116:119]
    ds_read_b64_tr_b16 a[76:77], v230 offset:57344
    v_mfma_f32_16x16x32_bf16 v[116:119], a[92:95], a[44:47], v[116:119]
    ds_read_b64_tr_b16 a[78:79], v230 offset:58368
    v_mfma_f32_16x16x32_bf16 v[120:123], a[88:91], a[48:51], v[120:123]
    v_mfma_f32_16x16x32_bf16 v[120:123], a[92:95], a[52:55], v[120:123]
    v_mfma_f32_16x16x32_bf16 v[124:127], a[88:91], a[56:59], v[124:127]
    buffer_load_dwordx4 v209, s[32:35], s64 offen offset:1024  lds
    v_mfma_f32_16x16x32_bf16 v[124:127], a[92:95], a[60:63], v[124:127]
    s_waitcnt lgkmcnt(4)
    v_mfma_f32_16x16x32_bf16 v[128:131], a[64:67], a[32:35], v[128:131]
    ds_read_b64_tr_b16 a[80:81], v231 offset:32768
    v_mfma_f32_16x16x32_bf16 v[128:131], a[68:71], a[36:39], v[128:131]
    ds_read_b64_tr_b16 a[82:83], v231 offset:33792
    v_mfma_f32_16x16x32_bf16 v[132:135], a[64:67], a[40:43], v[132:135]
    ds_read_b64_tr_b16 a[84:85], v231 offset:40960
    v_mfma_f32_16x16x32_bf16 v[132:135], a[68:71], a[44:47], v[132:135]
    ds_read_b64_tr_b16 a[86:87], v231 offset:41984
    s_waitcnt vmcnt(14)
    v_mfma_f32_16x16x32_bf16 v[136:139], a[64:67], a[48:51], v[136:139]
    ds_read_b128 a[0:3], v224 offset:0
    v_mfma_f32_16x16x32_bf16 v[136:139], a[68:71], a[52:55], v[136:139]
    ds_read_b128 a[4:7], v225 offset:0
    v_mfma_f32_16x16x32_bf16 v[140:143], a[64:67], a[56:59], v[140:143]
    buffer_load_dwordx4 v210, s[32:35], s64 offen offset:2048  lds
    v_mfma_f32_16x16x32_bf16 v[140:143], a[68:71], a[60:63], v[140:143]
    s_waitcnt lgkmcnt(6)
    v_mfma_f32_16x16x32_bf16 v[144:147], a[72:75], a[32:35], v[144:147]
    ds_read_b64_tr_b16 a[88:89], v231 offset:49152
    v_mfma_f32_16x16x32_bf16 v[144:147], a[76:79], a[36:39], v[144:147]
    ds_read_b64_tr_b16 a[90:91], v231 offset:50176
    v_mfma_f32_16x16x32_bf16 v[148:151], a[72:75], a[40:43], v[148:151]
    ds_read_b64_tr_b16 a[92:93], v231 offset:57344
    v_mfma_f32_16x16x32_bf16 v[148:151], a[76:79], a[44:47], v[148:151]
    ds_read_b64_tr_b16 a[94:95], v231 offset:58368
    v_mfma_f32_16x16x32_bf16 v[152:155], a[72:75], a[48:51], v[152:155]
    ds_read_b128 a[8:11], v224 offset:2048
    v_mfma_f32_16x16x32_bf16 v[152:155], a[76:79], a[52:55], v[152:155]
    ds_read_b128 a[12:15], v225 offset:2048
    v_mfma_f32_16x16x32_bf16 v[156:159], a[72:75], a[56:59], v[156:159]
    buffer_load_dwordx4 v211, s[32:35], s64 offen offset:3072  lds
    v_mfma_f32_16x16x32_bf16 v[156:159], a[76:79], a[60:63], v[156:159]
    s_waitcnt lgkmcnt(8)
    v_mfma_f32_16x16x32_bf16 v[160:163], a[80:83], a[32:35], v[160:163]
    ds_read_b64_tr_b16 a[64:65], v232 offset:32768
    v_mfma_f32_16x16x32_bf16 v[160:163], a[84:87], a[36:39], v[160:163]
    ds_read_b64_tr_b16 a[66:67], v232 offset:33792
    v_mfma_f32_16x16x32_bf16 v[164:167], a[80:83], a[40:43], v[164:167]
    ds_read_b64_tr_b16 a[68:69], v232 offset:40960
    v_mfma_f32_16x16x32_bf16 v[164:167], a[84:87], a[44:47], v[164:167]
    ds_read_b64_tr_b16 a[70:71], v232 offset:41984
    v_mfma_f32_16x16x32_bf16 v[168:171], a[80:83], a[48:51], v[168:171]
    ds_read_b128 a[16:19], v224 offset:4096
    v_mfma_f32_16x16x32_bf16 v[168:171], a[84:87], a[52:55], v[168:171]
    ds_read_b128 a[20:23], v225 offset:4096
    s_add_u32 m0, s66, 4096
    v_mfma_f32_16x16x32_bf16 v[172:175], a[80:83], a[56:59], v[172:175]
    buffer_load_dwordx4 v212, s[32:35], s64 offen offset:0  lds
    v_mfma_f32_16x16x32_bf16 v[172:175], a[84:87], a[60:63], v[172:175]
    s_waitcnt lgkmcnt(8)
    v_mfma_f32_16x16x32_bf16 v[176:179], a[88:91], a[32:35], v[176:179]
    ds_read_b64_tr_b16 a[72:73], v232 offset:49152
    v_mfma_f32_16x16x32_bf16 v[176:179], a[92:95], a[36:39], v[176:179]
    ds_read_b64_tr_b16 a[74:75], v232 offset:50176
    v_mfma_f32_16x16x32_bf16 v[180:183], a[88:91], a[40:43], v[180:183]
    ds_read_b64_tr_b16 a[76:77], v232 offset:57344
    v_mfma_f32_16x16x32_bf16 v[180:183], a[92:95], a[44:47], v[180:183]
    ds_read_b64_tr_b16 a[78:79], v232 offset:58368
    v_mfma_f32_16x16x32_bf16 v[184:187], a[88:91], a[48:51], v[184:187]
    ds_read_b128 a[24:27], v224 offset:6144
    v_mfma_f32_16x16x32_bf16 v[184:187], a[92:95], a[52:55], v[184:187]
    ds_read_b128 a[28:31], v225 offset:6144
    v_mfma_f32_16x16x32_bf16 v[188:191], a[88:91], a[56:59], v[188:191]
    buffer_load_dwordx4 v213, s[32:35], s64 offen offset:1024  lds
    v_mfma_f32_16x16x32_bf16 v[188:191], a[92:95], a[60:63], v[188:191]
    s_waitcnt lgkmcnt(8)
    v_mfma_f32_16x16x32_bf16 a[96:99], a[64:67], a[32:35], a[96:99]
    ds_read_b64_tr_b16 a[80:81], v233 offset:32768
    v_mfma_f32_16x16x32_bf16 a[96:99], a[68:71], a[36:39], a[96:99]
    ds_read_b64_tr_b16 a[82:83], v233 offset:33792
    v_mfma_f32_16x16x32_bf16 a[100:103], a[64:67], a[40:43], a[100:103]
    ds_read_b64_tr_b16 a[84:85], v233 offset:40960
    v_mfma_f32_16x16x32_bf16 a[100:103], a[68:71], a[44:47], a[100:103]
    ds_read_b64_tr_b16 a[86:87], v233 offset:41984
    v_mfma_f32_16x16x32_bf16 a[104:107], a[64:67], a[48:51], a[104:107]
    ds_read_b64_tr_b16 a[88:89], v233 offset:49152
    v_mfma_f32_16x16x32_bf16 a[104:107], a[68:71], a[52:55], a[104:107]
    ds_read_b64_tr_b16 a[90:91], v233 offset:50176
    v_mfma_f32_16x16x32_bf16 a[108:111], a[64:67], a[56:59], a[108:111]
    ds_read_b64_tr_b16 a[92:93], v233 offset:57344
    buffer_load_dwordx4 v214, s[32:35], s64 offen offset:2048  lds
    v_mfma_f32_16x16x32_bf16 a[108:111], a[68:71], a[60:63], a[108:111]
    ds_read_b64_tr_b16 a[94:95], v233 offset:58368
    s_waitcnt lgkmcnt(10)
    v_mfma_f32_16x16x32_bf16 a[112:115], a[72:75], a[32:35], a[112:115]
    v_mfma_f32_16x16x32_bf16 a[112:115], a[76:79], a[36:39], a[112:115]
    v_mfma_f32_16x16x32_bf16 a[116:119], a[72:75], a[40:43], a[116:119]
    v_mfma_f32_16x16x32_bf16 a[116:119], a[76:79], a[44:47], a[116:119]
    v_mfma_f32_16x16x32_bf16 a[120:123], a[72:75], a[48:51], a[120:123]
    v_mfma_f32_16x16x32_bf16 a[120:123], a[76:79], a[52:55], a[120:123]
    s_xor_b32 s66, s66, 8192
    v_mfma_f32_16x16x32_bf16 a[124:127], a[72:75], a[56:59], a[124:127]
    buffer_load_dwordx4 v215, s[32:35], s64 offen offset:3072  lds
    s_add_u32 s64, s64, 128
    v_mfma_f32_16x16x32_bf16 a[124:127], a[76:79], a[60:63], a[124:127]
    s_waitcnt vmcnt(12) lgkmcnt(0)
    v_mfma_f32_16x16x32_bf16 a[128:131], a[80:83], a[32:35], a[128:131]
    s_barrier
    v_mfma_f32_16x16x32_bf16 a[128:131], a[84:87], a[36:39], a[128:131]
    ds_read_b64_tr_b16 a[64:65], v226 offset:0
    v_mfma_f32_16x16x32_bf16 a[132:135], a[80:83], a[40:43], a[132:135]
    ds_read_b64_tr_b16 a[66:67], v226 offset:1024
    v_mfma_f32_16x16x32_bf16 a[132:135], a[84:87], a[44:47], a[132:135]
    ds_read_b64_tr_b16 a[68:69], v226 offset:8192
    v_mfma_f32_16x16x32_bf16 a[136:139], a[80:83], a[48:51], a[136:139]
    ds_read_b64_tr_b16 a[70:71], v226 offset:9216
    v_mfma_f32_16x16x32_bf16 a[136:139], a[84:87], a[52:55], a[136:139]
    s_mov_b32 m0, s67
    v_mfma_f32_16x16x32_bf16 a[140:143], a[80:83], a[56:59], a[140:143]
    buffer_load_dwordx4 v216, s[36:39], s65 offen offset:0  lds
    v_mfma_f32_16x16x32_bf16 a[140:143], a[84:87], a[60:63], a[140:143]
    v_mfma_f32_16x16x32_bf16 a[144:147], a[88:91], a[32:35], a[144:147]
    v_mfma_f32_16x16x32_bf16 a[144:147], a[92:95], a[36:39], a[144:147]
    ds_read_b64_tr_b16 a[72:73], v226 offset:16384
    v_mfma_f32_16x16x32_bf16 a[148:151], a[88:91], a[40:43], a[148:151]
    ds_read_b64_tr_b16 a[74:75], v226 offset:17408
    v_mfma_f32_16x16x32_bf16 a[148:151], a[92:95], a[44:47], a[148:151]
    ds_read_b64_tr_b16 a[76:77], v226 offset:24576
    v_mfma_f32_16x16x32_bf16 a[152:155], a[88:91], a[48:51], a[152:155]
    ds_read_b64_tr_b16 a[78:79], v226 offset:25600
    v_mfma_f32_16x16x32_bf16 a[152:155], a[92:95], a[52:55], a[152:155]
    v_mfma_f32_16x16x32_bf16 a[156:159], a[88:91], a[56:59], a[156:159]
    buffer_load_dwordx4 v217, s[36:39], s65 offen offset:1024  lds
    v_mfma_f32_16x16x32_bf16 a[156:159], a[92:95], a[60:63], a[156:159]
    s_waitcnt lgkmcnt(4)
    v_mfma_f32_16x16x32_bf16 v[0:3], a[64:67], a[0:3], v[0:3]
    ds_read_b64_tr_b16 a[80:81], v227 offset:0
    v_mfma_f32_16x16x32_bf16 v[0:3], a[68:71], a[4:7], v[0:3]
    ds_read_b64_tr_b16 a[82:83], v227 offset:1024
    v_mfma_f32_16x16x32_bf16 v[4:7], a[64:67], a[8:11], v[4:7]
    ds_read_b64_tr_b16 a[84:85], v227 offset:8192
    v_mfma_f32_16x16x32_bf16 v[4:7], a[68:71], a[12:15], v[4:7]
    ds_read_b64_tr_b16 a[86:87], v227 offset:9216
    v_mfma_f32_16x16x32_bf16 v[8:11], a[64:67], a[16:19], v[8:11]
    v_mfma_f32_16x16x32_bf16 v[8:11], a[68:71], a[20:23], v[8:11]
    v_mfma_f32_16x16x32_bf16 v[12:15], a[64:67], a[24:27], v[12:15]
    buffer_load_dwordx4 v218, s[36:39], s65 offen offset:2048  lds
    v_mfma_f32_16x16x32_bf16 v[12:15], a[68:71], a[28:31], v[12:15]
    s_waitcnt lgkmcnt(4)
    v_mfma_f32_16x16x32_bf16 v[16:19], a[72:75], a[0:3], v[16:19]
    ds_read_b64_tr_b16 a[88:89], v227 offset:16384
    v_mfma_f32_16x16x32_bf16 v[16:19], a[76:79], a[4:7], v[16:19]
    ds_read_b64_tr_b16 a[90:91], v227 offset:17408
    v_mfma_f32_16x16x32_bf16 v[20:23], a[72:75], a[8:11], v[20:23]
    ds_read_b64_tr_b16 a[92:93], v227 offset:24576
    v_mfma_f32_16x16x32_bf16 v[20:23], a[76:79], a[12:15], v[20:23]
    ds_read_b64_tr_b16 a[94:95], v227 offset:25600
    v_mfma_f32_16x16x32_bf16 v[24:27], a[72:75], a[16:19], v[24:27]
    v_mfma_f32_16x16x32_bf16 v[24:27], a[76:79], a[20:23], v[24:27]
    v_mfma_f32_16x16x32_bf16 v[28:31], a[72:75], a[24:27], v[28:31]
    buffer_load_dwordx4 v219, s[36:39], s65 offen offset:3072  lds
    v_mfma_f32_16x16x32_bf16 v[28:31], a[76:79], a[28:31], v[28:31]
    s_waitcnt lgkmcnt(4)
    v_mfma_f32_16x16x32_bf16 v[32:35], a[80:83], a[0:3], v[32:35]
    ds_read_b64_tr_b16 a[64:65], v228 offset:0
    v_mfma_f32_16x16x32_bf16 v[32:35], a[84:87], a[4:7], v[32:35]
    ds_read_b64_tr_b16 a[66:67], v228 offset:1024
    v_mfma_f32_16x16x32_bf16 v[36:39], a[80:83], a[8:11], v[36:39]
    ds_read_b64_tr_b16 a[68:69], v228 offset:8192
    v_mfma_f32_16x16x32_bf16 v[36:39], a[84:87], a[12:15], v[36:39]
    ds_read_b64_tr_b16 a[70:71], v228 offset:9216
    v_mfma_f32_16x16x32_bf16 v[40:43], a[80:83], a[16:19], v[40:43]
    v_mfma_f32_16x16x32_bf16 v[40:43], a[84:87], a[20:23], v[40:43]
    s_add_u32 m0, s67, 4096
    v_mfma_f32_16x16x32_bf16 v[44:47], a[80:83], a[24:27], v[44:47]
    buffer_load_dwordx4 v220, s[36:39], s65 offen offset:0  lds
    v_mfma_f32_16x16x32_bf16 v[44:47], a[84:87], a[28:31], v[44:47]
    s_waitcnt lgkmcnt(4)
    v_mfma_f32_16x16x32_bf16 v[48:51], a[88:91], a[0:3], v[48:51]
    ds_read_b64_tr_b16 a[72:73], v228 offset:16384
    v_mfma_f32_16x16x32_bf16 v[48:51], a[92:95], a[4:7], v[48:51]
    ds_read_b64_tr_b16 a[74:75], v228 offset:17408
    v_mfma_f32_16x16x32_bf16 v[52:55], a[88:91], a[8:11], v[52:55]
    ds_read_b64_tr_b16 a[76:77], v228 offset:24576
    v_mfma_f32_16x16x32_bf16 v[52:55], a[92:95], a[12:15], v[52:55]
    ds_read_b64_tr_b16 a[78:79], v228 offset:25600
    v_mfma_f32_16x16x32_bf16 v[56:59], a[88:91], a[16:19], v[56:59]
    v_mfma_f32_16x16x32_bf16 v[56:59], a[92:95], a[20:23], v[56:59]
    v_mfma_f32_16x16x32_bf16 v[60:63], a[88:91], a[24:27], v[60:63]
    buffer_load_dwordx4 v221, s[36:39], s65 offen offset:1024  lds
    v_mfma_f32_16x16x32_bf16 v[60:63], a[92:95], a[28:31], v[60:63]
    s_waitcnt lgkmcnt(4)
    v_mfma_f32_16x16x32_bf16 v[64:67], a[64:67], a[0:3], v[64:67]
    ds_read_b64_tr_b16 a[80:81], v229 offset:0
    v_mfma_f32_16x16x32_bf16 v[64:67], a[68:71], a[4:7], v[64:67]
    ds_read_b64_tr_b16 a[82:83], v229 offset:1024
    v_mfma_f32_16x16x32_bf16 v[68:71], a[64:67], a[8:11], v[68:71]
    ds_read_b64_tr_b16 a[84:85], v229 offset:8192
    v_mfma_f32_16x16x32_bf16 v[68:71], a[68:71], a[12:15], v[68:71]
    ds_read_b64_tr_b16 a[86:87], v229 offset:9216
    v_mfma_f32_16x16x32_bf16 v[72:75], a[64:67], a[16:19], v[72:75]
    v_mfma_f32_16x16x32_bf16 v[72:75], a[68:71], a[20:23], v[72:75]
    v_mfma_f32_16x16x32_bf16 v[76:79], a[64:67], a[24:27], v[76:79]
    buffer_load_dwordx4 v222, s[36:39], s65 offen offset:2048  lds
    v_mfma_f32_16x16x32_bf16 v[76:79], a[68:71], a[28:31], v[76:79]
    s_waitcnt lgkmcnt(4)
    v_mfma_f32_16x16x32_bf16 v[80:83], a[72:75], a[0:3], v[80:83]
    ds_read_b64_tr_b16 a[88:89], v229 offset:16384
    v_mfma_f32_16x16x32_bf16 v[80:83], a[76:79], a[4:7], v[80:83]
    ds_read_b64_tr_b16 a[90:91], v229 offset:17408
    v_mfma_f32_16x16x32_bf16 v[84:87], a[72:75], a[8:11], v[84:87]
    ds_read_b64_tr_b16 a[92:93], v229 offset:24576
    v_mfma_f32_16x16x32_bf16 v[84:87], a[76:79], a[12:15], v[84:87]
    ds_read_b64_tr_b16 a[94:95], v229 offset:25600
    v_mfma_f32_16x16x32_bf16 v[88:91], a[72:75], a[16:19], v[88:91]
    v_mfma_f32_16x16x32_bf16 v[88:91], a[76:79], a[20:23], v[88:91]
    s_xor_b32 s67, s67, 32768
    v_mfma_f32_16x16x32_bf16 v[92:95], a[72:75], a[24:27], v[92:95]
    buffer_load_dwordx4 v223, s[36:39], s65 offen offset:3072  lds
    s_add_u32 s65, s65, 458752
    v_mfma_f32_16x16x32_bf16 v[92:95], a[76:79], a[28:31], v[92:95]
    s_waitcnt lgkmcnt(4)
    v_mfma_f32_16x16x32_bf16 v[96:99], a[80:83], a[0:3], v[96:99]
    ds_read_b64_tr_b16 a[64:65], v230 offset:0
    v_mfma_f32_16x16x32_bf16 v[96:99], a[84:87], a[4:7], v[96:99]
    ds_read_b64_tr_b16 a[66:67], v230 offset:1024
    v_mfma_f32_16x16x32_bf16 v[100:103], a[80:83], a[8:11], v[100:103]
    ds_read_b64_tr_b16 a[68:69], v230 offset:8192
    buffer_load_dword v238, v234, s[40:43], s68 offen
    s_add_u32 s68, s68, 458752
    buffer_load_dword v239, v207, s[32:35], s88 offen
    s_add_u32 s88, s88, 128
    v_mfma_f32_16x16x32_bf16 v[100:103], a[84:87], a[12:15], v[100:103]
    ds_read_b64_tr_b16 a[70:71], v230 offset:9216
    buffer_load_dword v240, v235, s[44:47], s69 offen
    s_add_u32 s69, s69, 512
    v_mfma_f32_16x16x32_bf16 v[104:107], a[80:83], a[16:19], v[104:107]
    v_mfma_f32_16x16x32_bf16 v[104:107], a[84:87], a[20:23], v[104:107]
    s_mov_b32 m0, s66
    v_mfma_f32_16x16x32_bf16 v[108:111], a[80:83], a[24:27], v[108:111]
    buffer_load_dwordx4 v208, s[32:35], s64 offen offset:0  lds
    v_mfma_f32_16x16x32_bf16 v[108:111], a[84:87], a[28:31], v[108:111]
    s_waitcnt lgkmcnt(4)
    v_mfma_f32_16x16x32_bf16 v[112:115], a[88:91], a[0:3], v[112:115]
    ds_read_b64_tr_b16 a[72:73], v230 offset:16384
    v_mfma_f32_16x16x32_bf16 v[112:115], a[92:95], a[4:7], v[112:115]
    ds_read_b64_tr_b16 a[74:75], v230 offset:17408
    v_mfma_f32_16x16x32_bf16 v[116:119], a[88:91], a[8:11], v[116:119]
    ds_read_b64_tr_b16 a[76:77], v230 offset:24576
    v_mfma_f32_16x16x32_bf16 v[116:119], a[92:95], a[12:15], v[116:119]
    ds_read_b64_tr_b16 a[78:79], v230 offset:25600
    v_mfma_f32_16x16x32_bf16 v[120:123], a[88:91], a[16:19], v[120:123]
    s_waitcnt vmcnt(20)
    v_cmp_ne_u64 vcc, 0, v[194:195]
    s_nop 1
    s_cmp_eq_u64 vcc, -1
    s_cbranch_scc0 L_slow_nc
L_ok_nc:
    v_mfma_f32_16x16x32_bf16 v[120:123], a[92:95], a[20:23], v[120:123]
    v_readfirstlane_b32 s86, v194
    v_mfma_f32_16x16x32_bf16 v[124:127], a[88:91], a[24:27], v[124:127]
    buffer_load_dwordx4 v209, s[32:35], s64 offen offset:1024  lds
    v_mfma_f32_16x16x32_bf16 v[124:127], a[92:95], a[28:31], v[124:127]
    s_waitcnt lgkmcnt(4)
    v_readfirstlane_b32 s87, v195
    v_mfma_f32_16x16x32_bf16 v[128:131], a[64:67], a[0:3], v[128:131]
    ds_read_b64_tr_b16 a[80:81], v231 offset:0
    s_mov_b32 s63, 0x20000
    v_mfma_f32_16x16x32_bf16 v[128:131], a[68:71], a[4:7], v[128:131]
    ds_read_b64_tr_b16 a[82:83], v231 offset:1024
    s_mov_b32 s62, 1048576
    v_mfma_f32_16x16x32_bf16 v[132:135], a[64:67], a[8:11], v[132:135]
    ds_read_b64_tr_b16 a[84:85], v231 offset:8192
    s_add_u32 s60, s28, 27262976
    s_addc_u32 s61, s29, 0
    s_and_b32 s61, s61, 0xffff
    v_mfma_f32_16x16x32_bf16 v[132:135], a[68:71], a[12:15], v[132:135]
    ds_read_b64_tr_b16 a[86:87], v231 offset:9216
    s_waitcnt vmcnt(13)
    v_mfma_f32_16x16x32_bf16 v[136:139], a[64:67], a[16:19], v[136:139]
    ds_read_b128 a[32:35], v224 offset:8192
    s_lshl2_add_u32 s75, s2, s30
    v_mfma_f32_16x16x32_bf16 v[136:139], a[68:71], a[20:23], v[136:139]
    ds_read_b128 a[36:39], v225 offset:8192
    v_mfma_f32_16x16x32_bf16 v[140:143], a[64:67], a[24:27], v[140:143]
    buffer_load_dwordx4 v210, s[32:35], s64 offen offset:2048  lds
    v_mfma_f32_16x16x32_bf16 v[140:143], a[68:71], a[28:31], v[140:143]
    s_waitcnt lgkmcnt(6)
    s_lshl_b32 s75, s75, 10
    v_mfma_f32_16x16x32_bf16 v[144:147], a[72:75], a[0:3], v[144:147]
    ds_read_b64_tr_b16 a[88:89], v231 offset:16384
    v_mfma_f32_16x16x32_bf16 v[144:147], a[76:79], a[4:7], v[144:147]
    ds_read_b64_tr_b16 a[90:91], v231 offset:17408
    v_lshrrev_b32 v254, 4, v244
    v_mfma_f32_16x16x32_bf16 v[148:151], a[72:75], a[8:11], v[148:151]
    ds_read_b64_tr_b16 a[92:93], v231 offset:24576
    v_mfma_f32_16x16x32_bf16 v[148:151], a[76:79], a[12:15], v[148:151]
    ds_read_b64_tr_b16 a[94:95], v231 offset:25600
    v_mfma_f32_16x16x32_bf16 v[152:155], a[72:75], a[16:19], v[152:155]
    ds_read_b128 a[40:43], v224 offset:10240
    v_min_u32 v254, 1, v254
    v_mfma_f32_16x16x32_bf16 v[152:155], a[76:79], a[20:23], v[152:155]
    ds_read_b128 a[44:47], v225 offset:10240
    v_mfma_f32_16x16x32_bf16 v[156:159], a[72:75], a[24:27], v[156:159]
    buffer_load_dwordx4 v211, s[32:35], s64 offen offset:3072  lds
    v_mfma_f32_16x16x32_bf16 v[156:159], a[76:79], a[28:31], v[156:159]
    s_waitcnt lgkmcnt(8)
    v_lshlrev_b32 v254, 31, v254
    v_mfma_f32_16x16x32_bf16 v[160:163], a[80:83], a[0:3], v[160:163]
    ds_read_b64_tr_b16 a[64:65], v232 offset:0
    v_mfma_f32_16x16x32_bf16 v[160:163], a[84:87], a[4:7], v[160:163]
    ds_read_b64_tr_b16 a[66:67], v232 offset:1024
    v_lshl_add_u32 v254, v244, 3, v254
    v_mfma_f32_16x16x32_bf16 v[164:167], a[80:83], a[8:11], v[164:167]
    ds_read_b64_tr_b16 a[68:69], v232 offset:8192
    v_mfma_f32_16x16x32_bf16 v[164:167], a[84:87], a[12:15], v[164:167]
    ds_read_b64_tr_b16 a[70:71], v232 offset:9216
    v_mfma_f32_16x16x32_bf16 v[168:171], a[80:83], a[16:19], v[168:171]
    ds_read_b128 a[48:51], v224 offset:12288
    v_add_u32 v254, s75, v254
    v_mfma_f32_16x16x32_bf16 v[168:171], a[84:87], a[20:23], v[168:171]
    ds_read_b128 a[52:55], v225 offset:12288
    s_add_u32 m0, s66, 4096
    v_mfma_f32_16x16x32_bf16 v[172:175], a[80:83], a[24:27], v[172:175]
    buffer_load_dwordx4 v212, s[32:35], s64 offen offset:0  lds
    s_lshr_b32 s75, s2, 4
    v_mfma_f32_16x16x32_bf16 v[172:175], a[84:87], a[28:31], v[172:175]
    s_waitcnt lgkmcnt(8)
    v_mfma_f32_16x16x32_bf16 v[176:179], a[88:91], a[0:3], v[176:179]
    ds_read_b64_tr_b16 a[72:73], v232 offset:16384
    v_mfma_f32_16x16x32_bf16 v[176:179], a[92:95], a[4:7], v[176:179]
    ds_read_b64_tr_b16 a[74:75], v232 offset:17408
    s_lshl3_add_u32 s75, s75, 896
    v_mfma_f32_16x16x32_bf16 v[180:183], a[88:91], a[8:11], v[180:183]
    ds_read_b64_tr_b16 a[76:77], v232 offset:24576
    v_mfma_f32_16x16x32_bf16 v[180:183], a[92:95], a[12:15], v[180:183]
    ds_read_b64_tr_b16 a[78:79], v232 offset:25600
    s_bfe_u32 s76, s2, 0x20002
    v_mfma_f32_16x16x32_bf16 v[184:187], a[88:91], a[16:19], v[184:187]
    ds_read_b128 a[56:59], v224 offset:14336
    v_mfma_f32_16x16x32_bf16 v[184:187], a[92:95], a[20:23], v[184:187]
    ds_read_b128 a[60:63], v225 offset:14336
    v_mfma_f32_16x16x32_bf16 v[188:191], a[88:91], a[24:27], v[188:191]
    buffer_load_dwordx4 v213, s[32:35], s64 offen offset:1024  lds
    s_add_u32 s75, s75, s76
    v_mfma_f32_16x16x32_bf16 v[188:191], a[92:95], a[28:31], v[188:191]
    s_waitcnt lgkmcnt(8)
    v_mfma_f32_16x16x32_bf16 a[96:99], a[64:67], a[0:3], a[96:99]
    ds_read_b64_tr_b16 a[80:81], v233 offset:0
    v_mfma_f32_16x16x32_bf16 a[96:99], a[68:71], a[4:7], a[96:99]
    ds_read_b64_tr_b16 a[82:83], v233 offset:1024
    s_lshl_b32 s75, s75, 10
    v_mfma_f32_16x16x32_bf16 a[100:103], a[64:67], a[8:11], a[100:103]
    ds_read_b64_tr_b16 a[84:85], v233 offset:8192
    v_mfma_f32_16x16x32_bf16 a[100:103], a[68:71], a[12:15], a[100:103]
    ds_read_b64_tr_b16 a[86:87], v233 offset:9216
    s_add_u32 s75, s75, 256
    v_mfma_f32_16x16x32_bf16 a[104:107], a[64:67], a[16:19], a[104:107]
    ds_read_b64_tr_b16 a[88:89], v233 offset:16384
    v_mfma_f32_16x16x32_bf16 a[104:107], a[68:71], a[20:23], a[104:107]
    ds_read_b64_tr_b16 a[90:91], v233 offset:17408
    v_and_b32 v192, 1, v244
    v_mfma_f32_16x16x32_bf16 a[108:111], a[64:67], a[24:27], a[108:111]
    ds_read_b64_tr_b16 a[92:93], v233 offset:24576
    buffer_load_dwordx4 v214, s[32:35], s64 offen offset:2048  lds
    v_mfma_f32_16x16x32_bf16 a[108:111], a[68:71], a[28:31], a[108:111]
    ds_read_b64_tr_b16 a[94:95], v233 offset:25600
    s_waitcnt lgkmcnt(10)
    v_mfma_f32_16x16x32_bf16 a[112:115], a[72:75], a[0:3], a[112:115]
    v_lshlrev_b32 v192, 12, v192
    v_mfma_f32_16x16x32_bf16 a[112:115], a[76:79], a[4:7], a[112:115]
    v_mfma_f32_16x16x32_bf16 a[116:119], a[72:75], a[8:11], a[116:119]
    v_mfma_f32_16x16x32_bf16 a[116:119], a[76:79], a[12:15], a[116:119]
    v_add_u32 v192, s75, v192
    v_mfma_f32_16x16x32_bf16 a[120:123], a[72:75], a[16:19], a[120:123]
    v_mfma_f32_16x16x32_bf16 a[120:123], a[76:79], a[20:23], a[120:123]
    s_xor_b32 s66, s66, 8192
    v_mfma_f32_16x16x32_bf16 a[124:127], a[72:75], a[24:27], a[124:127]
    buffer_load_dwordx4 v215, s[32:35], s64 offen offset:3072  lds
    s_add_u32 s64, s64, 128
    v_mfma_f32_16x16x32_bf16 a[124:127], a[76:79], a[28:31], a[124:127]
    s_waitcnt vmcnt(11) lgkmcnt(0)
    v_mfma_f32_16x16x32_bf16 a[128:131], a[80:83], a[0:3], a[128:131]
    s_barrier
    v_mfma_f32_16x16x32_bf16 a[128:131], a[84:87], a[4:7], a[128:131]
    ds_read_b64_tr_b16 a[64:65], v226 offset:32768
    v_mfma_f32_16x16x32_bf16 a[132:135], a[80:83], a[8:11], a[132:135]
    ds_read_b64_tr_b16 a[66:67], v226 offset:33792
    v_mfma_f32_16x16x32_bf16 a[132:135], a[84:87], a[12:15], a[132:135]
    ds_read_b64_tr_b16 a[68:69], v226 offset:40960
    v_mfma_f32_16x16x32_bf16 a[136:139], a[80:83], a[16:19], a[136:139]
    ds_read_b64_tr_b16 a[70:71], v226 offset:41984
    v_mfma_f32_16x16x32_bf16 a[136:139], a[84:87], a[20:23], a[136:139]
    s_mov_b32 m0, s67
    v_mfma_f32_16x16x32_bf16 a[140:143], a[80:83], a[24:27], a[140:143]
    buffer_load_dwordx4 v216, s[36:39], s65 offen offset:0  lds
    v_mfma_f32_16x16x32_bf16 a[140:143], a[84:87], a[28:31], a[140:143]
    v_mfma_f32_16x16x32_bf16 a[144:147], a[88:91], a[0:3], a[144:147]
    v_mfma_f32_16x16x32_bf16 a[144:147], a[92:95], a[4:7], a[144:147]
    ds_read_b64_tr_b16 a[72:73], v226 offset:49152
    v_mfma_f32_16x16x32_bf16 a[148:151], a[88:91], a[8:11], a[148:151]
    ds_read_b64_tr_b16 a[74:75], v226 offset:50176
    v_mfma_f32_16x16x32_bf16 a[148:151], a[92:95], a[12:15], a[148:151]
    ds_read_b64_tr_b16 a[76:77], v226 offset:57344
    v_mfma_f32_16x16x32_bf16 a[152:155], a[88:91], a[16:19], a[152:155]
    ds_read_b64_tr_b16 a[78:79], v226 offset:58368
    v_mfma_f32_16x16x32_bf16 a[152:155], a[92:95], a[20:23], a[152:155]
    v_mfma_f32_16x16x32_bf16 a[156:159], a[88:91], a[24:27], a[156:159]
    buffer_load_dwordx4 v217, s[36:39], s65 offen offset:1024  lds
    v_mfma_f32_16x16x32_bf16 a[156:159], a[92:95], a[28:31], a[156:159]
    s_waitcnt lgkmcnt(4)
    v_mfma_f32_16x16x32_bf16 v[0:3], a[64:67], a[32:35], v[0:3]
    ds_read_b64_tr_b16 a[80:81], v227 offset:32768
    v_mfma_f32_16x16x32_bf16 v[0:3], a[68:71], a[36:39], v[0:3]
    ds_read_b64_tr_b16 a[82:83], v227 offset:33792
    v_mfma_f32_16x16x32_bf16 v[4:7], a[64:67], a[40:43], v[4:7]
    ds_read_b64_tr_b16 a[84:85], v227 offset:40960
    v_mfma_f32_16x16x32_bf16 v[4:7], a[68:71], a[44:47], v[4:7]
    ds_read_b64_tr_b16 a[86:87], v227 offset:41984
    v_mfma_f32_16x16x32_bf16 v[8:11], a[64:67], a[48:51], v[8:11]
    v_mfma_f32_16x16x32_bf16 v[8:11], a[68:71], a[52:55], v[8:11]
    v_mfma_f32_16x16x32_bf16 v[12:15], a[64:67], a[56:59], v[12:15]
    buffer_load_dwordx4 v218, s[36:39], s65 offen offset:2048  lds
    v_mfma_f32_16x16x32_bf16 v[12:15], a[68:71], a[60:63], v[12:15]
    s_waitcnt lgkmcnt(4)
    v_mfma_f32_16x16x32_bf16 v[16:19], a[72:75], a[32:35], v[16:19]
    ds_read_b64_tr_b16 a[88:89], v227 offset:49152
    v_mfma_f32_16x16x32_bf16 v[16:19], a[76:79], a[36:39], v[16:19]
    ds_read_b64_tr_b16 a[90:91], v227 offset:50176
    v_mfma_f32_16x16x32_bf16 v[20:23], a[72:75], a[40:43], v[20:23]
    ds_read_b64_tr_b16 a[92:93], v227 offset:57344
    v_mfma_f32_16x16x32_bf16 v[20:23], a[76:79], a[44:47], v[20:23]
    ds_read_b64_tr_b16 a[94:95], v227 offset:58368
    v_mfma_f32_16x16x32_bf16 v[24:27], a[72:75], a[48:51], v[24:27]
    v_mfma_f32_16x16x32_bf16 v[24:27], a[76:79], a[52:55], v[24:27]
    v_mfma_f32_16x16x32_bf16 v[28:31], a[72:75], a[56:59], v[28:31]
    buffer_load_dwordx4 v219, s[36:39], s65 offen offset:3072  lds
    v_mfma_f32_16x16x32_bf16 v[28:31], a[76:79], a[60:63], v[28:31]
    s_waitcnt lgkmcnt(4)
    v_mfma_f32_16x16x32_bf16 v[32:35], a[80:83], a[32:35], v[32:35]
    ds_read_b64_tr_b16 a[64:65], v228 offset:32768
    v_mfma_f32_16x16x32_bf16 v[32:35], a[84:87], a[36:39], v[32:35]
    ds_read_b64_tr_b16 a[66:67], v228 offset:33792
    v_mfma_f32_16x16x32_bf16 v[36:39], a[80:83], a[40:43], v[36:39]
    ds_read_b64_tr_b16 a[68:69], v228 offset:40960
    v_mfma_f32_16x16x32_bf16 v[36:39], a[84:87], a[44:47], v[36:39]
    ds_read_b64_tr_b16 a[70:71], v228 offset:41984
    v_mfma_f32_16x16x32_bf16 v[40:43], a[80:83], a[48:51], v[40:43]
    v_mfma_f32_16x16x32_bf16 v[40:43], a[84:87], a[52:55], v[40:43]
    s_add_u32 m0, s67, 4096
    v_mfma_f32_16x16x32_bf16 v[44:47], a[80:83], a[56:59], v[44:47]
    buffer_load_dwordx4 v220, s[36:39], s65 offen offset:0  lds
    v_mfma_f32_16x16x32_bf16 v[44:47], a[84:87], a[60:63], v[44:47]
    s_waitcnt lgkmcnt(4)
    v_mfma_f32_16x16x32_bf16 v[48:51], a[88:91], a[32:35], v[48:51]
    ds_read_b64_tr_b16 a[72:73], v228 offset:49152
    v_mfma_f32_16x16x32_bf16 v[48:51], a[92:95], a[36:39], v[48:51]
    ds_read_b64_tr_b16 a[74:75], v228 offset:50176
    v_mfma_f32_16x16x32_bf16 v[52:55], a[88:91], a[40:43], v[52:55]
    ds_read_b64_tr_b16 a[76:77], v228 offset:57344
    v_mfma_f32_16x16x32_bf16 v[52:55], a[92:95], a[44:47], v[52:55]
    ds_read_b64_tr_b16 a[78:79], v228 offset:58368
    v_mfma_f32_16x16x32_bf16 v[56:59], a[88:91], a[48:51], v[56:59]
    v_mfma_f32_16x16x32_bf16 v[56:59], a[92:95], a[52:55], v[56:59]
    v_mfma_f32_16x16x32_bf16 v[60:63], a[88:91], a[56:59], v[60:63]
    buffer_load_dwordx4 v221, s[36:39], s65 offen offset:1024  lds
    v_mfma_f32_16x16x32_bf16 v[60:63], a[92:95], a[60:63], v[60:63]
    s_waitcnt lgkmcnt(4)
    v_mfma_f32_16x16x32_bf16 v[64:67], a[64:67], a[32:35], v[64:67]
    ds_read_b64_tr_b16 a[80:81], v229 offset:32768
    v_mfma_f32_16x16x32_bf16 v[64:67], a[68:71], a[36:39], v[64:67]
    ds_read_b64_tr_b16 a[82:83], v229 offset:33792
    v_mfma_f32_16x16x32_bf16 v[68:71], a[64:67], a[40:43], v[68:71]
    ds_read_b64_tr_b16 a[84:85], v229 offset:40960
    v_mfma_f32_16x16x32_bf16 v[68:71], a[68:71], a[44:47], v[68:71]
    ds_read_b64_tr_b16 a[86:87], v229 offset:41984
    v_mfma_f32_16x16x32_bf16 v[72:75], a[64:67], a[48:51], v[72:75]
    v_mfma_f32_16x16x32_bf16 v[72:75], a[68:71], a[52:55], v[72:75]
    v_mfma_f32_16x16x32_bf16 v[76:79], a[64:67], a[56:59], v[76:79]
    buffer_load_dwordx4 v222, s[36:39], s65 offen offset:2048  lds
    v_mfma_f32_16x16x32_bf16 v[76:79], a[68:71], a[60:63], v[76:79]
    s_waitcnt lgkmcnt(4)
    v_mfma_f32_16x16x32_bf16 v[80:83], a[72:75], a[32:35], v[80:83]
    ds_read_b64_tr_b16 a[88:89], v229 offset:49152
    v_mfma_f32_16x16x32_bf16 v[80:83], a[76:79], a[36:39], v[80:83]
    ds_read_b64_tr_b16 a[90:91], v229 offset:50176
    v_mfma_f32_16x16x32_bf16 v[84:87], a[72:75], a[40:43], v[84:87]
    ds_read_b64_tr_b16 a[92:93], v229 offset:57344
    v_mfma_f32_16x16x32_bf16 v[84:87], a[76:79], a[44:47], v[84:87]
    ds_read_b64_tr_b16 a[94:95], v229 offset:58368
    v_mfma_f32_16x16x32_bf16 v[88:91], a[72:75], a[48:51], v[88:91]
    v_mfma_f32_16x16x32_bf16 v[88:91], a[76:79], a[52:55], v[88:91]
    s_xor_b32 s67, s67, 32768
    v_mfma_f32_16x16x32_bf16 v[92:95], a[72:75], a[56:59], v[92:95]
    buffer_load_dwordx4 v223, s[36:39], s65 offen offset:3072  lds
    s_add_u32 s65, s65, 458752
    v_mfma_f32_16x16x32_bf16 v[92:95], a[76:79], a[60:63], v[92:95]
    s_waitcnt lgkmcnt(4)
    v_mfma_f32_16x16x32_bf16 v[96:99], a[80:83], a[32:35], v[96:99]
    ds_read_b64_tr_b16 a[64:65], v230 offset:32768
    v_mfma_f32_16x16x32_bf16 v[96:99], a[84:87], a[36:39], v[96:99]
    ds_read_b64_tr_b16 a[66:67], v230 offset:33792
    v_mfma_f32_16x16x32_bf16 v[100:103], a[80:83], a[40:43], v[100:103]
    ds_read_b64_tr_b16 a[68:69], v230 offset:40960
    buffer_load_dword v241, v234, s[40:43], s68 offen
    s_add_u32 s68, s68, 458752
    buffer_load_dword v242, v207, s[32:35], s88 offen
    s_add_u32 s88, s88, 128
    v_mfma_f32_16x16x32_bf16 v[100:103], a[84:87], a[44:47], v[100:103]
    ds_read_b64_tr_b16 a[70:71], v230 offset:41984
    buffer_load_dword v243, v235, s[44:47], s69 offen
    s_add_u32 s69, s69, 512
    v_mfma_f32_16x16x32_bf16 v[104:107], a[80:83], a[48:51], v[104:107]
    v_mfma_f32_16x16x32_bf16 v[104:107], a[84:87], a[52:55], v[104:107]
    s_mov_b32 m0, s66
    v_mfma_f32_16x16x32_bf16 v[108:111], a[80:83], a[56:59], v[108:111]
    buffer_load_dwordx4 v208, s[32:35], s64 offen offset:0  lds
    v_mfma_f32_16x16x32_bf16 v[108:111], a[84:87], a[60:63], v[108:111]
    s_waitcnt lgkmcnt(4)
    v_mfma_f32_16x16x32_bf16 v[112:115], a[88:91], a[32:35], v[112:115]
    ds_read_b64_tr_b16 a[72:73], v230 offset:49152
    v_mfma_f32_16x16x32_bf16 v[112:115], a[92:95], a[36:39], v[112:115]
    ds_read_b64_tr_b16 a[74:75], v230 offset:50176
    v_mfma_f32_16x16x32_bf16 v[116:119], a[88:91], a[40:43], v[116:119]
    ds_read_b64_tr_b16 a[76:77], v230 offset:57344
    v_mfma_f32_16x16x32_bf16 v[116:119], a[92:95], a[44:47], v[116:119]
    ds_read_b64_tr_b16 a[78:79], v230 offset:58368
    v_mfma_f32_16x16x32_bf16 v[120:123], a[88:91], a[48:51], v[120:123]
    v_mfma_f32_16x16x32_bf16 v[120:123], a[92:95], a[52:55], v[120:123]
    v_mfma_f32_16x16x32_bf16 v[124:127], a[88:91], a[56:59], v[124:127]
    buffer_load_dwordx4 v209, s[32:35], s64 offen offset:1024  lds
    v_mfma_f32_16x16x32_bf16 v[124:127], a[92:95], a[60:63], v[124:127]
    s_waitcnt lgkmcnt(4)
    v_mfma_f32_16x16x32_bf16 v[128:131], a[64:67], a[32:35], v[128:131]
    ds_read_b64_tr_b16 a[80:81], v231 offset:32768
    v_mfma_f32_16x16x32_bf16 v[128:131], a[68:71], a[36:39], v[128:131]
    ds_read_b64_tr_b16 a[82:83], v231 offset:33792
    v_mfma_f32_16x16x32_bf16 v[132:135], a[64:67], a[40:43], v[132:135]
    ds_read_b64_tr_b16 a[84:85], v231 offset:40960
    v_mfma_f32_16x16x32_bf16 v[132:135], a[68:71], a[44:47], v[132:135]
    ds_read_b64_tr_b16 a[86:87], v231 offset:41984
    s_waitcnt vmcnt(13)
    v_mfma_f32_16x16x32_bf16 v[136:139], a[64:67], a[48:51], v[136:139]
    ds_read_b128 a[0:3], v224 offset:0
    v_mfma_f32_16x16x32_bf16 v[136:139], a[68:71], a[52:55], v[136:139]
    ds_read_b128 a[4:7], v225 offset:0
    v_mfma_f32_16x16x32_bf16 v[140:143], a[64:67], a[56:59], v[140:143]
    buffer_load_dwordx4 v210, s[32:35], s64 offen offset:2048  lds
    v_mfma_f32_16x16x32_bf16 v[140:143], a[68:71], a[60:63], v[140:143]
    s_waitcnt lgkmcnt(6)
    v_mfma_f32_16x16x32_bf16 v[144:147], a[72:75], a[32:35], v[144:147]
    ds_read_b64_tr_b16 a[88:89], v231 offset:49152
    v_mfma_f32_16x16x32_bf16 v[144:147], a[76:79], a[36:39], v[144:147]
    ds_read_b64_tr_b16 a[90:91], v231 offset:50176
    v_mfma_f32_16x16x32_bf16 v[148:151], a[72:75], a[40:43], v[148:151]
    ds_read_b64_tr_b16 a[92:93], v231 offset:57344
    v_mfma_f32_16x16x32_bf16 v[148:151], a[76:79], a[44:47], v[148:151]
    ds_read_b64_tr_b16 a[94:95], v231 offset:58368
    v_mfma_f32_16x16x32_bf16 v[152:155], a[72:75], a[48:51], v[152:155]
    ds_read_b128 a[8:11], v224 offset:2048
    v_mfma_f32_16x16x32_bf16 v[152:155], a[76:79], a[52:55], v[152:155]
    ds_read_b128 a[12:15], v225 offset:2048
    v_mfma_f32_16x16x32_bf16 v[156:159], a[72:75], a[56:59], v[156:159]
    buffer_load_dwordx4 v211, s[32:35], s64 offen offset:3072  lds
    v_mfma_f32_16x16x32_bf16 v[156:159], a[76:79], a[60:63], v[156:159]
    s_waitcnt lgkmcnt(8)
    v_mfma_f32_16x16x32_bf16 v[160:163], a[80:83], a[32:35], v[160:163]
    ds_read_b64_tr_b16 a[64:65], v232 offset:32768
    v_mfma_f32_16x16x32_bf16 v[160:163], a[84:87], a[36:39], v[160:163]
    ds_read_b64_tr_b16 a[66:67], v232 offset:33792
    v_mfma_f32_16x16x32_bf16 v[164:167], a[80:83], a[40:43], v[164:167]
    ds_read_b64_tr_b16 a[68:69], v232 offset:40960
    v_mfma_f32_16x16x32_bf16 v[164:167], a[84:87], a[44:47], v[164:167]
    ds_read_b64_tr_b16 a[70:71], v232 offset:41984
    v_mfma_f32_16x16x32_bf16 v[168:171], a[80:83], a[48:51], v[168:171]
    ds_read_b128 a[16:19], v224 offset:4096
    v_mfma_f32_16x16x32_bf16 v[168:171], a[84:87], a[52:55], v[168:171]
    ds_read_b128 a[20:23], v225 offset:4096
    s_add_u32 m0, s66, 4096
    v_mfma_f32_16x16x32_bf16 v[172:175], a[80:83], a[56:59], v[172:175]
    buffer_load_dwordx4 v212, s[32:35], s64 offen offset:0  lds
    v_mfma_f32_16x16x32_bf16 v[172:175], a[84:87], a[60:63], v[172:175]
    s_waitcnt lgkmcnt(8)
    v_mfma_f32_16x16x32_bf16 v[176:179], a[88:91], a[32:35], v[176:179]
    ds_read_b64_tr_b16 a[72:73], v232 offset:49152
    v_mfma_f32_16x16x32_bf16 v[176:179], a[92:95], a[36:39], v[176:179]
    ds_read_b64_tr_b16 a[74:75], v232 offset:50176
    v_mfma_f32_16x16x32_bf16 v[180:183], a[88:91], a[40:43], v[180:183]
    ds_read_b64_tr_b16 a[76:77], v232 offset:57344
    v_mfma_f32_16x16x32_bf16 v[180:183], a[92:95], a[44:47], v[180:183]
    ds_read_b64_tr_b16 a[78:79], v232 offset:58368
    v_mfma_f32_16x16x32_bf16 v[184:187], a[88:91], a[48:51], v[184:187]
    ds_read_b128 a[24:27], v224 offset:6144
    v_mfma_f32_16x16x32_bf16 v[184:187], a[92:95], a[52:55], v[184:187]
    ds_read_b128 a[28:31], v225 offset:6144
    v_mfma_f32_16x16x32_bf16 v[188:191], a[88:91], a[56:59], v[188:191]
    buffer_load_dwordx4 v213, s[32:35], s64 offen offset:1024  lds
    v_mfma_f32_16x16x32_bf16 v[188:191], a[92:95], a[60:63], v[188:191]
    s_waitcnt lgkmcnt(8)
    v_mfma_f32_16x16x32_bf16 a[96:99], a[64:67], a[32:35], a[96:99]
    ds_read_b64_tr_b16 a[80:81], v233 offset:32768
    v_mfma_f32_16x16x32_bf16 a[96:99], a[68:71], a[36:39], a[96:99]
    ds_read_b64_tr_b16 a[82:83], v233 offset:33792
    v_mfma_f32_16x16x32_bf16 a[100:103], a[64:67], a[40:43], a[100:103]
    ds_read_b64_tr_b16 a[84:85], v233 offset:40960
    v_mfma_f32_16x16x32_bf16 a[100:103], a[68:71], a[44:47], a[100:103]
    ds_read_b64_tr_b16 a[86:87], v233 offset:41984
    v_mfma_f32_16x16x32_bf16 a[104:107], a[64:67], a[48:51], a[104:107]
    ds_read_b64_tr_b16 a[88:89], v233 offset:49152
    v_mfma_f32_16x16x32_bf16 a[104:107], a[68:71], a[52:55], a[104:107]
    ds_read_b64_tr_b16 a[90:91], v233 offset:50176
    v_mfma_f32_16x16x32_bf16 a[108:111], a[64:67], a[56:59], a[108:111]
    ds_read_b64_tr_b16 a[92:93], v233 offset:57344
    buffer_load_dwordx4 v214, s[32:35], s64 offen offset:2048  lds
    v_mfma_f32_16x16x32_bf16 a[108:111], a[68:71], a[60:63], a[108:111]
    ds_read_b64_tr_b16 a[94:95], v233 offset:58368
    s_waitcnt lgkmcnt(10)
    v_mfma_f32_16x16x32_bf16 a[112:115], a[72:75], a[32:35], a[112:115]
    v_mfma_f32_16x16x32_bf16 a[112:115], a[76:79], a[36:39], a[112:115]
    v_mfma_f32_16x16x32_bf16 a[116:119], a[72:75], a[40:43], a[116:119]
    v_mfma_f32_16x16x32_bf16 a[116:119], a[76:79], a[44:47], a[116:119]
    v_mfma_f32_16x16x32_bf16 a[120:123], a[72:75], a[48:51], a[120:123]
    v_mfma_f32_16x16x32_bf16 a[120:123], a[76:79], a[52:55], a[120:123]
    s_xor_b32 s66, s66, 8192
    v_mfma_f32_16x16x32_bf16 a[124:127], a[72:75], a[56:59], a[124:127]
    buffer_load_dwordx4 v215, s[32:35], s64 offen offset:3072  lds
    s_add_u32 s64, s64, 128
    v_mfma_f32_16x16x32_bf16 a[124:127], a[76:79], a[60:63], a[124:127]
    s_waitcnt vmcnt(11) lgkmcnt(0)
    v_mfma_f32_16x16x32_bf16 a[128:131], a[80:83], a[32:35], a[128:131]
    s_barrier
    v_mfma_f32_16x16x32_bf16 a[128:131], a[84:87], a[36:39], a[128:131]
    ds_read_b64_tr_b16 a[64:65], v226 offset:0
    v_mfma_f32_16x16x32_bf16 a[132:135], a[80:83], a[40:43], a[132:135]
    ds_read_b64_tr_b16 a[66:67], v226 offset:1024
    v_mfma_f32_16x16x32_bf16 a[132:135], a[84:87], a[44:47], a[132:135]
    ds_read_b64_tr_b16 a[68:69], v226 offset:8192
    v_mfma_f32_16x16x32_bf16 a[136:139], a[80:83], a[48:51], a[136:139]
    ds_read_b64_tr_b16 a[70:71], v226 offset:9216
    v_mfma_f32_16x16x32_bf16 a[136:139], a[84:87], a[52:55], a[136:139]
    s_mov_b32 m0, s67
    v_mfma_f32_16x16x32_bf16 a[140:143], a[80:83], a[56:59], a[140:143]
    buffer_load_dwordx4 v216, s[36:39], s65 offen offset:0  lds
    v_mfma_f32_16x16x32_bf16 a[140:143], a[84:87], a[60:63], a[140:143]
    v_mfma_f32_16x16x32_bf16 a[144:147], a[88:91], a[32:35], a[144:147]
    v_mfma_f32_16x16x32_bf16 a[144:147], a[92:95], a[36:39], a[144:147]
    ds_read_b64_tr_b16 a[72:73], v226 offset:16384
    v_mfma_f32_16x16x32_bf16 a[148:151], a[88:91], a[40:43], a[148:151]
    ds_read_b64_tr_b16 a[74:75], v226 offset:17408
    v_mfma_f32_16x16x32_bf16 a[148:151], a[92:95], a[44:47], a[148:151]
    ds_read_b64_tr_b16 a[76:77], v226 offset:24576
    v_mfma_f32_16x16x32_bf16 a[152:155], a[88:91], a[48:51], a[152:155]
    ds_read_b64_tr_b16 a[78:79], v226 offset:25600
    v_mfma_f32_16x16x32_bf16 a[152:155], a[92:95], a[52:55], a[152:155]
    v_mfma_f32_16x16x32_bf16 a[156:159], a[88:91], a[56:59], a[156:159]
    buffer_load_dwordx4 v217, s[36:39], s65 offen offset:1024  lds
    v_mfma_f32_16x16x32_bf16 a[156:159], a[92:95], a[60:63], a[156:159]
    s_waitcnt lgkmcnt(4)
    v_mfma_f32_16x16x32_bf16 v[0:3], a[64:67], a[0:3], v[0:3]
    ds_read_b64_tr_b16 a[80:81], v227 offset:0
    v_mfma_f32_16x16x32_bf16 v[0:3], a[68:71], a[4:7], v[0:3]
    ds_read_b64_tr_b16 a[82:83], v227 offset:1024
    v_mfma_f32_16x16x32_bf16 v[4:7], a[64:67], a[8:11], v[4:7]
    ds_read_b64_tr_b16 a[84:85], v227 offset:8192
    v_mfma_f32_16x16x32_bf16 v[4:7], a[68:71], a[12:15], v[4:7]
    ds_read_b64_tr_b16 a[86:87], v227 offset:9216
    v_mfma_f32_16x16x32_bf16 v[8:11], a[64:67], a[16:19], v[8:11]
    v_mfma_f32_16x16x32_bf16 v[8:11], a[68:71], a[20:23], v[8:11]
    v_mfma_f32_16x16x32_bf16 v[12:15], a[64:67], a[24:27], v[12:15]
    buffer_load_dwordx4 v218, s[36:39], s65 offen offset:2048  lds
    v_mfma_f32_16x16x32_bf16 v[12:15], a[68:71], a[28:31], v[12:15]
    s_waitcnt lgkmcnt(4)
    v_mfma_f32_16x16x32_bf16 v[16:19], a[72:75], a[0:3], v[16:19]
    ds_read_b64_tr_b16 a[88:89], v227 offset:16384
    v_mfma_f32_16x16x32_bf16 v[16:19], a[76:79], a[4:7], v[16:19]
    ds_read_b64_tr_b16 a[90:91], v227 offset:17408
    v_mfma_f32_16x16x32_bf16 v[20:23], a[72:75], a[8:11], v[20:23]
    ds_read_b64_tr_b16 a[92:93], v227 offset:24576
    v_mfma_f32_16x16x32_bf16 v[20:23], a[76:79], a[12:15], v[20:23]
    ds_read_b64_tr_b16 a[94:95], v227 offset:25600
    v_mfma_f32_16x16x32_bf16 v[24:27], a[72:75], a[16:19], v[24:27]
    v_mfma_f32_16x16x32_bf16 v[24:27], a[76:79], a[20:23], v[24:27]
    v_mfma_f32_16x16x32_bf16 v[28:31], a[72:75], a[24:27], v[28:31]
    buffer_load_dwordx4 v219, s[36:39], s65 offen offset:3072  lds
    v_mfma_f32_16x16x32_bf16 v[28:31], a[76:79], a[28:31], v[28:31]
    s_waitcnt lgkmcnt(4)
    v_mfma_f32_16x16x32_bf16 v[32:35], a[80:83], a[0:3], v[32:35]
    ds_read_b64_tr_b16 a[64:65], v228 offset:0
    v_mfma_f32_16x16x32_bf16 v[32:35], a[84:87], a[4:7], v[32:35]
    ds_read_b64_tr_b16 a[66:67], v228 offset:1024
    v_mfma_f32_16x16x32_bf16 v[36:39], a[80:83], a[8:11], v[36:39]
    ds_read_b64_tr_b16 a[68:69], v228 offset:8192
    v_mfma_f32_16x16x32_bf16 v[36:39], a[84:87], a[12:15], v[36:39]
    ds_read_b64_tr_b16 a[70:71], v228 offset:9216
    v_mfma_f32_16x16x32_bf16 v[40:43], a[80:83], a[16:19], v[40:43]
    v_mfma_f32_16x16x32_bf16 v[40:43], a[84:87], a[20:23], v[40:43]
    s_add_u32 m0, s67, 4096
    v_mfma_f32_16x16x32_bf16 v[44:47], a[80:83], a[24:27], v[44:47]
    buffer_load_dwordx4 v220, s[36:39], s65 offen offset:0  lds
    v_mfma_f32_16x16x32_bf16 v[44:47], a[84:87], a[28:31], v[44:47]
    s_waitcnt lgkmcnt(4)
    v_mfma_f32_16x16x32_bf16 v[48:51], a[88:91], a[0:3], v[48:51]
    ds_read_b64_tr_b16 a[72:73], v228 offset:16384
    v_mfma_f32_16x16x32_bf16 v[48:51], a[92:95], a[4:7], v[48:51]
    ds_read_b64_tr_b16 a[74:75], v228 offset:17408
    v_mfma_f32_16x16x32_bf16 v[52:55], a[88:91], a[8:11], v[52:55]
    ds_read_b64_tr_b16 a[76:77], v228 offset:24576
    v_mfma_f32_16x16x32_bf16 v[52:55], a[92:95], a[12:15], v[52:55]
    ds_read_b64_tr_b16 a[78:79], v228 offset:25600
    v_mfma_f32_16x16x32_bf16 v[56:59], a[88:91], a[16:19], v[56:59]
    v_mfma_f32_16x16x32_bf16 v[56:59], a[92:95], a[20:23], v[56:59]
    v_mfma_f32_16x16x32_bf16 v[60:63], a[88:91], a[24:27], v[60:63]
    buffer_load_dwordx4 v221, s[36:39], s65 offen offset:1024  lds
    v_mfma_f32_16x16x32_bf16 v[60:63], a[92:95], a[28:31], v[60:63]
    s_waitcnt lgkmcnt(4)
    v_mfma_f32_16x16x32_bf16 v[64:67], a[64:67], a[0:3], v[64:67]
    ds_read_b64_tr_b16 a[80:81], v229 offset:0
    v_mfma_f32_16x16x32_bf16 v[64:67], a[68:71], a[4:7], v[64:67]
    ds_read_b64_tr_b16 a[82:83], v229 offset:1024
    v_mfma_f32_16x16x32_bf16 v[68:71], a[64:67], a[8:11], v[68:71]
    ds_read_b64_tr_b16 a[84:85], v229 offset:8192
    v_mfma_f32_16x16x32_bf16 v[68:71], a[68:71], a[12:15], v[68:71]
    ds_read_b64_tr_b16 a[86:87], v229 offset:9216
    v_mfma_f32_16x16x32_bf16 v[72:75], a[64:67], a[16:19], v[72:75]
    v_mfma_f32_16x16x32_bf16 v[72:75], a[68:71], a[20:23], v[72:75]
    v_mfma_f32_16x16x32_bf16 v[76:79], a[64:67], a[24:27], v[76:79]
    buffer_load_dwordx4 v222, s[36:39], s65 offen offset:2048  lds
    v_mfma_f32_16x16x32_bf16 v[76:79], a[68:71], a[28:31], v[76:79]
    s_waitcnt lgkmcnt(4)
    v_mfma_f32_16x16x32_bf16 v[80:83], a[72:75], a[0:3], v[80:83]
    ds_read_b64_tr_b16 a[88:89], v229 offset:16384
    v_mfma_f32_16x16x32_bf16 v[80:83], a[76:79], a[4:7], v[80:83]
    ds_read_b64_tr_b16 a[90:91], v229 offset:17408
    v_mfma_f32_16x16x32_bf16 v[84:87], a[72:75], a[8:11], v[84:87]
    ds_read_b64_tr_b16 a[92:93], v229 offset:24576
    v_mfma_f32_16x16x32_bf16 v[84:87], a[76:79], a[12:15], v[84:87]
    ds_read_b64_tr_b16 a[94:95], v229 offset:25600
    v_mfma_f32_16x16x32_bf16 v[88:91], a[72:75], a[16:19], v[88:91]
    v_mfma_f32_16x16x32_bf16 v[88:91], a[76:79], a[20:23], v[88:91]
    s_xor_b32 s67, s67, 32768
    v_mfma_f32_16x16x32_bf16 v[92:95], a[72:75], a[24:27], v[92:95]
    buffer_load_dwordx4 v223, s[36:39], s65 offen offset:3072  lds
    s_add_u32 s65, s65, 458752
    v_mfma_f32_16x16x32_bf16 v[92:95], a[76:79], a[28:31], v[92:95]
    s_waitcnt lgkmcnt(4)
    v_mfma_f32_16x16x32_bf16 v[96:99], a[80:83], a[0:3], v[96:99]
    ds_read_b64_tr_b16 a[64:65], v230 offset:0
    v_mfma_f32_16x16x32_bf16 v[96:99], a[84:87], a[4:7], v[96:99]
    ds_read_b64_tr_b16 a[66:67], v230 offset:1024
    v_mfma_f32_16x16x32_bf16 v[100:103], a[80:83], a[8:11], v[100:103]
    ds_read_b64_tr_b16 a[68:69], v230 offset:8192
    buffer_load_dword v236, v234, s[40:43], s68 offen
    s_add_u32 s68, s68, 458752
    buffer_load_dword v237, v207, s[32:35], s88 offen
    s_add_u32 s88, s88, 128
    v_mfma_f32_16x16x32_bf16 v[100:103], a[84:87], a[12:15], v[100:103]
    ds_read_b64_tr_b16 a[70:71], v230 offset:9216
    buffer_load_dword v238, v235, s[44:47], s69 offen
    s_add_u32 s69, s69, 512
    v_mfma_f32_16x16x32_bf16 v[104:107], a[80:83], a[16:19], v[104:107]
    v_mfma_f32_16x16x32_bf16 v[104:107], a[84:87], a[20:23], v[104:107]
    s_mov_b32 m0, s66
    v_mfma_f32_16x16x32_bf16 v[108:111], a[80:83], a[24:27], v[108:111]
    buffer_load_dwordx4 v208, s[32:35], s64 offen offset:0  lds
    v_mfma_f32_16x16x32_bf16 v[108:111], a[84:87], a[28:31], v[108:111]
    s_waitcnt lgkmcnt(4)
    v_mfma_f32_16x16x32_bf16 v[112:115], a[88:91], a[0:3], v[112:115]
    ds_read_b64_tr_b16 a[72:73], v230 offset:16384
    v_mfma_f32_16x16x32_bf16 v[112:115], a[92:95], a[4:7], v[112:115]
    ds_read_b64_tr_b16 a[74:75], v230 offset:17408
    v_mfma_f32_16x16x32_bf16 v[116:119], a[88:91], a[8:11], v[116:119]
    ds_read_b64_tr_b16 a[76:77], v230 offset:24576
    v_mfma_f32_16x16x32_bf16 v[116:119], a[92:95], a[12:15], v[116:119]
    ds_read_b64_tr_b16 a[78:79], v230 offset:25600
    v_mfma_f32_16x16x32_bf16 v[120:123], a[88:91], a[16:19], v[120:123]
    v_mfma_f32_16x16x32_bf16 v[120:123], a[92:95], a[20:23], v[120:123]
    v_mfma_f32_16x16x32_bf16 v[124:127], a[88:91], a[24:27], v[124:127]
    buffer_load_dwordx4 v209, s[32:35], s64 offen offset:1024  lds
    v_mfma_f32_16x16x32_bf16 v[124:127], a[92:95], a[28:31], v[124:127]
    s_waitcnt lgkmcnt(4)
    v_mfma_f32_16x16x32_bf16 v[128:131], a[64:67], a[0:3], v[128:131]
    ds_read_b64_tr_b16 a[80:81], v231 offset:0
    v_mfma_f32_16x16x32_bf16 v[128:131], a[68:71], a[4:7], v[128:131]
    ds_read_b64_tr_b16 a[82:83], v231 offset:1024
    v_mfma_f32_16x16x32_bf16 v[132:135], a[64:67], a[8:11], v[132:135]
    ds_read_b64_tr_b16 a[84:85], v231 offset:8192
    v_mfma_f32_16x16x32_bf16 v[132:135], a[68:71], a[12:15], v[132:135]
    ds_read_b64_tr_b16 a[86:87], v231 offset:9216
    s_waitcnt vmcnt(13)
    v_mfma_f32_16x16x32_bf16 v[136:139], a[64:67], a[16:19], v[136:139]
    ds_read_b128 a[32:35], v224 offset:8192
    v_mfma_f32_16x16x32_bf16 v[136:139], a[68:71], a[20:23], v[136:139]
    ds_read_b128 a[36:39], v225 offset:8192
    v_mfma_f32_16x16x32_bf16 v[140:143], a[64:67], a[24:27], v[140:143]
    buffer_load_dwordx4 v210, s[32:35], s64 offen offset:2048  lds
    v_mfma_f32_16x16x32_bf16 v[140:143], a[68:71], a[28:31], v[140:143]
    s_waitcnt lgkmcnt(6)
    v_mfma_f32_16x16x32_bf16 v[144:147], a[72:75], a[0:3], v[144:147]
    ds_read_b64_tr_b16 a[88:89], v231 offset:16384
    v_mfma_f32_16x16x32_bf16 v[144:147], a[76:79], a[4:7], v[144:147]
    ds_read_b64_tr_b16 a[90:91], v231 offset:17408
    v_mfma_f32_16x16x32_bf16 v[148:151], a[72:75], a[8:11], v[148:151]
    ds_read_b64_tr_b16 a[92:93], v231 offset:24576
    v_mfma_f32_16x16x32_bf16 v[148:151], a[76:79], a[12:15], v[148:151]
    ds_read_b64_tr_b16 a[94:95], v231 offset:25600
    v_mfma_f32_16x16x32_bf16 v[152:155], a[72:75], a[16:19], v[152:155]
    ds_read_b128 a[40:43], v224 offset:10240
    v_mfma_f32_16x16x32_bf16 v[152:155], a[76:79], a[20:23], v[152:155]
    ds_read_b128 a[44:47], v225 offset:10240
    v_mfma_f32_16x16x32_bf16 v[156:159], a[72:75], a[24:27], v[156:159]
    buffer_load_dwordx4 v211, s[32:35], s64 offen offset:3072  lds
    v_mfma_f32_16x16x32_bf16 v[156:159], a[76:79], a[28:31], v[156:159]
    s_waitcnt lgkmcnt(8)
    v_mfma_f32_16x16x32_bf16 v[160:163], a[80:83], a[0:3], v[160:163]
    ds_read_b64_tr_b16 a[64:65], v232 offset:0
    v_mfma_f32_16x16x32_bf16 v[160:163], a[84:87], a[4:7], v[160:163]
    ds_read_b64_tr_b16 a[66:67], v232 offset:1024
    v_mfma_f32_16x16x32_bf16 v[164:167], a[80:83], a[8:11], v[164:167]
    ds_read_b64_tr_b16 a[68:69], v232 offset:8192
    v_mfma_f32_16x16x32_bf16 v[164:167], a[84:87], a[12:15], v[164:167]
    ds_read_b64_tr_b16 a[70:71], v232 offset:9216
    v_mfma_f32_16x16x32_bf16 v[168:171], a[80:83], a[16:19], v[168:171]
    ds_read_b128 a[48:51], v224 offset:12288
    v_mfma_f32_16x16x32_bf16 v[168:171], a[84:87], a[20:23], v[168:171]
    ds_read_b128 a[52:55], v225 offset:12288
    s_add_u32 m0, s66, 4096
    v_mfma_f32_16x16x32_bf16 v[172:175], a[80:83], a[24:27], v[172:175]
    buffer_load_dwordx4 v212, s[32:35], s64 offen offset:0  lds
    v_mfma_f32_16x16x32_bf16 v[172:175], a[84:87], a[28:31], v[172:175]
    s_waitcnt lgkmcnt(8)
    v_mfma_f32_16x16x32_bf16 v[176:179], a[88:91], a[0:3], v[176:179]
    ds_read_b64_tr_b16 a[72:73], v232 offset:16384
    v_mfma_f32_16x16x32_bf16 v[176:179], a[92:95], a[4:7], v[176:179]
    ds_read_b64_tr_b16 a[74:75], v232 offset:17408
    v_mfma_f32_16x16x32_bf16 v[180:183], a[88:91], a[8:11], v[180:183]
    ds_read_b64_tr_b16 a[76:77], v232 offset:24576
    v_mfma_f32_16x16x32_bf16 v[180:183], a[92:95], a[12:15], v[180:183]
    ds_read_b64_tr_b16 a[78:79], v232 offset:25600
    v_mfma_f32_16x16x32_bf16 v[184:187], a[88:91], a[16:19], v[184:187]
    ds_read_b128 a[56:59], v224 offset:14336
    v_mfma_f32_16x16x32_bf16 v[184:187], a[92:95], a[20:23], v[184:187]
    ds_read_b128 a[60:63], v225 offset:14336
    v_mfma_f32_16x16x32_bf16 v[188:191], a[88:91], a[24:27], v[188:191]
    buffer_load_dwordx4 v213, s[32:35], s64 offen offset:1024  lds
    s_add_u32 s91, s77, 0
    s_add_u32 m0, s79, 32768
    v_mfma_f32_16x16x32_bf16 v[188:191], a[92:95], a[28:31], v[188:191]
    s_waitcnt lgkmcnt(8)
    buffer_load_dwordx4 v246, s[44:47], s91 offen offset:0 lds
    v_mfma_f32_16x16x32_bf16 a[96:99], a[64:67], a[0:3], a[96:99]
    ds_read_b64_tr_b16 a[80:81], v233 offset:0
    v_mfma_f32_16x16x32_bf16 a[96:99], a[68:71], a[4:7], a[96:99]
    ds_read_b64_tr_b16 a[82:83], v233 offset:1024
    buffer_load_dwordx4 v247, s[44:47], s91 offen offset:1024 lds
    v_mfma_f32_16x16x32_bf16 a[100:103], a[64:67], a[8:11], a[100:103]
    ds_read_b64_tr_b16 a[84:85], v233 offset:8192
    v_mfma_f32_16x16x32_bf16 a[100:103], a[68:71], a[12:15], a[100:103]
    ds_read_b64_tr_b16 a[86:87], v233 offset:9216
    v_mfma_f32_16x16x32_bf16 a[104:107], a[64:67], a[16:19], a[104:107]
    ds_read_b64_tr_b16 a[88:89], v233 offset:16384
    v_mfma_f32_16x16x32_bf16 a[104:107], a[68:71], a[20:23], a[104:107]
    ds_read_b64_tr_b16 a[90:91], v233 offset:17408
    s_add_u32 m0, s66, 4096
    v_mfma_f32_16x16x32_bf16 a[108:111], a[64:67], a[24:27], a[108:111]
    ds_read_b64_tr_b16 a[92:93], v233 offset:24576
    buffer_load_dwordx4 v214, s[32:35], s64 offen offset:2048  lds
    v_mfma_f32_16x16x32_bf16 a[108:111], a[68:71], a[28:31], a[108:111]
    ds_read_b64_tr_b16 a[94:95], v233 offset:25600
    s_waitcnt lgkmcnt(10)
    v_mfma_f32_16x16x32_bf16 a[112:115], a[72:75], a[0:3], a[112:115]
    v_mfma_f32_16x16x32_bf16 a[112:115], a[76:79], a[4:7], a[112:115]
    v_mfma_f32_16x16x32_bf16 a[116:119], a[72:75], a[8:11], a[116:119]
    s_add_u32 m0, s79, 32768
    v_mfma_f32_16x16x32_bf16 a[116:119], a[76:79], a[12:15], a[116:119]
    buffer_load_dwordx4 v248, s[44:47], s91 offen offset:2048 lds
    v_mfma_f32_16x16x32_bf16 a[120:123], a[72:75], a[16:19], a[120:123]
    v_mfma_f32_16x16x32_bf16 a[120:123], a[76:79], a[20:23], a[120:123]
    s_add_u32 m0, s66, 4096
    s_xor_b32 s66, s66, 8192
    v_mfma_f32_16x16x32_bf16 a[124:127], a[72:75], a[24:27], a[124:127]
    buffer_load_dwordx4 v215, s[32:35], s64 offen offset:3072  lds
    s_add_u32 s64, s64, 128
    v_mfma_f32_16x16x32_bf16 a[124:127], a[76:79], a[28:31], a[124:127]
    s_waitcnt vmcnt(14) lgkmcnt(0)
    v_mfma_f32_16x16x32_bf16 a[128:131], a[80:83], a[0:3], a[128:131]
    s_barrier
    v_mfma_f32_16x16x32_bf16 a[128:131], a[84:87], a[4:7], a[128:131]
    ds_read_b64_tr_b16 a[64:65], v226 offset:32768
    v_mfma_f32_16x16x32_bf16 a[132:135], a[80:83], a[8:11], a[132:135]
    ds_read_b64_tr_b16 a[66:67], v226 offset:33792
    v_mfma_f32_16x16x32_bf16 a[132:135], a[84:87], a[12:15], a[132:135]
    ds_read_b64_tr_b16 a[68:69], v226 offset:40960
    s_add_u32 m0, s79, 32768
    v_mfma_f32_16x16x32_bf16 a[136:139], a[80:83], a[16:19], a[136:139]
    ds_read_b64_tr_b16 a[70:71], v226 offset:41984
    buffer_load_dwordx4 v249, s[44:47], s91 offen offset:3072 lds
    v_mfma_f32_16x16x32_bf16 a[136:139], a[84:87], a[20:23], a[136:139]
    s_mov_b32 m0, s67
    v_mfma_f32_16x16x32_bf16 a[140:143], a[80:83], a[24:27], a[140:143]
    buffer_load_dwordx4 v216, s[36:39], s65 offen offset:0  lds
    v_mfma_f32_16x16x32_bf16 a[140:143], a[84:87], a[28:31], a[140:143]
    v_mfma_f32_16x16x32_bf16 a[144:147], a[88:91], a[0:3], a[144:147]
    v_mfma_f32_16x16x32_bf16 a[144:147], a[92:95], a[4:7], a[144:147]
    ds_read_b64_tr_b16 a[72:73], v226 offset:49152
    v_mfma_f32_16x16x32_bf16 a[148:151], a[88:91], a[8:11], a[148:151]
    ds_read_b64_tr_b16 a[74:75], v226 offset:50176
    v_mfma_f32_16x16x32_bf16 a[148:151], a[92:95], a[12:15], a[148:151]
    ds_read_b64_tr_b16 a[76:77], v226 offset:57344
    v_mfma_f32_16x16x32_bf16 a[152:155], a[88:91], a[16:19], a[152:155]
    ds_read_b64_tr_b16 a[78:79], v226 offset:58368
    v_mfma_f32_16x16x32_bf16 a[152:155], a[92:95], a[20:23], a[152:155]
    v_mfma_f32_16x16x32_bf16 a[156:159], a[88:91], a[24:27], a[156:159]
    buffer_load_dwordx4 v217, s[36:39], s65 offen offset:1024  lds
    v_mfma_f32_16x16x32_bf16 a[156:159], a[92:95], a[28:31], a[156:159]
    s_waitcnt lgkmcnt(4)
    v_mfma_f32_16x16x32_bf16 v[0:3], a[64:67], a[32:35], v[0:3]
    ds_read_b64_tr_b16 a[80:81], v227 offset:32768
    v_mfma_f32_16x16x32_bf16 v[0:3], a[68:71], a[36:39], v[0:3]
    ds_read_b64_tr_b16 a[82:83], v227 offset:33792
    v_mfma_f32_16x16x32_bf16 v[4:7], a[64:67], a[40:43], v[4:7]
    ds_read_b64_tr_b16 a[84:85], v227 offset:40960
    v_mfma_f32_16x16x32_bf16 v[4:7], a[68:71], a[44:47], v[4:7]
    ds_read_b64_tr_b16 a[86:87], v227 offset:41984
    v_mfma_f32_16x16x32_bf16 v[8:11], a[64:67], a[48:51], v[8:11]
    v_mfma_f32_16x16x32_bf16 v[8:11], a[68:71], a[52:55], v[8:11]
    v_mfma_f32_16x16x32_bf16 v[12:15], a[64:67], a[56:59], v[12:15]
    buffer_load_dwordx4 v218, s[36:39], s65 offen offset:2048  lds
    v_mfma_f32_16x16x32_bf16 v[12:15], a[68:71], a[60:63], v[12:15]
    s_waitcnt lgkmcnt(4)
    v_mfma_f32_16x16x32_bf16 v[16:19], a[72:75], a[32:35], v[16:19]
    ds_read_b64_tr_b16 a[88:89], v227 offset:49152
    v_mfma_f32_16x16x32_bf16 v[16:19], a[76:79], a[36:39], v[16:19]
    ds_read_b64_tr_b16 a[90:91], v227 offset:50176
    v_mfma_f32_16x16x32_bf16 v[20:23], a[72:75], a[40:43], v[20:23]
    ds_read_b64_tr_b16 a[92:93], v227 offset:57344
    v_mfma_f32_16x16x32_bf16 v[20:23], a[76:79], a[44:47], v[20:23]
    ds_read_b64_tr_b16 a[94:95], v227 offset:58368
    v_mfma_f32_16x16x32_bf16 v[24:27], a[72:75], a[48:51], v[24:27]
    v_mfma_f32_16x16x32_bf16 v[24:27], a[76:79], a[52:55], v[24:27]
    v_mfma_f32_16x16x32_bf16 v[28:31], a[72:75], a[56:59], v[28:31]
    buffer_load_dwordx4 v219, s[36:39], s65 offen offset:3072  lds
    v_mfma_f32_16x16x32_bf16 v[28:31], a[76:79], a[60:63], v[28:31]
    s_waitcnt lgkmcnt(4)
    v_mfma_f32_16x16x32_bf16 v[32:35], a[80:83], a[32:35], v[32:35]
    ds_read_b64_tr_b16 a[64:65], v228 offset:32768
    v_mfma_f32_16x16x32_bf16 v[32:35], a[84:87], a[36:39], v[32:35]
    ds_read_b64_tr_b16 a[66:67], v228 offset:33792
    v_mfma_f32_16x16x32_bf16 v[36:39], a[80:83], a[40:43], v[36:39]
    ds_read_b64_tr_b16 a[68:69], v228 offset:40960
    v_mfma_f32_16x16x32_bf16 v[36:39], a[84:87], a[44:47], v[36:39]
    ds_read_b64_tr_b16 a[70:71], v228 offset:41984
    v_mfma_f32_16x16x32_bf16 v[40:43], a[80:83], a[48:51], v[40:43]
    v_mfma_f32_16x16x32_bf16 v[40:43], a[84:87], a[52:55], v[40:43]
    s_add_u32 m0, s67, 4096
    v_mfma_f32_16x16x32_bf16 v[44:47], a[80:83], a[56:59], v[44:47]
    buffer_load_dwordx4 v220, s[36:39], s65 offen offset:0  lds
    v_mfma_f32_16x16x32_bf16 v[44:47], a[84:87], a[60:63], v[44:47]
    s_waitcnt lgkmcnt(4)
    v_mfma_f32_16x16x32_bf16 v[48:51], a[88:91], a[32:35], v[48:51]
    ds_read_b64_tr_b16 a[72:73], v228 offset:49152
    v_mfma_f32_16x16x32_bf16 v[48:51], a[92:95], a[36:39], v[48:51]
    ds_read_b64_tr_b16 a[74:75], v228 offset:50176
    v_mfma_f32_16x16x32_bf16 v[52:55], a[88:91], a[40:43], v[52:55]
    ds_read_b64_tr_b16 a[76:77], v228 offset:57344
    v_mfma_f32_16x16x32_bf16 v[52:55], a[92:95], a[44:47], v[52:55]
    ds_read_b64_tr_b16 a[78:79], v228 offset:58368
    v_mfma_f32_16x16x32_bf16 v[56:59], a[88:91], a[48:51], v[56:59]
    v_mfma_f32_16x16x32_bf16 v[56:59], a[92:95], a[52:55], v[56:59]
    v_mfma_f32_16x16x32_bf16 v[60:63], a[88:91], a[56:59], v[60:63]
    buffer_load_dwordx4 v221, s[36:39], s65 offen offset:1024  lds
    v_mfma_f32_16x16x32_bf16 v[60:63], a[92:95], a[60:63], v[60:63]
    s_waitcnt lgkmcnt(4)
    v_mfma_f32_16x16x32_bf16 v[64:67], a[64:67], a[32:35], v[64:67]
    ds_read_b64_tr_b16 a[80:81], v229 offset:32768
    v_mfma_f32_16x16x32_bf16 v[64:67], a[68:71], a[36:39], v[64:67]
    ds_read_b64_tr_b16 a[82:83], v229 offset:33792
    v_mfma_f32_16x16x32_bf16 v[68:71], a[64:67], a[40:43], v[68:71]
    ds_read_b64_tr_b16 a[84:85], v229 offset:40960
    v_mfma_f32_16x16x32_bf16 v[68:71], a[68:71], a[44:47], v[68:71]
    ds_read_b64_tr_b16 a[86:87], v229 offset:41984
    v_mfma_f32_16x16x32_bf16 v[72:75], a[64:67], a[48:51], v[72:75]
    v_mfma_f32_16x16x32_bf16 v[72:75], a[68:71], a[52:55], v[72:75]
    v_mfma_f32_16x16x32_bf16 v[76:79], a[64:67], a[56:59], v[76:79]
    buffer_load_dwordx4 v222, s[36:39], s65 offen offset:2048  lds
    v_mfma_f32_16x16x32_bf16 v[76:79], a[68:71], a[60:63], v[76:79]
    s_waitcnt lgkmcnt(4)
    v_mfma_f32_16x16x32_bf16 v[80:83], a[72:75], a[32:35], v[80:83]
    ds_read_b64_tr_b16 a[88:89], v229 offset:49152
    v_mfma_f32_16x16x32_bf16 v[80:83], a[76:79], a[36:39], v[80:83]
    ds_read_b64_tr_b16 a[90:91], v229 offset:50176
    v_mfma_f32_16x16x32_bf16 v[84:87], a[72:75], a[40:43], v[84:87]
    ds_read_b64_tr_b16 a[92:93], v229 offset:57344
    v_mfma_f32_16x16x32_bf16 v[84:87], a[76:79], a[44:47], v[84:87]
    ds_read_b64_tr_b16 a[94:95], v229 offset:58368
    v_mfma_f32_16x16x32_bf16 v[88:91], a[72:75], a[48:51], v[88:91]
    v_mfma_f32_16x16x32_bf16 v[88:91], a[76:79], a[52:55], v[88:91]
    s_xor_b32 s67, s67, 32768
    v_mfma_f32_16x16x32_bf16 v[92:95], a[72:75], a[56:59], v[92:95]
    buffer_load_dwordx4 v223, s[36:39], s65 offen offset:3072  lds
    s_add_u32 s65, s65, 458752
    v_mfma_f32_16x16x32_bf16 v[92:95], a[76:79], a[60:63], v[92:95]
    s_waitcnt lgkmcnt(4)
    v_mfma_f32_16x16x32_bf16 v[96:99], a[80:83], a[32:35], v[96:99]
    ds_read_b64_tr_b16 a[64:65], v230 offset:32768
    v_mfma_f32_16x16x32_bf16 v[96:99], a[84:87], a[36:39], v[96:99]
    ds_read_b64_tr_b16 a[66:67], v230 offset:33792
    v_mfma_f32_16x16x32_bf16 v[100:103], a[80:83], a[40:43], v[100:103]
    ds_read_b64_tr_b16 a[68:69], v230 offset:40960
    buffer_load_dword v239, v234, s[40:43], s68 offen
    s_add_u32 s68, s68, 458752
    buffer_load_dword v240, v207, s[32:35], s88 offen
    s_add_u32 s88, s88, 128
    v_mfma_f32_16x16x32_bf16 v[100:103], a[84:87], a[44:47], v[100:103]
    ds_read_b64_tr_b16 a[70:71], v230 offset:41984
    buffer_load_dword v241, v235, s[44:47], s69 offen
    s_add_u32 s69, s69, 457216
    v_mfma_f32_16x16x32_bf16 v[104:107], a[80:83], a[48:51], v[104:107]
    v_mfma_f32_16x16x32_bf16 v[104:107], a[84:87], a[52:55], v[104:107]
    s_mov_b32 m0, s66
    v_mfma_f32_16x16x32_bf16 v[108:111], a[80:83], a[56:59], v[108:111]
    buffer_load_dwordx4 v208, s[32:35], s64 offen offset:0  lds
    v_mfma_f32_16x16x32_bf16 v[108:111], a[84:87], a[60:63], v[108:111]
    s_waitcnt lgkmcnt(4)
    v_mfma_f32_16x16x32_bf16 v[112:115], a[88:91], a[32:35], v[112:115]
    ds_read_b64_tr_b16 a[72:73], v230 offset:49152
    v_mfma_f32_16x16x32_bf16 v[112:115], a[92:95], a[36:39], v[112:115]
    ds_read_b64_tr_b16 a[74:75], v230 offset:50176
    v_mfma_f32_16x16x32_bf16 v[116:119], a[88:91], a[40:43], v[116:119]
    ds_read_b64_tr_b16 a[76:77], v230 offset:57344
    v_mfma_f32_16x16x32_bf16 v[116:119], a[92:95], a[44:47], v[116:119]
    ds_read_b64_tr_b16 a[78:79], v230 offset:58368
    v_mfma_f32_16x16x32_bf16 v[120:123], a[88:91], a[48:51], v[120:123]
    v_mfma_f32_16x16x32_bf16 v[120:123], a[92:95], a[52:55], v[120:123]
    v_mfma_f32_16x16x32_bf16 v[124:127], a[88:91], a[56:59], v[124:127]
    buffer_load_dwordx4 v209, s[32:35], s64 offen offset:1024  lds
    v_mfma_f32_16x16x32_bf16 v[124:127], a[92:95], a[60:63], v[124:127]
    s_waitcnt lgkmcnt(4)
    v_mfma_f32_16x16x32_bf16 v[128:131], a[64:67], a[32:35], v[128:131]
    ds_read_b64_tr_b16 a[80:81], v231 offset:32768
    v_mfma_f32_16x16x32_bf16 v[128:131], a[68:71], a[36:39], v[128:131]
    ds_read_b64_tr_b16 a[82:83], v231 offset:33792
    v_mfma_f32_16x16x32_bf16 v[132:135], a[64:67], a[40:43], v[132:135]
    ds_read_b64_tr_b16 a[84:85], v231 offset:40960
    v_mfma_f32_16x16x32_bf16 v[132:135], a[68:71], a[44:47], v[132:135]
    ds_read_b64_tr_b16 a[86:87], v231 offset:41984
    s_waitcnt vmcnt(14)
    v_mfma_f32_16x16x32_bf16 v[136:139], a[64:67], a[48:51], v[136:139]
    ds_read_b128 a[0:3], v224 offset:0
    v_mfma_f32_16x16x32_bf16 v[136:139], a[68:71], a[52:55], v[136:139]
    ds_read_b128 a[4:7], v225 offset:0
    v_mfma_f32_16x16x32_bf16 v[140:143], a[64:67], a[56:59], v[140:143]
    buffer_load_dwordx4 v210, s[32:35], s64 offen offset:2048  lds
    v_mfma_f32_16x16x32_bf16 v[140:143], a[68:71], a[60:63], v[140:143]
    s_waitcnt lgkmcnt(6)
    v_mfma_f32_16x16x32_bf16 v[144:147], a[72:75], a[32:35], v[144:147]
    ds_read_b64_tr_b16 a[88:89], v231 offset:49152
    v_mfma_f32_16x16x32_bf16 v[144:147], a[76:79], a[36:39], v[144:147]
    ds_read_b64_tr_b16 a[90:91], v231 offset:50176
    v_mfma_f32_16x16x32_bf16 v[148:151], a[72:75], a[40:43], v[148:151]
    ds_read_b64_tr_b16 a[92:93], v231 offset:57344
    v_mfma_f32_16x16x32_bf16 v[148:151], a[76:79], a[44:47], v[148:151]
    ds_read_b64_tr_b16 a[94:95], v231 offset:58368
    v_mfma_f32_16x16x32_bf16 v[152:155], a[72:75], a[48:51], v[152:155]
    ds_read_b128 a[8:11], v224 offset:2048
    v_mfma_f32_16x16x32_bf16 v[152:155], a[76:79], a[52:55], v[152:155]
    ds_read_b128 a[12:15], v225 offset:2048
    v_mfma_f32_16x16x32_bf16 v[156:159], a[72:75], a[56:59], v[156:159]
    buffer_load_dwordx4 v211, s[32:35], s64 offen offset:3072  lds
    v_mfma_f32_16x16x32_bf16 v[156:159], a[76:79], a[60:63], v[156:159]
    s_waitcnt lgkmcnt(8)
    v_mfma_f32_16x16x32_bf16 v[160:163], a[80:83], a[32:35], v[160:163]
    ds_read_b64_tr_b16 a[64:65], v232 offset:32768
    v_mfma_f32_16x16x32_bf16 v[160:163], a[84:87], a[36:39], v[160:163]
    ds_read_b64_tr_b16 a[66:67], v232 offset:33792
    v_mfma_f32_16x16x32_bf16 v[164:167], a[80:83], a[40:43], v[164:167]
    ds_read_b64_tr_b16 a[68:69], v232 offset:40960
    v_mfma_f32_16x16x32_bf16 v[164:167], a[84:87], a[44:47], v[164:167]
    ds_read_b64_tr_b16 a[70:71], v232 offset:41984
    v_mfma_f32_16x16x32_bf16 v[168:171], a[80:83], a[48:51], v[168:171]
    ds_read_b128 a[16:19], v224 offset:4096
    v_mfma_f32_16x16x32_bf16 v[168:171], a[84:87], a[52:55], v[168:171]
    ds_read_b128 a[20:23], v225 offset:4096
    s_add_u32 m0, s66, 4096
    v_mfma_f32_16x16x32_bf16 v[172:175], a[80:83], a[56:59], v[172:175]
    buffer_load_dwordx4 v212, s[32:35], s64 offen offset:0  lds
    v_mfma_f32_16x16x32_bf16 v[172:175], a[84:87], a[60:63], v[172:175]
    s_waitcnt lgkmcnt(8)
    v_mfma_f32_16x16x32_bf16 v[176:179], a[88:91], a[32:35], v[176:179]
    ds_read_b64_tr_b16 a[72:73], v232 offset:49152
    v_mfma_f32_16x16x32_bf16 v[176:179], a[92:95], a[36:39], v[176:179]
    ds_read_b64_tr_b16 a[74:75], v232 offset:50176
    v_mfma_f32_16x16x32_bf16 v[180:183], a[88:91], a[40:43], v[180:183]
    ds_read_b64_tr_b16 a[76:77], v232 offset:57344
    v_mfma_f32_16x16x32_bf16 v[180:183], a[92:95], a[44:47], v[180:183]
    ds_read_b64_tr_b16 a[78:79], v232 offset:58368
    v_mfma_f32_16x16x32_bf16 v[184:187], a[88:91], a[48:51], v[184:187]
    ds_read_b128 a[24:27], v224 offset:6144
    v_mfma_f32_16x16x32_bf16 v[184:187], a[92:95], a[52:55], v[184:187]
    ds_read_b128 a[28:31], v225 offset:6144
    v_mfma_f32_16x16x32_bf16 v[188:191], a[88:91], a[56:59], v[188:191]
    buffer_load_dwordx4 v213, s[32:35], s64 offen offset:1024  lds
    s_add_u32 s78, s77, 65536
    s_add_u32 m0, s79, 36864
    v_mfma_f32_16x16x32_bf16 v[188:191], a[92:95], a[60:63], v[188:191]
    s_waitcnt lgkmcnt(8)
    buffer_load_dwordx4 v246, s[44:47], s78 offen offset:0 lds
    v_mfma_f32_16x16x32_bf16 a[96:99], a[64:67], a[32:35], a[96:99]
    ds_read_b64_tr_b16 a[80:81], v233 offset:32768
    v_mfma_f32_16x16x32_bf16 a[96:99], a[68:71], a[36:39], a[96:99]
    ds_read_b64_tr_b16 a[82:83], v233 offset:33792
    buffer_load_dwordx4 v247, s[44:47], s78 offen offset:1024 lds
    v_mfma_f32_16x16x32_bf16 a[100:103], a[64:67], a[40:43], a[100:103]
    ds_read_b64_tr_b16 a[84:85], v233 offset:40960
    v_mfma_f32_16x16x32_bf16 a[100:103], a[68:71], a[44:47], a[100:103]
    ds_read_b64_tr_b16 a[86:87], v233 offset:41984
    v_mfma_f32_16x16x32_bf16 a[104:107], a[64:67], a[48:51], a[104:107]
    ds_read_b64_tr_b16 a[88:89], v233 offset:49152
    v_mfma_f32_16x16x32_bf16 a[104:107], a[68:71], a[52:55], a[104:107]
    ds_read_b64_tr_b16 a[90:91], v233 offset:50176
    s_add_u32 m0, s66, 4096
    v_mfma_f32_16x16x32_bf16 a[108:111], a[64:67], a[56:59], a[108:111]
    ds_read_b64_tr_b16 a[92:93], v233 offset:57344
    buffer_load_dwordx4 v214, s[32:35], s64 offen offset:2048  lds
    v_mfma_f32_16x16x32_bf16 a[108:111], a[68:71], a[60:63], a[108:111]
    ds_read_b64_tr_b16 a[94:95], v233 offset:58368
    s_waitcnt lgkmcnt(10)
    v_mfma_f32_16x16x32_bf16 a[112:115], a[72:75], a[32:35], a[112:115]
    v_mfma_f32_16x16x32_bf16 a[112:115], a[76:79], a[36:39], a[112:115]
    v_mfma_f32_16x16x32_bf16 a[116:119], a[72:75], a[40:43], a[116:119]
    s_add_u32 m0, s79, 36864
    v_mfma_f32_16x16x32_bf16 a[116:119], a[76:79], a[44:47], a[116:119]
    buffer_load_dwordx4 v248, s[44:47], s78 offen offset:2048 lds
    v_mfma_f32_16x16x32_bf16 a[120:123], a[72:75], a[48:51], a[120:123]
    v_mfma_f32_16x16x32_bf16 a[120:123], a[76:79], a[52:55], a[120:123]
    s_add_u32 m0, s66, 4096
    s_xor_b32 s66, s66, 8192
    v_mfma_f32_16x16x32_bf16 a[124:127], a[72:75], a[56:59], a[124:127]
    buffer_load_dwordx4 v215, s[32:35], s64 offen offset:3072  lds
    s_add_u32 s64, s64, 128
    v_mfma_f32_16x16x32_bf16 a[124:127], a[76:79], a[60:63], a[124:127]
    s_waitcnt vmcnt(14) lgkmcnt(0)
    v_mfma_f32_16x16x32_bf16 a[128:131], a[80:83], a[32:35], a[128:131]
    s_barrier
    v_mfma_f32_16x16x32_bf16 a[128:131], a[84:87], a[36:39], a[128:131]
    ds_read_b64_tr_b16 a[64:65], v226 offset:0
    v_mfma_f32_16x16x32_bf16 a[132:135], a[80:83], a[40:43], a[132:135]
    ds_read_b64_tr_b16 a[66:67], v226 offset:1024
    v_mfma_f32_16x16x32_bf16 a[132:135], a[84:87], a[44:47], a[132:135]
    ds_read_b64_tr_b16 a[68:69], v226 offset:8192
    s_add_u32 m0, s79, 36864
    v_mfma_f32_16x16x32_bf16 a[136:139], a[80:83], a[48:51], a[136:139]
    ds_read_b64_tr_b16 a[70:71], v226 offset:9216
    buffer_load_dwordx4 v249, s[44:47], s78 offen offset:3072 lds
    v_mfma_f32_16x16x32_bf16 a[136:139], a[84:87], a[52:55], a[136:139]
    s_mov_b32 m0, s67
    v_mfma_f32_16x16x32_bf16 a[140:143], a[80:83], a[56:59], a[140:143]
    buffer_load_dwordx4 v216, s[36:39], s65 offen offset:0  lds
    v_mfma_f32_16x16x32_bf16 a[140:143], a[84:87], a[60:63], a[140:143]
    v_mfma_f32_16x16x32_bf16 a[144:147], a[88:91], a[32:35], a[144:147]
    v_mfma_f32_16x16x32_bf16 a[144:147], a[92:95], a[36:39], a[144:147]
    ds_read_b64_tr_b16 a[72:73], v226 offset:16384
    v_mfma_f32_16x16x32_bf16 a[148:151], a[88:91], a[40:43], a[148:151]
    ds_read_b64_tr_b16 a[74:75], v226 offset:17408
    v_mfma_f32_16x16x32_bf16 a[148:151], a[92:95], a[44:47], a[148:151]
    ds_read_b64_tr_b16 a[76:77], v226 offset:24576
    v_mfma_f32_16x16x32_bf16 a[152:155], a[88:91], a[48:51], a[152:155]
    ds_read_b64_tr_b16 a[78:79], v226 offset:25600
    v_mfma_f32_16x16x32_bf16 a[152:155], a[92:95], a[52:55], a[152:155]
    v_mfma_f32_16x16x32_bf16 a[156:159], a[88:91], a[56:59], a[156:159]
    buffer_load_dwordx4 v217, s[36:39], s65 offen offset:1024  lds
    v_mfma_f32_16x16x32_bf16 a[156:159], a[92:95], a[60:63], a[156:159]
    s_waitcnt lgkmcnt(4)
    v_mfma_f32_16x16x32_bf16 v[0:3], a[64:67], a[0:3], v[0:3]
    ds_read_b64_tr_b16 a[80:81], v227 offset:0
    v_mfma_f32_16x16x32_bf16 v[0:3], a[68:71], a[4:7], v[0:3]
    ds_read_b64_tr_b16 a[82:83], v227 offset:1024
    v_mfma_f32_16x16x32_bf16 v[4:7], a[64:67], a[8:11], v[4:7]
    ds_read_b64_tr_b16 a[84:85], v227 offset:8192
    v_mfma_f32_16x16x32_bf16 v[4:7], a[68:71], a[12:15], v[4:7]
    ds_read_b64_tr_b16 a[86:87], v227 offset:9216
    v_mfma_f32_16x16x32_bf16 v[8:11], a[64:67], a[16:19], v[8:11]
    v_mfma_f32_16x16x32_bf16 v[8:11], a[68:71], a[20:23], v[8:11]
    v_mfma_f32_16x16x32_bf16 v[12:15], a[64:67], a[24:27], v[12:15]
    buffer_load_dwordx4 v218, s[36:39], s65 offen offset:2048  lds
    v_mfma_f32_16x16x32_bf16 v[12:15], a[68:71], a[28:31], v[12:15]
    s_waitcnt lgkmcnt(4)
    v_mfma_f32_16x16x32_bf16 v[16:19], a[72:75], a[0:3], v[16:19]
    ds_read_b64_tr_b16 a[88:89], v227 offset:16384
    v_mfma_f32_16x16x32_bf16 v[16:19], a[76:79], a[4:7], v[16:19]
    ds_read_b64_tr_b16 a[90:91], v227 offset:17408
    v_mfma_f32_16x16x32_bf16 v[20:23], a[72:75], a[8:11], v[20:23]
    ds_read_b64_tr_b16 a[92:93], v227 offset:24576
    v_mfma_f32_16x16x32_bf16 v[20:23], a[76:79], a[12:15], v[20:23]
    ds_read_b64_tr_b16 a[94:95], v227 offset:25600
    v_mfma_f32_16x16x32_bf16 v[24:27], a[72:75], a[16:19], v[24:27]
    v_mfma_f32_16x16x32_bf16 v[24:27], a[76:79], a[20:23], v[24:27]
    v_mfma_f32_16x16x32_bf16 v[28:31], a[72:75], a[24:27], v[28:31]
    buffer_load_dwordx4 v219, s[36:39], s65 offen offset:3072  lds
    v_mfma_f32_16x16x32_bf16 v[28:31], a[76:79], a[28:31], v[28:31]
    s_waitcnt lgkmcnt(4)
    v_mfma_f32_16x16x32_bf16 v[32:35], a[80:83], a[0:3], v[32:35]
    ds_read_b64_tr_b16 a[64:65], v228 offset:0
    v_mfma_f32_16x16x32_bf16 v[32:35], a[84:87], a[4:7], v[32:35]
    ds_read_b64_tr_b16 a[66:67], v228 offset:1024
    v_mfma_f32_16x16x32_bf16 v[36:39], a[80:83], a[8:11], v[36:39]
    ds_read_b64_tr_b16 a[68:69], v228 offset:8192
    v_mfma_f32_16x16x32_bf16 v[36:39], a[84:87], a[12:15], v[36:39]
    ds_read_b64_tr_b16 a[70:71], v228 offset:9216
    v_mfma_f32_16x16x32_bf16 v[40:43], a[80:83], a[16:19], v[40:43]
    v_mfma_f32_16x16x32_bf16 v[40:43], a[84:87], a[20:23], v[40:43]
    s_add_u32 m0, s67, 4096
    v_mfma_f32_16x16x32_bf16 v[44:47], a[80:83], a[24:27], v[44:47]
    buffer_load_dwordx4 v220, s[36:39], s65 offen offset:0  lds
    v_mfma_f32_16x16x32_bf16 v[44:47], a[84:87], a[28:31], v[44:47]
    s_waitcnt lgkmcnt(4)
    v_mfma_f32_16x16x32_bf16 v[48:51], a[88:91], a[0:3], v[48:51]
    ds_read_b64_tr_b16 a[72:73], v228 offset:16384
    v_mfma_f32_16x16x32_bf16 v[48:51], a[92:95], a[4:7], v[48:51]
    ds_read_b64_tr_b16 a[74:75], v228 offset:17408
    v_mfma_f32_16x16x32_bf16 v[52:55], a[88:91], a[8:11], v[52:55]
    ds_read_b64_tr_b16 a[76:77], v228 offset:24576
    v_mfma_f32_16x16x32_bf16 v[52:55], a[92:95], a[12:15], v[52:55]
    ds_read_b64_tr_b16 a[78:79], v228 offset:25600
    v_mfma_f32_16x16x32_bf16 v[56:59], a[88:91], a[16:19], v[56:59]
    v_mfma_f32_16x16x32_bf16 v[56:59], a[92:95], a[20:23], v[56:59]
    v_mfma_f32_16x16x32_bf16 v[60:63], a[88:91], a[24:27], v[60:63]
    buffer_load_dwordx4 v221, s[36:39], s65 offen offset:1024  lds
    v_mfma_f32_16x16x32_bf16 v[60:63], a[92:95], a[28:31], v[60:63]
    s_waitcnt lgkmcnt(4)
    v_mfma_f32_16x16x32_bf16 v[64:67], a[64:67], a[0:3], v[64:67]
    ds_read_b64_tr_b16 a[80:81], v229 offset:0
    v_mfma_f32_16x16x32_bf16 v[64:67], a[68:71], a[4:7], v[64:67]
    ds_read_b64_tr_b16 a[82:83], v229 offset:1024
    v_mfma_f32_16x16x32_bf16 v[68:71], a[64:67], a[8:11], v[68:71]
    ds_read_b64_tr_b16 a[84:85], v229 offset:8192
    v_mfma_f32_16x16x32_bf16 v[68:71], a[68:71], a[12:15], v[68:71]
    ds_read_b64_tr_b16 a[86:87], v229 offset:9216
    v_mfma_f32_16x16x32_bf16 v[72:75], a[64:67], a[16:19], v[72:75]
    v_mfma_f32_16x16x32_bf16 v[72:75], a[68:71], a[20:23], v[72:75]
    v_mfma_f32_16x16x32_bf16 v[76:79], a[64:67], a[24:27], v[76:79]
    buffer_load_dwordx4 v222, s[36:39], s65 offen offset:2048  lds
    v_mfma_f32_16x16x32_bf16 v[76:79], a[68:71], a[28:31], v[76:79]
    s_waitcnt lgkmcnt(4)
    v_mfma_f32_16x16x32_bf16 v[80:83], a[72:75], a[0:3], v[80:83]
    ds_read_b64_tr_b16 a[88:89], v229 offset:16384
    v_mfma_f32_16x16x32_bf16 v[80:83], a[76:79], a[4:7], v[80:83]
    ds_read_b64_tr_b16 a[90:91], v229 offset:17408
    v_mfma_f32_16x16x32_bf16 v[84:87], a[72:75], a[8:11], v[84:87]
    ds_read_b64_tr_b16 a[92:93], v229 offset:24576
    v_mfma_f32_16x16x32_bf16 v[84:87], a[76:79], a[12:15], v[84:87]
    ds_read_b64_tr_b16 a[94:95], v229 offset:25600
    v_mfma_f32_16x16x32_bf16 v[88:91], a[72:75], a[16:19], v[88:91]
    v_mfma_f32_16x16x32_bf16 v[88:91], a[76:79], a[20:23], v[88:91]
    s_xor_b32 s67, s67, 32768
    v_mfma_f32_16x16x32_bf16 v[92:95], a[72:75], a[24:27], v[92:95]
    buffer_load_dwordx4 v223, s[36:39], s65 offen offset:3072  lds
    s_add_u32 s65, s65, 458752
    v_mfma_f32_16x16x32_bf16 v[92:95], a[76:79], a[28:31], v[92:95]
    s_waitcnt lgkmcnt(4)
    v_mfma_f32_16x16x32_bf16 v[96:99], a[80:83], a[0:3], v[96:99]
    ds_read_b64_tr_b16 a[64:65], v230 offset:0
    v_mfma_f32_16x16x32_bf16 v[96:99], a[84:87], a[4:7], v[96:99]
    ds_read_b64_tr_b16 a[66:67], v230 offset:1024
    v_mfma_f32_16x16x32_bf16 v[100:103], a[80:83], a[8:11], v[100:103]
    ds_read_b64_tr_b16 a[68:69], v230 offset:8192
    buffer_load_dword v242, v234, s[40:43], s68 offen
    s_add_u32 s68, s68, 458752
    buffer_load_dword v243, v207, s[32:35], s88 offen
    s_add_u32 s88, s88, 128
    v_mfma_f32_16x16x32_bf16 v[100:103], a[84:87], a[12:15], v[100:103]
    ds_read_b64_tr_b16 a[70:71], v230 offset:9216
    buffer_load_dword v236, v235, s[44:47], s69 offen
    s_add_u32 s69, s69, 512
    v_mfma_f32_16x16x32_bf16 v[104:107], a[80:83], a[16:19], v[104:107]
    v_mfma_f32_16x16x32_bf16 v[104:107], a[84:87], a[20:23], v[104:107]
    s_mov_b32 m0, s66
    v_mfma_f32_16x16x32_bf16 v[108:111], a[80:83], a[24:27], v[108:111]
    buffer_load_dwordx4 v208, s[32:35], s64 offen offset:0  lds
    v_mfma_f32_16x16x32_bf16 v[108:111], a[84:87], a[28:31], v[108:111]
    s_waitcnt lgkmcnt(4)
    v_mfma_f32_16x16x32_bf16 v[112:115], a[88:91], a[0:3], v[112:115]
    ds_read_b64_tr_b16 a[72:73], v230 offset:16384
    v_mfma_f32_16x16x32_bf16 v[112:115], a[92:95], a[4:7], v[112:115]
    ds_read_b64_tr_b16 a[74:75], v230 offset:17408
    v_mfma_f32_16x16x32_bf16 v[116:119], a[88:91], a[8:11], v[116:119]
    ds_read_b64_tr_b16 a[76:77], v230 offset:24576
    v_mfma_f32_16x16x32_bf16 v[116:119], a[92:95], a[12:15], v[116:119]
    ds_read_b64_tr_b16 a[78:79], v230 offset:25600
    v_mfma_f32_16x16x32_bf16 v[120:123], a[88:91], a[16:19], v[120:123]
    ds_read_b64_tr_b16 a[160:161], v250 offset:32768
    v_mfma_f32_16x16x32_bf16 v[120:123], a[92:95], a[20:23], v[120:123]
    v_mfma_f32_16x16x32_bf16 v[124:127], a[88:91], a[24:27], v[124:127]
    buffer_load_dwordx4 v209, s[32:35], s64 offen offset:1024  lds
    ds_read_b64_tr_b16 a[162:163], v250 offset:34816
    v_mfma_f32_16x16x32_bf16 v[124:127], a[92:95], a[28:31], v[124:127]
    s_waitcnt lgkmcnt(6)
    ds_read_b64_tr_b16 a[164:165], v251 offset:32768
    v_mfma_f32_16x16x32_bf16 v[128:131], a[64:67], a[0:3], v[128:131]
    ds_read_b64_tr_b16 a[80:81], v231 offset:0
    v_mfma_f32_16x16x32_bf16 v[128:131], a[68:71], a[4:7], v[128:131]
    ds_read_b64_tr_b16 a[82:83], v231 offset:1024
    v_mfma_f32_16x16x32_bf16 v[132:135], a[64:67], a[8:11], v[132:135]
    ds_read_b64_tr_b16 a[84:85], v231 offset:8192
    v_mfma_f32_16x16x32_bf16 v[132:135], a[68:71], a[12:15], v[132:135]
    ds_read_b64_tr_b16 a[86:87], v231 offset:9216
    s_waitcnt vmcnt(14)
    v_mfma_f32_16x16x32_bf16 v[136:139], a[64:67], a[16:19], v[136:139]
    ds_read_b128 a[32:35], v224 offset:8192
    v_mfma_f32_16x16x32_bf16 v[136:139], a[68:71], a[20:23], v[136:139]
    ds_read_b128 a[36:39], v225 offset:8192
    v_mfma_f32_16x16x32_bf16 v[140:143], a[64:67], a[24:27], v[140:143]
    buffer_load_dwordx4 v210, s[32:35], s64 offen offset:2048  lds
    ds_read_b64_tr_b16 a[166:167], v251 offset:34816
    v_mfma_f32_16x16x32_bf16 v[140:143], a[68:71], a[28:31], v[140:143]
    s_waitcnt lgkmcnt(10)
    ds_read_b64_tr_b16 a[168:169], v252 offset:32768
    v_mfma_f32_16x16x32_bf16 v[144:147], a[72:75], a[0:3], v[144:147]
    ds_read_b64_tr_b16 a[88:89], v231 offset:16384
    v_mfma_f32_16x16x32_bf16 v[144:147], a[76:79], a[4:7], v[144:147]
    ds_read_b64_tr_b16 a[90:91], v231 offset:17408
    v_mfma_f32_16x16x32_bf16 v[148:151], a[72:75], a[8:11], v[148:151]
    ds_read_b64_tr_b16 a[92:93], v231 offset:24576
    v_mfma_f32_16x16x32_bf16 v[148:151], a[76:79], a[12:15], v[148:151]
    ds_read_b64_tr_b16 a[94:95], v231 offset:25600
    v_mfma_f32_16x16x32_bf16 v[152:155], a[72:75], a[16:19], v[152:155]
    ds_read_b128 a[40:43], v224 offset:10240
    v_mfma_f32_16x16x32_bf16 v[152:155], a[76:79], a[20:23], v[152:155]
    ds_read_b128 a[44:47], v225 offset:10240
    v_mfma_f32_16x16x32_bf16 v[156:159], a[72:75], a[24:27], v[156:159]
    buffer_load_dwordx4 v211, s[32:35], s64 offen offset:3072  lds
    ds_read_b64_tr_b16 a[170:171], v252 offset:34816
    v_mfma_f32_16x16x32_bf16 v[156:159], a[76:79], a[28:31], v[156:159]
    s_waitcnt lgkmcnt(11)
    ds_read_b64_tr_b16 a[172:173], v253 offset:32768
    v_mfma_f32_16x16x32_bf16 v[160:163], a[80:83], a[0:3], v[160:163]
    ds_read_b64_tr_b16 a[64:65], v232 offset:0
    ds_read_b64_tr_b16 a[174:175], v253 offset:34816
    v_mfma_f32_16x16x32_bf16 v[160:163], a[84:87], a[4:7], v[160:163]
    ds_read_b64_tr_b16 a[66:67], v232 offset:1024
    v_mfma_f32_16x16x32_bf16 v[164:167], a[80:83], a[8:11], v[164:167]
    ds_read_b64_tr_b16 a[68:69], v232 offset:8192
    v_mfma_f32_16x16x32_bf16 v[164:167], a[84:87], a[12:15], v[164:167]
    ds_read_b64_tr_b16 a[70:71], v232 offset:9216
    v_mfma_f32_16x16x32_bf16 v[168:171], a[80:83], a[16:19], v[168:171]
    ds_read_b128 a[48:51], v224 offset:12288
    v_mfma_f32_16x16x32_bf16 v[168:171], a[84:87], a[20:23], v[168:171]
    ds_read_b128 a[52:55], v225 offset:12288
    s_add_u32 m0, s66, 4096
    v_mfma_f32_16x16x32_bf16 v[172:175], a[80:83], a[24:27], v[172:175]
    buffer_load_dwordx4 v212, s[32:35], s64 offen offset:0  lds
    v_mfma_f32_16x16x32_bf16 v[172:175], a[84:87], a[28:31], v[172:175]
    s_waitcnt lgkmcnt(11)
    v_mfma_f32_16x16x32_bf16 v[176:179], a[88:91], a[0:3], v[176:179]
    ds_read_b64_tr_b16 a[72:73], v232 offset:16384
    v_mfma_f32_16x16x32_bf16 v[176:179], a[92:95], a[4:7], v[176:179]
    ds_read_b64_tr_b16 a[74:75], v232 offset:17408
    v_mfma_f32_16x16x32_bf16 v[180:183], a[88:91], a[8:11], v[180:183]
    ds_read_b64_tr_b16 a[76:77], v232 offset:24576
    v_mfma_f32_16x16x32_bf16 v[180:183], a[92:95], a[12:15], v[180:183]
    ds_read_b64_tr_b16 a[78:79], v232 offset:25600
    v_mfma_f32_16x16x32_bf16 v[184:187], a[88:91], a[16:19], v[184:187]
    ds_read_b128 a[56:59], v224 offset:14336
    v_mfma_f32_16x16x32_bf16 v[184:187], a[92:95], a[20:23], v[184:187]
    ds_read_b128 a[60:63], v225 offset:14336
    v_mfma_f32_16x16x32_bf16 v[188:191], a[88:91], a[24:27], v[188:191]
    buffer_load_dwordx4 v213, s[32:35], s64 offen offset:1024  lds
    s_add_u32 s91, s77, 131072
    s_add_u32 m0, s79, 32768
    v_mfma_f32_16x16x32_bf16 v[188:191], a[92:95], a[28:31], v[188:191]
    s_waitcnt lgkmcnt(8)
    buffer_load_dwordx4 v246, s[44:47], s91 offen offset:0 lds
    v_mfma_f32_16x16x32_bf16 a[96:99], a[64:67], a[0:3], a[96:99]
    ds_read_b64_tr_b16 a[80:81], v233 offset:0
    v_mfma_f32_16x16x32_bf16 a[96:99], a[68:71], a[4:7], a[96:99]
    ds_read_b64_tr_b16 a[82:83], v233 offset:1024
    buffer_load_dwordx4 v247, s[44:47], s91 offen offset:1024 lds
    v_mfma_f32_16x16x32_bf16 a[100:103], a[64:67], a[8:11], a[100:103]
    ds_read_b64_tr_b16 a[84:85], v233 offset:8192
    v_mfma_f32_16x16x32_bf16 a[100:103], a[68:71], a[12:15], a[100:103]
    ds_read_b64_tr_b16 a[86:87], v233 offset:9216
    v_mfma_f32_16x16x32_bf16 a[104:107], a[64:67], a[16:19], a[104:107]
    ds_read_b64_tr_b16 a[88:89], v233 offset:16384
    v_mfma_f32_16x16x32_bf16 a[104:107], a[68:71], a[20:23], a[104:107]
    ds_read_b64_tr_b16 a[90:91], v233 offset:17408
    s_add_u32 m0, s66, 4096
    v_mfma_f32_16x16x32_bf16 a[108:111], a[64:67], a[24:27], a[108:111]
    ds_read_b64_tr_b16 a[92:93], v233 offset:24576
    buffer_load_dwordx4 v214, s[32:35], s64 offen offset:2048  lds
    v_mfma_f32_16x16x32_bf16 a[108:111], a[68:71], a[28:31], a[108:111]
    ds_read_b64_tr_b16 a[94:95], v233 offset:25600
    s_waitcnt lgkmcnt(10)
    v_mfma_f32_16x16x32_bf16 a[112:115], a[72:75], a[0:3], a[112:115]
    v_mfma_f32_16x16x32_bf16 a[112:115], a[76:79], a[4:7], a[112:115]
    v_mfma_f32_16x16x32_bf16 a[116:119], a[72:75], a[8:11], a[116:119]
    s_add_u32 m0, s79, 32768
    v_mfma_f32_16x16x32_bf16 a[116:119], a[76:79], a[12:15], a[116:119]
    buffer_load_dwordx4 v248, s[44:47], s91 offen offset:2048 lds
    v_mfma_f32_16x16x32_bf16 a[120:123], a[72:75], a[16:19], a[120:123]
    v_mfma_f32_16x16x32_bf16 a[120:123], a[76:79], a[20:23], a[120:123]
    s_add_u32 m0, s66, 4096
    s_xor_b32 s66, s66, 8192
    v_mfma_f32_16x16x32_bf16 a[124:127], a[72:75], a[24:27], a[124:127]
    buffer_load_dwordx4 v215, s[32:35], s64 offen offset:3072  lds
    s_add_u32 s64, s64, 128
    v_mfma_f32_16x16x32_bf16 a[124:127], a[76:79], a[28:31], a[124:127]
    s_waitcnt vmcnt(14) lgkmcnt(0)
    v_mfma_f32_16x16x32_bf16 a[128:131], a[80:83], a[0:3], a[128:131]
    s_barrier
    v_mfma_f32_16x16x32_bf16 a[128:131], a[84:87], a[4:7], a[128:131]
    ds_read_b64_tr_b16 a[64:65], v226 offset:32768
    v_mfma_f32_16x16x32_bf16 a[132:135], a[80:83], a[8:11], a[132:135]
    ds_read_b64_tr_b16 a[66:67], v226 offset:33792
    v_mfma_f32_16x16x32_bf16 a[132:135], a[84:87], a[12:15], a[132:135]
    ds_read_b64_tr_b16 a[68:69], v226 offset:40960
    s_add_u32 m0, s79, 32768
    v_mfma_f32_16x16x32_bf16 a[136:139], a[80:83], a[16:19], a[136:139]
    ds_read_b64_tr_b16 a[70:71], v226 offset:41984
    buffer_load_dwordx4 v249, s[44:47], s91 offen offset:3072 lds
    v_mfma_f32_16x16x32_bf16 a[136:139], a[84:87], a[20:23], a[136:139]
    s_mov_b32 m0, s67
    v_mfma_f32_16x16x32_bf16 a[140:143], a[80:83], a[24:27], a[140:143]
    buffer_load_dwordx4 v216, s[36:39], s65 offen offset:0  lds
    v_mfma_f32_16x16x32_bf16 a[140:143], a[84:87], a[28:31], a[140:143]
    v_mfma_f32_16x16x32_bf16 a[144:147], a[88:91], a[0:3], a[144:147]
    v_mfma_f32_16x16x32_bf16 a[144:147], a[92:95], a[4:7], a[144:147]
    ds_read_b64_tr_b16 a[72:73], v226 offset:49152
    v_mfma_f32_16x16x32_bf16 a[148:151], a[88:91], a[8:11], a[148:151]
    ds_read_b64_tr_b16 a[74:75], v226 offset:50176
    v_mfma_f32_16x16x32_bf16 a[148:151], a[92:95], a[12:15], a[148:151]
    ds_read_b64_tr_b16 a[76:77], v226 offset:57344
    v_mfma_f32_16x16x32_bf16 a[152:155], a[88:91], a[16:19], a[152:155]
    ds_read_b64_tr_b16 a[78:79], v226 offset:58368
    v_mfma_f32_16x16x32_bf16 a[152:155], a[92:95], a[20:23], a[152:155]
    v_mfma_f32_16x16x32_bf16 a[156:159], a[88:91], a[24:27], a[156:159]
    buffer_load_dwordx4 v217, s[36:39], s65 offen offset:1024  lds
    v_mfma_f32_16x16x32_bf16 a[156:159], a[92:95], a[28:31], a[156:159]
    s_waitcnt lgkmcnt(4)
    v_mfma_f32_16x16x32_bf16 v[0:3], a[64:67], a[32:35], v[0:3]
    ds_read_b64_tr_b16 a[80:81], v227 offset:32768
    v_mfma_f32_16x16x32_bf16 v[0:3], a[68:71], a[36:39], v[0:3]
    ds_read_b64_tr_b16 a[82:83], v227 offset:33792
    v_mfma_f32_16x16x32_bf16 v[4:7], a[64:67], a[40:43], v[4:7]
    ds_read_b64_tr_b16 a[84:85], v227 offset:40960
    v_mfma_f32_16x16x32_bf16 v[4:7], a[68:71], a[44:47], v[4:7]
    ds_read_b64_tr_b16 a[86:87], v227 offset:41984
    v_mfma_f32_16x16x32_bf16 v[8:11], a[64:67], a[48:51], v[8:11]
    v_mfma_f32_16x16x32_bf16 v[8:11], a[68:71], a[52:55], v[8:11]
    v_mfma_f32_16x16x32_bf16 v[12:15], a[64:67], a[56:59], v[12:15]
    buffer_load_dwordx4 v218, s[36:39], s65 offen offset:2048  lds
    v_mfma_f32_16x16x32_bf16 v[12:15], a[68:71], a[60:63], v[12:15]
    s_waitcnt lgkmcnt(4)
    v_mfma_f32_16x16x32_bf16 v[16:19], a[72:75], a[32:35], v[16:19]
    ds_read_b64_tr_b16 a[88:89], v227 offset:49152
    v_mfma_f32_16x16x32_bf16 v[16:19], a[76:79], a[36:39], v[16:19]
    ds_read_b64_tr_b16 a[90:91], v227 offset:50176
    v_mfma_f32_16x16x32_bf16 v[20:23], a[72:75], a[40:43], v[20:23]
    ds_read_b64_tr_b16 a[92:93], v227 offset:57344
    v_mfma_f32_16x16x32_bf16 v[20:23], a[76:79], a[44:47], v[20:23]
    ds_read_b64_tr_b16 a[94:95], v227 offset:58368
    v_mfma_f32_16x16x32_bf16 v[24:27], a[72:75], a[48:51], v[24:27]
    v_mfma_f32_16x16x32_bf16 v[24:27], a[76:79], a[52:55], v[24:27]
    v_mfma_f32_16x16x32_bf16 v[28:31], a[72:75], a[56:59], v[28:31]
    buffer_load_dwordx4 v219, s[36:39], s65 offen offset:3072  lds
    v_mfma_f32_16x16x32_bf16 v[28:31], a[76:79], a[60:63], v[28:31]
    s_waitcnt lgkmcnt(4)
    v_mfma_f32_16x16x32_bf16 v[32:35], a[80:83], a[32:35], v[32:35]
    ds_read_b64_tr_b16 a[64:65], v228 offset:32768
    v_mfma_f32_16x16x32_bf16 v[32:35], a[84:87], a[36:39], v[32:35]
    ds_read_b64_tr_b16 a[66:67], v228 offset:33792
    v_mfma_f32_16x16x32_bf16 v[36:39], a[80:83], a[40:43], v[36:39]
    ds_read_b64_tr_b16 a[68:69], v228 offset:40960
    v_mfma_f32_16x16x32_bf16 v[36:39], a[84:87], a[44:47], v[36:39]
    ds_read_b64_tr_b16 a[70:71], v228 offset:41984
    v_mfma_f32_16x16x32_bf16 v[40:43], a[80:83], a[48:51], v[40:43]
    v_mfma_f32_16x16x32_bf16 v[40:43], a[84:87], a[52:55], v[40:43]
    s_add_u32 m0, s67, 4096
    v_mfma_f32_16x16x32_bf16 v[44:47], a[80:83], a[56:59], v[44:47]
    buffer_load_dwordx4 v220, s[36:39], s65 offen offset:0  lds
    v_mfma_f32_16x16x32_bf16 v[44:47], a[84:87], a[60:63], v[44:47]
    s_waitcnt lgkmcnt(4)
    v_mfma_f32_16x16x32_bf16 v[48:51], a[88:91], a[32:35], v[48:51]
    ds_read_b64_tr_b16 a[72:73], v228 offset:49152
    v_mfma_f32_16x16x32_bf16 v[48:51], a[92:95], a[36:39], v[48:51]
    ds_read_b64_tr_b16 a[74:75], v228 offset:50176
    v_mfma_f32_16x16x32_bf16 v[52:55], a[88:91], a[40:43], v[52:55]
    ds_read_b64_tr_b16 a[76:77], v228 offset:57344
    v_mfma_f32_16x16x32_bf16 v[52:55], a[92:95], a[44:47], v[52:55]
    ds_read_b64_tr_b16 a[78:79], v228 offset:58368
    v_mfma_f32_16x16x32_bf16 v[56:59], a[88:91], a[48:51], v[56:59]
    v_mfma_f32_16x16x32_bf16 v[56:59], a[92:95], a[52:55], v[56:59]
    v_mfma_f32_16x16x32_bf16 v[60:63], a[88:91], a[56:59], v[60:63]
    buffer_load_dwordx4 v221, s[36:39], s65 offen offset:1024  lds
    v_mfma_f32_16x16x32_bf16 v[60:63], a[92:95], a[60:63], v[60:63]
    s_waitcnt lgkmcnt(4)
    v_mfma_f32_16x16x32_bf16 v[64:67], a[64:67], a[32:35], v[64:67]
    ds_read_b64_tr_b16 a[80:81], v229 offset:32768
    v_mfma_f32_16x16x32_bf16 v[64:67], a[68:71], a[36:39], v[64:67]
    ds_read_b64_tr_b16 a[82:83], v229 offset:33792
    v_mfma_f32_16x16x32_bf16 v[68:71], a[64:67], a[40:43], v[68:71]
    ds_read_b64_tr_b16 a[84:85], v229 offset:40960
    v_mfma_f32_16x16x32_bf16 v[68:71], a[68:71], a[44:47], v[68:71]
    ds_read_b64_tr_b16 a[86:87], v229 offset:41984
    v_mfma_f32_16x16x32_bf16 v[72:75], a[64:67], a[48:51], v[72:75]
    v_mfma_f32_16x16x32_bf16 v[72:75], a[68:71], a[52:55], v[72:75]
    v_mfma_f32_16x16x32_bf16 v[76:79], a[64:67], a[56:59], v[76:79]
    buffer_load_dwordx4 v222, s[36:39], s65 offen offset:2048  lds
    v_mfma_f32_16x16x32_bf16 v[76:79], a[68:71], a[60:63], v[76:79]
    s_waitcnt lgkmcnt(4)
    v_mfma_f32_16x16x32_bf16 v[80:83], a[72:75], a[32:35], v[80:83]
    ds_read_b64_tr_b16 a[88:89], v229 offset:49152
    v_mfma_f32_16x16x32_bf16 v[80:83], a[76:79], a[36:39], v[80:83]
    ds_read_b64_tr_b16 a[90:91], v229 offset:50176
    v_mfma_f32_16x16x32_bf16 v[84:87], a[72:75], a[40:43], v[84:87]
    ds_read_b64_tr_b16 a[92:93], v229 offset:57344
    v_mfma_f32_16x16x32_bf16 v[84:87], a[76:79], a[44:47], v[84:87]
    ds_read_b64_tr_b16 a[94:95], v229 offset:58368
    v_mfma_f32_16x16x32_bf16 v[88:91], a[72:75], a[48:51], v[88:91]
    v_mfma_f32_16x16x32_bf16 v[88:91], a[76:79], a[52:55], v[88:91]
    s_xor_b32 s67, s67, 32768
    v_mfma_f32_16x16x32_bf16 v[92:95], a[72:75], a[56:59], v[92:95]
    buffer_load_dwordx4 v223, s[36:39], s65 offen offset:3072  lds
    s_add_u32 s65, s65, 458752
    v_mfma_f32_16x16x32_bf16 v[92:95], a[76:79], a[60:63], v[92:95]
    s_waitcnt lgkmcnt(4)
    v_mfma_f32_16x16x32_bf16 v[96:99], a[80:83], a[32:35], v[96:99]
    ds_read_b64_tr_b16 a[64:65], v230 offset:32768
    v_mfma_f32_16x16x32_bf16 v[96:99], a[84:87], a[36:39], v[96:99]
    ds_read_b64_tr_b16 a[66:67], v230 offset:33792
    v_mfma_f32_16x16x32_bf16 v[100:103], a[80:83], a[40:43], v[100:103]
    ds_read_b64_tr_b16 a[68:69], v230 offset:40960
    buffer_load_dword v237, v234, s[40:43], s68 offen
    s_add_u32 s68, s68, 458752
    buffer_load_dword v238, v207, s[32:35], s88 offen
    s_add_u32 s88, s88, 128
    v_mfma_f32_16x16x32_bf16 v[100:103], a[84:87], a[44:47], v[100:103]
    ds_read_b64_tr_b16 a[70:71], v230 offset:41984
    buffer_load_dword v239, v235, s[44:47], s69 offen
    s_add_u32 s69, s69, 512
    v_mfma_f32_16x16x32_bf16 v[104:107], a[80:83], a[48:51], v[104:107]
    v_mfma_f32_16x16x32_bf16 v[104:107], a[84:87], a[52:55], v[104:107]
    s_mov_b32 m0, s66
    v_mfma_f32_16x16x32_bf16 v[108:111], a[80:83], a[56:59], v[108:111]
    buffer_load_dwordx4 v208, s[32:35], s64 offen offset:0  lds
    v_mfma_f32_16x16x32_bf16 v[108:111], a[84:87], a[60:63], v[108:111]
    s_waitcnt lgkmcnt(4)
    v_mfma_f32_16x16x32_bf16 v[112:115], a[88:91], a[32:35], v[112:115]
    ds_read_b64_tr_b16 a[72:73], v230 offset:49152
    v_mfma_f32_16x16x32_bf16 v[112:115], a[92:95], a[36:39], v[112:115]
    ds_read_b64_tr_b16 a[74:75], v230 offset:50176
    v_mfma_f32_16x16x32_bf16 v[116:119], a[88:91], a[40:43], v[116:119]
    ds_read_b64_tr_b16 a[76:77], v230 offset:57344
    v_mfma_f32_16x16x32_bf16 v[116:119], a[92:95], a[44:47], v[116:119]
    ds_read_b64_tr_b16 a[78:79], v230 offset:58368
    v_mfma_f32_16x16x32_bf16 v[120:123], a[88:91], a[48:51], v[120:123]
    ds_read_b64_tr_b16 a[176:177], v250 offset:36864
    v_mfma_f32_16x16x32_bf16 v[120:123], a[92:95], a[52:55], v[120:123]
    v_mfma_f32_16x16x32_bf16 v[124:127], a[88:91], a[56:59], v[124:127]
    buffer_load_dwordx4 v209, s[32:35], s64 offen offset:1024  lds
    ds_read_b64_tr_b16 a[178:179], v250 offset:38912
    v_mfma_f32_16x16x32_bf16 v[124:127], a[92:95], a[60:63], v[124:127]
    s_waitcnt lgkmcnt(6)
    ds_read_b64_tr_b16 a[180:181], v251 offset:36864
    v_mfma_f32_16x16x32_bf16 v[128:131], a[64:67], a[32:35], v[128:131]
    ds_read_b64_tr_b16 a[80:81], v231 offset:32768
    v_mfma_f32_16x16x32_bf16 v[128:131], a[68:71], a[36:39], v[128:131]
    ds_read_b64_tr_b16 a[82:83], v231 offset:33792
    v_mfma_f32_16x16x32_bf16 v[132:135], a[64:67], a[40:43], v[132:135]
    ds_read_b64_tr_b16 a[84:85], v231 offset:40960
    v_mfma_f32_16x16x32_bf16 v[132:135], a[68:71], a[44:47], v[132:135]
    ds_read_b64_tr_b16 a[86:87], v231 offset:41984
    s_waitcnt vmcnt(14)
    v_mfma_f32_16x16x32_bf16 v[136:139], a[64:67], a[48:51], v[136:139]
    ds_read_b128 a[0:3], v224 offset:0
    v_mfma_f32_16x16x32_bf16 v[136:139], a[68:71], a[52:55], v[136:139]
    ds_read_b128 a[4:7], v225 offset:0
    v_mfma_f32_16x16x32_bf16 v[140:143], a[64:67], a[56:59], v[140:143]
    buffer_load_dwordx4 v210, s[32:35], s64 offen offset:2048  lds
    ds_read_b64_tr_b16 a[182:183], v251 offset:38912
    v_mfma_f32_16x16x32_bf16 v[140:143], a[68:71], a[60:63], v[140:143]
    s_waitcnt lgkmcnt(10)
    ds_read_b64_tr_b16 a[184:185], v252 offset:36864
    v_mfma_f32_16x16x32_bf16 v[144:147], a[72:75], a[32:35], v[144:147]
    ds_read_b64_tr_b16 a[88:89], v231 offset:49152
    v_mfma_f32_16x16x32_bf16 v[144:147], a[76:79], a[36:39], v[144:147]
    ds_read_b64_tr_b16 a[90:91], v231 offset:50176
    v_mfma_f32_16x16x32_bf16 v[148:151], a[72:75], a[40:43], v[148:151]
    ds_read_b64_tr_b16 a[92:93], v231 offset:57344
    v_mfma_f32_16x16x32_bf16 v[148:151], a[76:79], a[44:47], v[148:151]
    ds_read_b64_tr_b16 a[94:95], v231 offset:58368
    v_mfma_f32_16x16x32_bf16 v[152:155], a[72:75], a[48:51], v[152:155]
    ds_read_b128 a[8:11], v224 offset:2048
    v_mfma_f32_16x16x32_bf16 v[152:155], a[76:79], a[52:55], v[152:155]
    ds_read_b128 a[12:15], v225 offset:2048
    v_mfma_f32_16x16x32_bf16 v[156:159], a[72:75], a[56:59], v[156:159]
    buffer_load_dwordx4 v211, s[32:35], s64 offen offset:3072  lds
    ds_read_b64_tr_b16 a[186:187], v252 offset:38912
    v_mfma_f32_16x16x32_bf16 v[156:159], a[76:79], a[60:63], v[156:159]
    s_waitcnt lgkmcnt(11)
    ds_read_b64_tr_b16 a[188:189], v253 offset:36864
    v_mfma_f32_16x16x32_bf16 v[160:163], a[80:83], a[32:35], v[160:163]
    ds_read_b64_tr_b16 a[64:65], v232 offset:32768
    ds_read_b64_tr_b16 a[190:191], v253 offset:38912
    v_mfma_f32_16x16x32_bf16 v[160:163], a[84:87], a[36:39], v[160:163]
    ds_read_b64_tr_b16 a[66:67], v232 offset:33792
    v_mfma_f32_16x16x32_bf16 v[164:167], a[80:83], a[40:43], v[164:167]
    ds_read_b64_tr_b16 a[68:69], v232 offset:40960
    v_mfma_f32_16x16x32_bf16 v[164:167], a[84:87], a[44:47], v[164:167]
    ds_read_b64_tr_b16 a[70:71], v232 offset:41984
    v_mfma_f32_16x16x32_bf16 v[168:171], a[80:83], a[48:51], v[168:171]
    ds_read_b128 a[16:19], v224 offset:4096
    v_mfma_f32_16x16x32_bf16 v[168:171], a[84:87], a[52:55], v[168:171]
    ds_read_b128 a[20:23], v225 offset:4096
    s_add_u32 m0, s66, 4096
    v_mfma_f32_16x16x32_bf16 v[172:175], a[80:83], a[56:59], v[172:175]
    buffer_load_dwordx4 v212, s[32:35], s64 offen offset:0  lds
    v_mfma_f32_16x16x32_bf16 v[172:175], a[84:87], a[60:63], v[172:175]
    s_waitcnt lgkmcnt(11)
    v_mfma_f32_16x16x32_bf16 v[176:179], a[88:91], a[32:35], v[176:179]
    ds_read_b64_tr_b16 a[72:73], v232 offset:49152
    v_mfma_f32_16x16x32_bf16 v[176:179], a[92:95], a[36:39], v[176:179]
    ds_read_b64_tr_b16 a[74:75], v232 offset:50176
    v_mfma_f32_16x16x32_bf16 v[180:183], a[88:91], a[40:43], v[180:183]
    ds_read_b64_tr_b16 a[76:77], v232 offset:57344
    v_mfma_f32_16x16x32_bf16 v[180:183], a[92:95], a[44:47], v[180:183]
    ds_read_b64_tr_b16 a[78:79], v232 offset:58368
    v_mfma_f32_16x16x32_bf16 v[184:187], a[88:91], a[48:51], v[184:187]
    ds_read_b128 a[24:27], v224 offset:6144
    v_mfma_f32_16x16x32_bf16 v[184:187], a[92:95], a[52:55], v[184:187]
    ds_read_b128 a[28:31], v225 offset:6144
    v_mfma_f32_16x16x32_bf16 v[188:191], a[88:91], a[56:59], v[188:191]
    buffer_load_dwordx4 v213, s[32:35], s64 offen offset:1024  lds
    s_add_u32 s78, s77, 196608
    s_add_u32 m0, s79, 36864
    v_mfma_f32_16x16x32_bf16 v[188:191], a[92:95], a[60:63], v[188:191]
    s_waitcnt lgkmcnt(8)
    buffer_load_dwordx4 v246, s[44:47], s78 offen offset:0 lds
    v_mfma_f32_16x16x32_bf16 a[96:99], a[64:67], a[32:35], a[96:99]
    ds_read_b64_tr_b16 a[80:81], v233 offset:32768
    v_mfma_f32_16x16x32_bf16 a[96:99], a[68:71], a[36:39], a[96:99]
    ds_read_b64_tr_b16 a[82:83], v233 offset:33792
    buffer_load_dwordx4 v247, s[44:47], s78 offen offset:1024 lds
    v_mfma_f32_16x16x32_bf16 a[100:103], a[64:67], a[40:43], a[100:103]
    ds_read_b64_tr_b16 a[84:85], v233 offset:40960
    v_mfma_f32_16x16x32_bf16 a[100:103], a[68:71], a[44:47], a[100:103]
    ds_read_b64_tr_b16 a[86:87], v233 offset:41984
    v_mfma_f32_16x16x32_bf16 a[104:107], a[64:67], a[48:51], a[104:107]
    ds_read_b64_tr_b16 a[88:89], v233 offset:49152
    v_mfma_f32_16x16x32_bf16 a[104:107], a[68:71], a[52:55], a[104:107]
    ds_read_b64_tr_b16 a[90:91], v233 offset:50176
    s_add_u32 m0, s66, 4096
    v_mfma_f32_16x16x32_bf16 a[108:111], a[64:67], a[56:59], a[108:111]
    ds_read_b64_tr_b16 a[92:93], v233 offset:57344
    buffer_load_dwordx4 v214, s[32:35], s64 offen offset:2048  lds
    v_mfma_f32_16x16x32_bf16 a[108:111], a[68:71], a[60:63], a[108:111]
    ds_read_b64_tr_b16 a[94:95], v233 offset:58368
    s_waitcnt lgkmcnt(10)
    v_mfma_f32_16x16x32_bf16 a[112:115], a[72:75], a[32:35], a[112:115]
    v_mfma_f32_16x16x32_bf16 a[112:115], a[76:79], a[36:39], a[112:115]
    v_mfma_f32_16x16x32_bf16 a[116:119], a[72:75], a[40:43], a[116:119]
    s_add_u32 m0, s79, 36864
    v_mfma_f32_16x16x32_bf16 a[116:119], a[76:79], a[44:47], a[116:119]
    buffer_load_dwordx4 v248, s[44:47], s78 offen offset:2048 lds
    v_mfma_f32_16x16x32_bf16 a[120:123], a[72:75], a[48:51], a[120:123]
    v_mfma_f32_16x16x32_bf16 a[120:123], a[76:79], a[52:55], a[120:123]
    s_add_u32 m0, s66, 4096
    s_xor_b32 s66, s66, 8192
    v_mfma_f32_16x16x32_bf16 a[124:127], a[72:75], a[56:59], a[124:127]
    buffer_load_dwordx4 v215, s[32:35], s64 offen offset:3072  lds
    s_add_u32 s64, s64, 128
    v_mfma_f32_16x16x32_bf16 a[124:127], a[76:79], a[60:63], a[124:127]
    s_waitcnt vmcnt(14) lgkmcnt(0)
    v_mfma_f32_16x16x32_bf16 a[128:131], a[80:83], a[32:35], a[128:131]
    s_barrier
    v_mfma_f32_16x16x32_bf16 a[128:131], a[84:87], a[36:39], a[128:131]
    ds_read_b64_tr_b16 a[64:65], v226 offset:0
    v_mfma_f32_16x16x32_bf16 a[132:135], a[80:83], a[40:43], a[132:135]
    ds_read_b64_tr_b16 a[66:67], v226 offset:1024
    v_mfma_f32_16x16x32_bf16 a[132:135], a[84:87], a[44:47], a[132:135]
    ds_read_b64_tr_b16 a[68:69], v226 offset:8192
    s_add_u32 m0, s79, 36864
    v_mfma_f32_16x16x32_bf16 a[136:139], a[80:83], a[48:51], a[136:139]
    ds_read_b64_tr_b16 a[70:71], v226 offset:9216
    buffer_load_dwordx4 v249, s[44:47], s78 offen offset:3072 lds
    v_mfma_f32_16x16x32_bf16 a[136:139], a[84:87], a[52:55], a[136:139]
    s_mov_b32 m0, s67
    v_mfma_f32_16x16x32_bf16 a[140:143], a[80:83], a[56:59], a[140:143]
    buffer_load_dwordx4 v216, s[36:39], s65 offen offset:0  lds
    v_mfma_f32_16x16x32_bf16 a[140:143], a[84:87], a[60:63], a[140:143]
    v_mfma_f32_16x16x32_bf16 a[144:147], a[88:91], a[32:35], a[144:147]
    v_mfma_f32_16x16x32_bf16 a[144:147], a[92:95], a[36:39], a[144:147]
    ds_read_b64_tr_b16 a[72:73], v226 offset:16384
    v_mfma_f32_16x16x32_bf16 a[148:151], a[88:91], a[40:43], a[148:151]
    ds_read_b64_tr_b16 a[74:75], v226 offset:17408
    v_mfma_f32_16x16x32_bf16 a[148:151], a[92:95], a[44:47], a[148:151]
    ds_read_b64_tr_b16 a[76:77], v226 offset:24576
    v_mfma_f32_16x16x32_bf16 a[152:155], a[88:91], a[48:51], a[152:155]
    ds_read_b64_tr_b16 a[78:79], v226 offset:25600
    v_mfma_f32_16x16x32_bf16 a[152:155], a[92:95], a[52:55], a[152:155]
    v_mfma_f32_16x16x32_bf16 a[156:159], a[88:91], a[56:59], a[156:159]
    buffer_load_dwordx4 v217, s[36:39], s65 offen offset:1024  lds
    v_mfma_f32_16x16x32_bf16 a[156:159], a[92:95], a[60:63], a[156:159]
    s_waitcnt lgkmcnt(4)
    v_mfma_f32_16x16x32_bf16 v[0:3], a[64:67], a[0:3], v[0:3]
    ds_read_b64_tr_b16 a[80:81], v227 offset:0
    v_mfma_f32_16x16x32_bf16 v[0:3], a[68:71], a[4:7], v[0:3]
    ds_read_b64_tr_b16 a[82:83], v227 offset:1024
    v_mfma_f32_16x16x32_bf16 v[4:7], a[64:67], a[8:11], v[4:7]
    ds_read_b64_tr_b16 a[84:85], v227 offset:8192
    v_mfma_f32_16x16x32_bf16 v[4:7], a[68:71], a[12:15], v[4:7]
    ds_read_b64_tr_b16 a[86:87], v227 offset:9216
    v_mfma_f32_16x16x32_bf16 v[8:11], a[64:67], a[16:19], v[8:11]
    v_mfma_f32_16x16x32_bf16 v[8:11], a[68:71], a[20:23], v[8:11]
    v_mfma_f32_16x16x32_bf16 v[12:15], a[64:67], a[24:27], v[12:15]
    buffer_load_dwordx4 v218, s[36:39], s65 offen offset:2048  lds
    v_mfma_f32_16x16x32_bf16 v[12:15], a[68:71], a[28:31], v[12:15]
    s_waitcnt lgkmcnt(4)
    v_mfma_f32_16x16x32_bf16 v[16:19], a[72:75], a[0:3], v[16:19]
    ds_read_b64_tr_b16 a[88:89], v227 offset:16384
    v_mfma_f32_16x16x32_bf16 v[16:19], a[76:79], a[4:7], v[16:19]
    ds_read_b64_tr_b16 a[90:91], v227 offset:17408
    v_mfma_f32_16x16x32_bf16 v[20:23], a[72:75], a[8:11], v[20:23]
    ds_read_b64_tr_b16 a[92:93], v227 offset:24576
    v_mfma_f32_16x16x32_bf16 v[20:23], a[76:79], a[12:15], v[20:23]
    ds_read_b64_tr_b16 a[94:95], v227 offset:25600
    v_mfma_f32_16x16x32_bf16 v[24:27], a[72:75], a[16:19], v[24:27]
    v_mfma_f32_16x16x32_bf16 v[24:27], a[76:79], a[20:23], v[24:27]
    v_mfma_f32_16x16x32_bf16 v[28:31], a[72:75], a[24:27], v[28:31]
    buffer_load_dwordx4 v219, s[36:39], s65 offen offset:3072  lds
    v_mfma_f32_16x16x32_bf16 v[28:31], a[76:79], a[28:31], v[28:31]
    s_waitcnt lgkmcnt(4)
    v_mfma_f32_16x16x32_bf16 v[32:35], a[80:83], a[0:3], v[32:35]
    ds_read_b64_tr_b16 a[64:65], v228 offset:0
    v_mfma_f32_16x16x32_bf16 v[32:35], a[84:87], a[4:7], v[32:35]
    ds_read_b64_tr_b16 a[66:67], v228 offset:1024
    v_mfma_f32_16x16x32_bf16 v[36:39], a[80:83], a[8:11], v[36:39]
    ds_read_b64_tr_b16 a[68:69], v228 offset:8192
    v_mfma_f32_16x16x32_bf16 v[36:39], a[84:87], a[12:15], v[36:39]
    ds_read_b64_tr_b16 a[70:71], v228 offset:9216
    v_mfma_f32_16x16x32_bf16 v[40:43], a[80:83], a[16:19], v[40:43]
    v_mfma_f32_16x16x32_bf16 v[40:43], a[84:87], a[20:23], v[40:43]
    s_add_u32 m0, s67, 4096
    v_mfma_f32_16x16x32_bf16 v[44:47], a[80:83], a[24:27], v[44:47]
    buffer_load_dwordx4 v220, s[36:39], s65 offen offset:0  lds
    v_mfma_f32_16x16x32_bf16 v[44:47], a[84:87], a[28:31], v[44:47]
    s_waitcnt lgkmcnt(4)
    v_mfma_f32_16x16x32_bf16 v[48:51], a[88:91], a[0:3], v[48:51]
    ds_read_b64_tr_b16 a[72:73], v228 offset:16384
    v_mfma_f32_16x16x32_bf16 v[48:51], a[92:95], a[4:7], v[48:51]
    ds_read_b64_tr_b16 a[74:75], v228 offset:17408
    v_mfma_f32_16x16x32_bf16 v[52:55], a[88:91], a[8:11], v[52:55]
    ds_read_b64_tr_b16 a[76:77], v228 offset:24576
    v_mfma_f32_16x16x32_bf16 v[52:55], a[92:95], a[12:15], v[52:55]
    ds_read_b64_tr_b16 a[78:79], v228 offset:25600
    v_mfma_f32_16x16x32_bf16 v[56:59], a[88:91], a[16:19], v[56:59]
    v_mfma_f32_16x16x32_bf16 v[56:59], a[92:95], a[20:23], v[56:59]
    v_mfma_f32_16x16x32_bf16 v[60:63], a[88:91], a[24:27], v[60:63]
    buffer_load_dwordx4 v221, s[36:39], s65 offen offset:1024  lds
    v_mfma_f32_16x16x32_bf16 v[60:63], a[92:95], a[28:31], v[60:63]
    s_waitcnt lgkmcnt(4)
    v_mfma_f32_16x16x32_bf16 v[64:67], a[64:67], a[0:3], v[64:67]
    ds_read_b64_tr_b16 a[80:81], v229 offset:0
    v_mfma_f32_16x16x32_bf16 v[64:67], a[68:71], a[4:7], v[64:67]
    ds_read_b64_tr_b16 a[82:83], v229 offset:1024
    v_mfma_f32_16x16x32_bf16 v[68:71], a[64:67], a[8:11], v[68:71]
    ds_read_b64_tr_b16 a[84:85], v229 offset:8192
    v_mfma_f32_16x16x32_bf16 v[68:71], a[68:71], a[12:15], v[68:71]
    ds_read_b64_tr_b16 a[86:87], v229 offset:9216
    v_mfma_f32_16x16x32_bf16 v[72:75], a[64:67], a[16:19], v[72:75]
    v_mfma_f32_16x16x32_bf16 v[72:75], a[68:71], a[20:23], v[72:75]
    v_mfma_f32_16x16x32_bf16 v[76:79], a[64:67], a[24:27], v[76:79]
    buffer_load_dwordx4 v222, s[36:39], s65 offen offset:2048  lds
    v_mfma_f32_16x16x32_bf16 v[76:79], a[68:71], a[28:31], v[76:79]
    s_waitcnt lgkmcnt(4)
    v_mfma_f32_16x16x32_bf16 v[80:83], a[72:75], a[0:3], v[80:83]
    ds_read_b64_tr_b16 a[88:89], v229 offset:16384
    v_mfma_f32_16x16x32_bf16 v[80:83], a[76:79], a[4:7], v[80:83]
    ds_read_b64_tr_b16 a[90:91], v229 offset:17408
    v_mfma_f32_16x16x32_bf16 v[84:87], a[72:75], a[8:11], v[84:87]
    ds_read_b64_tr_b16 a[92:93], v229 offset:24576
    v_mfma_f32_16x16x32_bf16 v[84:87], a[76:79], a[12:15], v[84:87]
    ds_read_b64_tr_b16 a[94:95], v229 offset:25600
    v_mfma_f32_16x16x32_bf16 v[88:91], a[72:75], a[16:19], v[88:91]
    v_mfma_f32_16x16x32_bf16 v[88:91], a[76:79], a[20:23], v[88:91]
    s_xor_b32 s67, s67, 32768
    v_mfma_f32_16x16x32_bf16 v[92:95], a[72:75], a[24:27], v[92:95]
    buffer_load_dwordx4 v223, s[36:39], s65 offen offset:3072  lds
    s_add_u32 s65, s65, 458752
    v_mfma_f32_16x16x32_bf16 v[92:95], a[76:79], a[28:31], v[92:95]
    s_waitcnt lgkmcnt(4)
    v_mfma_f32_16x16x32_bf16 v[96:99], a[80:83], a[0:3], v[96:99]
    ds_read_b64_tr_b16 a[64:65], v230 offset:0
    v_mfma_f32_16x16x32_bf16 v[96:99], a[84:87], a[4:7], v[96:99]
    ds_read_b64_tr_b16 a[66:67], v230 offset:1024
    v_mfma_f32_16x16x32_bf16 v[100:103], a[80:83], a[8:11], v[100:103]
    ds_read_b64_tr_b16 a[68:69], v230 offset:8192
    buffer_load_dword v240, v234, s[40:43], s68 offen
    s_add_u32 s68, s68, 458752
    v_mfma_f32_16x16x32_bf16 v[100:103], a[84:87], a[12:15], v[100:103]
    ds_read_b64_tr_b16 a[70:71], v230 offset:9216
    buffer_load_dword v241, v235, s[44:47], s69 offen
    s_add_u32 s69, s69, 512
    v_mfma_f32_16x16x32_bf16 v[104:107], a[80:83], a[16:19], v[104:107]
    v_mfma_f32_16x16x32_bf16 v[104:107], a[84:87], a[20:23], v[104:107]
    s_mov_b32 m0, s66
    v_mfma_f32_16x16x32_bf16 v[108:111], a[80:83], a[24:27], v[108:111]
    buffer_load_dwordx4 v208, s[32:35], s64 offen offset:0  lds
    v_mfma_f32_16x16x32_bf16 v[108:111], a[84:87], a[28:31], v[108:111]
    s_waitcnt lgkmcnt(4)
    v_mfma_f32_16x16x32_bf16 v[112:115], a[88:91], a[0:3], v[112:115]
    ds_read_b64_tr_b16 a[72:73], v230 offset:16384
    v_mfma_f32_16x16x32_bf16 v[112:115], a[92:95], a[4:7], v[112:115]
    ds_read_b64_tr_b16 a[74:75], v230 offset:17408
    v_mfma_f32_16x16x32_bf16 v[116:119], a[88:91], a[8:11], v[116:119]
    ds_read_b64_tr_b16 a[76:77], v230 offset:24576
    v_mfma_f32_16x16x32_bf16 v[116:119], a[92:95], a[12:15], v[116:119]
    ds_read_b64_tr_b16 a[78:79], v230 offset:25600
    v_mfma_f32_16x16x32_bf16 v[120:123], a[88:91], a[16:19], v[120:123]
    ds_read_b64_tr_b16 a[192:193], v250 offset:32768
    v_mfma_f32_16x16x32_bf16 v[120:123], a[92:95], a[20:23], v[120:123]
    v_mfma_f32_16x16x32_bf16 v[124:127], a[88:91], a[24:27], v[124:127]
    buffer_load_dwordx4 v209, s[32:35], s64 offen offset:1024  lds
    ds_read_b64_tr_b16 a[194:195], v250 offset:34816
    v_mfma_f32_16x16x32_bf16 v[124:127], a[92:95], a[28:31], v[124:127]
    s_waitcnt lgkmcnt(6)
    ds_read_b64_tr_b16 a[196:197], v251 offset:32768
    v_mfma_f32_16x16x32_bf16 v[128:131], a[64:67], a[0:3], v[128:131]
    ds_read_b64_tr_b16 a[80:81], v231 offset:0
    v_mfma_f32_16x16x32_bf16 v[128:131], a[68:71], a[4:7], v[128:131]
    ds_read_b64_tr_b16 a[82:83], v231 offset:1024
    v_mfma_f32_16x16x32_bf16 v[132:135], a[64:67], a[8:11], v[132:135]
    ds_read_b64_tr_b16 a[84:85], v231 offset:8192
    v_mfma_f32_16x16x32_bf16 v[132:135], a[68:71], a[12:15], v[132:135]
    ds_read_b64_tr_b16 a[86:87], v231 offset:9216
    s_waitcnt vmcnt(13)
    v_mfma_f32_16x16x32_bf16 v[136:139], a[64:67], a[16:19], v[136:139]
    ds_read_b128 a[32:35], v224 offset:8192
    v_mfma_f32_16x16x32_bf16 v[136:139], a[68:71], a[20:23], v[136:139]
    ds_read_b128 a[36:39], v225 offset:8192
    v_mfma_f32_16x16x32_bf16 v[140:143], a[64:67], a[24:27], v[140:143]
    buffer_load_dwordx4 v210, s[32:35], s64 offen offset:2048  lds
    ds_read_b64_tr_b16 a[198:199], v251 offset:34816
    v_mfma_f32_16x16x32_bf16 v[140:143], a[68:71], a[28:31], v[140:143]
    s_waitcnt lgkmcnt(10)
    ds_read_b64_tr_b16 a[200:201], v252 offset:32768
    v_mfma_f32_16x16x32_bf16 v[144:147], a[72:75], a[0:3], v[144:147]
    ds_read_b64_tr_b16 a[88:89], v231 offset:16384
    v_mfma_f32_16x16x32_bf16 v[144:147], a[76:79], a[4:7], v[144:147]
    ds_read_b64_tr_b16 a[90:91], v231 offset:17408
    v_mfma_f32_16x16x32_bf16 v[148:151], a[72:75], a[8:11], v[148:151]
    ds_read_b64_tr_b16 a[92:93], v231 offset:24576
    v_mfma_f32_16x16x32_bf16 v[148:151], a[76:79], a[12:15], v[148:151]
    ds_read_b64_tr_b16 a[94:95], v231 offset:25600
    v_mfma_f32_16x16x32_bf16 v[152:155], a[72:75], a[16:19], v[152:155]
    ds_read_b128 a[40:43], v224 offset:10240
    v_mfma_f32_16x16x32_bf16 v[152:155], a[76:79], a[20:23], v[152:155]
    ds_read_b128 a[44:47], v225 offset:10240
    v_mfma_f32_16x16x32_bf16 v[156:159], a[72:75], a[24:27], v[156:159]
    buffer_load_dwordx4 v211, s[32:35], s64 offen offset:3072  lds
    ds_read_b64_tr_b16 a[202:203], v252 offset:34816
    v_mfma_f32_16x16x32_bf16 v[156:159], a[76:79], a[28:31], v[156:159]
    s_waitcnt lgkmcnt(11)
    ds_read_b64_tr_b16 a[204:205], v253 offset:32768
    v_mfma_f32_16x16x32_bf16 v[160:163], a[80:83], a[0:3], v[160:163]
    ds_read_b64_tr_b16 a[64:65], v232 offset:0
    ds_read_b64_tr_b16 a[206:207], v253 offset:34816
    v_mfma_f32_16x16x32_bf16 v[160:163], a[84:87], a[4:7], v[160:163]
    ds_read_b64_tr_b16 a[66:67], v232 offset:1024
    v_mfma_f32_16x16x32_bf16 v[164:167], a[80:83], a[8:11], v[164:167]
    ds_read_b64_tr_b16 a[68:69], v232 offset:8192
    v_mfma_f32_16x16x32_bf16 v[164:167], a[84:87], a[12:15], v[164:167]
    ds_read_b64_tr_b16 a[70:71], v232 offset:9216
    v_mfma_f32_16x16x32_bf16 v[168:171], a[80:83], a[16:19], v[168:171]
    ds_read_b128 a[48:51], v224 offset:12288
    v_mfma_f32_16x16x32_bf16 v[168:171], a[84:87], a[20:23], v[168:171]
    ds_read_b128 a[52:55], v225 offset:12288
    s_add_u32 m0, s66, 4096
    v_mfma_f32_16x16x32_bf16 v[172:175], a[80:83], a[24:27], v[172:175]
    buffer_load_dwordx4 v212, s[32:35], s64 offen offset:0  lds
    v_mfma_f32_16x16x32_bf16 v[172:175], a[84:87], a[28:31], v[172:175]
    s_waitcnt lgkmcnt(11)
    v_mfma_f32_16x16x32_bf16 v[176:179], a[88:91], a[0:3], v[176:179]
    ds_read_b64_tr_b16 a[72:73], v232 offset:16384
    v_mfma_f32_16x16x32_bf16 v[176:179], a[92:95], a[4:7], v[176:179]
    ds_read_b64_tr_b16 a[74:75], v232 offset:17408
    v_mfma_f32_16x16x32_bf16 v[180:183], a[88:91], a[8:11], v[180:183]
    ds_read_b64_tr_b16 a[76:77], v232 offset:24576
    v_mfma_f32_16x16x32_bf16 v[180:183], a[92:95], a[12:15], v[180:183]
    ds_read_b64_tr_b16 a[78:79], v232 offset:25600
    v_mfma_f32_16x16x32_bf16 v[184:187], a[88:91], a[16:19], v[184:187]
    ds_read_b128 a[56:59], v224 offset:14336
    v_mfma_f32_16x16x32_bf16 v[184:187], a[92:95], a[20:23], v[184:187]
    ds_read_b128 a[60:63], v225 offset:14336
    v_mfma_f32_16x16x32_bf16 v[188:191], a[88:91], a[24:27], v[188:191]
    buffer_load_dwordx4 v213, s[32:35], s64 offen offset:1024  lds
    s_add_u32 s91, s77, 262144
    s_add_u32 m0, s79, 32768
    v_mfma_f32_16x16x32_bf16 v[188:191], a[92:95], a[28:31], v[188:191]
    s_waitcnt lgkmcnt(8)
    buffer_load_dwordx4 v246, s[44:47], s91 offen offset:0 lds
    v_mfma_f32_16x16x32_bf16 a[96:99], a[64:67], a[0:3], a[96:99]
    ds_read_b64_tr_b16 a[80:81], v233 offset:0
    v_mfma_f32_16x16x32_bf16 a[96:99], a[68:71], a[4:7], a[96:99]
    ds_read_b64_tr_b16 a[82:83], v233 offset:1024
    buffer_load_dwordx4 v247, s[44:47], s91 offen offset:1024 lds
    v_mfma_f32_16x16x32_bf16 a[100:103], a[64:67], a[8:11], a[100:103]
    ds_read_b64_tr_b16 a[84:85], v233 offset:8192
    v_mfma_f32_16x16x32_bf16 a[100:103], a[68:71], a[12:15], a[100:103]
    ds_read_b64_tr_b16 a[86:87], v233 offset:9216
    v_mfma_f32_16x16x32_bf16 a[104:107], a[64:67], a[16:19], a[104:107]
    ds_read_b64_tr_b16 a[88:89], v233 offset:16384
    v_mfma_f32_16x16x32_bf16 a[104:107], a[68:71], a[20:23], a[104:107]
    ds_read_b64_tr_b16 a[90:91], v233 offset:17408
    s_add_u32 m0, s66, 4096
    v_mfma_f32_16x16x32_bf16 a[108:111], a[64:67], a[24:27], a[108:111]
    ds_read_b64_tr_b16 a[92:93], v233 offset:24576
    buffer_load_dwordx4 v214, s[32:35], s64 offen offset:2048  lds
    v_mfma_f32_16x16x32_bf16 a[108:111], a[68:71], a[28:31], a[108:111]
    ds_read_b64_tr_b16 a[94:95], v233 offset:25600
    s_waitcnt lgkmcnt(10)
    v_mfma_f32_16x16x32_bf16 a[112:115], a[72:75], a[0:3], a[112:115]
    v_mfma_f32_16x16x32_bf16 a[112:115], a[76:79], a[4:7], a[112:115]
    v_mfma_f32_16x16x32_bf16 a[116:119], a[72:75], a[8:11], a[116:119]
    s_add_u32 m0, s79, 32768
    v_mfma_f32_16x16x32_bf16 a[116:119], a[76:79], a[12:15], a[116:119]
    buffer_load_dwordx4 v248, s[44:47], s91 offen offset:2048 lds
    v_mfma_f32_16x16x32_bf16 a[120:123], a[72:75], a[16:19], a[120:123]
    v_mfma_f32_16x16x32_bf16 a[120:123], a[76:79], a[20:23], a[120:123]
    s_add_u32 m0, s66, 4096
    s_xor_b32 s66, s66, 8192
    v_mfma_f32_16x16x32_bf16 a[124:127], a[72:75], a[24:27], a[124:127]
    buffer_load_dwordx4 v215, s[32:35], s64 offen offset:3072  lds
    s_add_u32 s64, s64, 128
    v_mfma_f32_16x16x32_bf16 a[124:127], a[76:79], a[28:31], a[124:127]
    s_waitcnt vmcnt(13) lgkmcnt(0)
    v_mfma_f32_16x16x32_bf16 a[128:131], a[80:83], a[0:3], a[128:131]
    s_barrier
    v_mfma_f32_16x16x32_bf16 a[128:131], a[84:87], a[4:7], a[128:131]
    ds_read_b64_tr_b16 a[64:65], v226 offset:32768
    v_mfma_f32_16x16x32_bf16 a[132:135], a[80:83], a[8:11], a[132:135]
    ds_read_b64_tr_b16 a[66:67], v226 offset:33792
    v_mfma_f32_16x16x32_bf16 a[132:135], a[84:87], a[12:15], a[132:135]
    ds_read_b64_tr_b16 a[68:69], v226 offset:40960
    s_add_u32 m0, s79, 32768
    v_mfma_f32_16x16x32_bf16 a[136:139], a[80:83], a[16:19], a[136:139]
    ds_read_b64_tr_b16 a[70:71], v226 offset:41984
    buffer_load_dwordx4 v249, s[44:47], s91 offen offset:3072 lds
    v_mfma_f32_16x16x32_bf16 a[136:139], a[84:87], a[20:23], a[136:139]
    s_mov_b32 m0, s67
    v_mfma_f32_16x16x32_bf16 a[140:143], a[80:83], a[24:27], a[140:143]
    buffer_load_dwordx4 v216, s[36:39], s65 offen offset:0  lds
    v_mfma_f32_16x16x32_bf16 a[140:143], a[84:87], a[28:31], a[140:143]
    v_mfma_f32_16x16x32_bf16 a[144:147], a[88:91], a[0:3], a[144:147]
    v_mfma_f32_16x16x32_bf16 a[144:147], a[92:95], a[4:7], a[144:147]
    ds_read_b64_tr_b16 a[72:73], v226 offset:49152
    v_mfma_f32_16x16x32_bf16 a[148:151], a[88:91], a[8:11], a[148:151]
    ds_read_b64_tr_b16 a[74:75], v226 offset:50176
    v_mfma_f32_16x16x32_bf16 a[148:151], a[92:95], a[12:15], a[148:151]
    ds_read_b64_tr_b16 a[76:77], v226 offset:57344
    v_mfma_f32_16x16x32_bf16 a[152:155], a[88:91], a[16:19], a[152:155]
    ds_read_b64_tr_b16 a[78:79], v226 offset:58368
    v_mfma_f32_16x16x32_bf16 a[152:155], a[92:95], a[20:23], a[152:155]
    v_mfma_f32_16x16x32_bf16 a[156:159], a[88:91], a[24:27], a[156:159]
    buffer_load_dwordx4 v217, s[36:39], s65 offen offset:1024  lds
    v_mfma_f32_16x16x32_bf16 a[156:159], a[92:95], a[28:31], a[156:159]
    s_waitcnt lgkmcnt(4)
    v_mfma_f32_16x16x32_bf16 v[0:3], a[64:67], a[32:35], v[0:3]
    ds_read_b64_tr_b16 a[80:81], v227 offset:32768
    v_mfma_f32_16x16x32_bf16 v[0:3], a[68:71], a[36:39], v[0:3]
    ds_read_b64_tr_b16 a[82:83], v227 offset:33792
    v_mfma_f32_16x16x32_bf16 v[4:7], a[64:67], a[40:43], v[4:7]
    ds_read_b64_tr_b16 a[84:85], v227 offset:40960
    v_mfma_f32_16x16x32_bf16 v[4:7], a[68:71], a[44:47], v[4:7]
    ds_read_b64_tr_b16 a[86:87], v227 offset:41984
    v_mfma_f32_16x16x32_bf16 v[8:11], a[64:67], a[48:51], v[8:11]
    v_mfma_f32_16x16x32_bf16 v[8:11], a[68:71], a[52:55], v[8:11]
    v_mfma_f32_16x16x32_bf16 v[12:15], a[64:67], a[56:59], v[12:15]
    buffer_load_dwordx4 v218, s[36:39], s65 offen offset:2048  lds
    v_mfma_f32_16x16x32_bf16 v[12:15], a[68:71], a[60:63], v[12:15]
    s_waitcnt lgkmcnt(4)
    v_mfma_f32_16x16x32_bf16 v[16:19], a[72:75], a[32:35], v[16:19]
    ds_read_b64_tr_b16 a[88:89], v227 offset:49152
    v_mfma_f32_16x16x32_bf16 v[16:19], a[76:79], a[36:39], v[16:19]
    ds_read_b64_tr_b16 a[90:91], v227 offset:50176
    v_mfma_f32_16x16x32_bf16 v[20:23], a[72:75], a[40:43], v[20:23]
    ds_read_b64_tr_b16 a[92:93], v227 offset:57344
    v_mfma_f32_16x16x32_bf16 v[20:23], a[76:79], a[44:47], v[20:23]
    ds_read_b64_tr_b16 a[94:95], v227 offset:58368
    v_mfma_f32_16x16x32_bf16 v[24:27], a[72:75], a[48:51], v[24:27]
    v_mfma_f32_16x16x32_bf16 v[24:27], a[76:79], a[52:55], v[24:27]
    v_mfma_f32_16x16x32_bf16 v[28:31], a[72:75], a[56:59], v[28:31]
    buffer_load_dwordx4 v219, s[36:39], s65 offen offset:3072  lds
    v_mfma_f32_16x16x32_bf16 v[28:31], a[76:79], a[60:63], v[28:31]
    s_waitcnt lgkmcnt(4)
    v_mfma_f32_16x16x32_bf16 v[32:35], a[80:83], a[32:35], v[32:35]
    ds_read_b64_tr_b16 a[64:65], v228 offset:32768
    v_mfma_f32_16x16x32_bf16 v[32:35], a[84:87], a[36:39], v[32:35]
    ds_read_b64_tr_b16 a[66:67], v228 offset:33792
    v_mfma_f32_16x16x32_bf16 v[36:39], a[80:83], a[40:43], v[36:39]
    ds_read_b64_tr_b16 a[68:69], v228 offset:40960
    v_mfma_f32_16x16x32_bf16 v[36:39], a[84:87], a[44:47], v[36:39]
    ds_read_b64_tr_b16 a[70:71], v228 offset:41984
    v_mfma_f32_16x16x32_bf16 v[40:43], a[80:83], a[48:51], v[40:43]
    v_mfma_f32_16x16x32_bf16 v[40:43], a[84:87], a[52:55], v[40:43]
    s_add_u32 m0, s67, 4096
    v_mfma_f32_16x16x32_bf16 v[44:47], a[80:83], a[56:59], v[44:47]
    buffer_load_dwordx4 v220, s[36:39], s65 offen offset:0  lds
    v_mfma_f32_16x16x32_bf16 v[44:47], a[84:87], a[60:63], v[44:47]
    s_waitcnt lgkmcnt(4)
    v_mfma_f32_16x16x32_bf16 v[48:51], a[88:91], a[32:35], v[48:51]
    ds_read_b64_tr_b16 a[72:73], v228 offset:49152
    v_mfma_f32_16x16x32_bf16 v[48:51], a[92:95], a[36:39], v[48:51]
    ds_read_b64_tr_b16 a[74:75], v228 offset:50176
    v_mfma_f32_16x16x32_bf16 v[52:55], a[88:91], a[40:43], v[52:55]
    ds_read_b64_tr_b16 a[76:77], v228 offset:57344
    v_mfma_f32_16x16x32_bf16 v[52:55], a[92:95], a[44:47], v[52:55]
    ds_read_b64_tr_b16 a[78:79], v228 offset:58368
    v_mfma_f32_16x16x32_bf16 v[56:59], a[88:91], a[48:51], v[56:59]
    v_mfma_f32_16x16x32_bf16 v[56:59], a[92:95], a[52:55], v[56:59]
    v_mfma_f32_16x16x32_bf16 v[60:63], a[88:91], a[56:59], v[60:63]
    buffer_load_dwordx4 v221, s[36:39], s65 offen offset:1024  lds
    v_mfma_f32_16x16x32_bf16 v[60:63], a[92:95], a[60:63], v[60:63]
    s_waitcnt lgkmcnt(4)
    v_mfma_f32_16x16x32_bf16 v[64:67], a[64:67], a[32:35], v[64:67]
    ds_read_b64_tr_b16 a[80:81], v229 offset:32768
    v_mfma_f32_16x16x32_bf16 v[64:67], a[68:71], a[36:39], v[64:67]
    ds_read_b64_tr_b16 a[82:83], v229 offset:33792
    v_mfma_f32_16x16x32_bf16 v[68:71], a[64:67], a[40:43], v[68:71]
    ds_read_b64_tr_b16 a[84:85], v229 offset:40960
    v_mfma_f32_16x16x32_bf16 v[68:71], a[68:71], a[44:47], v[68:71]
    ds_read_b64_tr_b16 a[86:87], v229 offset:41984
    v_mfma_f32_16x16x32_bf16 v[72:75], a[64:67], a[48:51], v[72:75]
    v_mfma_f32_16x16x32_bf16 v[72:75], a[68:71], a[52:55], v[72:75]
    v_mfma_f32_16x16x32_bf16 v[76:79], a[64:67], a[56:59], v[76:79]
    buffer_load_dwordx4 v222, s[36:39], s65 offen offset:2048  lds
    v_mfma_f32_16x16x32_bf16 v[76:79], a[68:71], a[60:63], v[76:79]
    s_waitcnt lgkmcnt(4)
    v_mfma_f32_16x16x32_bf16 v[80:83], a[72:75], a[32:35], v[80:83]
    ds_read_b64_tr_b16 a[88:89], v229 offset:49152
    v_mfma_f32_16x16x32_bf16 v[80:83], a[76:79], a[36:39], v[80:83]
    ds_read_b64_tr_b16 a[90:91], v229 offset:50176
    v_mfma_f32_16x16x32_bf16 v[84:87], a[72:75], a[40:43], v[84:87]
    ds_read_b64_tr_b16 a[92:93], v229 offset:57344
    v_mfma_f32_16x16x32_bf16 v[84:87], a[76:79], a[44:47], v[84:87]
    ds_read_b64_tr_b16 a[94:95], v229 offset:58368
    v_mfma_f32_16x16x32_bf16 v[88:91], a[72:75], a[48:51], v[88:91]
    v_mfma_f32_16x16x32_bf16 v[88:91], a[76:79], a[52:55], v[88:91]
    s_xor_b32 s67, s67, 32768
    v_mfma_f32_16x16x32_bf16 v[92:95], a[72:75], a[56:59], v[92:95]
    buffer_load_dwordx4 v223, s[36:39], s65 offen offset:3072  lds
    s_add_u32 s65, s65, 458752
    v_mfma_f32_16x16x32_bf16 v[92:95], a[76:79], a[60:63], v[92:95]
    s_waitcnt lgkmcnt(4)
    v_mfma_f32_16x16x32_bf16 v[96:99], a[80:83], a[32:35], v[96:99]
    ds_read_b64_tr_b16 a[64:65], v230 offset:32768
    v_mfma_f32_16x16x32_bf16 v[96:99], a[84:87], a[36:39], v[96:99]
    ds_read_b64_tr_b16 a[66:67], v230 offset:33792
    v_mfma_f32_16x16x32_bf16 v[100:103], a[80:83], a[40:43], v[100:103]
    ds_read_b64_tr_b16 a[68:69], v230 offset:40960
    v_mfma_f32_16x16x32_bf16 v[100:103], a[84:87], a[44:47], v[100:103]
    ds_read_b64_tr_b16 a[70:71], v230 offset:41984
    buffer_load_dword v242, v235, s[44:47], s69 offen
    s_add_u32 s69, s69, 457216
    v_mfma_f32_16x16x32_bf16 v[104:107], a[80:83], a[48:51], v[104:107]
    v_mfma_f32_16x16x32_bf16 v[104:107], a[84:87], a[52:55], v[104:107]
    s_mov_b32 m0, s66
    v_mfma_f32_16x16x32_bf16 v[108:111], a[80:83], a[56:59], v[108:111]
    buffer_load_dwordx4 v208, s[32:35], s64 offen offset:0  lds
    v_mfma_f32_16x16x32_bf16 v[108:111], a[84:87], a[60:63], v[108:111]
    s_waitcnt lgkmcnt(4)
    v_mfma_f32_16x16x32_bf16 v[112:115], a[88:91], a[32:35], v[112:115]
    ds_read_b64_tr_b16 a[72:73], v230 offset:49152
    v_mfma_f32_16x16x32_bf16 v[112:115], a[92:95], a[36:39], v[112:115]
    ds_read_b64_tr_b16 a[74:75], v230 offset:50176
    v_mfma_f32_16x16x32_bf16 v[116:119], a[88:91], a[40:43], v[116:119]
    ds_read_b64_tr_b16 a[76:77], v230 offset:57344
    v_mfma_f32_16x16x32_bf16 v[116:119], a[92:95], a[44:47], v[116:119]
    ds_read_b64_tr_b16 a[78:79], v230 offset:58368
    v_mfma_f32_16x16x32_bf16 v[120:123], a[88:91], a[48:51], v[120:123]
    ds_read_b64_tr_b16 a[208:209], v250 offset:36864
    v_mfma_f32_16x16x32_bf16 v[120:123], a[92:95], a[52:55], v[120:123]
    v_mfma_f32_16x16x32_bf16 v[124:127], a[88:91], a[56:59], v[124:127]
    buffer_load_dwordx4 v209, s[32:35], s64 offen offset:1024  lds
    ds_read_b64_tr_b16 a[210:211], v250 offset:38912
    v_mfma_f32_16x16x32_bf16 v[124:127], a[92:95], a[60:63], v[124:127]
    s_waitcnt lgkmcnt(6)
    ds_read_b64_tr_b16 a[212:213], v251 offset:36864
    v_mfma_f32_16x16x32_bf16 v[128:131], a[64:67], a[32:35], v[128:131]
    ds_read_b64_tr_b16 a[80:81], v231 offset:32768
    v_mfma_f32_16x16x32_bf16 v[128:131], a[68:71], a[36:39], v[128:131]
    ds_read_b64_tr_b16 a[82:83], v231 offset:33792
    v_mfma_f32_16x16x32_bf16 v[132:135], a[64:67], a[40:43], v[132:135]
    ds_read_b64_tr_b16 a[84:85], v231 offset:40960
    v_mfma_f32_16x16x32_bf16 v[132:135], a[68:71], a[44:47], v[132:135]
    ds_read_b64_tr_b16 a[86:87], v231 offset:41984
    s_waitcnt vmcnt(12)
    v_mfma_f32_16x16x32_bf16 v[136:139], a[64:67], a[48:51], v[136:139]
    ds_read_b128 a[0:3], v224 offset:0
    v_mfma_f32_16x16x32_bf16 v[136:139], a[68:71], a[52:55], v[136:139]
    ds_read_b128 a[4:7], v225 offset:0
    v_mfma_f32_16x16x32_bf16 v[140:143], a[64:67], a[56:59], v[140:143]
    buffer_load_dwordx4 v210, s[32:35], s64 offen offset:2048  lds
    ds_read_b64_tr_b16 a[214:215], v251 offset:38912
    v_mfma_f32_16x16x32_bf16 v[140:143], a[68:71], a[60:63], v[140:143]
    s_waitcnt lgkmcnt(10)
    ds_read_b64_tr_b16 a[216:217], v252 offset:36864
    v_mfma_f32_16x16x32_bf16 v[144:147], a[72:75], a[32:35], v[144:147]
    ds_read_b64_tr_b16 a[88:89], v231 offset:49152
    v_mfma_f32_16x16x32_bf16 v[144:147], a[76:79], a[36:39], v[144:147]
    ds_read_b64_tr_b16 a[90:91], v231 offset:50176
    v_mfma_f32_16x16x32_bf16 v[148:151], a[72:75], a[40:43], v[148:151]
    ds_read_b64_tr_b16 a[92:93], v231 offset:57344
    v_mfma_f32_16x16x32_bf16 v[148:151], a[76:79], a[44:47], v[148:151]
    ds_read_b64_tr_b16 a[94:95], v231 offset:58368
    v_mfma_f32_16x16x32_bf16 v[152:155], a[72:75], a[48:51], v[152:155]
    ds_read_b128 a[8:11], v224 offset:2048
    v_mfma_f32_16x16x32_bf16 v[152:155], a[76:79], a[52:55], v[152:155]
    ds_read_b128 a[12:15], v225 offset:2048
    v_mfma_f32_16x16x32_bf16 v[156:159], a[72:75], a[56:59], v[156:159]
    buffer_load_dwordx4 v211, s[32:35], s64 offen offset:3072  lds
    ds_read_b64_tr_b16 a[218:219], v252 offset:38912
    v_mfma_f32_16x16x32_bf16 v[156:159], a[76:79], a[60:63], v[156:159]
    s_waitcnt lgkmcnt(11)
    ds_read_b64_tr_b16 a[220:221], v253 offset:36864
    v_mfma_f32_16x16x32_bf16 v[160:163], a[80:83], a[32:35], v[160:163]
    ds_read_b64_tr_b16 a[64:65], v232 offset:32768
    ds_read_b64_tr_b16 a[222:223], v253 offset:38912
    v_mfma_f32_16x16x32_bf16 v[160:163], a[84:87], a[36:39], v[160:163]
    ds_read_b64_tr_b16 a[66:67], v232 offset:33792
    v_mfma_f32_16x16x32_bf16 v[164:167], a[80:83], a[40:43], v[164:167]
    ds_read_b64_tr_b16 a[68:69], v232 offset:40960
    v_mfma_f32_16x16x32_bf16 v[164:167], a[84:87], a[44:47], v[164:167]
    ds_read_b64_tr_b16 a[70:71], v232 offset:41984
    v_mfma_f32_16x16x32_bf16 v[168:171], a[80:83], a[48:51], v[168:171]
    ds_read_b128 a[16:19], v224 offset:4096
    v_mfma_f32_16x16x32_bf16 v[168:171], a[84:87], a[52:55], v[168:171]
    ds_read_b128 a[20:23], v225 offset:4096
    s_add_u32 m0, s66, 4096
    v_mfma_f32_16x16x32_bf16 v[172:175], a[80:83], a[56:59], v[172:175]
    buffer_load_dwordx4 v212, s[32:35], s64 offen offset:0  lds
    v_mfma_f32_16x16x32_bf16 v[172:175], a[84:87], a[60:63], v[172:175]
    s_waitcnt lgkmcnt(11)
    v_mfma_f32_16x16x32_bf16 v[176:179], a[88:91], a[32:35], v[176:179]
    ds_read_b64_tr_b16 a[72:73], v232 offset:49152
    v_mfma_f32_16x16x32_bf16 v[176:179], a[92:95], a[36:39], v[176:179]
    ds_read_b64_tr_b16 a[74:75], v232 offset:50176
    v_mfma_f32_16x16x32_bf16 v[180:183], a[88:91], a[40:43], v[180:183]
    ds_read_b64_tr_b16 a[76:77], v232 offset:57344
    v_mfma_f32_16x16x32_bf16 v[180:183], a[92:95], a[44:47], v[180:183]
    ds_read_b64_tr_b16 a[78:79], v232 offset:58368
    v_mfma_f32_16x16x32_bf16 v[184:187], a[88:91], a[48:51], v[184:187]
    ds_read_b128 a[24:27], v224 offset:6144
    v_mfma_f32_16x16x32_bf16 v[184:187], a[92:95], a[52:55], v[184:187]
    ds_read_b128 a[28:31], v225 offset:6144
    v_mfma_f32_16x16x32_bf16 v[188:191], a[88:91], a[56:59], v[188:191]
    buffer_load_dwordx4 v213, s[32:35], s64 offen offset:1024  lds
    s_add_u32 s78, s77, 327680
    s_add_u32 m0, s79, 36864
    v_mfma_f32_16x16x32_bf16 v[188:191], a[92:95], a[60:63], v[188:191]
    s_waitcnt lgkmcnt(8)
    buffer_load_dwordx4 v246, s[44:47], s78 offen offset:0 lds
    v_mfma_f32_16x16x32_bf16 a[96:99], a[64:67], a[32:35], a[96:99]
    ds_read_b64_tr_b16 a[80:81], v233 offset:32768
    v_mfma_f32_16x16x32_bf16 a[96:99], a[68:71], a[36:39], a[96:99]
    ds_read_b64_tr_b16 a[82:83], v233 offset:33792
    buffer_load_dwordx4 v247, s[44:47], s78 offen offset:1024 lds
    v_mfma_f32_16x16x32_bf16 a[100:103], a[64:67], a[40:43], a[100:103]
    ds_read_b64_tr_b16 a[84:85], v233 offset:40960
    v_mfma_f32_16x16x32_bf16 a[100:103], a[68:71], a[44:47], a[100:103]
    ds_read_b64_tr_b16 a[86:87], v233 offset:41984
    v_mfma_f32_16x16x32_bf16 a[104:107], a[64:67], a[48:51], a[104:107]
    ds_read_b64_tr_b16 a[88:89], v233 offset:49152
    v_mfma_f32_16x16x32_bf16 a[104:107], a[68:71], a[52:55], a[104:107]
    ds_read_b64_tr_b16 a[90:91], v233 offset:50176
    s_add_u32 m0, s66, 4096
    v_mfma_f32_16x16x32_bf16 a[108:111], a[64:67], a[56:59], a[108:111]
    ds_read_b64_tr_b16 a[92:93], v233 offset:57344
    buffer_load_dwordx4 v214, s[32:35], s64 offen offset:2048  lds
    v_mfma_f32_16x16x32_bf16 a[108:111], a[68:71], a[60:63], a[108:111]
    ds_read_b64_tr_b16 a[94:95], v233 offset:58368
    s_waitcnt lgkmcnt(10)
    v_mfma_f32_16x16x32_bf16 a[112:115], a[72:75], a[32:35], a[112:115]
    v_mfma_f32_16x16x32_bf16 a[112:115], a[76:79], a[36:39], a[112:115]
    v_mfma_f32_16x16x32_bf16 a[116:119], a[72:75], a[40:43], a[116:119]
    s_add_u32 m0, s79, 36864
    v_mfma_f32_16x16x32_bf16 a[116:119], a[76:79], a[44:47], a[116:119]
    buffer_load_dwordx4 v248, s[44:47], s78 offen offset:2048 lds
    v_mfma_f32_16x16x32_bf16 a[120:123], a[72:75], a[48:51], a[120:123]
    v_mfma_f32_16x16x32_bf16 a[120:123], a[76:79], a[52:55], a[120:123]
    s_add_u32 m0, s66, 4096
    s_xor_b32 s66, s66, 8192
    v_mfma_f32_16x16x32_bf16 a[124:127], a[72:75], a[56:59], a[124:127]
    buffer_load_dwordx4 v215, s[32:35], s64 offen offset:3072  lds
    s_add_u32 s64, s64, 128
    v_mfma_f32_16x16x32_bf16 a[124:127], a[76:79], a[60:63], a[124:127]
    s_waitcnt vmcnt(12) lgkmcnt(0)
    v_mfma_f32_16x16x32_bf16 a[128:131], a[80:83], a[32:35], a[128:131]
    s_barrier
    v_mfma_f32_16x16x32_bf16 a[128:131], a[84:87], a[36:39], a[128:131]
    ds_read_b64_tr_b16 a[64:65], v226 offset:0
    v_mfma_f32_16x16x32_bf16 a[132:135], a[80:83], a[40:43], a[132:135]
    ds_read_b64_tr_b16 a[66:67], v226 offset:1024
    v_mfma_f32_16x16x32_bf16 a[132:135], a[84:87], a[44:47], a[132:135]
    ds_read_b64_tr_b16 a[68:69], v226 offset:8192
    s_add_u32 m0, s79, 36864
    v_mfma_f32_16x16x32_bf16 a[136:139], a[80:83], a[48:51], a[136:139]
    ds_read_b64_tr_b16 a[70:71], v226 offset:9216
    buffer_load_dwordx4 v249, s[44:47], s78 offen offset:3072 lds
    v_mfma_f32_16x16x32_bf16 a[136:139], a[84:87], a[52:55], a[136:139]
    s_mov_b32 m0, s67
    v_mfma_f32_16x16x32_bf16 a[140:143], a[80:83], a[56:59], a[140:143]
    buffer_load_dwordx4 v216, s[36:39], s65 offen offset:0  lds
    v_mfma_f32_16x16x32_bf16 a[140:143], a[84:87], a[60:63], a[140:143]
    v_mfma_f32_16x16x32_bf16 a[144:147], a[88:91], a[32:35], a[144:147]
    v_mfma_f32_16x16x32_bf16 a[144:147], a[92:95], a[36:39], a[144:147]
    ds_read_b64_tr_b16 a[72:73], v226 offset:16384
    v_mfma_f32_16x16x32_bf16 a[148:151], a[88:91], a[40:43], a[148:151]
    ds_read_b64_tr_b16 a[74:75], v226 offset:17408
    v_mfma_f32_16x16x32_bf16 a[148:151], a[92:95], a[44:47], a[148:151]
    ds_read_b64_tr_b16 a[76:77], v226 offset:24576
    v_mfma_f32_16x16x32_bf16 a[152:155], a[88:91], a[48:51], a[152:155]
    ds_read_b64_tr_b16 a[78:79], v226 offset:25600
    v_mfma_f32_16x16x32_bf16 a[152:155], a[92:95], a[52:55], a[152:155]
    v_mfma_f32_16x16x32_bf16 a[156:159], a[88:91], a[56:59], a[156:159]
    buffer_load_dwordx4 v217, s[36:39], s65 offen offset:1024  lds
    v_mfma_f32_16x16x32_bf16 a[156:159], a[92:95], a[60:63], a[156:159]
    s_waitcnt lgkmcnt(4)
    v_mfma_f32_16x16x32_bf16 v[0:3], a[64:67], a[0:3], v[0:3]
    ds_read_b64_tr_b16 a[80:81], v227 offset:0
    v_mfma_f32_16x16x32_bf16 v[0:3], a[68:71], a[4:7], v[0:3]
    ds_read_b64_tr_b16 a[82:83], v227 offset:1024
    v_mfma_f32_16x16x32_bf16 v[4:7], a[64:67], a[8:11], v[4:7]
    ds_read_b64_tr_b16 a[84:85], v227 offset:8192
    v_mfma_f32_16x16x32_bf16 v[4:7], a[68:71], a[12:15], v[4:7]
    ds_read_b64_tr_b16 a[86:87], v227 offset:9216
    v_mfma_f32_16x16x32_bf16 v[8:11], a[64:67], a[16:19], v[8:11]
    v_mfma_f32_16x16x32_bf16 v[8:11], a[68:71], a[20:23], v[8:11]
    v_mfma_f32_16x16x32_bf16 v[12:15], a[64:67], a[24:27], v[12:15]
    buffer_load_dwordx4 v218, s[36:39], s65 offen offset:2048  lds
    v_mfma_f32_16x16x32_bf16 v[12:15], a[68:71], a[28:31], v[12:15]
    s_waitcnt lgkmcnt(4)
    v_mfma_f32_16x16x32_bf16 v[16:19], a[72:75], a[0:3], v[16:19]
    ds_read_b64_tr_b16 a[88:89], v227 offset:16384
    v_mfma_f32_16x16x32_bf16 v[16:19], a[76:79], a[4:7], v[16:19]
    ds_read_b64_tr_b16 a[90:91], v227 offset:17408
    v_mfma_f32_16x16x32_bf16 v[20:23], a[72:75], a[8:11], v[20:23]
    ds_read_b64_tr_b16 a[92:93], v227 offset:24576
    s_mov_b32 s52, s12
    v_mfma_f32_16x16x32_bf16 v[20:23], a[76:79], a[12:15], v[20:23]
    ds_read_b64_tr_b16 a[94:95], v227 offset:25600
    v_mfma_f32_16x16x32_bf16 v[24:27], a[72:75], a[16:19], v[24:27]
    v_mfma_f32_16x16x32_bf16 v[24:27], a[76:79], a[20:23], v[24:27]
    s_and_b32 s53, s13, 0xffff
    v_mfma_f32_16x16x32_bf16 v[28:31], a[72:75], a[24:27], v[28:31]
    buffer_load_dwordx4 v219, s[36:39], s65 offen offset:3072  lds
    v_mfma_f32_16x16x32_bf16 v[28:31], a[76:79], a[28:31], v[28:31]
    s_waitcnt lgkmcnt(4)
    v_mfma_f32_16x16x32_bf16 v[32:35], a[80:83], a[0:3], v[32:35]
    ds_read_b64_tr_b16 a[64:65], v228 offset:0
    s_mov_b32 s54, 4194304
    v_mfma_f32_16x16x32_bf16 v[32:35], a[84:87], a[4:7], v[32:35]
    ds_read_b64_tr_b16 a[66:67], v228 offset:1024
    v_mfma_f32_16x16x32_bf16 v[36:39], a[80:83], a[8:11], v[36:39]
    ds_read_b64_tr_b16 a[68:69], v228 offset:8192
    v_mfma_f32_16x16x32_bf16 v[36:39], a[84:87], a[12:15], v[36:39]
    ds_read_b64_tr_b16 a[70:71], v228 offset:9216
    s_mov_b32 s55, 0x20000
    v_mfma_f32_16x16x32_bf16 v[40:43], a[80:83], a[16:19], v[40:43]
    v_mfma_f32_16x16x32_bf16 v[40:43], a[84:87], a[20:23], v[40:43]
    s_add_u32 m0, s67, 4096
    v_mfma_f32_16x16x32_bf16 v[44:47], a[80:83], a[24:27], v[44:47]
    buffer_load_dwordx4 v220, s[36:39], s65 offen offset:0  lds
    s_lshl2_add_u32 s73, s2, s30
    v_mfma_f32_16x16x32_bf16 v[44:47], a[84:87], a[28:31], v[44:47]
    s_waitcnt lgkmcnt(4)
    v_mfma_f32_16x16x32_bf16 v[48:51], a[88:91], a[0:3], v[48:51]
    ds_read_b64_tr_b16 a[72:73], v228 offset:16384
    v_mfma_f32_16x16x32_bf16 v[48:51], a[92:95], a[4:7], v[48:51]
    ds_read_b64_tr_b16 a[74:75], v228 offset:17408
    s_mul_i32 s95, s30, 8288
    v_mfma_f32_16x16x32_bf16 v[52:55], a[88:91], a[8:11], v[52:55]
    ds_read_b64_tr_b16 a[76:77], v228 offset:24576
    v_mfma_f32_16x16x32_bf16 v[52:55], a[92:95], a[12:15], v[52:55]
    ds_read_b64_tr_b16 a[78:79], v228 offset:25600
    v_mfma_f32_16x16x32_bf16 v[56:59], a[88:91], a[16:19], v[56:59]
    s_add_u32 s95, s95, 65536
    v_mfma_f32_16x16x32_bf16 v[56:59], a[92:95], a[20:23], v[56:59]
    v_mfma_f32_16x16x32_bf16 v[60:63], a[88:91], a[24:27], v[60:63]
    buffer_load_dwordx4 v221, s[36:39], s65 offen offset:1024  lds
    v_mfma_f32_16x16x32_bf16 v[60:63], a[92:95], a[28:31], v[60:63]
    s_waitcnt lgkmcnt(4)
    s_mul_i32 s89, s30, 4576
    v_mfma_f32_16x16x32_bf16 v[64:67], a[64:67], a[0:3], v[64:67]
    ds_read_b64_tr_b16 a[80:81], v229 offset:0
    v_mfma_f32_16x16x32_bf16 v[64:67], a[68:71], a[4:7], v[64:67]
    ds_read_b64_tr_b16 a[82:83], v229 offset:1024
    v_mfma_f32_16x16x32_bf16 v[68:71], a[64:67], a[8:11], v[68:71]
    ds_read_b64_tr_b16 a[84:85], v229 offset:8192
    s_add_u32 s89, s89, 98688
    v_mfma_f32_16x16x32_bf16 v[68:71], a[68:71], a[12:15], v[68:71]
    ds_read_b64_tr_b16 a[86:87], v229 offset:9216
    v_mfma_f32_16x16x32_bf16 v[72:75], a[64:67], a[16:19], v[72:75]
    v_mfma_f32_16x16x32_bf16 v[72:75], a[68:71], a[20:23], v[72:75]
    s_lshl_b32 s74, s73, 12
    v_mfma_f32_16x16x32_bf16 v[76:79], a[64:67], a[24:27], v[76:79]
    buffer_load_dwordx4 v222, s[36:39], s65 offen offset:2048  lds
    v_mfma_f32_16x16x32_bf16 v[76:79], a[68:71], a[28:31], v[76:79]
    s_waitcnt lgkmcnt(4)
    v_mfma_f32_16x16x32_bf16 v[80:83], a[72:75], a[0:3], v[80:83]
    ds_read_b64_tr_b16 a[88:89], v229 offset:16384
    v_lshrrev_b32 v196, 5, v244
    v_mfma_f32_16x16x32_bf16 v[80:83], a[76:79], a[4:7], v[80:83]
    ds_read_b64_tr_b16 a[90:91], v229 offset:17408
    v_mfma_f32_16x16x32_bf16 v[84:87], a[72:75], a[8:11], v[84:87]
    ds_read_b64_tr_b16 a[92:93], v229 offset:24576
    v_mfma_f32_16x16x32_bf16 v[84:87], a[76:79], a[12:15], v[84:87]
    ds_read_b64_tr_b16 a[94:95], v229 offset:25600
    v_lshlrev_b32 v196, 31, v196
    v_mfma_f32_16x16x32_bf16 v[88:91], a[72:75], a[16:19], v[88:91]
    v_mfma_f32_16x16x32_bf16 v[88:91], a[76:79], a[20:23], v[88:91]
    v_lshl_add_u32 v196, v244, 7, v196
    s_xor_b32 s67, s67, 32768
    v_mfma_f32_16x16x32_bf16 v[92:95], a[72:75], a[24:27], v[92:95]
    buffer_load_dwordx4 v223, s[36:39], s65 offen offset:3072  lds
    s_add_u32 s65, s65, 458752
    v_mfma_f32_16x16x32_bf16 v[92:95], a[76:79], a[28:31], v[92:95]
    s_waitcnt lgkmcnt(4)
    v_mfma_f32_16x16x32_bf16 v[96:99], a[80:83], a[0:3], v[96:99]
    ds_read_b64_tr_b16 a[64:65], v230 offset:0
    v_mfma_f32_16x16x32_bf16 v[96:99], a[84:87], a[4:7], v[96:99]
    ds_read_b64_tr_b16 a[66:67], v230 offset:1024
    buffer_load_dword v236, v196, s[52:55], s74 offen nt
    v_mfma_f32_16x16x32_bf16 v[100:103], a[80:83], a[8:11], v[100:103]
    ds_read_b64_tr_b16 a[68:69], v230 offset:8192
    v_mfma_f32_16x16x32_bf16 v[100:103], a[84:87], a[12:15], v[100:103]
    ds_read_b64_tr_b16 a[70:71], v230 offset:9216
    buffer_load_dword v243, v235, s[44:47], s69 offen
    s_add_u32 s69, s69, 512
    v_mfma_f32_16x16x32_bf16 v[104:107], a[80:83], a[16:19], v[104:107]
    v_mfma_f32_16x16x32_bf16 v[104:107], a[84:87], a[20:23], v[104:107]
    s_mov_b32 m0, s66
    v_mfma_f32_16x16x32_bf16 v[108:111], a[80:83], a[24:27], v[108:111]
    buffer_load_dwordx4 v208, s[32:35], s64 offen offset:0  lds
    v_mfma_f32_16x16x32_bf16 v[108:111], a[84:87], a[28:31], v[108:111]
    s_waitcnt lgkmcnt(4)
    v_mfma_f32_16x16x32_bf16 v[112:115], a[88:91], a[0:3], v[112:115]
    ds_read_b64_tr_b16 a[72:73], v230 offset:16384
    v_mfma_f32_16x16x32_bf16 v[112:115], a[92:95], a[4:7], v[112:115]
    ds_read_b64_tr_b16 a[74:75], v230 offset:17408
    v_mfma_f32_16x16x32_bf16 v[116:119], a[88:91], a[8:11], v[116:119]
    ds_read_b64_tr_b16 a[76:77], v230 offset:24576
    v_mfma_f32_16x16x32_bf16 v[116:119], a[92:95], a[12:15], v[116:119]
    ds_read_b64_tr_b16 a[78:79], v230 offset:25600
    v_mfma_f32_16x16x32_bf16 v[120:123], a[88:91], a[16:19], v[120:123]
    ds_read_b64_tr_b16 a[224:225], v250 offset:32768
    v_mfma_f32_16x16x32_bf16 v[120:123], a[92:95], a[20:23], v[120:123]
    v_mfma_f32_16x16x32_bf16 v[124:127], a[88:91], a[24:27], v[124:127]
    buffer_load_dwordx4 v209, s[32:35], s64 offen offset:1024  lds
    ds_read_b64_tr_b16 a[226:227], v250 offset:34816
    v_mfma_f32_16x16x32_bf16 v[124:127], a[92:95], a[28:31], v[124:127]
    s_waitcnt lgkmcnt(6)
    ds_read_b64_tr_b16 a[228:229], v251 offset:32768
    v_mfma_f32_16x16x32_bf16 v[128:131], a[64:67], a[0:3], v[128:131]
    ds_read_b64_tr_b16 a[80:81], v231 offset:0
    v_mfma_f32_16x16x32_bf16 v[128:131], a[68:71], a[4:7], v[128:131]
    ds_read_b64_tr_b16 a[82:83], v231 offset:1024
    v_mfma_f32_16x16x32_bf16 v[132:135], a[64:67], a[8:11], v[132:135]
    ds_read_b64_tr_b16 a[84:85], v231 offset:8192
    v_mfma_f32_16x16x32_bf16 v[132:135], a[68:71], a[12:15], v[132:135]
    ds_read_b64_tr_b16 a[86:87], v231 offset:9216
    s_waitcnt vmcnt(13)
    v_mfma_f32_16x16x32_bf16 v[136:139], a[64:67], a[16:19], v[136:139]
    ds_read_b128 a[32:35], v224 offset:8192
    v_mfma_f32_16x16x32_bf16 v[136:139], a[68:71], a[20:23], v[136:139]
    ds_read_b128 a[36:39], v225 offset:8192
    v_mfma_f32_16x16x32_bf16 v[140:143], a[64:67], a[24:27], v[140:143]
    buffer_load_dwordx4 v210, s[32:35], s64 offen offset:2048  lds
    ds_read_b64_tr_b16 a[230:231], v251 offset:34816
    v_mfma_f32_16x16x32_bf16 v[140:143], a[68:71], a[28:31], v[140:143]
    s_waitcnt lgkmcnt(10)
    ds_read_b64_tr_b16 a[232:233], v252 offset:32768
    v_mfma_f32_16x16x32_bf16 v[144:147], a[72:75], a[0:3], v[144:147]
    ds_read_b64_tr_b16 a[88:89], v231 offset:16384
    v_mfma_f32_16x16x32_bf16 v[144:147], a[76:79], a[4:7], v[144:147]
    ds_read_b64_tr_b16 a[90:91], v231 offset:17408
    v_mfma_f32_16x16x32_bf16 v[148:151], a[72:75], a[8:11], v[148:151]
    ds_read_b64_tr_b16 a[92:93], v231 offset:24576
    v_mfma_f32_16x16x32_bf16 v[148:151], a[76:79], a[12:15], v[148:151]
    ds_read_b64_tr_b16 a[94:95], v231 offset:25600
    v_mfma_f32_16x16x32_bf16 v[152:155], a[72:75], a[16:19], v[152:155]
    ds_read_b128 a[40:43], v224 offset:10240
    v_mfma_f32_16x16x32_bf16 v[152:155], a[76:79], a[20:23], v[152:155]
    ds_read_b128 a[44:47], v225 offset:10240
    v_mfma_f32_16x16x32_bf16 v[156:159], a[72:75], a[24:27], v[156:159]
    buffer_load_dwordx4 v211, s[32:35], s64 offen offset:3072  lds
    ds_read_b64_tr_b16 a[234:235], v252 offset:34816
    v_mfma_f32_16x16x32_bf16 v[156:159], a[76:79], a[28:31], v[156:159]
    s_waitcnt lgkmcnt(11)
    ds_read_b64_tr_b16 a[236:237], v253 offset:32768
    v_mfma_f32_16x16x32_bf16 v[160:163], a[80:83], a[0:3], v[160:163]
    ds_read_b64_tr_b16 a[64:65], v232 offset:0
    ds_read_b64_tr_b16 a[238:239], v253 offset:34816
    v_mfma_f32_16x16x32_bf16 v[160:163], a[84:87], a[4:7], v[160:163]
    ds_read_b64_tr_b16 a[66:67], v232 offset:1024
    v_mfma_f32_16x16x32_bf16 v[164:167], a[80:83], a[8:11], v[164:167]
    ds_read_b64_tr_b16 a[68:69], v232 offset:8192
    v_mfma_f32_16x16x32_bf16 v[164:167], a[84:87], a[12:15], v[164:167]
    ds_read_b64_tr_b16 a[70:71], v232 offset:9216
    v_mfma_f32_16x16x32_bf16 v[168:171], a[80:83], a[16:19], v[168:171]
    ds_read_b128 a[48:51], v224 offset:12288
    v_mfma_f32_16x16x32_bf16 v[168:171], a[84:87], a[20:23], v[168:171]
    ds_read_b128 a[52:55], v225 offset:12288
    s_add_u32 m0, s66, 4096
    v_mfma_f32_16x16x32_bf16 v[172:175], a[80:83], a[24:27], v[172:175]
    buffer_load_dwordx4 v212, s[32:35], s64 offen offset:0  lds
    v_mfma_f32_16x16x32_bf16 v[172:175], a[84:87], a[28:31], v[172:175]
    s_waitcnt lgkmcnt(11)
    v_mfma_f32_16x16x32_bf16 v[176:179], a[88:91], a[0:3], v[176:179]
    ds_read_b64_tr_b16 a[72:73], v232 offset:16384
    v_mfma_f32_16x16x32_bf16 v[176:179], a[92:95], a[4:7], v[176:179]
    ds_read_b64_tr_b16 a[74:75], v232 offset:17408
    v_mfma_f32_16x16x32_bf16 v[180:183], a[88:91], a[8:11], v[180:183]
    ds_read_b64_tr_b16 a[76:77], v232 offset:24576
    v_mfma_f32_16x16x32_bf16 v[180:183], a[92:95], a[12:15], v[180:183]
    ds_read_b64_tr_b16 a[78:79], v232 offset:25600
    v_mfma_f32_16x16x32_bf16 v[184:187], a[88:91], a[16:19], v[184:187]
    ds_read_b128 a[56:59], v224 offset:14336
    v_mfma_f32_16x16x32_bf16 v[184:187], a[92:95], a[20:23], v[184:187]
    ds_read_b128 a[60:63], v225 offset:14336
    v_mfma_f32_16x16x32_bf16 v[188:191], a[88:91], a[24:27], v[188:191]
    buffer_load_dwordx4 v213, s[32:35], s64 offen offset:1024  lds
    s_add_u32 s91, s77, 393216
    s_add_u32 m0, s79, 32768
    v_mfma_f32_16x16x32_bf16 v[188:191], a[92:95], a[28:31], v[188:191]
    s_waitcnt lgkmcnt(8)
    buffer_load_dwordx4 v246, s[44:47], s91 offen offset:0 lds
    v_mfma_f32_16x16x32_bf16 a[96:99], a[64:67], a[0:3], a[96:99]
    ds_read_b64_tr_b16 a[80:81], v233 offset:0
    v_mfma_f32_16x16x32_bf16 a[96:99], a[68:71], a[4:7], a[96:99]
    ds_read_b64_tr_b16 a[82:83], v233 offset:1024
    buffer_load_dwordx4 v247, s[44:47], s91 offen offset:1024 lds
    v_mfma_f32_16x16x32_bf16 a[100:103], a[64:67], a[8:11], a[100:103]
    ds_read_b64_tr_b16 a[84:85], v233 offset:8192
    v_mfma_f32_16x16x32_bf16 a[100:103], a[68:71], a[12:15], a[100:103]
    ds_read_b64_tr_b16 a[86:87], v233 offset:9216
    v_mfma_f32_16x16x32_bf16 a[104:107], a[64:67], a[16:19], a[104:107]
    ds_read_b64_tr_b16 a[88:89], v233 offset:16384
    v_mfma_f32_16x16x32_bf16 a[104:107], a[68:71], a[20:23], a[104:107]
    ds_read_b64_tr_b16 a[90:91], v233 offset:17408
    s_add_u32 m0, s66, 4096
    v_mfma_f32_16x16x32_bf16 a[108:111], a[64:67], a[24:27], a[108:111]
    ds_read_b64_tr_b16 a[92:93], v233 offset:24576
    buffer_load_dwordx4 v214, s[32:35], s64 offen offset:2048  lds
    v_mfma_f32_16x16x32_bf16 a[108:111], a[68:71], a[28:31], a[108:111]
    ds_read_b64_tr_b16 a[94:95], v233 offset:25600
    s_waitcnt lgkmcnt(10)
    v_mfma_f32_16x16x32_bf16 a[112:115], a[72:75], a[0:3], a[112:115]
    v_mfma_f32_16x16x32_bf16 a[112:115], a[76:79], a[4:7], a[112:115]
    v_mfma_f32_16x16x32_bf16 a[116:119], a[72:75], a[8:11], a[116:119]
    s_add_u32 m0, s79, 32768
    v_mfma_f32_16x16x32_bf16 a[116:119], a[76:79], a[12:15], a[116:119]
    buffer_load_dwordx4 v248, s[44:47], s91 offen offset:2048 lds
    v_mfma_f32_16x16x32_bf16 a[120:123], a[72:75], a[16:19], a[120:123]
    v_mfma_f32_16x16x32_bf16 a[120:123], a[76:79], a[20:23], a[120:123]
    s_add_u32 m0, s66, 4096
    s_xor_b32 s66, s66, 8192
    v_mfma_f32_16x16x32_bf16 a[124:127], a[72:75], a[24:27], a[124:127]
    buffer_load_dwordx4 v215, s[32:35], s64 offen offset:3072  lds
    s_add_u32 s64, s64, 128
    v_mfma_f32_16x16x32_bf16 a[124:127], a[76:79], a[28:31], a[124:127]
    s_waitcnt vmcnt(13) lgkmcnt(0)
    v_mfma_f32_16x16x32_bf16 a[128:131], a[80:83], a[0:3], a[128:131]
    s_barrier
    v_mfma_f32_16x16x32_bf16 a[128:131], a[84:87], a[4:7], a[128:131]
    ds_read_b64_tr_b16 a[64:65], v226 offset:32768
    v_mfma_f32_16x16x32_bf16 a[132:135], a[80:83], a[8:11], a[132:135]
    ds_read_b64_tr_b16 a[66:67], v226 offset:33792
    v_mfma_f32_16x16x32_bf16 a[132:135], a[84:87], a[12:15], a[132:135]
    ds_read_b64_tr_b16 a[68:69], v226 offset:40960
    s_add_u32 m0, s79, 32768
    v_mfma_f32_16x16x32_bf16 a[136:139], a[80:83], a[16:19], a[136:139]
    ds_read_b64_tr_b16 a[70:71], v226 offset:41984
    buffer_load_dwordx4 v249, s[44:47], s91 offen offset:3072 lds
    v_mfma_f32_16x16x32_bf16 a[136:139], a[84:87], a[20:23], a[136:139]
    s_mov_b32 m0, s67
    v_mfma_f32_16x16x32_bf16 a[140:143], a[80:83], a[24:27], a[140:143]
    buffer_load_dwordx4 v216, s[36:39], s65 offen offset:0  lds
    v_mfma_f32_16x16x32_bf16 a[140:143], a[84:87], a[28:31], a[140:143]
    v_mfma_f32_16x16x32_bf16 a[144:147], a[88:91], a[0:3], a[144:147]
    v_mfma_f32_16x16x32_bf16 a[144:147], a[92:95], a[4:7], a[144:147]
    ds_read_b64_tr_b16 a[72:73], v226 offset:49152
    v_mfma_f32_16x16x32_bf16 a[148:151], a[88:91], a[8:11], a[148:151]
    ds_read_b64_tr_b16 a[74:75], v226 offset:50176
    v_mfma_f32_16x16x32_bf16 a[148:151], a[92:95], a[12:15], a[148:151]
    ds_read_b64_tr_b16 a[76:77], v226 offset:57344
    v_mfma_f32_16x16x32_bf16 a[152:155], a[88:91], a[16:19], a[152:155]
    ds_read_b64_tr_b16 a[78:79], v226 offset:58368
    v_mfma_f32_16x16x32_bf16 a[152:155], a[92:95], a[20:23], a[152:155]
    v_mfma_f32_16x16x32_bf16 a[156:159], a[88:91], a[24:27], a[156:159]
    buffer_load_dwordx4 v217, s[36:39], s65 offen offset:1024  lds
    v_mfma_f32_16x16x32_bf16 a[156:159], a[92:95], a[28:31], a[156:159]
    s_waitcnt lgkmcnt(4)
    v_mfma_f32_16x16x32_bf16 v[0:3], a[64:67], a[32:35], v[0:3]
    ds_read_b64_tr_b16 a[80:81], v227 offset:32768
    v_mfma_f32_16x16x32_bf16 v[0:3], a[68:71], a[36:39], v[0:3]
    ds_read_b64_tr_b16 a[82:83], v227 offset:33792
    v_mfma_f32_16x16x32_bf16 v[4:7], a[64:67], a[40:43], v[4:7]
    ds_read_b64_tr_b16 a[84:85], v227 offset:40960
    v_mfma_f32_16x16x32_bf16 v[4:7], a[68:71], a[44:47], v[4:7]
    ds_read_b64_tr_b16 a[86:87], v227 offset:41984
    v_mfma_f32_16x16x32_bf16 v[8:11], a[64:67], a[48:51], v[8:11]
    v_mfma_f32_16x16x32_bf16 v[8:11], a[68:71], a[52:55], v[8:11]
    v_mfma_f32_16x16x32_bf16 v[12:15], a[64:67], a[56:59], v[12:15]
    buffer_load_dwordx4 v218, s[36:39], s65 offen offset:2048  lds
    v_mfma_f32_16x16x32_bf16 v[12:15], a[68:71], a[60:63], v[12:15]
    s_waitcnt lgkmcnt(4)
    v_mfma_f32_16x16x32_bf16 v[16:19], a[72:75], a[32:35], v[16:19]
    ds_read_b64_tr_b16 a[88:89], v227 offset:49152
    v_mfma_f32_16x16x32_bf16 v[16:19], a[76:79], a[36:39], v[16:19]
    ds_read_b64_tr_b16 a[90:91], v227 offset:50176
    v_mfma_f32_16x16x32_bf16 v[20:23], a[72:75], a[40:43], v[20:23]
    ds_read_b64_tr_b16 a[92:93], v227 offset:57344
    v_mfma_f32_16x16x32_bf16 v[20:23], a[76:79], a[44:47], v[20:23]
    ds_read_b64_tr_b16 a[94:95], v227 offset:58368
    v_mfma_f32_16x16x32_bf16 v[24:27], a[72:75], a[48:51], v[24:27]
    v_mfma_f32_16x16x32_bf16 v[24:27], a[76:79], a[52:55], v[24:27]
    v_mfma_f32_16x16x32_bf16 v[28:31], a[72:75], a[56:59], v[28:31]
    buffer_load_dwordx4 v219, s[36:39], s65 offen offset:3072  lds
    v_mfma_f32_16x16x32_bf16 v[28:31], a[76:79], a[60:63], v[28:31]
    s_waitcnt lgkmcnt(4)
    v_mfma_f32_16x16x32_bf16 v[32:35], a[80:83], a[32:35], v[32:35]
    ds_read_b64_tr_b16 a[64:65], v228 offset:32768
    v_mfma_f32_16x16x32_bf16 v[32:35], a[84:87], a[36:39], v[32:35]
    ds_read_b64_tr_b16 a[66:67], v228 offset:33792
    v_mfma_f32_16x16x32_bf16 v[36:39], a[80:83], a[40:43], v[36:39]
    ds_read_b64_tr_b16 a[68:69], v228 offset:40960
    v_mfma_f32_16x16x32_bf16 v[36:39], a[84:87], a[44:47], v[36:39]
    ds_read_b64_tr_b16 a[70:71], v228 offset:41984
    v_mfma_f32_16x16x32_bf16 v[40:43], a[80:83], a[48:51], v[40:43]
    v_mfma_f32_16x16x32_bf16 v[40:43], a[84:87], a[52:55], v[40:43]
    s_add_u32 m0, s67, 4096
    v_mfma_f32_16x16x32_bf16 v[44:47], a[80:83], a[56:59], v[44:47]
    buffer_load_dwordx4 v220, s[36:39], s65 offen offset:0  lds
    v_mfma_f32_16x16x32_bf16 v[44:47], a[84:87], a[60:63], v[44:47]
    s_waitcnt lgkmcnt(4)
    v_mfma_f32_16x16x32_bf16 v[48:51], a[88:91], a[32:35], v[48:51]
    ds_read_b64_tr_b16 a[72:73], v228 offset:49152
    v_mfma_f32_16x16x32_bf16 v[48:51], a[92:95], a[36:39], v[48:51]
    ds_read_b64_tr_b16 a[74:75], v228 offset:50176
    v_mfma_f32_16x16x32_bf16 v[52:55], a[88:91], a[40:43], v[52:55]
    ds_read_b64_tr_b16 a[76:77], v228 offset:57344
    v_mfma_f32_16x16x32_bf16 v[52:55], a[92:95], a[44:47], v[52:55]
    ds_read_b64_tr_b16 a[78:79], v228 offset:58368
    v_mfma_f32_16x16x32_bf16 v[56:59], a[88:91], a[48:51], v[56:59]
    v_mfma_f32_16x16x32_bf16 v[56:59], a[92:95], a[52:55], v[56:59]
    v_mfma_f32_16x16x32_bf16 v[60:63], a[88:91], a[56:59], v[60:63]
    buffer_load_dwordx4 v221, s[36:39], s65 offen offset:1024  lds
    v_mfma_f32_16x16x32_bf16 v[60:63], a[92:95], a[60:63], v[60:63]
    s_waitcnt lgkmcnt(4)
    v_mfma_f32_16x16x32_bf16 v[64:67], a[64:67], a[32:35], v[64:67]
    ds_read_b64_tr_b16 a[80:81], v229 offset:32768
    v_mfma_f32_16x16x32_bf16 v[64:67], a[68:71], a[36:39], v[64:67]
    ds_read_b64_tr_b16 a[82:83], v229 offset:33792
    v_mfma_f32_16x16x32_bf16 v[68:71], a[64:67], a[40:43], v[68:71]
    ds_read_b64_tr_b16 a[84:85], v229 offset:40960
    v_mfma_f32_16x16x32_bf16 v[68:71], a[68:71], a[44:47], v[68:71]
    ds_read_b64_tr_b16 a[86:87], v229 offset:41984
    v_mfma_f32_16x16x32_bf16 v[72:75], a[64:67], a[48:51], v[72:75]
    v_mfma_f32_16x16x32_bf16 v[72:75], a[68:71], a[52:55], v[72:75]
    v_mfma_f32_16x16x32_bf16 v[76:79], a[64:67], a[56:59], v[76:79]
    buffer_load_dwordx4 v222, s[36:39], s65 offen offset:2048  lds
    v_mfma_f32_16x16x32_bf16 v[76:79], a[68:71], a[60:63], v[76:79]
    s_waitcnt lgkmcnt(4)
    v_mfma_f32_16x16x32_bf16 v[80:83], a[72:75], a[32:35], v[80:83]
    ds_read_b64_tr_b16 a[88:89], v229 offset:49152
    v_mfma_f32_16x16x32_bf16 v[80:83], a[76:79], a[36:39], v[80:83]
    ds_read_b64_tr_b16 a[90:91], v229 offset:50176
    v_mfma_f32_16x16x32_bf16 v[84:87], a[72:75], a[40:43], v[84:87]
    ds_read_b64_tr_b16 a[92:93], v229 offset:57344
    v_mfma_f32_16x16x32_bf16 v[84:87], a[76:79], a[44:47], v[84:87]
    ds_read_b64_tr_b16 a[94:95], v229 offset:58368
    v_mfma_f32_16x16x32_bf16 v[88:91], a[72:75], a[48:51], v[88:91]
    v_mfma_f32_16x16x32_bf16 v[88:91], a[76:79], a[52:55], v[88:91]
    s_xor_b32 s67, s67, 32768
    v_mfma_f32_16x16x32_bf16 v[92:95], a[72:75], a[56:59], v[92:95]
    buffer_load_dwordx4 v223, s[36:39], s65 offen offset:3072  lds
    s_add_u32 s65, s65, 458752
    v_mfma_f32_16x16x32_bf16 v[92:95], a[76:79], a[60:63], v[92:95]
    s_waitcnt lgkmcnt(4)
    v_mfma_f32_16x16x32_bf16 v[96:99], a[80:83], a[32:35], v[96:99]
    ds_read_b64_tr_b16 a[64:65], v230 offset:32768
    v_mfma_f32_16x16x32_bf16 v[96:99], a[84:87], a[36:39], v[96:99]
    ds_read_b64_tr_b16 a[66:67], v230 offset:33792
    v_mfma_f32_16x16x32_bf16 v[100:103], a[80:83], a[40:43], v[100:103]
    ds_read_b64_tr_b16 a[68:69], v230 offset:40960
    v_mfma_f32_16x16x32_bf16 v[100:103], a[84:87], a[44:47], v[100:103]
    ds_read_b64_tr_b16 a[70:71], v230 offset:41984
    buffer_load_dword v237, v235, s[44:47], s69 offen
    s_add_u32 s69, s69, 512
    v_mfma_f32_16x16x32_bf16 v[104:107], a[80:83], a[48:51], v[104:107]
    v_mfma_f32_16x16x32_bf16 v[104:107], a[84:87], a[52:55], v[104:107]
    s_mov_b32 m0, s66
    v_mfma_f32_16x16x32_bf16 v[108:111], a[80:83], a[56:59], v[108:111]
    buffer_load_dwordx4 v208, s[32:35], s64 offen offset:0  lds
    v_mfma_f32_16x16x32_bf16 v[108:111], a[84:87], a[60:63], v[108:111]
    s_waitcnt lgkmcnt(4)
    v_mfma_f32_16x16x32_bf16 v[112:115], a[88:91], a[32:35], v[112:115]
    ds_read_b64_tr_b16 a[72:73], v230 offset:49152
    v_mfma_f32_16x16x32_bf16 v[112:115], a[92:95], a[36:39], v[112:115]
    ds_read_b64_tr_b16 a[74:75], v230 offset:50176
    v_mfma_f32_16x16x32_bf16 v[116:119], a[88:91], a[40:43], v[116:119]
    ds_read_b64_tr_b16 a[76:77], v230 offset:57344
    v_mfma_f32_16x16x32_bf16 v[116:119], a[92:95], a[44:47], v[116:119]
    ds_read_b64_tr_b16 a[78:79], v230 offset:58368
    v_mfma_f32_16x16x32_bf16 v[120:123], a[88:91], a[48:51], v[120:123]
    ds_read_b64_tr_b16 a[240:241], v250 offset:36864
    v_mfma_f32_16x16x32_bf16 v[120:123], a[92:95], a[52:55], v[120:123]
    v_mfma_f32_16x16x32_bf16 v[124:127], a[88:91], a[56:59], v[124:127]
    buffer_load_dwordx4 v209, s[32:35], s64 offen offset:1024  lds
    ds_read_b64_tr_b16 a[242:243], v250 offset:38912
    v_mfma_f32_16x16x32_bf16 v[124:127], a[92:95], a[60:63], v[124:127]
    s_waitcnt lgkmcnt(6)
    ds_read_b64_tr_b16 a[244:245], v251 offset:36864
    v_mfma_f32_16x16x32_bf16 v[128:131], a[64:67], a[32:35], v[128:131]
    ds_read_b64_tr_b16 a[80:81], v231 offset:32768
    v_mfma_f32_16x16x32_bf16 v[128:131], a[68:71], a[36:39], v[128:131]
    ds_read_b64_tr_b16 a[82:83], v231 offset:33792
    v_mfma_f32_16x16x32_bf16 v[132:135], a[64:67], a[40:43], v[132:135]
    ds_read_b64_tr_b16 a[84:85], v231 offset:40960
    v_mfma_f32_16x16x32_bf16 v[132:135], a[68:71], a[44:47], v[132:135]
    ds_read_b64_tr_b16 a[86:87], v231 offset:41984
    s_waitcnt vmcnt(12)
    v_mfma_f32_16x16x32_bf16 v[136:139], a[64:67], a[48:51], v[136:139]
    ds_read_b128 a[0:3], v224 offset:0
    v_mfma_f32_16x16x32_bf16 v[136:139], a[68:71], a[52:55], v[136:139]
    ds_read_b128 a[4:7], v225 offset:0
    v_mfma_f32_16x16x32_bf16 v[140:143], a[64:67], a[56:59], v[140:143]
    buffer_load_dwordx4 v210, s[32:35], s64 offen offset:2048  lds
    ds_read_b64_tr_b16 a[246:247], v251 offset:38912
    v_mfma_f32_16x16x32_bf16 v[140:143], a[68:71], a[60:63], v[140:143]
    s_waitcnt lgkmcnt(10)
    ds_read_b64_tr_b16 a[248:249], v252 offset:36864
    v_mfma_f32_16x16x32_bf16 v[144:147], a[72:75], a[32:35], v[144:147]
    ds_read_b64_tr_b16 a[88:89], v231 offset:49152
    v_mfma_f32_16x16x32_bf16 v[144:147], a[76:79], a[36:39], v[144:147]
    ds_read_b64_tr_b16 a[90:91], v231 offset:50176
    v_mfma_f32_16x16x32_bf16 v[148:151], a[72:75], a[40:43], v[148:151]
    ds_read_b64_tr_b16 a[92:93], v231 offset:57344
    v_mfma_f32_16x16x32_bf16 v[148:151], a[76:79], a[44:47], v[148:151]
    ds_read_b64_tr_b16 a[94:95], v231 offset:58368
    v_mfma_f32_16x16x32_bf16 v[152:155], a[72:75], a[48:51], v[152:155]
    ds_read_b128 a[8:11], v224 offset:2048
    v_mfma_f32_16x16x32_bf16 v[152:155], a[76:79], a[52:55], v[152:155]
    ds_read_b128 a[12:15], v225 offset:2048
    v_mfma_f32_16x16x32_bf16 v[156:159], a[72:75], a[56:59], v[156:159]
    buffer_load_dwordx4 v211, s[32:35], s64 offen offset:3072  lds
    ds_read_b64_tr_b16 a[250:251], v252 offset:38912
    v_mfma_f32_16x16x32_bf16 v[156:159], a[76:79], a[60:63], v[156:159]
    s_waitcnt lgkmcnt(11)
    ds_read_b64_tr_b16 a[252:253], v253 offset:36864
    v_mfma_f32_16x16x32_bf16 v[160:163], a[80:83], a[32:35], v[160:163]
    ds_read_b64_tr_b16 a[64:65], v232 offset:32768
    ds_read_b64_tr_b16 a[254:255], v253 offset:38912
    v_mfma_f32_16x16x32_bf16 v[160:163], a[84:87], a[36:39], v[160:163]
    ds_read_b64_tr_b16 a[66:67], v232 offset:33792
    v_mfma_f32_16x16x32_bf16 v[164:167], a[80:83], a[40:43], v[164:167]
    ds_read_b64_tr_b16 a[68:69], v232 offset:40960
    v_mfma_f32_16x16x32_bf16 v[164:167], a[84:87], a[44:47], v[164:167]
    ds_read_b64_tr_b16 a[70:71], v232 offset:41984
    v_mfma_f32_16x16x32_bf16 v[168:171], a[80:83], a[48:51], v[168:171]
    ds_read_b128 a[16:19], v224 offset:4096
    v_mfma_f32_16x16x32_bf16 v[168:171], a[84:87], a[52:55], v[168:171]
    ds_read_b128 a[20:23], v225 offset:4096
    s_add_u32 m0, s66, 4096
    v_mfma_f32_16x16x32_bf16 v[172:175], a[80:83], a[56:59], v[172:175]
    buffer_load_dwordx4 v212, s[32:35], s64 offen offset:0  lds
    v_mfma_f32_16x16x32_bf16 v[172:175], a[84:87], a[60:63], v[172:175]
    s_waitcnt lgkmcnt(11)
    v_mfma_f32_16x16x32_bf16 v[176:179], a[88:91], a[32:35], v[176:179]
    ds_read_b64_tr_b16 a[72:73], v232 offset:49152
    v_mfma_f32_16x16x32_bf16 v[176:179], a[92:95], a[36:39], v[176:179]
    ds_read_b64_tr_b16 a[74:75], v232 offset:50176
    v_mfma_f32_16x16x32_bf16 v[180:183], a[88:91], a[40:43], v[180:183]
    ds_read_b64_tr_b16 a[76:77], v232 offset:57344
    v_mfma_f32_16x16x32_bf16 v[180:183], a[92:95], a[44:47], v[180:183]
    ds_read_b64_tr_b16 a[78:79], v232 offset:58368
    v_mfma_f32_16x16x32_bf16 v[184:187], a[88:91], a[48:51], v[184:187]
    ds_read_b128 a[24:27], v224 offset:6144
    v_mfma_f32_16x16x32_bf16 v[184:187], a[92:95], a[52:55], v[184:187]
    ds_read_b128 a[28:31], v225 offset:6144
    v_mfma_f32_16x16x32_bf16 v[188:191], a[88:91], a[56:59], v[188:191]
    buffer_load_dwordx4 v213, s[32:35], s64 offen offset:1024  lds
    s_add_u32 s78, s77, 458752
    s_add_u32 m0, s79, 36864
    v_mfma_f32_16x16x32_bf16 v[188:191], a[92:95], a[60:63], v[188:191]
    s_waitcnt lgkmcnt(8)
    buffer_load_dwordx4 v246, s[44:47], s78 offen offset:0 lds
    v_mfma_f32_16x16x32_bf16 a[96:99], a[64:67], a[32:35], a[96:99]
    ds_read_b64_tr_b16 a[80:81], v233 offset:32768
    v_mfma_f32_16x16x32_bf16 a[96:99], a[68:71], a[36:39], a[96:99]
    ds_read_b64_tr_b16 a[82:83], v233 offset:33792
    buffer_load_dwordx4 v247, s[44:47], s78 offen offset:1024 lds
    v_mfma_f32_16x16x32_bf16 a[100:103], a[64:67], a[40:43], a[100:103]
    ds_read_b64_tr_b16 a[84:85], v233 offset:40960
    v_mfma_f32_16x16x32_bf16 a[100:103], a[68:71], a[44:47], a[100:103]
    ds_read_b64_tr_b16 a[86:87], v233 offset:41984
    v_mfma_f32_16x16x32_bf16 a[104:107], a[64:67], a[48:51], a[104:107]
    ds_read_b64_tr_b16 a[88:89], v233 offset:49152
    v_mfma_f32_16x16x32_bf16 a[104:107], a[68:71], a[52:55], a[104:107]
    ds_read_b64_tr_b16 a[90:91], v233 offset:50176
    s_add_u32 m0, s66, 4096
    v_mfma_f32_16x16x32_bf16 a[108:111], a[64:67], a[56:59], a[108:111]
    ds_read_b64_tr_b16 a[92:93], v233 offset:57344
    buffer_load_dwordx4 v214, s[32:35], s64 offen offset:2048  lds
    v_mfma_f32_16x16x32_bf16 a[108:111], a[68:71], a[60:63], a[108:111]
    ds_read_b64_tr_b16 a[94:95], v233 offset:58368
    s_waitcnt lgkmcnt(10)
    v_mfma_f32_16x16x32_bf16 a[112:115], a[72:75], a[32:35], a[112:115]
    v_mfma_f32_16x16x32_bf16 a[112:115], a[76:79], a[36:39], a[112:115]
    v_mfma_f32_16x16x32_bf16 a[116:119], a[72:75], a[40:43], a[116:119]
    s_add_u32 m0, s79, 36864
    v_mfma_f32_16x16x32_bf16 a[116:119], a[76:79], a[44:47], a[116:119]
    buffer_load_dwordx4 v248, s[44:47], s78 offen offset:2048 lds
    v_mfma_f32_16x16x32_bf16 a[120:123], a[72:75], a[48:51], a[120:123]
    v_mfma_f32_16x16x32_bf16 a[120:123], a[76:79], a[52:55], a[120:123]
    s_add_u32 m0, s66, 4096
    s_xor_b32 s66, s66, 8192
    v_mfma_f32_16x16x32_bf16 a[124:127], a[72:75], a[56:59], a[124:127]
    buffer_load_dwordx4 v215, s[32:35], s64 offen offset:3072  lds
    s_add_u32 s64, s64, 128
    v_mfma_f32_16x16x32_bf16 a[124:127], a[76:79], a[60:63], a[124:127]
    s_waitcnt vmcnt(12) lgkmcnt(0)
    v_mfma_f32_16x16x32_bf16 a[128:131], a[80:83], a[32:35], a[128:131]
    s_barrier
    v_mfma_f32_16x16x32_bf16 a[128:131], a[84:87], a[36:39], a[128:131]
    ds_read_b64_tr_b16 a[64:65], v226 offset:0
    v_mfma_f32_16x16x32_bf16 a[132:135], a[80:83], a[40:43], a[132:135]
    ds_read_b64_tr_b16 a[66:67], v226 offset:1024
    v_mfma_f32_16x16x32_bf16 a[132:135], a[84:87], a[44:47], a[132:135]
    ds_read_b64_tr_b16 a[68:69], v226 offset:8192
    s_add_u32 m0, s79, 36864
    v_mfma_f32_16x16x32_bf16 a[136:139], a[80:83], a[48:51], a[136:139]
    ds_read_b64_tr_b16 a[70:71], v226 offset:9216
    buffer_load_dwordx4 v249, s[44:47], s78 offen offset:3072 lds
    v_mfma_f32_16x16x32_bf16 a[136:139], a[84:87], a[52:55], a[136:139]
    s_mov_b32 m0, s67
    v_mfma_f32_16x16x32_bf16 a[140:143], a[80:83], a[56:59], a[140:143]
    buffer_load_dwordx4 v216, s[36:39], s65 offen offset:0  lds
    v_mfma_f32_16x16x32_bf16 a[140:143], a[84:87], a[60:63], a[140:143]
    v_mfma_f32_16x16x32_bf16 a[144:147], a[88:91], a[32:35], a[144:147]
    v_mfma_f32_16x16x32_bf16 a[144:147], a[92:95], a[36:39], a[144:147]
    ds_read_b64_tr_b16 a[72:73], v226 offset:16384
    v_mfma_f32_16x16x32_bf16 a[148:151], a[88:91], a[40:43], a[148:151]
    ds_read_b64_tr_b16 a[74:75], v226 offset:17408
    v_mfma_f32_16x16x32_bf16 a[148:151], a[92:95], a[44:47], a[148:151]
    ds_read_b64_tr_b16 a[76:77], v226 offset:24576
    v_mfma_f32_16x16x32_bf16 a[152:155], a[88:91], a[48:51], a[152:155]
    ds_read_b64_tr_b16 a[78:79], v226 offset:25600
    v_mfma_f32_16x16x32_bf16 a[152:155], a[92:95], a[52:55], a[152:155]
    v_mfma_f32_16x16x32_bf16 a[156:159], a[88:91], a[56:59], a[156:159]
    buffer_load_dwordx4 v217, s[36:39], s65 offen offset:1024  lds
    v_mfma_f32_16x16x32_bf16 a[156:159], a[92:95], a[60:63], a[156:159]
    s_waitcnt lgkmcnt(4)
    v_mfma_f32_16x16x32_bf16 v[0:3], a[64:67], a[0:3], v[0:3]
    ds_read_b64_tr_b16 a[80:81], v227 offset:0
    v_mfma_f32_16x16x32_bf16 v[0:3], a[68:71], a[4:7], v[0:3]
    ds_read_b64_tr_b16 a[82:83], v227 offset:1024
    v_mfma_f32_16x16x32_bf16 v[4:7], a[64:67], a[8:11], v[4:7]
    ds_read_b64_tr_b16 a[84:85], v227 offset:8192
    v_mfma_f32_16x16x32_bf16 v[4:7], a[68:71], a[12:15], v[4:7]
    ds_read_b64_tr_b16 a[86:87], v227 offset:9216
    v_mfma_f32_16x16x32_bf16 v[8:11], a[64:67], a[16:19], v[8:11]
    v_mfma_f32_16x16x32_bf16 v[8:11], a[68:71], a[20:23], v[8:11]
    v_mfma_f32_16x16x32_bf16 v[12:15], a[64:67], a[24:27], v[12:15]
    buffer_load_dwordx4 v218, s[36:39], s65 offen offset:2048  lds
    v_mfma_f32_16x16x32_bf16 v[12:15], a[68:71], a[28:31], v[12:15]
    s_waitcnt lgkmcnt(4)
    v_mfma_f32_16x16x32_bf16 v[16:19], a[72:75], a[0:3], v[16:19]
    ds_read_b64_tr_b16 a[88:89], v227 offset:16384
    v_mfma_f32_16x16x32_bf16 v[16:19], a[76:79], a[4:7], v[16:19]
    ds_read_b64_tr_b16 a[90:91], v227 offset:17408
    v_mfma_f32_16x16x32_bf16 v[20:23], a[72:75], a[8:11], v[20:23]
    ds_read_b64_tr_b16 a[92:93], v227 offset:24576
    v_mfma_f32_16x16x32_bf16 v[20:23], a[76:79], a[12:15], v[20:23]
    ds_read_b64_tr_b16 a[94:95], v227 offset:25600
    v_mfma_f32_16x16x32_bf16 v[24:27], a[72:75], a[16:19], v[24:27]
    v_mfma_f32_16x16x32_bf16 v[24:27], a[76:79], a[20:23], v[24:27]
    v_mfma_f32_16x16x32_bf16 v[28:31], a[72:75], a[24:27], v[28:31]
    buffer_load_dwordx4 v219, s[36:39], s65 offen offset:3072  lds
    v_mfma_f32_16x16x32_bf16 v[28:31], a[76:79], a[28:31], v[28:31]
    s_waitcnt lgkmcnt(4)
    v_mfma_f32_16x16x32_bf16 v[32:35], a[80:83], a[0:3], v[32:35]
    ds_read_b64_tr_b16 a[64:65], v228 offset:0
    v_mfma_f32_16x16x32_bf16 v[32:35], a[84:87], a[4:7], v[32:35]
    ds_read_b64_tr_b16 a[66:67], v228 offset:1024
    v_mfma_f32_16x16x32_bf16 v[36:39], a[80:83], a[8:11], v[36:39]
    ds_read_b64_tr_b16 a[68:69], v228 offset:8192
    v_mfma_f32_16x16x32_bf16 v[36:39], a[84:87], a[12:15], v[36:39]
    ds_read_b64_tr_b16 a[70:71], v228 offset:9216
    v_mfma_f32_16x16x32_bf16 v[40:43], a[80:83], a[16:19], v[40:43]
    v_mfma_f32_16x16x32_bf16 v[40:43], a[84:87], a[20:23], v[40:43]
    s_add_u32 m0, s67, 4096
    v_mfma_f32_16x16x32_bf16 v[44:47], a[80:83], a[24:27], v[44:47]
    buffer_load_dwordx4 v220, s[36:39], s65 offen offset:0  lds
    v_mfma_f32_16x16x32_bf16 v[44:47], a[84:87], a[28:31], v[44:47]
    s_waitcnt lgkmcnt(4)
    v_mfma_f32_16x16x32_bf16 v[48:51], a[88:91], a[0:3], v[48:51]
    ds_read_b64_tr_b16 a[72:73], v228 offset:16384
    v_mfma_f32_16x16x32_bf16 v[48:51], a[92:95], a[4:7], v[48:51]
    ds_read_b64_tr_b16 a[74:75], v228 offset:17408
    v_mfma_f32_16x16x32_bf16 v[52:55], a[88:91], a[8:11], v[52:55]
    ds_read_b64_tr_b16 a[76:77], v228 offset:24576
    v_mfma_f32_16x16x32_bf16 v[52:55], a[92:95], a[12:15], v[52:55]
    ds_read_b64_tr_b16 a[78:79], v228 offset:25600
    v_mfma_f32_16x16x32_bf16 v[56:59], a[88:91], a[16:19], v[56:59]
    v_mfma_f32_16x16x32_bf16 v[56:59], a[92:95], a[20:23], v[56:59]
    v_mfma_f32_16x16x32_bf16 v[60:63], a[88:91], a[24:27], v[60:63]
    buffer_load_dwordx4 v221, s[36:39], s65 offen offset:1024  lds
    v_mfma_f32_16x16x32_bf16 v[60:63], a[92:95], a[28:31], v[60:63]
    s_waitcnt lgkmcnt(4)
    v_mfma_f32_16x16x32_bf16 v[64:67], a[64:67], a[0:3], v[64:67]
    ds_read_b64_tr_b16 a[80:81], v229 offset:0
    v_mfma_f32_16x16x32_bf16 v[64:67], a[68:71], a[4:7], v[64:67]
    ds_read_b64_tr_b16 a[82:83], v229 offset:1024
    v_mfma_f32_16x16x32_bf16 v[68:71], a[64:67], a[8:11], v[68:71]
    ds_read_b64_tr_b16 a[84:85], v229 offset:8192
    v_mfma_f32_16x16x32_bf16 v[68:71], a[68:71], a[12:15], v[68:71]
    ds_read_b64_tr_b16 a[86:87], v229 offset:9216
    v_mfma_f32_16x16x32_bf16 v[72:75], a[64:67], a[16:19], v[72:75]
    v_mfma_f32_16x16x32_bf16 v[72:75], a[68:71], a[20:23], v[72:75]
    v_mfma_f32_16x16x32_bf16 v[76:79], a[64:67], a[24:27], v[76:79]
    buffer_load_dwordx4 v222, s[36:39], s65 offen offset:2048  lds
    v_mfma_f32_16x16x32_bf16 v[76:79], a[68:71], a[28:31], v[76:79]
    s_waitcnt lgkmcnt(4)
    v_mfma_f32_16x16x32_bf16 v[80:83], a[72:75], a[0:3], v[80:83]
    ds_read_b64_tr_b16 a[88:89], v229 offset:16384
    v_mfma_f32_16x16x32_bf16 v[80:83], a[76:79], a[4:7], v[80:83]
    ds_read_b64_tr_b16 a[90:91], v229 offset:17408
    v_mfma_f32_16x16x32_bf16 v[84:87], a[72:75], a[8:11], v[84:87]
    ds_read_b64_tr_b16 a[92:93], v229 offset:24576
    v_mfma_f32_16x16x32_bf16 v[84:87], a[76:79], a[12:15], v[84:87]
    ds_read_b64_tr_b16 a[94:95], v229 offset:25600
    v_mfma_f32_16x16x32_bf16 v[88:91], a[72:75], a[16:19], v[88:91]
    v_mfma_f32_16x16x32_bf16 v[88:91], a[76:79], a[20:23], v[88:91]
    s_xor_b32 s67, s67, 32768
    v_mfma_f32_16x16x32_bf16 v[92:95], a[72:75], a[24:27], v[92:95]
    buffer_load_dwordx4 v223, s[36:39], s65 offen offset:3072  lds
    s_add_u32 s65, s65, 458752
    v_mfma_f32_16x16x32_bf16 v[92:95], a[76:79], a[28:31], v[92:95]
    s_waitcnt lgkmcnt(4)
    v_mfma_f32_16x16x32_bf16 v[96:99], a[80:83], a[0:3], v[96:99]
    ds_read_b64_tr_b16 a[64:65], v230 offset:0
    v_mfma_f32_16x16x32_bf16 v[96:99], a[84:87], a[4:7], v[96:99]
    ds_read_b64_tr_b16 a[66:67], v230 offset:1024
    v_mfma_f32_16x16x32_bf16 v[100:103], a[80:83], a[8:11], v[100:103]
    ds_read_b64_tr_b16 a[68:69], v230 offset:8192
    v_mfma_f32_16x16x32_bf16 v[100:103], a[84:87], a[12:15], v[100:103]
    ds_read_b64_tr_b16 a[70:71], v230 offset:9216
    buffer_load_dword v238, v235, s[44:47], s69 offen
    s_add_u32 s69, s69, 512
    v_mfma_f32_16x16x32_bf16 v[104:107], a[80:83], a[16:19], v[104:107]
    v_mfma_f32_16x16x32_bf16 v[104:107], a[84:87], a[20:23], v[104:107]
    v_mfma_f32_16x16x32_bf16 v[108:111], a[80:83], a[24:27], v[108:111]
    v_mfma_f32_16x16x32_bf16 v[108:111], a[84:87], a[28:31], v[108:111]
    s_waitcnt lgkmcnt(4)
    v_mfma_f32_16x16x32_bf16 v[112:115], a[88:91], a[0:3], v[112:115]
    ds_read_b64_tr_b16 a[72:73], v230 offset:16384
    v_mfma_f32_16x16x32_bf16 v[112:115], a[92:95], a[4:7], v[112:115]
    ds_read_b64_tr_b16 a[74:75], v230 offset:17408
    v_mfma_f32_16x16x32_bf16 v[116:119], a[88:91], a[8:11], v[116:119]
    ds_read_b64_tr_b16 a[76:77], v230 offset:24576
    v_mfma_f32_16x16x32_bf16 v[116:119], a[92:95], a[12:15], v[116:119]
    ds_read_b64_tr_b16 a[78:79], v230 offset:25600
    v_mfma_f32_16x16x32_bf16 v[120:123], a[88:91], a[16:19], v[120:123]
    v_mfma_f32_16x16x32_bf16 v[120:123], a[92:95], a[20:23], v[120:123]
    v_mfma_f32_16x16x32_bf16 v[124:127], a[88:91], a[24:27], v[124:127]
    v_mfma_f32_16x16x32_bf16 v[124:127], a[92:95], a[28:31], v[124:127]
    s_waitcnt lgkmcnt(4)
    v_mfma_f32_16x16x32_bf16 v[128:131], a[64:67], a[0:3], v[128:131]
    ds_read_b64_tr_b16 a[80:81], v231 offset:0
    v_mfma_f32_16x16x32_bf16 v[128:131], a[68:71], a[4:7], v[128:131]
    ds_read_b64_tr_b16 a[82:83], v231 offset:1024
    v_mfma_f32_16x16x32_bf16 v[132:135], a[64:67], a[8:11], v[132:135]
    ds_read_b64_tr_b16 a[84:85], v231 offset:8192
    v_mfma_f32_16x16x32_bf16 v[132:135], a[68:71], a[12:15], v[132:135]
    ds_read_b64_tr_b16 a[86:87], v231 offset:9216
    s_waitcnt vmcnt(10)
    v_mfma_f32_16x16x32_bf16 v[136:139], a[64:67], a[16:19], v[136:139]
    ds_read_b128 a[32:35], v224 offset:8192
    v_mfma_f32_16x16x32_bf16 v[136:139], a[68:71], a[20:23], v[136:139]
    ds_read_b128 a[36:39], v225 offset:8192
    v_mfma_f32_16x16x32_bf16 v[140:143], a[64:67], a[24:27], v[140:143]
    v_mfma_f32_16x16x32_bf16 v[140:143], a[68:71], a[28:31], v[140:143]
    s_waitcnt lgkmcnt(6)
    v_mfma_f32_16x16x32_bf16 v[144:147], a[72:75], a[0:3], v[144:147]
    ds_read_b64_tr_b16 a[88:89], v231 offset:16384
    v_mfma_f32_16x16x32_bf16 v[144:147], a[76:79], a[4:7], v[144:147]
    ds_read_b64_tr_b16 a[90:91], v231 offset:17408
    v_mfma_f32_16x16x32_bf16 v[148:151], a[72:75], a[8:11], v[148:151]
    ds_read_b64_tr_b16 a[92:93], v231 offset:24576
    v_mfma_f32_16x16x32_bf16 v[148:151], a[76:79], a[12:15], v[148:151]
    ds_read_b64_tr_b16 a[94:95], v231 offset:25600
    v_mfma_f32_16x16x32_bf16 v[152:155], a[72:75], a[16:19], v[152:155]
    ds_read_b128 a[40:43], v224 offset:10240
    v_mfma_f32_16x16x32_bf16 v[152:155], a[76:79], a[20:23], v[152:155]
    ds_read_b128 a[44:47], v225 offset:10240
    v_mfma_f32_16x16x32_bf16 v[156:159], a[72:75], a[24:27], v[156:159]
    v_mfma_f32_16x16x32_bf16 v[156:159], a[76:79], a[28:31], v[156:159]
    s_waitcnt lgkmcnt(8)
    v_mfma_f32_16x16x32_bf16 v[160:163], a[80:83], a[0:3], v[160:163]
    ds_read_b64_tr_b16 a[64:65], v232 offset:0
    v_mfma_f32_16x16x32_bf16 v[160:163], a[84:87], a[4:7], v[160:163]
    ds_read_b64_tr_b16 a[66:67], v232 offset:1024
    v_mfma_f32_16x16x32_bf16 v[164:167], a[80:83], a[8:11], v[164:167]
    ds_read_b64_tr_b16 a[68:69], v232 offset:8192
    v_mfma_f32_16x16x32_bf16 v[164:167], a[84:87], a[12:15], v[164:167]
    ds_read_b64_tr_b16 a[70:71], v232 offset:9216
    v_mfma_f32_16x16x32_bf16 v[168:171], a[80:83], a[16:19], v[168:171]
    ds_read_b128 a[48:51], v224 offset:12288
    v_mfma_f32_16x16x32_bf16 v[168:171], a[84:87], a[20:23], v[168:171]
    ds_read_b128 a[52:55], v225 offset:12288
    v_mfma_f32_16x16x32_bf16 v[172:175], a[80:83], a[24:27], v[172:175]
    v_mfma_f32_16x16x32_bf16 v[172:175], a[84:87], a[28:31], v[172:175]
    s_waitcnt lgkmcnt(8)
    v_mfma_f32_16x16x32_bf16 v[176:179], a[88:91], a[0:3], v[176:179]
    ds_read_b64_tr_b16 a[72:73], v232 offset:16384
    v_mfma_f32_16x16x32_bf16 v[176:179], a[92:95], a[4:7], v[176:179]
    ds_read_b64_tr_b16 a[74:75], v232 offset:17408
    v_mfma_f32_16x16x32_bf16 v[180:183], a[88:91], a[8:11], v[180:183]
    ds_read_b64_tr_b16 a[76:77], v232 offset:24576
    v_mfma_f32_16x16x32_bf16 v[180:183], a[92:95], a[12:15], v[180:183]
    ds_read_b64_tr_b16 a[78:79], v232 offset:25600
    v_mfma_f32_16x16x32_bf16 v[184:187], a[88:91], a[16:19], v[184:187]
    ds_read_b128 a[56:59], v224 offset:14336
    v_mfma_f32_16x16x32_bf16 v[184:187], a[92:95], a[20:23], v[184:187]
    ds_read_b128 a[60:63], v225 offset:14336
    v_mfma_f32_16x16x32_bf16 v[188:191], a[88:91], a[24:27], v[188:191]
    v_mfma_f32_16x16x32_bf16 v[188:191], a[92:95], a[28:31], v[188:191]
    s_waitcnt lgkmcnt(8)
    v_mfma_f32_16x16x32_bf16 a[96:99], a[64:67], a[0:3], a[96:99]
    ds_read_b64_tr_b16 a[80:81], v233 offset:0
    v_mfma_f32_16x16x32_bf16 a[96:99], a[68:71], a[4:7], a[96:99]
    ds_read_b64_tr_b16 a[82:83], v233 offset:1024
    v_mfma_f32_16x16x32_bf16 a[100:103], a[64:67], a[8:11], a[100:103]
    ds_read_b64_tr_b16 a[84:85], v233 offset:8192
    v_mfma_f32_16x16x32_bf16 a[100:103], a[68:71], a[12:15], a[100:103]
    ds_read_b64_tr_b16 a[86:87], v233 offset:9216
    v_mfma_f32_16x16x32_bf16 a[104:107], a[64:67], a[16:19], a[104:107]
    ds_read_b64_tr_b16 a[88:89], v233 offset:16384
    v_mfma_f32_16x16x32_bf16 a[104:107], a[68:71], a[20:23], a[104:107]
    ds_read_b64_tr_b16 a[90:91], v233 offset:17408
    v_mfma_f32_16x16x32_bf16 a[108:111], a[64:67], a[24:27], a[108:111]
    ds_read_b64_tr_b16 a[92:93], v233 offset:24576
    v_mfma_f32_16x16x32_bf16 a[108:111], a[68:71], a[28:31], a[108:111]
    ds_read_b64_tr_b16 a[94:95], v233 offset:25600
    s_waitcnt lgkmcnt(10)
    v_mfma_f32_16x16x32_bf16 a[112:115], a[72:75], a[0:3], a[112:115]
    v_mfma_f32_16x16x32_bf16 a[112:115], a[76:79], a[4:7], a[112:115]
    v_mfma_f32_16x16x32_bf16 a[116:119], a[72:75], a[8:11], a[116:119]
    v_mfma_f32_16x16x32_bf16 a[116:119], a[76:79], a[12:15], a[116:119]
    v_mfma_f32_16x16x32_bf16 a[120:123], a[72:75], a[16:19], a[120:123]
    v_mfma_f32_16x16x32_bf16 a[120:123], a[76:79], a[20:23], a[120:123]
    v_mfma_f32_16x16x32_bf16 a[124:127], a[72:75], a[24:27], a[124:127]
    v_mfma_f32_16x16x32_bf16 a[124:127], a[76:79], a[28:31], a[124:127]
    s_waitcnt vmcnt(1) lgkmcnt(0)
    v_mfma_f32_16x16x32_bf16 a[128:131], a[80:83], a[0:3], a[128:131]
    s_barrier
    v_mfma_f32_16x16x32_bf16 a[128:131], a[84:87], a[4:7], a[128:131]
    ds_read_b64_tr_b16 a[64:65], v226 offset:32768
    v_mfma_f32_16x16x32_bf16 a[132:135], a[80:83], a[8:11], a[132:135]
    ds_read_b64_tr_b16 a[66:67], v226 offset:33792
    v_add_u32 v196, 0, v245
    v_mfma_f32_16x16x32_bf16 a[132:135], a[84:87], a[12:15], a[132:135]
    ds_read_b64_tr_b16 a[68:69], v226 offset:40960
    v_mfma_f32_16x16x32_bf16 a[136:139], a[80:83], a[16:19], a[136:139]
    ds_read_b64_tr_b16 a[70:71], v226 offset:41984
    v_mfma_f32_16x16x32_bf16 a[136:139], a[84:87], a[20:23], a[136:139]
    s_add_u32 m0, s95, 32
    v_mfma_f32_16x16x32_bf16 a[140:143], a[80:83], a[24:27], a[140:143]
    buffer_load_dwordx4 v196, s[52:55], s74 offen offset:0 lds
    v_mfma_f32_16x16x32_bf16 a[140:143], a[84:87], a[28:31], a[140:143]
    v_mfma_f32_16x16x32_bf16 a[144:147], a[88:91], a[0:3], a[144:147]
    v_mfma_f32_16x16x32_bf16 a[144:147], a[92:95], a[4:7], a[144:147]
    ds_read_b64_tr_b16 a[72:73], v226 offset:49152
    v_mfma_f32_16x16x32_bf16 a[148:151], a[88:91], a[8:11], a[148:151]
    ds_read_b64_tr_b16 a[74:75], v226 offset:50176
    buffer_load_dwordx4 v196, s[52:55], s74 offen offset:1024 lds
    v_mfma_f32_16x16x32_bf16 a[148:151], a[92:95], a[12:15], a[148:151]
    ds_read_b64_tr_b16 a[76:77], v226 offset:57344
    v_mfma_f32_16x16x32_bf16 a[152:155], a[88:91], a[16:19], a[152:155]
    ds_read_b64_tr_b16 a[78:79], v226 offset:58368
    v_mfma_f32_16x16x32_bf16 a[152:155], a[92:95], a[20:23], a[152:155]
    v_mfma_f32_16x16x32_bf16 a[156:159], a[88:91], a[24:27], a[156:159]
    v_mfma_f32_16x16x32_bf16 a[156:159], a[92:95], a[28:31], a[156:159]
    s_waitcnt lgkmcnt(4)
    v_mfma_f32_16x16x32_bf16 v[0:3], a[64:67], a[32:35], v[0:3]
    ds_read_b64_tr_b16 a[80:81], v227 offset:32768
    buffer_load_dwordx4 v196, s[52:55], s74 offen offset:2048 lds
    v_mfma_f32_16x16x32_bf16 v[0:3], a[68:71], a[36:39], v[0:3]
    ds_read_b64_tr_b16 a[82:83], v227 offset:33792
    v_mfma_f32_16x16x32_bf16 v[4:7], a[64:67], a[40:43], v[4:7]
    ds_read_b64_tr_b16 a[84:85], v227 offset:40960
    v_mfma_f32_16x16x32_bf16 v[4:7], a[68:71], a[44:47], v[4:7]
    ds_read_b64_tr_b16 a[86:87], v227 offset:41984
    v_mfma_f32_16x16x32_bf16 v[8:11], a[64:67], a[48:51], v[8:11]
    v_mfma_f32_16x16x32_bf16 v[8:11], a[68:71], a[52:55], v[8:11]
    v_mfma_f32_16x16x32_bf16 v[12:15], a[64:67], a[56:59], v[12:15]
    v_mfma_f32_16x16x32_bf16 v[12:15], a[68:71], a[60:63], v[12:15]
    s_waitcnt lgkmcnt(4)
    v_mfma_f32_16x16x32_bf16 v[16:19], a[72:75], a[32:35], v[16:19]
    ds_read_b64_tr_b16 a[88:89], v227 offset:49152
    v_mfma_f32_16x16x32_bf16 v[16:19], a[76:79], a[36:39], v[16:19]
    ds_read_b64_tr_b16 a[90:91], v227 offset:50176
    v_mfma_f32_16x16x32_bf16 v[20:23], a[72:75], a[40:43], v[20:23]
    ds_read_b64_tr_b16 a[92:93], v227 offset:57344
    v_mfma_f32_16x16x32_bf16 v[20:23], a[76:79], a[44:47], v[20:23]
    ds_read_b64_tr_b16 a[94:95], v227 offset:58368
    v_mfma_f32_16x16x32_bf16 v[24:27], a[72:75], a[48:51], v[24:27]
    v_mfma_f32_16x16x32_bf16 v[24:27], a[76:79], a[52:55], v[24:27]
    v_mfma_f32_16x16x32_bf16 v[28:31], a[72:75], a[56:59], v[28:31]
    v_mfma_f32_16x16x32_bf16 v[28:31], a[76:79], a[60:63], v[28:31]
    s_waitcnt lgkmcnt(4)
    v_mfma_f32_16x16x32_bf16 v[32:35], a[80:83], a[32:35], v[32:35]
    ds_read_b64_tr_b16 a[64:65], v228 offset:32768
    v_mfma_f32_16x16x32_bf16 v[32:35], a[84:87], a[36:39], v[32:35]
    ds_read_b64_tr_b16 a[66:67], v228 offset:33792
    v_mfma_f32_16x16x32_bf16 v[36:39], a[80:83], a[40:43], v[36:39]
    ds_read_b64_tr_b16 a[68:69], v228 offset:40960
    buffer_load_dwordx4 v196, s[52:55], s74 offen offset:3072 lds
    v_mfma_f32_16x16x32_bf16 v[36:39], a[84:87], a[44:47], v[36:39]
    ds_read_b64_tr_b16 a[70:71], v228 offset:41984
    v_mfma_f32_16x16x32_bf16 v[40:43], a[80:83], a[48:51], v[40:43]
    v_mfma_f32_16x16x32_bf16 v[40:43], a[84:87], a[52:55], v[40:43]
    v_mfma_f32_16x16x32_bf16 v[44:47], a[80:83], a[56:59], v[44:47]
    v_mfma_f32_16x16x32_bf16 v[44:47], a[84:87], a[60:63], v[44:47]
    s_waitcnt lgkmcnt(4)
    v_mfma_f32_16x16x32_bf16 v[48:51], a[88:91], a[32:35], v[48:51]
    ds_read_b64_tr_b16 a[72:73], v228 offset:49152
    v_mfma_f32_16x16x32_bf16 v[48:51], a[92:95], a[36:39], v[48:51]
    ds_read_b64_tr_b16 a[74:75], v228 offset:50176
    v_mfma_f32_16x16x32_bf16 v[52:55], a[88:91], a[40:43], v[52:55]
    ds_read_b64_tr_b16 a[76:77], v228 offset:57344
    v_mfma_f32_16x16x32_bf16 v[52:55], a[92:95], a[44:47], v[52:55]
    ds_read_b64_tr_b16 a[78:79], v228 offset:58368
    v_mfma_f32_16x16x32_bf16 v[56:59], a[88:91], a[48:51], v[56:59]
    v_mfma_f32_16x16x32_bf16 v[56:59], a[92:95], a[52:55], v[56:59]
    v_mfma_f32_16x16x32_bf16 v[60:63], a[88:91], a[56:59], v[60:63]
    v_mfma_f32_16x16x32_bf16 v[60:63], a[92:95], a[60:63], v[60:63]
    s_waitcnt lgkmcnt(4)
    v_mfma_f32_16x16x32_bf16 v[64:67], a[64:67], a[32:35], v[64:67]
    ds_read_b64_tr_b16 a[80:81], v229 offset:32768
    v_mfma_f32_16x16x32_bf16 v[64:67], a[68:71], a[36:39], v[64:67]
    ds_read_b64_tr_b16 a[82:83], v229 offset:33792
    v_mfma_f32_16x16x32_bf16 v[68:71], a[64:67], a[40:43], v[68:71]
    ds_read_b64_tr_b16 a[84:85], v229 offset:40960
    v_mfma_f32_16x16x32_bf16 v[68:71], a[68:71], a[44:47], v[68:71]
    ds_read_b64_tr_b16 a[86:87], v229 offset:41984
    v_mfma_f32_16x16x32_bf16 v[72:75], a[64:67], a[48:51], v[72:75]
    v_add_u32 v196, 2, v245
    v_mfma_f32_16x16x32_bf16 v[72:75], a[68:71], a[52:55], v[72:75]
    v_mfma_f32_16x16x32_bf16 v[76:79], a[64:67], a[56:59], v[76:79]
    v_mfma_f32_16x16x32_bf16 v[76:79], a[68:71], a[60:63], v[76:79]
    s_waitcnt lgkmcnt(4)
    v_mfma_f32_16x16x32_bf16 v[80:83], a[72:75], a[32:35], v[80:83]
    ds_read_b64_tr_b16 a[88:89], v229 offset:49152
    v_mfma_f32_16x16x32_bf16 v[80:83], a[76:79], a[36:39], v[80:83]
    ds_read_b64_tr_b16 a[90:91], v229 offset:50176
    v_mfma_f32_16x16x32_bf16 v[84:87], a[72:75], a[40:43], v[84:87]
    ds_read_b64_tr_b16 a[92:93], v229 offset:57344
    v_mfma_f32_16x16x32_bf16 v[84:87], a[76:79], a[44:47], v[84:87]
    ds_read_b64_tr_b16 a[94:95], v229 offset:58368
    v_mfma_f32_16x16x32_bf16 v[88:91], a[72:75], a[48:51], v[88:91]
    v_mfma_f32_16x16x32_bf16 v[88:91], a[76:79], a[52:55], v[88:91]
    v_mfma_f32_16x16x32_bf16 v[92:95], a[72:75], a[56:59], v[92:95]
    v_mfma_f32_16x16x32_bf16 v[92:95], a[76:79], a[60:63], v[92:95]
    s_waitcnt lgkmcnt(4)
    v_mfma_f32_16x16x32_bf16 v[96:99], a[80:83], a[32:35], v[96:99]
    ds_read_b64_tr_b16 a[64:65], v230 offset:32768
    v_mfma_f32_16x16x32_bf16 v[96:99], a[84:87], a[36:39], v[96:99]
    ds_read_b64_tr_b16 a[66:67], v230 offset:33792
    v_mfma_f32_16x16x32_bf16 v[100:103], a[80:83], a[40:43], v[100:103]
    ds_read_b64_tr_b16 a[68:69], v230 offset:40960
    v_mfma_f32_16x16x32_bf16 v[100:103], a[84:87], a[44:47], v[100:103]
    ds_read_b64_tr_b16 a[70:71], v230 offset:41984
    buffer_load_dword v239, v235, s[44:47], s69 offen
    s_add_u32 s69, s69, 457216
    v_mfma_f32_16x16x32_bf16 v[104:107], a[80:83], a[48:51], v[104:107]
    v_mfma_f32_16x16x32_bf16 v[104:107], a[84:87], a[52:55], v[104:107]
    v_mfma_f32_16x16x32_bf16 v[108:111], a[80:83], a[56:59], v[108:111]
    s_add_u32 m0, s95, 4192
    v_mfma_f32_16x16x32_bf16 v[108:111], a[84:87], a[60:63], v[108:111]
    s_waitcnt lgkmcnt(4)
    buffer_load_dwordx4 v196, s[52:55], s74 offen offset:0 lds
    v_mfma_f32_16x16x32_bf16 v[112:115], a[88:91], a[32:35], v[112:115]
    ds_read_b64_tr_b16 a[72:73], v230 offset:49152
    v_mfma_f32_16x16x32_bf16 v[112:115], a[92:95], a[36:39], v[112:115]
    ds_read_b64_tr_b16 a[74:75], v230 offset:50176
    v_mfma_f32_16x16x32_bf16 v[116:119], a[88:91], a[40:43], v[116:119]
    ds_read_b64_tr_b16 a[76:77], v230 offset:57344
    v_mfma_f32_16x16x32_bf16 v[116:119], a[92:95], a[44:47], v[116:119]
    ds_read_b64_tr_b16 a[78:79], v230 offset:58368
    v_mfma_f32_16x16x32_bf16 v[120:123], a[88:91], a[48:51], v[120:123]
    v_mfma_f32_16x16x32_bf16 v[120:123], a[92:95], a[52:55], v[120:123]
    v_mfma_f32_16x16x32_bf16 v[124:127], a[88:91], a[56:59], v[124:127]
    v_mfma_f32_16x16x32_bf16 v[124:127], a[92:95], a[60:63], v[124:127]
    s_waitcnt lgkmcnt(4)
    v_mfma_f32_16x16x32_bf16 v[128:131], a[64:67], a[32:35], v[128:131]
    ds_read_b64_tr_b16 a[80:81], v231 offset:32768
    v_mfma_f32_16x16x32_bf16 v[128:131], a[68:71], a[36:39], v[128:131]
    ds_read_b64_tr_b16 a[82:83], v231 offset:33792
    v_mfma_f32_16x16x32_bf16 v[132:135], a[64:67], a[40:43], v[132:135]
    ds_read_b64_tr_b16 a[84:85], v231 offset:40960
    v_mfma_f32_16x16x32_bf16 v[132:135], a[68:71], a[44:47], v[132:135]
    ds_read_b64_tr_b16 a[86:87], v231 offset:41984
    v_mfma_f32_16x16x32_bf16 v[136:139], a[64:67], a[48:51], v[136:139]
    v_mfma_f32_16x16x32_bf16 v[136:139], a[68:71], a[52:55], v[136:139]
    v_mfma_f32_16x16x32_bf16 v[140:143], a[64:67], a[56:59], v[140:143]
    v_mfma_f32_16x16x32_bf16 v[140:143], a[68:71], a[60:63], v[140:143]
    s_waitcnt lgkmcnt(4)
    v_mfma_f32_16x16x32_bf16 v[144:147], a[72:75], a[32:35], v[144:147]
    ds_read_b64_tr_b16 a[88:89], v231 offset:49152
    v_mfma_f32_16x16x32_bf16 v[144:147], a[76:79], a[36:39], v[144:147]
    ds_read_b64_tr_b16 a[90:91], v231 offset:50176
    buffer_load_dwordx4 v196, s[52:55], s74 offen offset:1024 lds
    v_mfma_f32_16x16x32_bf16 v[148:151], a[72:75], a[40:43], v[148:151]
    ds_read_b64_tr_b16 a[92:93], v231 offset:57344
    v_mfma_f32_16x16x32_bf16 v[148:151], a[76:79], a[44:47], v[148:151]
    ds_read_b64_tr_b16 a[94:95], v231 offset:58368
    v_mfma_f32_16x16x32_bf16 v[152:155], a[72:75], a[48:51], v[152:155]
    v_mfma_f32_16x16x32_bf16 v[152:155], a[76:79], a[52:55], v[152:155]
    v_mfma_f32_16x16x32_bf16 v[156:159], a[72:75], a[56:59], v[156:159]
    v_mfma_f32_16x16x32_bf16 v[156:159], a[76:79], a[60:63], v[156:159]
    s_waitcnt lgkmcnt(4)
    v_mfma_f32_16x16x32_bf16 v[160:163], a[80:83], a[32:35], v[160:163]
    ds_read_b64_tr_b16 a[64:65], v232 offset:32768
    v_mfma_f32_16x16x32_bf16 v[160:163], a[84:87], a[36:39], v[160:163]
    ds_read_b64_tr_b16 a[66:67], v232 offset:33792
    v_mfma_f32_16x16x32_bf16 v[164:167], a[80:83], a[40:43], v[164:167]
    ds_read_b64_tr_b16 a[68:69], v232 offset:40960
    v_mfma_f32_16x16x32_bf16 v[164:167], a[84:87], a[44:47], v[164:167]
    ds_read_b64_tr_b16 a[70:71], v232 offset:41984
    v_mfma_f32_16x16x32_bf16 v[168:171], a[80:83], a[48:51], v[168:171]
    v_mfma_f32_16x16x32_bf16 v[168:171], a[84:87], a[52:55], v[168:171]
    v_mfma_f32_16x16x32_bf16 v[172:175], a[80:83], a[56:59], v[172:175]
    v_mfma_f32_16x16x32_bf16 v[172:175], a[84:87], a[60:63], v[172:175]
    s_waitcnt lgkmcnt(4)
    v_mfma_f32_16x16x32_bf16 v[176:179], a[88:91], a[32:35], v[176:179]
    ds_read_b64_tr_b16 a[72:73], v232 offset:49152
    v_mfma_f32_16x16x32_bf16 v[176:179], a[92:95], a[36:39], v[176:179]
    ds_read_b64_tr_b16 a[74:75], v232 offset:50176
    v_mfma_f32_16x16x32_bf16 v[180:183], a[88:91], a[40:43], v[180:183]
    ds_read_b64_tr_b16 a[76:77], v232 offset:57344
    v_mfma_f32_16x16x32_bf16 v[180:183], a[92:95], a[44:47], v[180:183]
    ds_read_b64_tr_b16 a[78:79], v232 offset:58368
    buffer_load_dwordx4 v196, s[52:55], s74 offen offset:2048 lds
    v_mfma_f32_16x16x32_bf16 v[184:187], a[88:91], a[48:51], v[184:187]
    v_mfma_f32_16x16x32_bf16 v[184:187], a[92:95], a[52:55], v[184:187]
    v_mfma_f32_16x16x32_bf16 v[188:191], a[88:91], a[56:59], v[188:191]
    v_mfma_f32_16x16x32_bf16 v[188:191], a[92:95], a[60:63], v[188:191]
    s_waitcnt lgkmcnt(4)
    v_mfma_f32_16x16x32_bf16 a[96:99], a[64:67], a[32:35], a[96:99]
    ds_read_b64_tr_b16 a[80:81], v233 offset:32768
    v_mfma_f32_16x16x32_bf16 a[96:99], a[68:71], a[36:39], a[96:99]
    ds_read_b64_tr_b16 a[82:83], v233 offset:33792
    v_mfma_f32_16x16x32_bf16 a[100:103], a[64:67], a[40:43], a[100:103]
    ds_read_b64_tr_b16 a[84:85], v233 offset:40960
    v_mfma_f32_16x16x32_bf16 a[100:103], a[68:71], a[44:47], a[100:103]
    ds_read_b64_tr_b16 a[86:87], v233 offset:41984
    v_mfma_f32_16x16x32_bf16 a[104:107], a[64:67], a[48:51], a[104:107]
    ds_read_b64_tr_b16 a[88:89], v233 offset:49152
    v_mfma_f32_16x16x32_bf16 a[104:107], a[68:71], a[52:55], a[104:107]
    ds_read_b64_tr_b16 a[90:91], v233 offset:50176
    v_mfma_f32_16x16x32_bf16 a[108:111], a[64:67], a[56:59], a[108:111]
    ds_read_b64_tr_b16 a[92:93], v233 offset:57344
    v_mfma_f32_16x16x32_bf16 a[108:111], a[68:71], a[60:63], a[108:111]
    ds_read_b64_tr_b16 a[94:95], v233 offset:58368
    s_waitcnt lgkmcnt(8)
    v_mfma_f32_16x16x32_bf16 a[112:115], a[72:75], a[32:35], a[112:115]
    v_mfma_f32_16x16x32_bf16 a[112:115], a[76:79], a[36:39], a[112:115]
    v_mfma_f32_16x16x32_bf16 a[116:119], a[72:75], a[40:43], a[116:119]
    v_mfma_f32_16x16x32_bf16 a[116:119], a[76:79], a[44:47], a[116:119]
    v_mfma_f32_16x16x32_bf16 a[120:123], a[72:75], a[48:51], a[120:123]
    v_mfma_f32_16x16x32_bf16 a[120:123], a[76:79], a[52:55], a[120:123]
    v_mfma_f32_16x16x32_bf16 a[124:127], a[72:75], a[56:59], a[124:127]
    v_mfma_f32_16x16x32_bf16 a[124:127], a[76:79], a[60:63], a[124:127]
    s_waitcnt lgkmcnt(4)
    v_mfma_f32_16x16x32_bf16 a[128:131], a[80:83], a[32:35], a[128:131]
    v_mfma_f32_16x16x32_bf16 a[128:131], a[84:87], a[36:39], a[128:131]
    v_mfma_f32_16x16x32_bf16 a[132:135], a[80:83], a[40:43], a[132:135]
    v_mfma_f32_16x16x32_bf16 a[132:135], a[84:87], a[44:47], a[132:135]
    v_mfma_f32_16x16x32_bf16 a[136:139], a[80:83], a[48:51], a[136:139]
    v_mfma_f32_16x16x32_bf16 a[136:139], a[84:87], a[52:55], a[136:139]
    v_mfma_f32_16x16x32_bf16 a[140:143], a[80:83], a[56:59], a[140:143]
    v_mfma_f32_16x16x32_bf16 a[140:143], a[84:87], a[60:63], a[140:143]
    s_waitcnt lgkmcnt(0)
    v_mfma_f32_16x16x32_bf16 a[144:147], a[88:91], a[32:35], a[144:147]
    v_mfma_f32_16x16x32_bf16 a[144:147], a[92:95], a[36:39], a[144:147]
    v_mfma_f32_16x16x32_bf16 a[148:151], a[88:91], a[40:43], a[148:151]
    v_mfma_f32_16x16x32_bf16 a[148:151], a[92:95], a[44:47], a[148:151]
    v_mfma_f32_16x16x32_bf16 a[152:155], a[88:91], a[48:51], a[152:155]
    v_mfma_f32_16x16x32_bf16 a[152:155], a[92:95], a[52:55], a[152:155]
    v_mfma_f32_16x16x32_bf16 a[156:159], a[88:91], a[56:59], a[156:159]
    v_mfma_f32_16x16x32_bf16 a[156:159], a[92:95], a[60:63], a[156:159]
    s_barrier
    s_mov_b32 s56, s28
    s_and_b32 s57, s29, 0xffff
    s_mov_b32 s58, 14680064
    s_mov_b32 s59, 0x20000
    s_lshr_b32 s93, s30, 1
    s_lshl1_add_u32 s92, s71, s93
    s_mul_i32 s92, s92, 28
    s_add_u32 s92, s92, s72
    s_lshl_b32 s92, s92, 15
    s_and_b32 s93, s30, 1
    s_lshl_b32 s93, s93, 12
    s_add_u32 s92, s92, s93
    s_mov_b32 s100, 0xbfb8aa3b
    s_mov_b32 s101, 0xbfb8aa3b
    buffer_load_dwordx4 v196, s[52:55], s74 offen offset:3072 lds
    v_pk_mul_f32 v[208:209], v[0:1], s[100:101]
    v_pk_mul_f32 v[210:211], v[2:3], s[100:101]
    v_pk_mul_f32 v[212:213], v[32:33], s[100:101]
    v_pk_mul_f32 v[214:215], v[34:35], s[100:101]
    v_exp_f32 v208, v208
    v_exp_f32 v209, v209
    v_exp_f32 v210, v210
    v_exp_f32 v211, v211
    v_exp_f32 v212, v212
    v_exp_f32 v213, v213
    v_exp_f32 v214, v214
    v_exp_f32 v215, v215
    v_pk_add_f32 v[208:209], v[208:209], 1.0 op_sel_hi:[1,0]
    v_pk_add_f32 v[210:211], v[210:211], 1.0 op_sel_hi:[1,0]
    v_pk_mul_f32 v[0:1], v[0:1], v[16:17]
    v_pk_mul_f32 v[2:3], v[2:3], v[18:19]
    v_pk_add_f32 v[212:213], v[212:213], 1.0 op_sel_hi:[1,0]
    v_pk_add_f32 v[214:215], v[214:215], 1.0 op_sel_hi:[1,0]
    v_pk_mul_f32 v[32:33], v[32:33], v[48:49]
    v_pk_mul_f32 v[34:35], v[34:35], v[50:51]
    v_rcp_f32 v208, v208
    v_rcp_f32 v209, v209
    v_rcp_f32 v210, v210
    v_rcp_f32 v211, v211
    v_rcp_f32 v212, v212
    v_rcp_f32 v213, v213
    v_rcp_f32 v214, v214
    v_rcp_f32 v215, v215
    v_pk_mul_f32 v[208:209], v[208:209], v[0:1]
    v_pk_mul_f32 v[210:211], v[210:211], v[2:3]
    v_pk_mul_f32 v[212:213], v[212:213], v[32:33]
    v_pk_mul_f32 v[214:215], v[214:215], v[34:35]
    v_cvt_pk_bf16_f32 v216, v208, v209
    v_cvt_pk_bf16_f32 v217, v210, v211
    v_cvt_pk_bf16_f32 v218, v212, v213
    v_cvt_pk_bf16_f32 v219, v214, v215
    buffer_store_dwordx4 v[216:219], v245, s[56:59], s92 offen offset:0 sc1
    v_pk_mul_f32 v[208:209], v[4:5], s[100:101]
    v_pk_mul_f32 v[210:211], v[6:7], s[100:101]
    v_pk_mul_f32 v[212:213], v[36:37], s[100:101]
    v_pk_mul_f32 v[214:215], v[38:39], s[100:101]
    v_exp_f32 v208, v208
    v_exp_f32 v209, v209
    v_exp_f32 v210, v210
    v_exp_f32 v211, v211
    v_exp_f32 v212, v212
    v_exp_f32 v213, v213
    v_exp_f32 v214, v214
    v_exp_f32 v215, v215
    v_pk_add_f32 v[208:209], v[208:209], 1.0 op_sel_hi:[1,0]
    v_pk_add_f32 v[210:211], v[210:211], 1.0 op_sel_hi:[1,0]
    v_pk_mul_f32 v[4:5], v[4:5], v[20:21]
    v_pk_mul_f32 v[6:7], v[6:7], v[22:23]
    v_pk_add_f32 v[212:213], v[212:213], 1.0 op_sel_hi:[1,0]
    v_pk_add_f32 v[214:215], v[214:215], 1.0 op_sel_hi:[1,0]
    v_pk_mul_f32 v[36:37], v[36:37], v[52:53]
    v_pk_mul_f32 v[38:39], v[38:39], v[54:55]
    v_rcp_f32 v208, v208
    v_rcp_f32 v209, v209
    v_rcp_f32 v210, v210
    v_rcp_f32 v211, v211
    v_rcp_f32 v212, v212
    v_rcp_f32 v213, v213
    v_rcp_f32 v214, v214
    v_rcp_f32 v215, v215
    v_pk_mul_f32 v[208:209], v[208:209], v[4:5]
    v_pk_mul_f32 v[210:211], v[210:211], v[6:7]
    v_pk_mul_f32 v[212:213], v[212:213], v[36:37]
    v_pk_mul_f32 v[214:215], v[214:215], v[38:39]
    v_cvt_pk_bf16_f32 v220, v208, v209
    v_cvt_pk_bf16_f32 v221, v210, v211
    v_cvt_pk_bf16_f32 v222, v212, v213
    v_cvt_pk_bf16_f32 v223, v214, v215
    buffer_store_dwordx4 v[220:223], v245, s[56:59], s92 offen offset:1024 sc1
    v_pk_mul_f32 v[208:209], v[8:9], s[100:101]
    v_pk_mul_f32 v[210:211], v[10:11], s[100:101]
    v_pk_mul_f32 v[212:213], v[40:41], s[100:101]
    v_pk_mul_f32 v[214:215], v[42:43], s[100:101]
    v_exp_f32 v208, v208
    v_exp_f32 v209, v209
    v_exp_f32 v210, v210
    v_exp_f32 v211, v211
    v_exp_f32 v212, v212
    v_exp_f32 v213, v213
    v_exp_f32 v214, v214
    v_exp_f32 v215, v215
    v_pk_add_f32 v[208:209], v[208:209], 1.0 op_sel_hi:[1,0]
    v_pk_add_f32 v[210:211], v[210:211], 1.0 op_sel_hi:[1,0]
    v_pk_mul_f32 v[8:9], v[8:9], v[24:25]
    v_pk_mul_f32 v[10:11], v[10:11], v[26:27]
    v_pk_add_f32 v[212:213], v[212:213], 1.0 op_sel_hi:[1,0]
    v_pk_add_f32 v[214:215], v[214:215], 1.0 op_sel_hi:[1,0]
    v_pk_mul_f32 v[40:41], v[40:41], v[56:57]
    v_pk_mul_f32 v[42:43], v[42:43], v[58:59]
    v_rcp_f32 v208, v208
    v_rcp_f32 v209, v209
    v_rcp_f32 v210, v210
    v_rcp_f32 v211, v211
    v_rcp_f32 v212, v212
    v_rcp_f32 v213, v213
    v_rcp_f32 v214, v214
    v_rcp_f32 v215, v215
    v_pk_mul_f32 v[208:209], v[208:209], v[8:9]
    v_pk_mul_f32 v[210:211], v[210:211], v[10:11]
    v_pk_mul_f32 v[212:213], v[212:213], v[40:41]
    v_pk_mul_f32 v[214:215], v[214:215], v[42:43]
    v_cvt_pk_bf16_f32 v216, v208, v209
    v_cvt_pk_bf16_f32 v217, v210, v211
    v_cvt_pk_bf16_f32 v218, v212, v213
    v_cvt_pk_bf16_f32 v219, v214, v215
    buffer_store_dwordx4 v[216:219], v245, s[56:59], s92 offen offset:2048 sc1
    v_pk_mul_f32 v[208:209], v[12:13], s[100:101]
    v_pk_mul_f32 v[210:211], v[14:15], s[100:101]
    v_pk_mul_f32 v[212:213], v[44:45], s[100:101]
    v_pk_mul_f32 v[214:215], v[46:47], s[100:101]
    v_exp_f32 v208, v208
    v_exp_f32 v209, v209
    v_exp_f32 v210, v210
    v_exp_f32 v211, v211
    v_exp_f32 v212, v212
    v_exp_f32 v213, v213
    v_exp_f32 v214, v214
    v_exp_f32 v215, v215
    v_pk_add_f32 v[208:209], v[208:209], 1.0 op_sel_hi:[1,0]
    v_pk_add_f32 v[210:211], v[210:211], 1.0 op_sel_hi:[1,0]
    v_pk_mul_f32 v[12:13], v[12:13], v[28:29]
    v_pk_mul_f32 v[14:15], v[14:15], v[30:31]
    v_pk_add_f32 v[212:213], v[212:213], 1.0 op_sel_hi:[1,0]
    v_pk_add_f32 v[214:215], v[214:215], 1.0 op_sel_hi:[1,0]
    v_pk_mul_f32 v[44:45], v[44:45], v[60:61]
    v_pk_mul_f32 v[46:47], v[46:47], v[62:63]
    v_rcp_f32 v208, v208
    v_rcp_f32 v209, v209
    v_rcp_f32 v210, v210
    v_rcp_f32 v211, v211
    v_rcp_f32 v212, v212
    v_rcp_f32 v213, v213
    v_rcp_f32 v214, v214
    v_rcp_f32 v215, v215
    v_pk_mul_f32 v[208:209], v[208:209], v[12:13]
    v_pk_mul_f32 v[210:211], v[210:211], v[14:15]
    v_pk_mul_f32 v[212:213], v[212:213], v[44:45]
    v_pk_mul_f32 v[214:215], v[214:215], v[46:47]
    v_cvt_pk_bf16_f32 v220, v208, v209
    v_cvt_pk_bf16_f32 v221, v210, v211
    v_cvt_pk_bf16_f32 v222, v212, v213
    v_cvt_pk_bf16_f32 v223, v214, v215
    buffer_store_dwordx4 v[220:223], v245, s[56:59], s92 offen offset:3072 sc1
    buffer_load_dwordx2 v[194:195], v192, s[60:63], 0 offen sc1
    s_add_u32 s92, s92, 8192
    v_pk_mul_f32 v[208:209], v[64:65], s[100:101]
    v_pk_mul_f32 v[210:211], v[66:67], s[100:101]
    v_pk_mul_f32 v[212:213], v[96:97], s[100:101]
    v_pk_mul_f32 v[214:215], v[98:99], s[100:101]
    v_exp_f32 v208, v208
    v_exp_f32 v209, v209
    v_exp_f32 v210, v210
    v_exp_f32 v211, v211
    v_exp_f32 v212, v212
    v_exp_f32 v213, v213
    v_exp_f32 v214, v214
    v_exp_f32 v215, v215
    v_pk_add_f32 v[208:209], v[208:209], 1.0 op_sel_hi:[1,0]
    v_pk_add_f32 v[210:211], v[210:211], 1.0 op_sel_hi:[1,0]
    v_pk_mul_f32 v[64:65], v[64:65], v[80:81]
    v_pk_mul_f32 v[66:67], v[66:67], v[82:83]
    v_pk_add_f32 v[212:213], v[212:213], 1.0 op_sel_hi:[1,0]
    v_pk_add_f32 v[214:215], v[214:215], 1.0 op_sel_hi:[1,0]
    v_pk_mul_f32 v[96:97], v[96:97], v[112:113]
    v_pk_mul_f32 v[98:99], v[98:99], v[114:115]
    v_rcp_f32 v208, v208
    v_rcp_f32 v209, v209
    v_rcp_f32 v210, v210
    v_rcp_f32 v211, v211
    v_rcp_f32 v212, v212
    v_rcp_f32 v213, v213
    v_rcp_f32 v214, v214
    v_rcp_f32 v215, v215
    v_pk_mul_f32 v[208:209], v[208:209], v[64:65]
    v_pk_mul_f32 v[210:211], v[210:211], v[66:67]
    v_pk_mul_f32 v[212:213], v[212:213], v[96:97]
    v_pk_mul_f32 v[214:215], v[214:215], v[98:99]
    v_cvt_pk_bf16_f32 v216, v208, v209
    v_cvt_pk_bf16_f32 v217, v210, v211
    v_cvt_pk_bf16_f32 v218, v212, v213
    v_cvt_pk_bf16_f32 v219, v214, v215
    buffer_store_dwordx4 v[216:219], v245, s[56:59], s92 offen offset:0 sc1
    v_pk_mul_f32 v[208:209], v[68:69], s[100:101]
    v_pk_mul_f32 v[210:211], v[70:71], s[100:101]
    v_pk_mul_f32 v[212:213], v[100:101], s[100:101]
    v_pk_mul_f32 v[214:215], v[102:103], s[100:101]
    v_exp_f32 v208, v208
    v_exp_f32 v209, v209
    v_exp_f32 v210, v210
    v_exp_f32 v211, v211
    v_exp_f32 v212, v212
    v_exp_f32 v213, v213
    v_exp_f32 v214, v214
    v_exp_f32 v215, v215
    v_pk_add_f32 v[208:209], v[208:209], 1.0 op_sel_hi:[1,0]
    v_pk_add_f32 v[210:211], v[210:211], 1.0 op_sel_hi:[1,0]
    v_pk_mul_f32 v[68:69], v[68:69], v[84:85]
    v_pk_mul_f32 v[70:71], v[70:71], v[86:87]
    v_pk_add_f32 v[212:213], v[212:213], 1.0 op_sel_hi:[1,0]
    v_pk_add_f32 v[214:215], v[214:215], 1.0 op_sel_hi:[1,0]
    v_pk_mul_f32 v[100:101], v[100:101], v[116:117]
    v_pk_mul_f32 v[102:103], v[102:103], v[118:119]
    v_rcp_f32 v208, v208
    v_rcp_f32 v209, v209
    v_rcp_f32 v210, v210
    v_rcp_f32 v211, v211
    v_rcp_f32 v212, v212
    v_rcp_f32 v213, v213
    v_rcp_f32 v214, v214
    v_rcp_f32 v215, v215
    v_pk_mul_f32 v[208:209], v[208:209], v[68:69]
    v_pk_mul_f32 v[210:211], v[210:211], v[70:71]
    v_pk_mul_f32 v[212:213], v[212:213], v[100:101]
    v_pk_mul_f32 v[214:215], v[214:215], v[102:103]
    v_cvt_pk_bf16_f32 v220, v208, v209
    v_cvt_pk_bf16_f32 v221, v210, v211
    v_cvt_pk_bf16_f32 v222, v212, v213
    v_cvt_pk_bf16_f32 v223, v214, v215
    buffer_store_dwordx4 v[220:223], v245, s[56:59], s92 offen offset:1024 sc1
    v_pk_mul_f32 v[208:209], v[72:73], s[100:101]
    v_pk_mul_f32 v[210:211], v[74:75], s[100:101]
    v_pk_mul_f32 v[212:213], v[104:105], s[100:101]
    v_pk_mul_f32 v[214:215], v[106:107], s[100:101]
    v_exp_f32 v208, v208
    v_exp_f32 v209, v209
    v_exp_f32 v210, v210
    v_exp_f32 v211, v211
    v_exp_f32 v212, v212
    v_exp_f32 v213, v213
    v_exp_f32 v214, v214
    v_exp_f32 v215, v215
    v_pk_add_f32 v[208:209], v[208:209], 1.0 op_sel_hi:[1,0]
    v_pk_add_f32 v[210:211], v[210:211], 1.0 op_sel_hi:[1,0]
    v_pk_mul_f32 v[72:73], v[72:73], v[88:89]
    v_pk_mul_f32 v[74:75], v[74:75], v[90:91]
    v_pk_add_f32 v[212:213], v[212:213], 1.0 op_sel_hi:[1,0]
    v_pk_add_f32 v[214:215], v[214:215], 1.0 op_sel_hi:[1,0]
    v_pk_mul_f32 v[104:105], v[104:105], v[120:121]
    v_pk_mul_f32 v[106:107], v[106:107], v[122:123]
    v_rcp_f32 v208, v208
    v_rcp_f32 v209, v209
    v_rcp_f32 v210, v210
    v_rcp_f32 v211, v211
    v_rcp_f32 v212, v212
    v_rcp_f32 v213, v213
    v_rcp_f32 v214, v214
    v_rcp_f32 v215, v215
    v_pk_mul_f32 v[208:209], v[208:209], v[72:73]
    v_pk_mul_f32 v[210:211], v[210:211], v[74:75]
    v_pk_mul_f32 v[212:213], v[212:213], v[104:105]
    v_pk_mul_f32 v[214:215], v[214:215], v[106:107]
    v_cvt_pk_bf16_f32 v216, v208, v209
    v_cvt_pk_bf16_f32 v217, v210, v211
    v_cvt_pk_bf16_f32 v218, v212, v213
    v_cvt_pk_bf16_f32 v219, v214, v215
    buffer_store_dwordx4 v[216:219], v245, s[56:59], s92 offen offset:2048 sc1
    s_waitcnt vmcnt(3)
    v_cmp_eq_u64 vcc, s[86:87], v[194:195]
    s_nop 1
    s_cmp_eq_u64 vcc, -1
    s_cbranch_scc0 L_slow_ur
L_ok_ur:
    s_add_u32 s48, s28, 16777216
    s_addc_u32 s49, s29, 0
    s_and_b32 s49, s49, 0xffff
    s_mov_b32 s50, 4194304
    s_mov_b32 s51, 0x20000
    s_mov_b32 m0, s89
    s_nop 0
    buffer_load_dwordx4 v245, s[48:51], s74 offen offset:0 sc1 lds
    buffer_load_dwordx4 v245, s[48:51], s74 offen offset:1024 sc1 lds
    buffer_load_dwordx4 v245, s[48:51], s74 offen offset:2048 sc1 lds
    buffer_load_dwordx4 v245, s[48:51], s74 offen offset:3072 sc1 lds
    v_pk_mul_f32 v[208:209], v[76:77], s[100:101]
    v_pk_mul_f32 v[210:211], v[78:79], s[100:101]
    v_pk_mul_f32 v[212:213], v[108:109], s[100:101]
    v_pk_mul_f32 v[214:215], v[110:111], s[100:101]
    v_exp_f32 v208, v208
    v_exp_f32 v209, v209
    v_exp_f32 v210, v210
    v_exp_f32 v211, v211
    v_exp_f32 v212, v212
    v_exp_f32 v213, v213
    v_exp_f32 v214, v214
    v_exp_f32 v215, v215
    v_pk_add_f32 v[208:209], v[208:209], 1.0 op_sel_hi:[1,0]
    v_pk_add_f32 v[210:211], v[210:211], 1.0 op_sel_hi:[1,0]
    v_pk_mul_f32 v[76:77], v[76:77], v[92:93]
    v_pk_mul_f32 v[78:79], v[78:79], v[94:95]
    v_pk_add_f32 v[212:213], v[212:213], 1.0 op_sel_hi:[1,0]
    v_pk_add_f32 v[214:215], v[214:215], 1.0 op_sel_hi:[1,0]
    v_pk_mul_f32 v[108:109], v[108:109], v[124:125]
    v_pk_mul_f32 v[110:111], v[110:111], v[126:127]
    v_rcp_f32 v208, v208
    v_rcp_f32 v209, v209
    v_rcp_f32 v210, v210
    v_rcp_f32 v211, v211
    v_rcp_f32 v212, v212
    v_rcp_f32 v213, v213
    v_rcp_f32 v214, v214
    v_rcp_f32 v215, v215
    v_pk_mul_f32 v[208:209], v[208:209], v[76:77]
    v_pk_mul_f32 v[210:211], v[210:211], v[78:79]
    v_pk_mul_f32 v[212:213], v[212:213], v[108:109]
    v_pk_mul_f32 v[214:215], v[214:215], v[110:111]
    v_cvt_pk_bf16_f32 v220, v208, v209
    v_cvt_pk_bf16_f32 v221, v210, v211
    v_cvt_pk_bf16_f32 v222, v212, v213
    v_cvt_pk_bf16_f32 v223, v214, v215
    buffer_store_dwordx4 v[220:223], v245, s[56:59], s92 offen offset:3072 sc1
    s_add_u32 s92, s92, 8192
    v_pk_mul_f32 v[208:209], v[128:129], s[100:101]
    v_pk_mul_f32 v[210:211], v[130:131], s[100:101]
    v_pk_mul_f32 v[212:213], v[160:161], s[100:101]
    v_pk_mul_f32 v[214:215], v[162:163], s[100:101]
    v_exp_f32 v208, v208
    v_exp_f32 v209, v209
    v_exp_f32 v210, v210
    v_exp_f32 v211, v211
    v_exp_f32 v212, v212
    v_exp_f32 v213, v213
    v_exp_f32 v214, v214
    v_exp_f32 v215, v215
    v_pk_add_f32 v[208:209], v[208:209], 1.0 op_sel_hi:[1,0]
    v_pk_add_f32 v[210:211], v[210:211], 1.0 op_sel_hi:[1,0]
    v_pk_mul_f32 v[128:129], v[128:129], v[144:145]
    v_pk_mul_f32 v[130:131], v[130:131], v[146:147]
    v_pk_add_f32 v[212:213], v[212:213], 1.0 op_sel_hi:[1,0]
    v_pk_add_f32 v[214:215], v[214:215], 1.0 op_sel_hi:[1,0]
    v_pk_mul_f32 v[160:161], v[160:161], v[176:177]
    v_pk_mul_f32 v[162:163], v[162:163], v[178:179]
    v_rcp_f32 v208, v208
    v_rcp_f32 v209, v209
    v_rcp_f32 v210, v210
    v_rcp_f32 v211, v211
    v_rcp_f32 v212, v212
    v_rcp_f32 v213, v213
    v_rcp_f32 v214, v214
    v_rcp_f32 v215, v215
    v_pk_mul_f32 v[208:209], v[208:209], v[128:129]
    v_pk_mul_f32 v[210:211], v[210:211], v[130:131]
    v_pk_mul_f32 v[212:213], v[212:213], v[160:161]
    v_pk_mul_f32 v[214:215], v[214:215], v[162:163]
    v_cvt_pk_bf16_f32 v216, v208, v209
    v_cvt_pk_bf16_f32 v217, v210, v211
    v_cvt_pk_bf16_f32 v218, v212, v213
    v_cvt_pk_bf16_f32 v219, v214, v215
    buffer_store_dwordx4 v[216:219], v245, s[56:59], s92 offen offset:0 sc1
    v_pk_mul_f32 v[208:209], v[132:133], s[100:101]
    v_pk_mul_f32 v[210:211], v[134:135], s[100:101]
    v_pk_mul_f32 v[212:213], v[164:165], s[100:101]
    v_pk_mul_f32 v[214:215], v[166:167], s[100:101]
    v_exp_f32 v208, v208
    v_exp_f32 v209, v209
    v_exp_f32 v210, v210
    v_exp_f32 v211, v211
    v_exp_f32 v212, v212
    v_exp_f32 v213, v213
    v_exp_f32 v214, v214
    v_exp_f32 v215, v215
    v_pk_add_f32 v[208:209], v[208:209], 1.0 op_sel_hi:[1,0]
    v_pk_add_f32 v[210:211], v[210:211], 1.0 op_sel_hi:[1,0]
    v_pk_mul_f32 v[132:133], v[132:133], v[148:149]
    v_pk_mul_f32 v[134:135], v[134:135], v[150:151]
    v_pk_add_f32 v[212:213], v[212:213], 1.0 op_sel_hi:[1,0]
    v_pk_add_f32 v[214:215], v[214:215], 1.0 op_sel_hi:[1,0]
    v_pk_mul_f32 v[164:165], v[164:165], v[180:181]
    v_pk_mul_f32 v[166:167], v[166:167], v[182:183]
    v_rcp_f32 v208, v208
    v_rcp_f32 v209, v209
    v_rcp_f32 v210, v210
    v_rcp_f32 v211, v211
    v_rcp_f32 v212, v212
    v_rcp_f32 v213, v213
    v_rcp_f32 v214, v214
    v_rcp_f32 v215, v215
    v_pk_mul_f32 v[208:209], v[208:209], v[132:133]
    v_pk_mul_f32 v[210:211], v[210:211], v[134:135]
    v_pk_mul_f32 v[212:213], v[212:213], v[164:165]
    v_pk_mul_f32 v[214:215], v[214:215], v[166:167]
    v_cvt_pk_bf16_f32 v220, v208, v209
    v_cvt_pk_bf16_f32 v221, v210, v211
    v_cvt_pk_bf16_f32 v222, v212, v213
    v_cvt_pk_bf16_f32 v223, v214, v215
    buffer_store_dwordx4 v[220:223], v245, s[56:59], s92 offen offset:1024 sc1
    v_pk_mul_f32 v[208:209], v[136:137], s[100:101]
    v_pk_mul_f32 v[210:211], v[138:139], s[100:101]
    v_pk_mul_f32 v[212:213], v[168:169], s[100:101]
    v_pk_mul_f32 v[214:215], v[170:171], s[100:101]
    v_exp_f32 v208, v208
    v_exp_f32 v209, v209
    v_exp_f32 v210, v210
    v_exp_f32 v211, v211
    v_exp_f32 v212, v212
    v_exp_f32 v213, v213
    v_exp_f32 v214, v214
    v_exp_f32 v215, v215
    v_pk_add_f32 v[208:209], v[208:209], 1.0 op_sel_hi:[1,0]
    v_pk_add_f32 v[210:211], v[210:211], 1.0 op_sel_hi:[1,0]
    v_pk_mul_f32 v[136:137], v[136:137], v[152:153]
    v_pk_mul_f32 v[138:139], v[138:139], v[154:155]
    v_pk_add_f32 v[212:213], v[212:213], 1.0 op_sel_hi:[1,0]
    v_pk_add_f32 v[214:215], v[214:215], 1.0 op_sel_hi:[1,0]
    v_pk_mul_f32 v[168:169], v[168:169], v[184:185]
    v_pk_mul_f32 v[170:171], v[170:171], v[186:187]
    v_rcp_f32 v208, v208
    v_rcp_f32 v209, v209
    v_rcp_f32 v210, v210
    v_rcp_f32 v211, v211
    v_rcp_f32 v212, v212
    v_rcp_f32 v213, v213
    v_rcp_f32 v214, v214
    v_rcp_f32 v215, v215
    v_pk_mul_f32 v[208:209], v[208:209], v[136:137]
    v_pk_mul_f32 v[210:211], v[210:211], v[138:139]
    v_pk_mul_f32 v[212:213], v[212:213], v[168:169]
    v_pk_mul_f32 v[214:215], v[214:215], v[170:171]
    v_cvt_pk_bf16_f32 v216, v208, v209
    v_cvt_pk_bf16_f32 v217, v210, v211
    v_cvt_pk_bf16_f32 v218, v212, v213
    v_cvt_pk_bf16_f32 v219, v214, v215
    buffer_store_dwordx4 v[216:219], v245, s[56:59], s92 offen offset:2048 sc1
    v_pk_mul_f32 v[208:209], v[140:141], s[100:101]
    v_pk_mul_f32 v[210:211], v[142:143], s[100:101]
    v_pk_mul_f32 v[212:213], v[172:173], s[100:101]
    v_pk_mul_f32 v[214:215], v[174:175], s[100:101]
    v_exp_f32 v208, v208
    v_exp_f32 v209, v209
    v_exp_f32 v210, v210
    v_exp_f32 v211, v211
    v_exp_f32 v212, v212
    v_exp_f32 v213, v213
    v_exp_f32 v214, v214
    v_exp_f32 v215, v215
    v_pk_add_f32 v[208:209], v[208:209], 1.0 op_sel_hi:[1,0]
    v_pk_add_f32 v[210:211], v[210:211], 1.0 op_sel_hi:[1,0]
    v_pk_mul_f32 v[140:141], v[140:141], v[156:157]
    v_pk_mul_f32 v[142:143], v[142:143], v[158:159]
    v_pk_add_f32 v[212:213], v[212:213], 1.0 op_sel_hi:[1,0]
    v_pk_add_f32 v[214:215], v[214:215], 1.0 op_sel_hi:[1,0]
    v_pk_mul_f32 v[172:173], v[172:173], v[188:189]
    v_pk_mul_f32 v[174:175], v[174:175], v[190:191]
    v_rcp_f32 v208, v208
    v_rcp_f32 v209, v209
    v_rcp_f32 v210, v210
    v_rcp_f32 v211, v211
    v_rcp_f32 v212, v212
    v_rcp_f32 v213, v213
    v_rcp_f32 v214, v214
    v_rcp_f32 v215, v215
    v_pk_mul_f32 v[208:209], v[208:209], v[140:141]
    v_pk_mul_f32 v[210:211], v[210:211], v[142:143]
    v_pk_mul_f32 v[212:213], v[212:213], v[172:173]
    v_pk_mul_f32 v[214:215], v[214:215], v[174:175]
    v_cvt_pk_bf16_f32 v220, v208, v209
    v_cvt_pk_bf16_f32 v221, v210, v211
    v_cvt_pk_bf16_f32 v222, v212, v213
    v_cvt_pk_bf16_f32 v223, v214, v215
    buffer_store_dwordx4 v[220:223], v245, s[56:59], s92 offen offset:3072 sc1
    s_waitcnt vmcnt(4)
    v_mov_b32 v228, s86
    v_mov_b32 v229, s87
    buffer_store_dwordx2 v[228:229], v254, s[60:63], 0 offen offset:0 sc1
    s_add_u32 s92, s92, 8192
    v_accvgpr_read_b32 v0, a96
    v_accvgpr_read_b32 v1, a97
    v_accvgpr_read_b32 v2, a98
    v_accvgpr_read_b32 v3, a99
    v_accvgpr_read_b32 v4, a100
    v_accvgpr_read_b32 v5, a101
    v_accvgpr_read_b32 v6, a102
    v_accvgpr_read_b32 v7, a103
    v_accvgpr_read_b32 v8, a104
    v_accvgpr_read_b32 v9, a105
    v_accvgpr_read_b32 v10, a106
    v_accvgpr_read_b32 v11, a107
    v_accvgpr_read_b32 v12, a108
    v_accvgpr_read_b32 v13, a109
    v_accvgpr_read_b32 v14, a110
    v_accvgpr_read_b32 v15, a111
    v_accvgpr_read_b32 v16, a112
    v_accvgpr_read_b32 v17, a113
    v_accvgpr_read_b32 v18, a114
    v_accvgpr_read_b32 v19, a115
    v_accvgpr_read_b32 v20, a116
    v_accvgpr_read_b32 v21, a117
    v_accvgpr_read_b32 v22, a118
    v_accvgpr_read_b32 v23, a119
    v_accvgpr_read_b32 v24, a120
    v_accvgpr_read_b32 v25, a121
    v_accvgpr_read_b32 v26, a122
    v_accvgpr_read_b32 v27, a123
    v_accvgpr_read_b32 v28, a124
    v_accvgpr_read_b32 v29, a125
    v_accvgpr_read_b32 v30, a126
    v_accvgpr_read_b32 v31, a127
    v_accvgpr_read_b32 v32, a128
    v_accvgpr_read_b32 v33, a129
    v_accvgpr_read_b32 v34, a130
    v_accvgpr_read_b32 v35, a131
    v_accvgpr_read_b32 v36, a132
    v_accvgpr_read_b32 v37, a133
    v_accvgpr_read_b32 v38, a134
    v_accvgpr_read_b32 v39, a135
    v_accvgpr_read_b32 v40, a136
    v_accvgpr_read_b32 v41, a137
    v_accvgpr_read_b32 v42, a138
    v_accvgpr_read_b32 v43, a139
    v_accvgpr_read_b32 v44, a140
    v_accvgpr_read_b32 v45, a141
    v_accvgpr_read_b32 v46, a142
    v_accvgpr_read_b32 v47, a143
    v_accvgpr_read_b32 v48, a144
    v_accvgpr_read_b32 v49, a145
    v_accvgpr_read_b32 v50, a146
    v_accvgpr_read_b32 v51, a147
    v_accvgpr_read_b32 v52, a148
    v_accvgpr_read_b32 v53, a149
    v_accvgpr_read_b32 v54, a150
    v_accvgpr_read_b32 v55, a151
    v_accvgpr_read_b32 v56, a152
    v_accvgpr_read_b32 v57, a153
    v_accvgpr_read_b32 v58, a154
    v_accvgpr_read_b32 v59, a155
    v_accvgpr_read_b32 v60, a156
    v_accvgpr_read_b32 v61, a157
    v_accvgpr_read_b32 v62, a158
    v_accvgpr_read_b32 v63, a159
    v_pk_mul_f32 v[208:209], v[0:1], s[100:101]
    v_pk_mul_f32 v[210:211], v[2:3], s[100:101]
    v_pk_mul_f32 v[212:213], v[32:33], s[100:101]
    v_pk_mul_f32 v[214:215], v[34:35], s[100:101]
    v_exp_f32 v208, v208
    v_exp_f32 v209, v209
    v_exp_f32 v210, v210
    v_exp_f32 v211, v211
    v_exp_f32 v212, v212
    v_exp_f32 v213, v213
    v_exp_f32 v214, v214
    v_exp_f32 v215, v215
    v_pk_add_f32 v[208:209], v[208:209], 1.0 op_sel_hi:[1,0]
    v_pk_add_f32 v[210:211], v[210:211], 1.0 op_sel_hi:[1,0]
    v_pk_mul_f32 v[0:1], v[0:1], v[16:17]
    v_pk_mul_f32 v[2:3], v[2:3], v[18:19]
    v_pk_add_f32 v[212:213], v[212:213], 1.0 op_sel_hi:[1,0]
    v_pk_add_f32 v[214:215], v[214:215], 1.0 op_sel_hi:[1,0]
    v_pk_mul_f32 v[32:33], v[32:33], v[48:49]
    v_pk_mul_f32 v[34:35], v[34:35], v[50:51]
    v_rcp_f32 v208, v208
    v_rcp_f32 v209, v209
    v_rcp_f32 v210, v210
    v_rcp_f32 v211, v211
    v_rcp_f32 v212, v212
    v_rcp_f32 v213, v213
    v_rcp_f32 v214, v214
    v_rcp_f32 v215, v215
    v_pk_mul_f32 v[208:209], v[208:209], v[0:1]
    v_pk_mul_f32 v[210:211], v[210:211], v[2:3]
    v_pk_mul_f32 v[212:213], v[212:213], v[32:33]
    v_pk_mul_f32 v[214:215], v[214:215], v[34:35]
    v_cvt_pk_bf16_f32 v216, v208, v209
    v_cvt_pk_bf16_f32 v217, v210, v211
    v_cvt_pk_bf16_f32 v218, v212, v213
    v_cvt_pk_bf16_f32 v219, v214, v215
    buffer_store_dwordx4 v[216:219], v245, s[56:59], s92 offen offset:0 sc1
    v_pk_mul_f32 v[208:209], v[4:5], s[100:101]
    v_pk_mul_f32 v[210:211], v[6:7], s[100:101]
    v_pk_mul_f32 v[212:213], v[36:37], s[100:101]
    v_pk_mul_f32 v[214:215], v[38:39], s[100:101]
    v_exp_f32 v208, v208
    v_exp_f32 v209, v209
    v_exp_f32 v210, v210
    v_exp_f32 v211, v211
    v_exp_f32 v212, v212
    v_exp_f32 v213, v213
    v_exp_f32 v214, v214
    v_exp_f32 v215, v215
    v_pk_add_f32 v[208:209], v[208:209], 1.0 op_sel_hi:[1,0]
    v_pk_add_f32 v[210:211], v[210:211], 1.0 op_sel_hi:[1,0]
    v_pk_mul_f32 v[4:5], v[4:5], v[20:21]
    v_pk_mul_f32 v[6:7], v[6:7], v[22:23]
    v_pk_add_f32 v[212:213], v[212:213], 1.0 op_sel_hi:[1,0]
    v_pk_add_f32 v[214:215], v[214:215], 1.0 op_sel_hi:[1,0]
    v_pk_mul_f32 v[36:37], v[36:37], v[52:53]
    v_pk_mul_f32 v[38:39], v[38:39], v[54:55]
    v_rcp_f32 v208, v208
    v_rcp_f32 v209, v209
    v_rcp_f32 v210, v210
    v_rcp_f32 v211, v211
    v_rcp_f32 v212, v212
    v_rcp_f32 v213, v213
    v_rcp_f32 v214, v214
    v_rcp_f32 v215, v215
    v_pk_mul_f32 v[208:209], v[208:209], v[4:5]
    v_pk_mul_f32 v[210:211], v[210:211], v[6:7]
    v_pk_mul_f32 v[212:213], v[212:213], v[36:37]
    v_pk_mul_f32 v[214:215], v[214:215], v[38:39]
    v_cvt_pk_bf16_f32 v220, v208, v209
    v_cvt_pk_bf16_f32 v221, v210, v211
    v_cvt_pk_bf16_f32 v222, v212, v213
    v_cvt_pk_bf16_f32 v223, v214, v215
    buffer_store_dwordx4 v[220:223], v245, s[56:59], s92 offen offset:1024 sc1
    v_pk_mul_f32 v[208:209], v[8:9], s[100:101]
    v_pk_mul_f32 v[210:211], v[10:11], s[100:101]
    v_pk_mul_f32 v[212:213], v[40:41], s[100:101]
    v_pk_mul_f32 v[214:215], v[42:43], s[100:101]
    v_exp_f32 v208, v208
    v_exp_f32 v209, v209
    v_exp_f32 v210, v210
    v_exp_f32 v211, v211
    v_exp_f32 v212, v212
    v_exp_f32 v213, v213
    v_exp_f32 v214, v214
    v_exp_f32 v215, v215
    v_pk_add_f32 v[208:209], v[208:209], 1.0 op_sel_hi:[1,0]
    v_pk_add_f32 v[210:211], v[210:211], 1.0 op_sel_hi:[1,0]
    v_pk_mul_f32 v[8:9], v[8:9], v[24:25]
    v_pk_mul_f32 v[10:11], v[10:11], v[26:27]
    v_pk_add_f32 v[212:213], v[212:213], 1.0 op_sel_hi:[1,0]
    v_pk_add_f32 v[214:215], v[214:215], 1.0 op_sel_hi:[1,0]
    v_pk_mul_f32 v[40:41], v[40:41], v[56:57]
    v_pk_mul_f32 v[42:43], v[42:43], v[58:59]
    v_rcp_f32 v208, v208
    v_rcp_f32 v209, v209
    v_rcp_f32 v210, v210
    v_rcp_f32 v211, v211
    v_rcp_f32 v212, v212
    v_rcp_f32 v213, v213
    v_rcp_f32 v214, v214
    v_rcp_f32 v215, v215
    v_pk_mul_f32 v[208:209], v[208:209], v[8:9]
    v_pk_mul_f32 v[210:211], v[210:211], v[10:11]
    v_pk_mul_f32 v[212:213], v[212:213], v[40:41]
    v_pk_mul_f32 v[214:215], v[214:215], v[42:43]
    v_cvt_pk_bf16_f32 v216, v208, v209
    v_cvt_pk_bf16_f32 v217, v210, v211
    v_cvt_pk_bf16_f32 v218, v212, v213
    v_cvt_pk_bf16_f32 v219, v214, v215
    buffer_store_dwordx4 v[216:219], v245, s[56:59], s92 offen offset:2048 sc1
    v_pk_mul_f32 v[208:209], v[12:13], s[100:101]
    v_pk_mul_f32 v[210:211], v[14:15], s[100:101]
    v_pk_mul_f32 v[212:213], v[44:45], s[100:101]
    v_pk_mul_f32 v[214:215], v[46:47], s[100:101]
    v_exp_f32 v208, v208
    v_exp_f32 v209, v209
    v_exp_f32 v210, v210
    v_exp_f32 v211, v211
    v_exp_f32 v212, v212
    v_exp_f32 v213, v213
    v_exp_f32 v214, v214
    v_exp_f32 v215, v215
    v_pk_add_f32 v[208:209], v[208:209], 1.0 op_sel_hi:[1,0]
    v_pk_add_f32 v[210:211], v[210:211], 1.0 op_sel_hi:[1,0]
    v_pk_mul_f32 v[12:13], v[12:13], v[28:29]
    v_pk_mul_f32 v[14:15], v[14:15], v[30:31]
    v_pk_add_f32 v[212:213], v[212:213], 1.0 op_sel_hi:[1,0]
    v_pk_add_f32 v[214:215], v[214:215], 1.0 op_sel_hi:[1,0]
    v_pk_mul_f32 v[44:45], v[44:45], v[60:61]
    v_pk_mul_f32 v[46:47], v[46:47], v[62:63]
    v_rcp_f32 v208, v208
    v_rcp_f32 v209, v209
    v_rcp_f32 v210, v210
    v_rcp_f32 v211, v211
    v_rcp_f32 v212, v212
    v_rcp_f32 v213, v213
    v_rcp_f32 v214, v214
    v_rcp_f32 v215, v215
    v_pk_mul_f32 v[208:209], v[208:209], v[12:13]
    v_pk_mul_f32 v[210:211], v[210:211], v[14:15]
    v_pk_mul_f32 v[212:213], v[212:213], v[44:45]
    v_pk_mul_f32 v[214:215], v[214:215], v[46:47]
    v_cvt_pk_bf16_f32 v220, v208, v209
    v_cvt_pk_bf16_f32 v221, v210, v211
    v_cvt_pk_bf16_f32 v222, v212, v213
    v_cvt_pk_bf16_f32 v223, v214, v215
    buffer_store_dwordx4 v[220:223], v245, s[56:59], s92 offen offset:3072 sc1
L_join:
    v_mov_b32 v48, 0
    v_mov_b32 v49, 0
    v_mov_b32 v50, 0
    v_mov_b32 v51, 0
    v_min_u32 v36, 29, v244
    v_lshlrev_b32 v36, 4, v36
    v_add_u32 v36, s89, v36
    ds_write_b128 v36, v[48:51] offset:4096
    v_and_b32 v37, 1, v244
    v_mul_u32_u24 v36, 4160, v37
    v_add_u32 v36, s95, v36
    ds_write_b128 v36, v[48:51]
    s_lshl_b32 s75, s96, 16
    v_mul_lo_u32 v51, v37, s75
    ds_write_b128 v36, v[48:51] offset:16
    v_and_b32 v36, 15, v244
    v_add_u32 v37, 1, v36
    v_and_b32 v38, 1, v37
    v_and_b32 v37, 30, v37
    v_lshrrev_b32 v39, 4, v244
    v_lshl_add_u32 v37, v39, 3, v37
    v_mul_u32_u24 v38, 4160, v38
    v_lshl_add_u32 v40, v37, 1, v38
    v_add_u32 v40, s95, v40
    v_add_u32 v41, 1024, v40
    v_add_u32 v42, 2048, v40
    v_add_u32 v43, 3072, v40
    v_lshlrev_b32 v37, 5, v36
    v_sub_u32 v37, 480, v37
    v_lshl_add_u32 v37, v39, 4, v37
    v_add_u32 v33, s89, v37
    s_and_b32 s75, s73, 1
    s_lshl_b32 s75, s75, 4
    s_lshr_b32 s76, s31, s75
    s_and_b32 s76, s76, 0xffff
    v_sub_u32 v37, 15, v36
    v_lshlrev_b32 v38, 3, v39
    v_sub_u32 v37, v37, v38
    v_and_b32 v38, 1, v37
    v_lshlrev_b32 v38, 4, v38
    v_lshlrev_b32 v38, v38, s76
    v_ashrrev_i32 v37, 1, v37
    v_cmp_eq_u32 vcc, 0, v37
    s_nop 1
    v_cndmask_b32 v44, 0, v38, vcc
    v_cmp_eq_u32 vcc, 1, v37
    s_nop 1
    v_cndmask_b32 v45, 0, v38, vcc
    v_cmp_eq_u32 vcc, 2, v37
    s_nop 1
    v_cndmask_b32 v46, 0, v38, vcc
    v_cmp_eq_u32 vcc, 3, v37
    s_nop 1
    v_cndmask_b32 v47, 0, v38, vcc
    s_waitcnt lgkmcnt(0)
    ds_read2_b32 a[64:65], v40 offset0:0 offset1:1
    ds_read2_b32 a[66:67], v40 offset0:2 offset1:3
    ds_read_b128 v[48:51], v33 offset:3584
    ds_read2_b32 a[68:69], v40 offset0:128 offset1:129
    ds_read2_b32 a[70:71], v40 offset0:130 offset1:131
    ds_read_b128 v[52:55], v33 offset:3072
    ds_read2_b32 a[72:73], v41 offset0:0 offset1:1
    ds_read2_b32 a[74:75], v41 offset0:2 offset1:3
    ds_read_b128 v[56:59], v33 offset:2560
    ds_read2_b32 a[76:77], v41 offset0:128 offset1:129
    ds_read2_b32 a[78:79], v41 offset0:130 offset1:131
    ds_read_b128 v[60:63], v33 offset:2048
    ds_read2_b32 a[80:81], v42 offset0:0 offset1:1
    ds_read2_b32 a[82:83], v42 offset0:2 offset1:3
    ds_read_b128 v[64:67], v33 offset:1536
    ds_read2_b32 a[84:85], v42 offset0:128 offset1:129
    ds_read2_b32 a[86:87], v42 offset0:130 offset1:131
    ds_read_b128 v[68:71], v33 offset:1024
    ds_read2_b32 a[88:89], v43 offset0:0 offset1:1
    ds_read2_b32 a[90:91], v43 offset0:2 offset1:3
    ds_read_b128 v[72:75], v33 offset:512
    ds_read2_b32 a[92:93], v43 offset0:128 offset1:129
    ds_read2_b32 a[94:95], v43 offset0:130 offset1:131
    ds_read_b128 v[76:79], v33 offset:0
    s_waitcnt lgkmcnt(14)
    v_mfma_f32_16x16x32_bf16 v[96:99], v[44:47], v[48:51], 0
    v_mfma_f32_16x16x32_bf16 v[96:99], a[64:67], v[48:51], v[96:99]
    v_mfma_f32_16x16x32_bf16 v[100:103], v[44:47], v[52:55], 0
    v_mfma_f32_16x16x32_bf16 v[100:103], a[64:67], v[52:55], v[100:103]
    v_mfma_f32_16x16x32_bf16 v[100:103], a[68:71], v[48:51], v[100:103]
    s_lshr_b32 s92, s80, 1
    v_mfma_f32_16x16x32_bf16 v[104:107], v[44:47], v[56:59], 0
    v_mfma_f32_16x16x32_bf16 v[104:107], a[64:67], v[56:59], v[104:107]
    s_lshr_b32 s93, s92, 2
    v_mfma_f32_16x16x32_bf16 v[104:107], a[68:71], v[52:55], v[104:107]
    s_and_b32 s92, s92, 3
    v_mfma_f32_16x16x32_bf16 v[104:107], a[72:75], v[48:51], v[104:107]
    ds_read_b64_tr_b16 a[96:97], v250 offset:32768
    s_waitcnt lgkmcnt(13)
    v_mfma_f32_16x16x32_bf16 v[108:111], v[44:47], v[60:63], 0
    ds_read_b64_tr_b16 a[98:99], v250 offset:34816
    v_mfma_f32_16x16x32_bf16 v[108:111], a[64:67], v[60:63], v[108:111]
    ds_read_b64_tr_b16 a[100:101], v251 offset:32768
    s_lshl3_add_u32 s92, s92, s93
    v_mfma_f32_16x16x32_bf16 v[108:111], a[68:71], v[56:59], v[108:111]
    ds_read_b64_tr_b16 a[102:103], v251 offset:34816
    v_mfma_f32_16x16x32_bf16 v[108:111], a[72:75], v[52:55], v[108:111]
    ds_read_b64_tr_b16 a[104:105], v252 offset:32768
    s_lshl1_add_u32 s92, s82, s92
    v_mfma_f32_16x16x32_bf16 v[108:111], a[76:79], v[48:51], v[108:111]
    ds_read_b64_tr_b16 a[106:107], v252 offset:34816
    s_waitcnt lgkmcnt(14)
    v_mfma_f32_16x16x32_bf16 v[112:115], v[44:47], v[64:67], 0
    ds_read_b64_tr_b16 a[108:109], v253 offset:32768
    s_and_b32 s93, s80, 1
    v_mfma_f32_16x16x32_bf16 v[112:115], a[64:67], v[64:67], v[112:115]
    ds_read_b64_tr_b16 a[110:111], v253 offset:34816
    v_mfma_f32_16x16x32_bf16 v[112:115], a[68:71], v[60:63], v[112:115]
    ds_read2_b32 a[0:1], v40 offset0:16 offset1:17
    s_lshl_b32 s93, s93, 1
    v_mfma_f32_16x16x32_bf16 v[112:115], a[72:75], v[56:59], v[112:115]
    ds_read2_b32 a[2:3], v40 offset0:18 offset1:19
    v_mfma_f32_16x16x32_bf16 v[112:115], a[76:79], v[52:55], v[112:115]
    ds_read_b128 a[32:35], v33 offset:3648
    s_lshl2_add_u32 s92, s92, s93
    v_mfma_f32_16x16x32_bf16 v[112:115], a[80:83], v[48:51], v[112:115]
    ds_read2_b32 a[4:5], v40 offset0:144 offset1:145
    s_waitcnt lgkmcnt(14)
    v_mfma_f32_16x16x32_bf16 v[116:119], v[44:47], v[68:71], 0
    ds_read2_b32 a[6:7], v40 offset0:146 offset1:147
    s_lshl_b32 s92, s92, 10
    v_mfma_f32_16x16x32_bf16 v[116:119], a[64:67], v[68:71], v[116:119]
    ds_read_b128 a[36:39], v33 offset:3136
    v_mfma_f32_16x16x32_bf16 v[116:119], a[68:71], v[64:67], v[116:119]
    ds_read2_b32 a[8:9], v41 offset0:16 offset1:17
    v_mfma_f32_16x16x32_bf16 v[116:119], a[72:75], v[60:63], v[116:119]
    ds_read2_b32 a[10:11], v41 offset0:18 offset1:19
    v_min_u32 v226, 27, v244
    v_mfma_f32_16x16x32_bf16 v[116:119], a[76:79], v[56:59], v[116:119]
    ds_read_b128 a[40:43], v33 offset:2624
    s_add_u32 s91, s77, 524288
    v_mfma_f32_16x16x32_bf16 v[116:119], a[80:83], v[52:55], v[116:119]
    ds_read2_b32 a[12:13], v41 offset0:144 offset1:145
    v_lshrrev_b32 v225, 2, v226
    s_add_u32 m0, s79, 32768
    v_mfma_f32_16x16x32_bf16 v[116:119], a[84:87], v[48:51], v[116:119]
    ds_read2_b32 a[14:15], v41 offset0:146 offset1:147
    s_waitcnt lgkmcnt(11)
    buffer_load_dwordx4 v246, s[44:47], s91 offen offset:0 lds
    v_mfma_f32_16x16x32_bf16 v[120:123], v[44:47], v[72:75], 0
    ds_read_b128 a[44:47], v33 offset:2112
    v_lshlrev_b32 v225, 17, v225
    v_mfma_f32_16x16x32_bf16 v[120:123], a[64:67], v[72:75], v[120:123]
    ds_read2_b32 a[16:17], v42 offset0:16 offset1:17
    v_mfma_f32_16x16x32_bf16 v[120:123], a[68:71], v[68:71], v[120:123]
    ds_read2_b32 a[18:19], v42 offset0:18 offset1:19
    v_and_b32 v227, 1, v226
    v_mfma_f32_16x16x32_bf16 v[120:123], a[72:75], v[64:67], v[120:123]
    ds_read_b128 a[48:51], v33 offset:1600
    buffer_load_dwordx4 v247, s[44:47], s91 offen offset:1024 lds
    v_mfma_f32_16x16x32_bf16 v[120:123], a[76:79], v[60:63], v[120:123]
    ds_read2_b32 a[20:21], v42 offset0:144 offset1:145
    v_lshl_add_u32 v225, v227, 10, v225
    v_mfma_f32_16x16x32_bf16 v[120:123], a[80:83], v[56:59], v[120:123]
    ds_read2_b32 a[22:23], v42 offset0:146 offset1:147
    v_mfma_f32_16x16x32_bf16 v[120:123], a[84:87], v[52:55], v[120:123]
    ds_read_b128 a[52:55], v33 offset:1088
    v_bfe_u32 v227, v226, 1, 1
    v_mfma_f32_16x16x32_bf16 v[120:123], a[88:91], v[48:51], v[120:123]
    ds_read2_b32 a[24:25], v43 offset0:16 offset1:17
    buffer_load_dwordx4 v248, s[44:47], s91 offen offset:2048 lds
    v_mfma_f32_16x16x32_bf16 v[124:127], v[44:47], v[76:79], 0
    ds_read2_b32 a[26:27], v43 offset0:18 offset1:19
    v_lshl_add_u32 v225, v227, 7, v225
    v_mfma_f32_16x16x32_bf16 v[124:127], a[64:67], v[76:79], v[124:127]
    ds_read_b128 a[56:59], v33 offset:576
    v_mfma_f32_16x16x32_bf16 v[124:127], a[68:71], v[72:75], v[124:127]
    ds_read2_b32 a[28:29], v43 offset0:144 offset1:145
    v_add_u32 v234, s92, v225
    v_mfma_f32_16x16x32_bf16 v[124:127], a[72:75], v[68:71], v[124:127]
    ds_read2_b32 a[30:31], v43 offset0:146 offset1:147
    buffer_load_dwordx4 v249, s[44:47], s91 offen offset:3072 lds
    v_mfma_f32_16x16x32_bf16 v[124:127], a[76:79], v[64:67], v[124:127]
    ds_read_b128 a[60:63], v33 offset:64
    v_mfma_f32_16x16x32_bf16 v[124:127], a[80:83], v[60:63], v[124:127]
    v_cmp_gt_u32 vcc, 6, v244
    v_mov_b32 v225, s92
    s_nop 0
    v_cndmask_b32 v235, v225, v234, vcc
    v_mfma_f32_16x16x32_bf16 v[124:127], a[84:87], v[56:59], v[124:127]
    v_mfma_f32_16x16x32_bf16 v[124:127], a[88:91], v[52:55], v[124:127]
    v_mfma_f32_16x16x32_bf16 v[124:127], a[92:95], v[48:51], v[124:127]
    s_waitcnt lgkmcnt(12)
    v_mfma_f32_16x16x32_bf16 v[96:99], a[0:3], a[32:35], v[96:99]
    s_waitcnt vmcnt(4)
    ds_read_b64_tr_b16 a[112:113], v250 offset:36864
    v_mfma_f32_16x16x32_bf16 v[100:103], a[0:3], a[36:39], v[100:103]
    v_mov_b32 v228, s86
    ds_read_b64_tr_b16 a[114:115], v250 offset:38912
    v_mfma_f32_16x16x32_bf16 v[100:103], a[4:7], a[32:35], v[100:103]
    v_mov_b32 v229, s87
    ds_read_b64_tr_b16 a[116:117], v251 offset:36864
    v_mfma_f32_16x16x32_bf16 v[104:107], a[0:3], a[40:43], v[104:107]
    buffer_store_dwordx2 v[228:229], v254, s[60:63], 0 offen offset:128 sc1
    ds_read_b64_tr_b16 a[118:119], v251 offset:38912
    v_mfma_f32_16x16x32_bf16 v[104:107], a[4:7], a[36:39], v[104:107]
    ds_read_b64_tr_b16 a[120:121], v252 offset:36864
    v_mfma_f32_16x16x32_bf16 v[104:107], a[8:11], a[32:35], v[104:107]
    ds_read_b64_tr_b16 a[122:123], v252 offset:38912
    v_mfma_f32_16x16x32_bf16 v[108:111], a[0:3], a[44:47], v[108:111]
    ds_read_b64_tr_b16 a[124:125], v253 offset:36864
    v_mfma_f32_16x16x32_bf16 v[108:111], a[4:7], a[40:43], v[108:111]
    ds_read_b64_tr_b16 a[126:127], v253 offset:38912
    v_mfma_f32_16x16x32_bf16 v[108:111], a[8:11], a[36:39], v[108:111]
    ds_read2_b32 a[64:65], v40 offset0:32 offset1:33
    v_mfma_f32_16x16x32_bf16 v[108:111], a[12:15], a[32:35], v[108:111]
    ds_read2_b32 a[66:67], v40 offset0:34 offset1:35
    s_waitcnt lgkmcnt(10)
    v_mfma_f32_16x16x32_bf16 v[112:115], a[0:3], a[48:51], v[112:115]
    ds_read_b128 v[48:51], v33 offset:3712
    v_mfma_f32_16x16x32_bf16 v[112:115], a[4:7], a[44:47], v[112:115]
    ds_read2_b32 a[68:69], v40 offset0:160 offset1:161
    v_mfma_f32_16x16x32_bf16 v[112:115], a[8:11], a[40:43], v[112:115]
    ds_read2_b32 a[70:71], v40 offset0:162 offset1:163
    v_mfma_f32_16x16x32_bf16 v[112:115], a[12:15], a[36:39], v[112:115]
    ds_read_b128 v[52:55], v33 offset:3200
    v_mfma_f32_16x16x32_bf16 v[112:115], a[16:19], a[32:35], v[112:115]
    ds_read2_b32 a[72:73], v41 offset0:32 offset1:33
    v_mfma_f32_16x16x32_bf16 v[116:119], a[0:3], a[52:55], v[116:119]
    ds_read2_b32 a[74:75], v41 offset0:34 offset1:35
    v_mfma_f32_16x16x32_bf16 v[116:119], a[4:7], a[48:51], v[116:119]
    ds_read_b128 v[56:59], v33 offset:2688
    buffer_load_dwordx2 v[236:237], v235, s[60:63], 0 offen sc1
    v_mfma_f32_16x16x32_bf16 v[116:119], a[8:11], a[44:47], v[116:119]
    ds_read2_b32 a[76:77], v41 offset0:160 offset1:161
    s_add_u32 s78, s77, 589824
    s_add_u32 m0, s79, 36864
    v_mfma_f32_16x16x32_bf16 v[116:119], a[12:15], a[40:43], v[116:119]
    ds_read2_b32 a[78:79], v41 offset0:162 offset1:163
    s_waitcnt lgkmcnt(11)
    buffer_load_dwordx4 v246, s[44:47], s78 offen offset:0 lds
    v_mfma_f32_16x16x32_bf16 v[116:119], a[16:19], a[36:39], v[116:119]
    ds_read_b128 v[60:63], v33 offset:2176
    v_mfma_f32_16x16x32_bf16 v[116:119], a[20:23], a[32:35], v[116:119]
    ds_read2_b32 a[80:81], v42 offset0:32 offset1:33
    v_mfma_f32_16x16x32_bf16 v[120:123], a[0:3], a[56:59], v[120:123]
    ds_read2_b32 a[82:83], v42 offset0:34 offset1:35
    v_mfma_f32_16x16x32_bf16 v[120:123], a[4:7], a[52:55], v[120:123]
    ds_read_b128 v[64:67], v33 offset:1664
    buffer_load_dwordx4 v247, s[44:47], s78 offen offset:1024 lds
    v_mfma_f32_16x16x32_bf16 v[120:123], a[8:11], a[48:51], v[120:123]
    ds_read2_b32 a[84:85], v42 offset0:160 offset1:161
    v_mfma_f32_16x16x32_bf16 v[120:123], a[12:15], a[44:47], v[120:123]
    ds_read2_b32 a[86:87], v42 offset0:162 offset1:163
    v_mfma_f32_16x16x32_bf16 v[120:123], a[16:19], a[40:43], v[120:123]
    ds_read_b128 v[68:71], v33 offset:1152
    v_mfma_f32_16x16x32_bf16 v[120:123], a[20:23], a[36:39], v[120:123]
    ds_read2_b32 a[88:89], v43 offset0:32 offset1:33
    buffer_load_dwordx4 v248, s[44:47], s78 offen offset:2048 lds
    v_mfma_f32_16x16x32_bf16 v[120:123], a[24:27], a[32:35], v[120:123]
    ds_read2_b32 a[90:91], v43 offset0:34 offset1:35
    v_mfma_f32_16x16x32_bf16 v[124:127], a[0:3], a[60:63], v[124:127]
    ds_read_b128 v[72:75], v33 offset:640
    v_mfma_f32_16x16x32_bf16 v[124:127], a[4:7], a[56:59], v[124:127]
    ds_read2_b32 a[92:93], v43 offset0:160 offset1:161
    v_mfma_f32_16x16x32_bf16 v[124:127], a[8:11], a[52:55], v[124:127]
    ds_read2_b32 a[94:95], v43 offset0:162 offset1:163
    buffer_load_dwordx4 v249, s[44:47], s78 offen offset:3072 lds
    v_mfma_f32_16x16x32_bf16 v[124:127], a[12:15], a[48:51], v[124:127]
    ds_read_b128 v[76:79], v33 offset:128
    v_mfma_f32_16x16x32_bf16 v[124:127], a[16:19], a[44:47], v[124:127]
    v_mfma_f32_16x16x32_bf16 v[124:127], a[20:23], a[40:43], v[124:127]
    v_mfma_f32_16x16x32_bf16 v[124:127], a[24:27], a[36:39], v[124:127]
    v_mfma_f32_16x16x32_bf16 v[124:127], a[28:31], a[32:35], v[124:127]
    s_waitcnt vmcnt(6) lgkmcnt(12)
    v_mfma_f32_16x16x32_bf16 v[96:99], a[64:67], v[48:51], v[96:99]
    ds_read_b64_tr_b16 a[128:129], v250 offset:32768
    s_xor_b32 s92, s82, 0
    v_mfma_f32_16x16x32_bf16 v[100:103], a[64:67], v[52:55], v[100:103]
    ds_read_b64_tr_b16 a[130:131], v250 offset:34816
    s_lshl_b32 s92, s92, 11
    v_mfma_f32_16x16x32_bf16 v[100:103], a[68:71], v[48:51], v[100:103]
    ds_read_b64_tr_b16 a[132:133], v251 offset:32768
    s_and_b32 s93, s85, 16384
    v_mfma_f32_16x16x32_bf16 v[104:107], a[64:67], v[56:59], v[104:107]
    ds_read_b64_tr_b16 a[134:135], v251 offset:34816
    v_mfma_f32_16x16x32_bf16 v[104:107], a[68:71], v[52:55], v[104:107]
    ds_read_b64_tr_b16 a[136:137], v252 offset:32768
    s_add_u32 s92, s92, s93
    v_mfma_f32_16x16x32_bf16 v[104:107], a[72:75], v[48:51], v[104:107]
    ds_read_b64_tr_b16 a[138:139], v252 offset:34816
    s_add_u32 s92, s92, 0
    v_mfma_f32_16x16x32_bf16 v[108:111], a[64:67], v[60:63], v[108:111]
    ds_read_b64_tr_b16 a[140:141], v253 offset:32768
    v_mfma_f32_16x16x32_bf16 v[108:111], a[68:71], v[56:59], v[108:111]
    ds_read_b64_tr_b16 a[142:143], v253 offset:34816
    v_add_u32 v230, s92, v245
    v_mfma_f32_16x16x32_bf16 v[108:111], a[72:75], v[52:55], v[108:111]
    ds_read2_b32 a[0:1], v40 offset0:48 offset1:49
    s_xor_b32 s92, s82, 2
    v_mfma_f32_16x16x32_bf16 v[108:111], a[76:79], v[48:51], v[108:111]
    ds_read2_b32 a[2:3], v40 offset0:50 offset1:51
    s_waitcnt lgkmcnt(10)
    v_mfma_f32_16x16x32_bf16 v[112:115], a[64:67], v[64:67], v[112:115]
    ds_read_b128 a[32:35], v33 offset:3776
    s_lshl_b32 s92, s92, 11
    v_mfma_f32_16x16x32_bf16 v[112:115], a[68:71], v[60:63], v[112:115]
    ds_read2_b32 a[4:5], v40 offset0:176 offset1:177
    s_and_b32 s93, s85, 16384
    v_mfma_f32_16x16x32_bf16 v[112:115], a[72:75], v[56:59], v[112:115]
    ds_read2_b32 a[6:7], v40 offset0:178 offset1:179
    v_mfma_f32_16x16x32_bf16 v[112:115], a[76:79], v[52:55], v[112:115]
    ds_read_b128 a[36:39], v33 offset:3264
    s_add_u32 s92, s92, s93
    v_mfma_f32_16x16x32_bf16 v[112:115], a[80:83], v[48:51], v[112:115]
    ds_read2_b32 a[8:9], v41 offset0:48 offset1:49
    s_add_u32 s92, s92, 0
    v_mfma_f32_16x16x32_bf16 v[116:119], a[64:67], v[68:71], v[116:119]
    ds_read2_b32 a[10:11], v41 offset0:50 offset1:51
    s_add_u32 s91, s77, 655360
    v_mfma_f32_16x16x32_bf16 v[116:119], a[68:71], v[64:67], v[116:119]
    ds_read_b128 a[40:43], v33 offset:2752
    v_add_u32 v231, s92, v245
    v_mfma_f32_16x16x32_bf16 v[116:119], a[72:75], v[60:63], v[116:119]
    ds_read2_b32 a[12:13], v41 offset0:176 offset1:177
    s_xor_b32 s92, s82, 1
    s_add_u32 m0, s79, 32768
    v_mfma_f32_16x16x32_bf16 v[116:119], a[76:79], v[56:59], v[116:119]
    ds_read2_b32 a[14:15], v41 offset0:178 offset1:179
    s_waitcnt lgkmcnt(11)
    buffer_load_dwordx4 v246, s[44:47], s91 offen offset:0 lds
    v_mfma_f32_16x16x32_bf16 v[116:119], a[80:83], v[52:55], v[116:119]
    ds_read_b128 a[44:47], v33 offset:2240
    s_lshl_b32 s92, s92, 11
    v_mfma_f32_16x16x32_bf16 v[116:119], a[84:87], v[48:51], v[116:119]
    ds_read2_b32 a[16:17], v42 offset0:48 offset1:49
    s_and_b32 s93, s85, 16384
    v_mfma_f32_16x16x32_bf16 v[120:123], a[64:67], v[72:75], v[120:123]
    ds_read2_b32 a[18:19], v42 offset0:50 offset1:51
    s_add_u32 s92, s92, s93
    v_mfma_f32_16x16x32_bf16 v[120:123], a[68:71], v[68:71], v[120:123]
    ds_read_b128 a[48:51], v33 offset:1728
    buffer_load_dwordx4 v247, s[44:47], s91 offen offset:1024 lds
    v_mfma_f32_16x16x32_bf16 v[120:123], a[72:75], v[64:67], v[120:123]
    ds_read2_b32 a[20:21], v42 offset0:176 offset1:177
    s_add_u32 s92, s92, 0
    v_mfma_f32_16x16x32_bf16 v[120:123], a[76:79], v[60:63], v[120:123]
    ds_read2_b32 a[22:23], v42 offset0:178 offset1:179
    v_add_u32 v232, s92, v245
    v_mfma_f32_16x16x32_bf16 v[120:123], a[80:83], v[56:59], v[120:123]
    ds_read_b128 a[52:55], v33 offset:1216
    s_xor_b32 s92, s82, 3
    v_mfma_f32_16x16x32_bf16 v[120:123], a[84:87], v[52:55], v[120:123]
    ds_read2_b32 a[24:25], v43 offset0:48 offset1:49
    buffer_load_dwordx4 v248, s[44:47], s91 offen offset:2048 lds
    v_mfma_f32_16x16x32_bf16 v[120:123], a[88:91], v[48:51], v[120:123]
    ds_read2_b32 a[26:27], v43 offset0:50 offset1:51
    s_lshl_b32 s92, s92, 11
    v_mfma_f32_16x16x32_bf16 v[124:127], a[64:67], v[76:79], v[124:127]
    ds_read_b128 a[56:59], v33 offset:704
    v_mfma_f32_16x16x32_bf16 v[124:127], a[68:71], v[72:75], v[124:127]
    ds_read2_b32 a[28:29], v43 offset0:176 offset1:177
    s_and_b32 s93, s85, 16384
    v_mfma_f32_16x16x32_bf16 v[124:127], a[72:75], v[68:71], v[124:127]
    ds_read2_b32 a[30:31], v43 offset0:178 offset1:179
    buffer_load_dwordx4 v249, s[44:47], s91 offen offset:3072 lds
    v_mfma_f32_16x16x32_bf16 v[124:127], a[76:79], v[64:67], v[124:127]
    ds_read_b128 a[60:63], v33 offset:192
    s_add_u32 s92, s92, s93
    v_mfma_f32_16x16x32_bf16 v[124:127], a[80:83], v[60:63], v[124:127]
    s_add_u32 s92, s92, 0
    v_mfma_f32_16x16x32_bf16 v[124:127], a[84:87], v[56:59], v[124:127]
    v_add_u32 v233, s92, v245
    v_mfma_f32_16x16x32_bf16 v[124:127], a[88:91], v[52:55], v[124:127]
    v_mfma_f32_16x16x32_bf16 v[124:127], a[92:95], v[48:51], v[124:127]
    s_waitcnt vmcnt(4) lgkmcnt(12)
    v_mfma_f32_16x16x32_bf16 v[96:99], a[0:3], a[32:35], v[96:99]
    ds_read_b64_tr_b16 a[144:145], v250 offset:36864
    v_mfma_f32_16x16x32_bf16 v[100:103], a[0:3], a[36:39], v[100:103]
    ds_read_b64_tr_b16 a[146:147], v250 offset:38912
    v_cmp_eq_u64 vcc, s[86:87], v[236:237]
    s_nop 1
    s_and_b32 s3, vcc_lo, 3
    s_cmp_eq_u32 s3, 3
    s_cbranch_scc0 L_slow_h0
L_ok_h0:
    v_mfma_f32_16x16x32_bf16 v[100:103], a[4:7], a[32:35], v[100:103]
    ds_read_b64_tr_b16 a[148:149], v251 offset:36864
    s_add_u32 s90, s84, 0
    s_mov_b32 m0, s85
    v_mfma_f32_16x16x32_bf16 v[104:107], a[0:3], a[40:43], v[104:107]
    ds_read_b64_tr_b16 a[150:151], v251 offset:38912
    buffer_load_dwordx4 v245, s[56:59], s90 offen offset:0 sc1 lds
    v_mfma_f32_16x16x32_bf16 v[104:107], a[4:7], a[36:39], v[104:107]
    ds_read_b64_tr_b16 a[152:153], v252 offset:36864
    v_mfma_f32_16x16x32_bf16 v[104:107], a[8:11], a[32:35], v[104:107]
    ds_read_b64_tr_b16 a[154:155], v252 offset:38912
    buffer_load_dwordx4 v245, s[56:59], s90 offen offset:1024 sc1 lds
    v_mfma_f32_16x16x32_bf16 v[108:111], a[0:3], a[44:47], v[108:111]
    ds_read_b64_tr_b16 a[156:157], v253 offset:36864
    v_mfma_f32_16x16x32_bf16 v[108:111], a[4:7], a[40:43], v[108:111]
    ds_read_b64_tr_b16 a[158:159], v253 offset:38912
    buffer_load_dwordx4 v245, s[56:59], s90 offen offset:2048 sc1 lds
    v_mfma_f32_16x16x32_bf16 v[108:111], a[8:11], a[36:39], v[108:111]
    ds_read2_b32 a[64:65], v40 offset0:64 offset1:65
    v_mfma_f32_16x16x32_bf16 v[108:111], a[12:15], a[32:35], v[108:111]
    ds_read2_b32 a[66:67], v40 offset0:66 offset1:67
    s_waitcnt lgkmcnt(10)
    buffer_load_dwordx4 v245, s[56:59], s90 offen offset:3072 sc1 lds
    v_mfma_f32_16x16x32_bf16 v[112:115], a[0:3], a[48:51], v[112:115]
    ds_read_b128 v[48:51], v33 offset:3840
    s_add_u32 s90, s84, 4096
    s_add_u32 m0, s85, 4096
    v_mfma_f32_16x16x32_bf16 v[112:115], a[4:7], a[44:47], v[112:115]
    ds_read2_b32 a[68:69], v40 offset0:192 offset1:193
    buffer_load_dwordx4 v245, s[56:59], s90 offen offset:0 sc1 lds
    v_mfma_f32_16x16x32_bf16 v[112:115], a[8:11], a[40:43], v[112:115]
    ds_read2_b32 a[70:71], v40 offset0:194 offset1:195
    v_mfma_f32_16x16x32_bf16 v[112:115], a[12:15], a[36:39], v[112:115]
    ds_read_b128 v[52:55], v33 offset:3328
    buffer_load_dwordx4 v245, s[56:59], s90 offen offset:1024 sc1 lds
    v_mfma_f32_16x16x32_bf16 v[112:115], a[16:19], a[32:35], v[112:115]
    ds_read2_b32 a[72:73], v41 offset0:64 offset1:65
    v_mfma_f32_16x16x32_bf16 v[116:119], a[0:3], a[52:55], v[116:119]
    ds_read2_b32 a[74:75], v41 offset0:66 offset1:67
    buffer_load_dwordx4 v245, s[56:59], s90 offen offset:2048 sc1 lds
    v_mfma_f32_16x16x32_bf16 v[116:119], a[4:7], a[48:51], v[116:119]
    ds_read_b128 v[56:59], v33 offset:2816
    v_mfma_f32_16x16x32_bf16 v[116:119], a[8:11], a[44:47], v[116:119]
    ds_read2_b32 a[76:77], v41 offset0:192 offset1:193
    s_add_u32 s78, s77, 720896
    s_add_u32 m0, s79, 36864
    v_mfma_f32_16x16x32_bf16 v[116:119], a[12:15], a[40:43], v[116:119]
    ds_read2_b32 a[78:79], v41 offset0:194 offset1:195
    s_waitcnt lgkmcnt(11)
    buffer_load_dwordx4 v246, s[44:47], s78 offen offset:0 lds
    v_mfma_f32_16x16x32_bf16 v[116:119], a[16:19], a[36:39], v[116:119]
    ds_read_b128 v[60:63], v33 offset:2304
    v_mfma_f32_16x16x32_bf16 v[116:119], a[20:23], a[32:35], v[116:119]
    ds_read2_b32 a[80:81], v42 offset0:64 offset1:65
    v_mfma_f32_16x16x32_bf16 v[120:123], a[0:3], a[56:59], v[120:123]
    ds_read2_b32 a[82:83], v42 offset0:66 offset1:67
    v_mfma_f32_16x16x32_bf16 v[120:123], a[4:7], a[52:55], v[120:123]
    ds_read_b128 v[64:67], v33 offset:1792
    buffer_load_dwordx4 v247, s[44:47], s78 offen offset:1024 lds
    v_mfma_f32_16x16x32_bf16 v[120:123], a[8:11], a[48:51], v[120:123]
    ds_read2_b32 a[84:85], v42 offset0:192 offset1:193
    v_mfma_f32_16x16x32_bf16 v[120:123], a[12:15], a[44:47], v[120:123]
    ds_read2_b32 a[86:87], v42 offset0:194 offset1:195
    v_mfma_f32_16x16x32_bf16 v[120:123], a[16:19], a[40:43], v[120:123]
    ds_read_b128 v[68:71], v33 offset:1280
    v_mfma_f32_16x16x32_bf16 v[120:123], a[20:23], a[36:39], v[120:123]
    ds_read2_b32 a[88:89], v43 offset0:64 offset1:65
    buffer_load_dwordx4 v248, s[44:47], s78 offen offset:2048 lds
    v_mfma_f32_16x16x32_bf16 v[120:123], a[24:27], a[32:35], v[120:123]
    ds_read2_b32 a[90:91], v43 offset0:66 offset1:67
    v_mfma_f32_16x16x32_bf16 v[124:127], a[0:3], a[60:63], v[124:127]
    ds_read_b128 v[72:75], v33 offset:768
    v_mfma_f32_16x16x32_bf16 v[124:127], a[4:7], a[56:59], v[124:127]
    ds_read2_b32 a[92:93], v43 offset0:192 offset1:193
    v_mfma_f32_16x16x32_bf16 v[124:127], a[8:11], a[52:55], v[124:127]
    ds_read2_b32 a[94:95], v43 offset0:194 offset1:195
    buffer_load_dwordx4 v249, s[44:47], s78 offen offset:3072 lds
    v_mfma_f32_16x16x32_bf16 v[124:127], a[12:15], a[48:51], v[124:127]
    ds_read_b128 v[76:79], v33 offset:256
    s_add_u32 m0, s85, 4096
    v_mfma_f32_16x16x32_bf16 v[124:127], a[16:19], a[44:47], v[124:127]
    buffer_load_dwordx4 v245, s[56:59], s90 offen offset:3072 sc1 lds
    v_mfma_f32_16x16x32_bf16 v[124:127], a[20:23], a[40:43], v[124:127]
    v_mfma_f32_16x16x32_bf16 v[124:127], a[24:27], a[36:39], v[124:127]
    v_mfma_f32_16x16x32_bf16 v[124:127], a[28:31], a[32:35], v[124:127]
    s_waitcnt vmcnt(12) lgkmcnt(12)
    v_mfma_f32_16x16x32_bf16 v[96:99], a[64:67], v[48:51], v[96:99]
    ds_read_b64_tr_b16 v[160:161], v250 offset:32768
    v_mfma_f32_16x16x32_bf16 v[100:103], a[64:67], v[52:55], v[100:103]
    ds_read_b64_tr_b16 v[162:163], v250 offset:34816
    v_mfma_f32_16x16x32_bf16 v[100:103], a[68:71], v[48:51], v[100:103]
    ds_read_b64_tr_b16 v[164:165], v251 offset:32768
    v_mfma_f32_16x16x32_bf16 v[104:107], a[64:67], v[56:59], v[104:107]
    ds_read_b64_tr_b16 v[166:167], v251 offset:34816
    v_mfma_f32_16x16x32_bf16 v[104:107], a[68:71], v[52:55], v[104:107]
    ds_read_b64_tr_b16 v[168:169], v252 offset:32768
    v_mfma_f32_16x16x32_bf16 v[104:107], a[72:75], v[48:51], v[104:107]
    ds_read_b64_tr_b16 v[170:171], v252 offset:34816
    v_mfma_f32_16x16x32_bf16 v[108:111], a[64:67], v[60:63], v[108:111]
    ds_read_b64_tr_b16 v[172:173], v253 offset:32768
    v_mfma_f32_16x16x32_bf16 v[108:111], a[68:71], v[56:59], v[108:111]
    ds_read_b64_tr_b16 v[174:175], v253 offset:34816
    v_mfma_f32_16x16x32_bf16 v[108:111], a[72:75], v[52:55], v[108:111]
    ds_read2_b32 a[0:1], v40 offset0:80 offset1:81
    v_mfma_f32_16x16x32_bf16 v[108:111], a[76:79], v[48:51], v[108:111]
    ds_read2_b32 a[2:3], v40 offset0:82 offset1:83
    s_waitcnt lgkmcnt(10)
    v_mfma_f32_16x16x32_bf16 v[112:115], a[64:67], v[64:67], v[112:115]
    ds_read_b128 a[32:35], v33 offset:3904
    v_mfma_f32_16x16x32_bf16 v[112:115], a[68:71], v[60:63], v[112:115]
    ds_read2_b32 a[4:5], v40 offset0:208 offset1:209
    v_mfma_f32_16x16x32_bf16 v[112:115], a[72:75], v[56:59], v[112:115]
    ds_read2_b32 a[6:7], v40 offset0:210 offset1:211
    v_mfma_f32_16x16x32_bf16 v[112:115], a[76:79], v[52:55], v[112:115]
    ds_read_b128 a[36:39], v33 offset:3392
    v_mfma_f32_16x16x32_bf16 v[112:115], a[80:83], v[48:51], v[112:115]
    ds_read2_b32 a[8:9], v41 offset0:80 offset1:81
    v_mfma_f32_16x16x32_bf16 v[116:119], a[64:67], v[68:71], v[116:119]
    ds_read2_b32 a[10:11], v41 offset0:82 offset1:83
    v_mfma_f32_16x16x32_bf16 v[116:119], a[68:71], v[64:67], v[116:119]
    ds_read_b128 a[40:43], v33 offset:2880
    buffer_load_dwordx2 v[236:237], v235, s[60:63], 0 offen sc1
    v_mfma_f32_16x16x32_bf16 v[116:119], a[72:75], v[60:63], v[116:119]
    ds_read2_b32 a[12:13], v41 offset0:208 offset1:209
    s_add_u32 s91, s77, 786432
    s_add_u32 m0, s79, 32768
    v_mfma_f32_16x16x32_bf16 v[116:119], a[76:79], v[56:59], v[116:119]
    ds_read2_b32 a[14:15], v41 offset0:210 offset1:211
    s_waitcnt lgkmcnt(11)
    buffer_load_dwordx4 v246, s[44:47], s91 offen offset:0 lds
    v_mfma_f32_16x16x32_bf16 v[116:119], a[80:83], v[52:55], v[116:119]
    ds_read_b128 a[44:47], v33 offset:2368
    v_mfma_f32_16x16x32_bf16 v[116:119], a[84:87], v[48:51], v[116:119]
    ds_read2_b32 a[16:17], v42 offset0:80 offset1:81
    v_mfma_f32_16x16x32_bf16 v[120:123], a[64:67], v[72:75], v[120:123]
    ds_read2_b32 a[18:19], v42 offset0:82 offset1:83
    v_mfma_f32_16x16x32_bf16 v[120:123], a[68:71], v[68:71], v[120:123]
    ds_read_b128 a[48:51], v33 offset:1856
    buffer_load_dwordx4 v247, s[44:47], s91 offen offset:1024 lds
    v_mfma_f32_16x16x32_bf16 v[120:123], a[72:75], v[64:67], v[120:123]
    ds_read2_b32 a[20:21], v42 offset0:208 offset1:209
    v_mfma_f32_16x16x32_bf16 v[120:123], a[76:79], v[60:63], v[120:123]
    ds_read2_b32 a[22:23], v42 offset0:210 offset1:211
    v_mfma_f32_16x16x32_bf16 v[120:123], a[80:83], v[56:59], v[120:123]
    ds_read_b128 a[52:55], v33 offset:1344
    v_mfma_f32_16x16x32_bf16 v[120:123], a[84:87], v[52:55], v[120:123]
    ds_read2_b32 a[24:25], v43 offset0:80 offset1:81
    buffer_load_dwordx4 v248, s[44:47], s91 offen offset:2048 lds
    v_mfma_f32_16x16x32_bf16 v[120:123], a[88:91], v[48:51], v[120:123]
    ds_read2_b32 a[26:27], v43 offset0:82 offset1:83
    v_mfma_f32_16x16x32_bf16 v[124:127], a[64:67], v[76:79], v[124:127]
    ds_read_b128 a[56:59], v33 offset:832
    v_mfma_f32_16x16x32_bf16 v[124:127], a[68:71], v[72:75], v[124:127]
    ds_read2_b32 a[28:29], v43 offset0:208 offset1:209
    v_mfma_f32_16x16x32_bf16 v[124:127], a[72:75], v[68:71], v[124:127]
    ds_read2_b32 a[30:31], v43 offset0:210 offset1:211
    buffer_load_dwordx4 v249, s[44:47], s91 offen offset:3072 lds
    v_mfma_f32_16x16x32_bf16 v[124:127], a[76:79], v[64:67], v[124:127]
    ds_read_b128 a[60:63], v33 offset:320
    v_mfma_f32_16x16x32_bf16 v[124:127], a[80:83], v[60:63], v[124:127]
    v_mfma_f32_16x16x32_bf16 v[124:127], a[84:87], v[56:59], v[124:127]
    v_mfma_f32_16x16x32_bf16 v[124:127], a[88:91], v[52:55], v[124:127]
    s_mov_b32 s55, 0x20000
    v_mfma_f32_16x16x32_bf16 v[124:127], a[92:95], v[48:51], v[124:127]
    s_waitcnt vmcnt(6) lgkmcnt(12)
    s_mov_b32 s54, 4194304
    v_mfma_f32_16x16x32_bf16 v[96:99], a[0:3], a[32:35], v[96:99]
    ds_read_b64_tr_b16 v[176:177], v250 offset:36864
    s_add_u32 s52, s28, 22020096
    s_addc_u32 s53, s29, 0
    s_and_b32 s53, s53, 0xffff
    v_mfma_f32_16x16x32_bf16 v[100:103], a[0:3], a[36:39], v[100:103]
    ds_read_b64_tr_b16 v[178:179], v250 offset:38912
    v_mfma_f32_16x16x32_bf16 v[100:103], a[4:7], a[32:35], v[100:103]
    ds_read_b64_tr_b16 v[180:181], v251 offset:36864
    v_mfma_f32_16x16x32_bf16 v[104:107], a[0:3], a[40:43], v[104:107]
    ds_read_b64_tr_b16 v[182:183], v251 offset:38912
    v_mfma_f32_16x16x32_bf16 v[104:107], a[4:7], a[36:39], v[104:107]
    ds_read_b64_tr_b16 v[184:185], v252 offset:36864
    v_mfma_f32_16x16x32_bf16 v[104:107], a[8:11], a[32:35], v[104:107]
    ds_read_b64_tr_b16 v[186:187], v252 offset:38912
    v_mfma_f32_16x16x32_bf16 v[108:111], a[0:3], a[44:47], v[108:111]
    ds_read_b64_tr_b16 v[188:189], v253 offset:36864
    v_mfma_f32_16x16x32_bf16 v[108:111], a[4:7], a[40:43], v[108:111]
    ds_read_b64_tr_b16 v[190:191], v253 offset:38912
    v_and_b32 v128, 15, v244
    v_mfma_f32_16x16x32_bf16 v[108:111], a[8:11], a[36:39], v[108:111]
    ds_read2_b32 a[64:65], v40 offset0:96 offset1:97
    v_mfma_f32_16x16x32_bf16 v[108:111], a[12:15], a[32:35], v[108:111]
    ds_read2_b32 a[66:67], v40 offset0:98 offset1:99
    s_waitcnt lgkmcnt(10)
    v_mfma_f32_16x16x32_bf16 v[112:115], a[0:3], a[48:51], v[112:115]
    ds_read_b128 v[48:51], v33 offset:3968
    v_mfma_f32_16x16x32_bf16 v[112:115], a[4:7], a[44:47], v[112:115]
    ds_read2_b32 a[68:69], v40 offset0:224 offset1:225
    v_mfma_f32_16x16x32_bf16 v[112:115], a[8:11], a[40:43], v[112:115]
    ds_read2_b32 a[70:71], v40 offset0:226 offset1:227
    v_mfma_f32_16x16x32_bf16 v[112:115], a[12:15], a[36:39], v[112:115]
    ds_read_b128 v[52:55], v33 offset:3456
    v_mfma_f32_16x16x32_bf16 v[112:115], a[16:19], a[32:35], v[112:115]
    ds_read2_b32 a[72:73], v41 offset0:96 offset1:97
    v_lshrrev_b32 v129, 4, v244
    v_mfma_f32_16x16x32_bf16 v[116:119], a[0:3], a[52:55], v[116:119]
    ds_read2_b32 a[74:75], v41 offset0:98 offset1:99
    v_mfma_f32_16x16x32_bf16 v[116:119], a[4:7], a[48:51], v[116:119]
    ds_read_b128 v[56:59], v33 offset:2944
    v_mfma_f32_16x16x32_bf16 v[116:119], a[8:11], a[44:47], v[116:119]
    ds_read2_b32 a[76:77], v41 offset0:224 offset1:225
    s_add_u32 s78, s77, 851968
    s_add_u32 m0, s79, 36864
    v_mfma_f32_16x16x32_bf16 v[116:119], a[12:15], a[40:43], v[116:119]
    ds_read2_b32 a[78:79], v41 offset0:226 offset1:227
    s_waitcnt lgkmcnt(11)
    buffer_load_dwordx4 v246, s[44:47], s78 offen offset:0 lds
    v_mfma_f32_16x16x32_bf16 v[116:119], a[16:19], a[36:39], v[116:119]
    ds_read_b128 v[60:63], v33 offset:2432
    v_mfma_f32_16x16x32_bf16 v[116:119], a[20:23], a[32:35], v[116:119]
    ds_read2_b32 a[80:81], v42 offset0:96 offset1:97
    v_mfma_f32_16x16x32_bf16 v[120:123], a[0:3], a[56:59], v[120:123]
    ds_read2_b32 a[82:83], v42 offset0:98 offset1:99
    v_lshlrev_b32 v128, 5, v128
    v_mfma_f32_16x16x32_bf16 v[120:123], a[4:7], a[52:55], v[120:123]
    ds_read_b128 v[64:67], v33 offset:1920
    buffer_load_dwordx4 v247, s[44:47], s78 offen offset:1024 lds
    v_mfma_f32_16x16x32_bf16 v[120:123], a[8:11], a[48:51], v[120:123]
    ds_read2_b32 a[84:85], v42 offset0:224 offset1:225
    v_mfma_f32_16x16x32_bf16 v[120:123], a[12:15], a[44:47], v[120:123]
    ds_read2_b32 a[86:87], v42 offset0:226 offset1:227
    v_mfma_f32_16x16x32_bf16 v[120:123], a[16:19], a[40:43], v[120:123]
    ds_read_b128 v[68:71], v33 offset:1408
    v_mfma_f32_16x16x32_bf16 v[120:123], a[20:23], a[36:39], v[120:123]
    ds_read2_b32 a[88:89], v43 offset0:96 offset1:97
    buffer_load_dwordx4 v248, s[44:47], s78 offen offset:2048 lds
    v_mfma_f32_16x16x32_bf16 v[120:123], a[24:27], a[32:35], v[120:123]
    ds_read2_b32 a[90:91], v43 offset0:98 offset1:99
    v_mfma_f32_16x16x32_bf16 v[124:127], a[0:3], a[60:63], v[124:127]
    ds_read_b128 v[72:75], v33 offset:896
    v_lshl_add_u32 v128, v129, 3, v128
    v_mfma_f32_16x16x32_bf16 v[124:127], a[4:7], a[56:59], v[124:127]
    ds_read2_b32 a[92:93], v43 offset0:224 offset1:225
    v_mfma_f32_16x16x32_bf16 v[124:127], a[8:11], a[52:55], v[124:127]
    ds_read2_b32 a[94:95], v43 offset0:226 offset1:227
    buffer_load_dwordx4 v249, s[44:47], s78 offen offset:3072 lds
    v_mfma_f32_16x16x32_bf16 v[124:127], a[12:15], a[48:51], v[124:127]
    ds_read_b128 v[76:79], v33 offset:384
    v_mfma_f32_16x16x32_bf16 v[124:127], a[16:19], a[44:47], v[124:127]
    v_mfma_f32_16x16x32_bf16 v[124:127], a[20:23], a[40:43], v[124:127]
    v_mfma_f32_16x16x32_bf16 v[124:127], a[24:27], a[36:39], v[124:127]
    v_mfma_f32_16x16x32_bf16 v[124:127], a[28:31], a[32:35], v[124:127]
    s_waitcnt vmcnt(4) lgkmcnt(12)
    v_mfma_f32_16x16x32_bf16 v[96:99], a[64:67], v[48:51], v[96:99]
    ds_read_b64_tr_b16 v[192:193], v250 offset:32768
    v_mfma_f32_16x16x32_bf16 v[100:103], a[64:67], v[52:55], v[100:103]
    ds_read_b64_tr_b16 v[194:195], v250 offset:34816
    v_cmp_eq_u64 vcc, s[86:87], v[236:237]
    s_nop 1
    s_and_b32 s3, vcc_lo, 63
    s_cmp_eq_u32 s3, 63
    s_cbranch_scc0 L_slow_h1
L_ok_h1:
    v_mfma_f32_16x16x32_bf16 v[100:103], a[68:71], v[48:51], v[100:103]
    ds_read_b64_tr_b16 v[196:197], v251 offset:32768
    s_add_u32 s90, s84, 16384
    s_add_u32 m0, s85, 32768
    v_mfma_f32_16x16x32_bf16 v[104:107], a[64:67], v[56:59], v[104:107]
    ds_read_b64_tr_b16 v[198:199], v251 offset:34816
    buffer_load_dwordx4 v245, s[56:59], s90 offen offset:0 sc1 lds
    v_mfma_f32_16x16x32_bf16 v[104:107], a[68:71], v[52:55], v[104:107]
    ds_read_b64_tr_b16 v[200:201], v252 offset:32768
    v_mfma_f32_16x16x32_bf16 v[104:107], a[72:75], v[48:51], v[104:107]
    ds_read_b64_tr_b16 v[202:203], v252 offset:34816
    buffer_load_dwordx4 v245, s[56:59], s90 offen offset:1024 sc1 lds
    v_mfma_f32_16x16x32_bf16 v[108:111], a[64:67], v[60:63], v[108:111]
    ds_read_b64_tr_b16 v[204:205], v253 offset:32768
    v_mfma_f32_16x16x32_bf16 v[108:111], a[68:71], v[56:59], v[108:111]
    ds_read_b64_tr_b16 v[206:207], v253 offset:34816
    buffer_load_dwordx4 v245, s[56:59], s90 offen offset:2048 sc1 lds
    v_mfma_f32_16x16x32_bf16 v[108:111], a[72:75], v[52:55], v[108:111]
    ds_read2_b32 a[0:1], v40 offset0:112 offset1:113
    v_mfma_f32_16x16x32_bf16 v[108:111], a[76:79], v[48:51], v[108:111]
    ds_read2_b32 a[2:3], v40 offset0:114 offset1:115
    s_waitcnt lgkmcnt(10)
    buffer_load_dwordx4 v245, s[56:59], s90 offen offset:3072 sc1 lds
    v_mfma_f32_16x16x32_bf16 v[112:115], a[64:67], v[64:67], v[112:115]
    ds_read_b128 a[32:35], v33 offset:4032
    s_add_u32 s90, s84, 20480
    s_add_u32 m0, s85, 36864
    v_mfma_f32_16x16x32_bf16 v[112:115], a[68:71], v[60:63], v[112:115]
    ds_read2_b32 a[4:5], v40 offset0:240 offset1:241
    buffer_load_dwordx4 v245, s[56:59], s90 offen offset:0 sc1 lds
    v_mfma_f32_16x16x32_bf16 v[112:115], a[72:75], v[56:59], v[112:115]
    ds_read2_b32 a[6:7], v40 offset0:242 offset1:243
    v_mfma_f32_16x16x32_bf16 v[112:115], a[76:79], v[52:55], v[112:115]
    ds_read_b128 a[36:39], v33 offset:3520
    buffer_load_dwordx4 v245, s[56:59], s90 offen offset:1024 sc1 lds
    v_mfma_f32_16x16x32_bf16 v[112:115], a[80:83], v[48:51], v[112:115]
    ds_read2_b32 a[8:9], v41 offset0:112 offset1:113
    v_mfma_f32_16x16x32_bf16 v[116:119], a[64:67], v[68:71], v[116:119]
    ds_read2_b32 a[10:11], v41 offset0:114 offset1:115
    buffer_load_dwordx4 v245, s[56:59], s90 offen offset:2048 sc1 lds
    v_mfma_f32_16x16x32_bf16 v[116:119], a[68:71], v[64:67], v[116:119]
    ds_read_b128 a[40:43], v33 offset:3008
    v_mfma_f32_16x16x32_bf16 v[116:119], a[72:75], v[60:63], v[116:119]
    ds_read2_b32 a[12:13], v41 offset0:240 offset1:241
    s_add_u32 s91, s77, 917504
    s_add_u32 m0, s79, 32768
    v_mfma_f32_16x16x32_bf16 v[116:119], a[76:79], v[56:59], v[116:119]
    ds_read2_b32 a[14:15], v41 offset0:242 offset1:243
    s_waitcnt lgkmcnt(11)
    buffer_load_dwordx4 v246, s[44:47], s91 offen offset:0 lds
    v_mfma_f32_16x16x32_bf16 v[116:119], a[80:83], v[52:55], v[116:119]
    ds_read_b128 a[44:47], v33 offset:2496
    v_mfma_f32_16x16x32_bf16 v[116:119], a[84:87], v[48:51], v[116:119]
    ds_read2_b32 a[16:17], v42 offset0:112 offset1:113
    v_mfma_f32_16x16x32_bf16 v[120:123], a[64:67], v[72:75], v[120:123]
    ds_read2_b32 a[18:19], v42 offset0:114 offset1:115
    v_mfma_f32_16x16x32_bf16 v[120:123], a[68:71], v[68:71], v[120:123]
    ds_read_b128 a[48:51], v33 offset:1984
    buffer_load_dwordx4 v247, s[44:47], s91 offen offset:1024 lds
    v_mfma_f32_16x16x32_bf16 v[120:123], a[72:75], v[64:67], v[120:123]
    ds_read2_b32 a[20:21], v42 offset0:240 offset1:241
    v_mfma_f32_16x16x32_bf16 v[120:123], a[76:79], v[60:63], v[120:123]
    ds_read2_b32 a[22:23], v42 offset0:242 offset1:243
    v_mfma_f32_16x16x32_bf16 v[120:123], a[80:83], v[56:59], v[120:123]
    ds_read_b128 a[52:55], v33 offset:1472
    v_mfma_f32_16x16x32_bf16 v[120:123], a[84:87], v[52:55], v[120:123]
    ds_read2_b32 a[24:25], v43 offset0:112 offset1:113
    buffer_load_dwordx4 v248, s[44:47], s91 offen offset:2048 lds
    v_mfma_f32_16x16x32_bf16 v[120:123], a[88:91], v[48:51], v[120:123]
    ds_read2_b32 a[26:27], v43 offset0:114 offset1:115
    v_mfma_f32_16x16x32_bf16 v[124:127], a[64:67], v[76:79], v[124:127]
    ds_read_b128 a[56:59], v33 offset:960
    v_mfma_f32_16x16x32_bf16 v[124:127], a[68:71], v[72:75], v[124:127]
    ds_read2_b32 a[28:29], v43 offset0:240 offset1:241
    v_mfma_f32_16x16x32_bf16 v[124:127], a[72:75], v[68:71], v[124:127]
    ds_read2_b32 a[30:31], v43 offset0:242 offset1:243
    buffer_load_dwordx4 v249, s[44:47], s91 offen offset:3072 lds
    v_mfma_f32_16x16x32_bf16 v[124:127], a[76:79], v[64:67], v[124:127]
    ds_read_b128 a[60:63], v33 offset:448
    s_add_u32 m0, s85, 36864
    v_mfma_f32_16x16x32_bf16 v[124:127], a[80:83], v[60:63], v[124:127]
    buffer_load_dwordx4 v245, s[56:59], s90 offen offset:3072 sc1 lds
    v_mfma_f32_16x16x32_bf16 v[124:127], a[84:87], v[56:59], v[124:127]
    v_mfma_f32_16x16x32_bf16 v[124:127], a[88:91], v[52:55], v[124:127]
    v_mfma_f32_16x16x32_bf16 v[124:127], a[92:95], v[48:51], v[124:127]
    s_waitcnt vmcnt(12) lgkmcnt(12)
    v_mfma_f32_16x16x32_bf16 v[96:99], a[0:3], a[32:35], v[96:99]
    ds_read_b64_tr_b16 v[208:209], v250 offset:36864
    v_mfma_f32_16x16x32_bf16 v[100:103], a[0:3], a[36:39], v[100:103]
    ds_read_b64_tr_b16 v[210:211], v250 offset:38912
    v_mfma_f32_16x16x32_bf16 v[100:103], a[4:7], a[32:35], v[100:103]
    ds_read_b64_tr_b16 v[212:213], v251 offset:36864
    v_mfma_f32_16x16x32_bf16 v[104:107], a[0:3], a[40:43], v[104:107]
    ds_read_b64_tr_b16 v[214:215], v251 offset:38912
    v_mfma_f32_16x16x32_bf16 v[104:107], a[4:7], a[36:39], v[104:107]
    ds_read_b64_tr_b16 v[216:217], v252 offset:36864
    v_mfma_f32_16x16x32_bf16 v[104:107], a[8:11], a[32:35], v[104:107]
    ds_read_b64_tr_b16 v[218:219], v252 offset:38912
    v_mfma_f32_16x16x32_bf16 v[108:111], a[0:3], a[44:47], v[108:111]
    ds_read_b64_tr_b16 v[220:221], v253 offset:36864
    v_mfma_f32_16x16x32_bf16 v[108:111], a[4:7], a[40:43], v[108:111]
    ds_read_b64_tr_b16 v[222:223], v253 offset:38912
    v_mfma_f32_16x16x32_bf16 v[108:111], a[8:11], a[36:39], v[108:111]
    v_mfma_f32_16x16x32_bf16 v[108:111], a[12:15], a[32:35], v[108:111]
    s_waitcnt lgkmcnt(8)
    v_mfma_f32_16x16x32_bf16 v[112:115], a[0:3], a[48:51], v[112:115]
    v_mfma_f32_16x16x32_bf16 v[112:115], a[4:7], a[44:47], v[112:115]
    v_mfma_f32_16x16x32_bf16 v[112:115], a[8:11], a[40:43], v[112:115]
    v_mfma_f32_16x16x32_bf16 v[112:115], a[12:15], a[36:39], v[112:115]
    v_mfma_f32_16x16x32_bf16 v[112:115], a[16:19], a[32:35], v[112:115]
    s_waitcnt lgkmcnt(0)
    v_mfma_f32_16x16x32_bf16 v[116:119], a[0:3], a[52:55], v[116:119]
    s_barrier
    v_mfma_f32_16x16x32_bf16 v[116:119], a[4:7], a[48:51], v[116:119]
    s_add_u32 m0, s79, 36864
    v_mfma_f32_16x16x32_bf16 v[116:119], a[8:11], a[44:47], v[116:119]
    buffer_load_dwordx2 v[236:237], v234, s[60:63], 0 offen sc1
    s_add_u32 s78, s77, 983040
    v_mfma_f32_16x16x32_bf16 v[116:119], a[12:15], a[40:43], v[116:119]
    buffer_load_dwordx4 v246, s[44:47], s78 offen offset:0 lds
    v_mfma_f32_16x16x32_bf16 v[116:119], a[16:19], a[36:39], v[116:119]
    s_add_u32 s90, s84, 32768
    s_add_u32 m0, s85, 65536
    v_mfma_f32_16x16x32_bf16 v[116:119], a[20:23], a[32:35], v[116:119]
    buffer_load_dwordx4 v245, s[56:59], s90 offen offset:0 sc1 lds
    v_mfma_f32_16x16x32_bf16 v[120:123], a[0:3], a[56:59], v[120:123]
    s_add_u32 m0, s79, 36864
    v_mfma_f32_16x16x32_bf16 v[120:123], a[4:7], a[52:55], v[120:123]
    buffer_load_dwordx4 v247, s[44:47], s78 offen offset:1024 lds
    v_mfma_f32_16x16x32_bf16 v[120:123], a[8:11], a[48:51], v[120:123]
    s_add_u32 m0, s85, 65536
    v_mfma_f32_16x16x32_bf16 v[120:123], a[12:15], a[44:47], v[120:123]
    buffer_load_dwordx4 v245, s[56:59], s90 offen offset:1024 sc1 lds
    v_mfma_f32_16x16x32_bf16 v[120:123], a[16:19], a[40:43], v[120:123]
    ds_read_b128 a[64:67], v230 offset:0
    s_add_u32 m0, s79, 36864
    v_mfma_f32_16x16x32_bf16 v[120:123], a[20:23], a[36:39], v[120:123]
    buffer_load_dwordx4 v248, s[44:47], s78 offen offset:2048 lds
    v_mfma_f32_16x16x32_bf16 v[120:123], a[24:27], a[32:35], v[120:123]
    ds_read_b128 a[68:71], v230 offset:8192
    s_add_u32 m0, s85, 65536
    v_mfma_f32_16x16x32_bf16 v[124:127], a[0:3], a[60:63], v[124:127]
    buffer_load_dwordx4 v245, s[56:59], s90 offen offset:2048 sc1 lds
    v_mfma_f32_16x16x32_bf16 v[124:127], a[4:7], a[56:59], v[124:127]
    ds_read_b128 a[72:75], v230 offset:1024
    s_add_u32 m0, s79, 36864
    v_mfma_f32_16x16x32_bf16 v[124:127], a[8:11], a[52:55], v[124:127]
    buffer_load_dwordx4 v249, s[44:47], s78 offen offset:3072 lds
    s_add_u32 m0, s85, 65536
    v_mfma_f32_16x16x32_bf16 v[124:127], a[12:15], a[48:51], v[124:127]
    ds_read_b128 a[76:79], v230 offset:9216
    v_add_u32 v230, 32768, v230
    v_mfma_f32_16x16x32_bf16 v[124:127], a[16:19], a[44:47], v[124:127]
    buffer_load_dwordx4 v245, s[56:59], s90 offen offset:3072 sc1 lds
    v_mfma_f32_16x16x32_bf16 v[124:127], a[20:23], a[40:43], v[124:127]
    v_mfma_f32_16x16x32_bf16 v[124:127], a[24:27], a[36:39], v[124:127]
    v_mfma_f32_16x16x32_bf16 v[124:127], a[28:31], a[32:35], v[124:127]
    s_waitcnt lgkmcnt(2)
    v_mfma_f32_16x16x32_bf16 v[0:3], a[160:163], a[64:67], 0
    s_add_u32 s90, s84, 36864
    s_add_u32 m0, s85, 69632
    v_mfma_f32_16x16x32_bf16 v[0:3], a[176:179], a[68:71], v[0:3]
    ds_read_b128 a[80:83], v231 offset:0
    buffer_load_dwordx4 v245, s[56:59], s90 offen offset:0 sc1 lds
    v_mfma_f32_16x16x32_bf16 v[4:7], a[164:167], a[64:67], 0
    v_mfma_f32_16x16x32_bf16 v[4:7], a[180:183], a[68:71], v[4:7]
    ds_read_b128 a[84:87], v231 offset:8192
    v_mfma_f32_16x16x32_bf16 v[8:11], a[168:171], a[64:67], 0
    v_cvt_pk_bf16_f32 v96, v96, v97
    v_mfma_f32_16x16x32_bf16 v[8:11], a[184:187], a[68:71], v[8:11]
    buffer_load_dwordx4 v245, s[56:59], s90 offen offset:1024 sc1 lds
    v_mfma_f32_16x16x32_bf16 v[12:15], a[172:175], a[64:67], 0
    v_cvt_pk_bf16_f32 v97, v98, v99
    v_mfma_f32_16x16x32_bf16 v[12:15], a[188:191], a[68:71], v[12:15]
    s_waitcnt lgkmcnt(2)
    v_mfma_f32_16x16x32_bf16 v[16:19], a[160:163], a[72:75], 0
    buffer_store_dwordx2 v[96:97], v128, s[52:55], s74 offen offset:0 sc1
    v_mfma_f32_16x16x32_bf16 v[16:19], a[176:179], a[76:79], v[16:19]
    ds_read_b128 a[88:91], v231 offset:1024
    buffer_load_dwordx4 v245, s[56:59], s90 offen offset:2048 sc1 lds
    v_mfma_f32_16x16x32_bf16 v[20:23], a[164:167], a[72:75], 0
    v_mfma_f32_16x16x32_bf16 v[20:23], a[180:183], a[76:79], v[20:23]
    ds_read_b128 a[92:95], v231 offset:9216
    v_add_u32 v231, 32768, v231
    v_mfma_f32_16x16x32_bf16 v[24:27], a[168:171], a[72:75], 0
    v_mfma_f32_16x16x32_bf16 v[24:27], a[184:187], a[76:79], v[24:27]
    buffer_load_dwordx4 v245, s[56:59], s90 offen offset:3072 sc1 lds
    v_mfma_f32_16x16x32_bf16 v[28:31], a[172:175], a[72:75], 0
    v_mfma_f32_16x16x32_bf16 v[28:31], a[188:191], a[76:79], v[28:31]
    s_waitcnt lgkmcnt(2)
    v_mfma_f32_16x16x32_bf16 v[32:35], a[160:163], a[80:83], 0
    v_mfma_f32_16x16x32_bf16 v[32:35], a[176:179], a[84:87], v[32:35]
    ds_read_b128 a[64:67], v232 offset:0
    v_mfma_f32_16x16x32_bf16 v[36:39], a[164:167], a[80:83], 0
    s_mov_b32 m0, s79
    v_mfma_f32_16x16x32_bf16 v[36:39], a[180:183], a[84:87], v[36:39]
    ds_read_b128 a[68:71], v232 offset:8192
    s_add_u32 s91, s77, 1048576
    v_mfma_f32_16x16x32_bf16 v[40:43], a[168:171], a[80:83], 0
    buffer_load_dwordx4 v246, s[44:47], s91 offen offset:0 lds
    v_mfma_f32_16x16x32_bf16 v[40:43], a[184:187], a[84:87], v[40:43]
    v_mfma_f32_16x16x32_bf16 v[44:47], a[172:175], a[80:83], 0
    v_mfma_f32_16x16x32_bf16 v[44:47], a[188:191], a[84:87], v[44:47]
    s_waitcnt lgkmcnt(2)
    buffer_load_dwordx4 v247, s[44:47], s91 offen offset:1024 lds
    v_mfma_f32_16x16x32_bf16 v[48:51], a[160:163], a[88:91], 0
    v_cvt_pk_bf16_f32 v100, v100, v101
    v_mfma_f32_16x16x32_bf16 v[48:51], a[176:179], a[92:95], v[48:51]
    ds_read_b128 a[72:75], v232 offset:1024
    v_mfma_f32_16x16x32_bf16 v[52:55], a[164:167], a[88:91], 0
    buffer_load_dwordx4 v248, s[44:47], s91 offen offset:2048 lds
    v_cvt_pk_bf16_f32 v101, v102, v103
    v_mfma_f32_16x16x32_bf16 v[52:55], a[180:183], a[92:95], v[52:55]
    ds_read_b128 a[76:79], v232 offset:9216
    v_add_u32 v232, 32768, v232
    v_mfma_f32_16x16x32_bf16 v[56:59], a[168:171], a[88:91], 0
    buffer_store_dwordx2 v[100:101], v128, s[52:55], s74 offen offset:512 sc1
    v_mfma_f32_16x16x32_bf16 v[56:59], a[184:187], a[92:95], v[56:59]
    buffer_load_dwordx4 v249, s[44:47], s91 offen offset:3072 lds
    v_mfma_f32_16x16x32_bf16 v[60:63], a[172:175], a[88:91], 0
    s_add_u32 m0, s79, 4096
    v_mfma_f32_16x16x32_bf16 v[60:63], a[188:191], a[92:95], v[60:63]
    s_waitcnt lgkmcnt(2)
    s_add_u32 s78, s77, 1114112
    v_mfma_f32_16x16x32_bf16 a[0:3], a[160:163], a[64:67], 0
    buffer_load_dwordx4 v246, s[44:47], s78 offen offset:0 lds
    v_mfma_f32_16x16x32_bf16 a[0:3], a[176:179], a[68:71], a[0:3]
    ds_read_b128 a[80:83], v233 offset:0
    v_mfma_f32_16x16x32_bf16 a[4:7], a[164:167], a[64:67], 0
    v_mfma_f32_16x16x32_bf16 a[4:7], a[180:183], a[68:71], a[4:7]
    ds_read_b128 a[84:87], v233 offset:8192
    buffer_load_dwordx4 v247, s[44:47], s78 offen offset:1024 lds
    v_mfma_f32_16x16x32_bf16 a[8:11], a[168:171], a[64:67], 0
    v_mfma_f32_16x16x32_bf16 a[8:11], a[184:187], a[68:71], a[8:11]
    ds_read_b128 a[88:91], v233 offset:1024
    v_mfma_f32_16x16x32_bf16 a[12:15], a[172:175], a[64:67], 0
    buffer_load_dwordx4 v248, s[44:47], s78 offen offset:2048 lds
    v_mfma_f32_16x16x32_bf16 a[12:15], a[188:191], a[68:71], a[12:15]
    s_waitcnt lgkmcnt(3)
    ds_read_b128 a[92:95], v233 offset:9216
    v_add_u32 v233, 32768, v233
    v_mfma_f32_16x16x32_bf16 a[16:19], a[160:163], a[72:75], 0
    v_mfma_f32_16x16x32_bf16 a[16:19], a[176:179], a[76:79], a[16:19]
    buffer_load_dwordx4 v249, s[44:47], s78 offen offset:3072 lds
    v_mfma_f32_16x16x32_bf16 a[20:23], a[164:167], a[72:75], 0
    v_mfma_f32_16x16x32_bf16 a[20:23], a[180:183], a[76:79], a[20:23]
    v_mfma_f32_16x16x32_bf16 a[24:27], a[168:171], a[72:75], 0
    v_mfma_f32_16x16x32_bf16 a[24:27], a[184:187], a[76:79], a[24:27]
    v_mfma_f32_16x16x32_bf16 a[28:31], a[172:175], a[72:75], 0
    v_mfma_f32_16x16x32_bf16 a[28:31], a[188:191], a[76:79], a[28:31]
    s_waitcnt vmcnt(23) lgkmcnt(0)
    v_mfma_f32_16x16x32_bf16 a[32:35], a[160:163], a[80:83], 0
    s_barrier
    v_mfma_f32_16x16x32_bf16 a[32:35], a[176:179], a[84:87], a[32:35]
    ds_read_b128 a[64:67], v230 offset:0
    v_mfma_f32_16x16x32_bf16 a[36:39], a[164:167], a[80:83], 0
    s_waitcnt vmcnt(22)
    v_cmp_eq_u64 vcc, s[86:87], v[236:237]
    s_nop 1
    s_and_b32 s3, vcc_lo, 268435455
    s_cmp_eq_u32 s3, 268435455
    s_cbranch_scc0 L_slow_hall
L_ok_hall:
    v_mfma_f32_16x16x32_bf16 a[36:39], a[180:183], a[84:87], a[36:39]
    ds_read_b128 a[68:71], v230 offset:8192
    s_add_u32 s90, s84, 49152
    v_mfma_f32_16x16x32_bf16 a[40:43], a[168:171], a[80:83], 0
    s_mov_b32 m0, s85
    s_nop 0
    buffer_load_dwordx4 v245, s[56:59], s90 offen offset:0 sc1 lds
    v_mfma_f32_16x16x32_bf16 a[40:43], a[184:187], a[84:87], a[40:43]
    v_mfma_f32_16x16x32_bf16 a[44:47], a[172:175], a[80:83], 0
    v_mfma_f32_16x16x32_bf16 a[44:47], a[188:191], a[84:87], a[44:47]
    v_mfma_f32_16x16x32_bf16 a[48:51], a[160:163], a[88:91], 0
    buffer_load_dwordx4 v245, s[56:59], s90 offen offset:1024 sc1 lds
    v_mfma_f32_16x16x32_bf16 a[48:51], a[176:179], a[92:95], a[48:51]
    ds_read_b128 a[72:75], v230 offset:1024
    v_mfma_f32_16x16x32_bf16 a[52:55], a[164:167], a[88:91], 0
    v_mfma_f32_16x16x32_bf16 a[52:55], a[180:183], a[92:95], a[52:55]
    ds_read_b128 a[76:79], v230 offset:9216
    v_add_u32 v230, 32768, v230
    v_mfma_f32_16x16x32_bf16 a[56:59], a[168:171], a[88:91], 0
    buffer_load_dwordx4 v245, s[56:59], s90 offen offset:2048 sc1 lds
    v_mfma_f32_16x16x32_bf16 a[56:59], a[184:187], a[92:95], a[56:59]
    v_mfma_f32_16x16x32_bf16 a[60:63], a[172:175], a[88:91], 0
    v_mfma_f32_16x16x32_bf16 a[60:63], a[188:191], a[92:95], a[60:63]
    s_waitcnt lgkmcnt(2)
    v_mfma_f32_16x16x32_bf16 v[0:3], a[192:195], a[64:67], v[0:3]
    ds_read_b64_tr_b16 a[160:161], v250 offset:32768
    v_mfma_f32_16x16x32_bf16 v[0:3], a[208:211], a[68:71], v[0:3]
    ds_read_b128 a[80:83], v231 offset:0
    buffer_load_dwordx4 v245, s[56:59], s90 offen offset:3072 sc1 lds
    v_mfma_f32_16x16x32_bf16 v[4:7], a[196:199], a[64:67], v[4:7]
    ds_read_b64_tr_b16 a[162:163], v250 offset:34816
    v_mfma_f32_16x16x32_bf16 v[4:7], a[212:215], a[68:71], v[4:7]
    ds_read_b128 a[84:87], v231 offset:8192
    s_add_u32 s90, s84, 53248
    v_mfma_f32_16x16x32_bf16 v[8:11], a[200:203], a[64:67], v[8:11]
    ds_read_b64_tr_b16 a[164:165], v251 offset:32768
    v_cvt_pk_bf16_f32 v104, v104, v105
    s_add_u32 m0, s85, 4096
    v_mfma_f32_16x16x32_bf16 v[8:11], a[216:219], a[68:71], v[8:11]
    buffer_load_dwordx4 v245, s[56:59], s90 offen offset:0 sc1 lds
    ds_read_b64_tr_b16 a[166:167], v251 offset:34816
    v_mfma_f32_16x16x32_bf16 v[12:15], a[204:207], a[64:67], v[12:15]
    ds_read_b64_tr_b16 a[168:169], v252 offset:32768
    v_cvt_pk_bf16_f32 v105, v106, v107
    v_mfma_f32_16x16x32_bf16 v[12:15], a[220:223], a[68:71], v[12:15]
    s_waitcnt lgkmcnt(7)
    ds_read_b64_tr_b16 a[170:171], v252 offset:34816
    v_mfma_f32_16x16x32_bf16 v[16:19], a[192:195], a[72:75], v[16:19]
    ds_read_b64_tr_b16 a[172:173], v253 offset:32768
    buffer_store_dwordx2 v[104:105], v128, s[52:55], s74 offen offset:1024 sc1
    v_mfma_f32_16x16x32_bf16 v[16:19], a[208:211], a[76:79], v[16:19]
    ds_read_b128 a[88:91], v231 offset:1024
    buffer_load_dwordx4 v245, s[56:59], s90 offen offset:1024 sc1 lds
    v_mfma_f32_16x16x32_bf16 v[20:23], a[196:199], a[72:75], v[20:23]
    ds_read_b64_tr_b16 a[174:175], v253 offset:34816
    v_mfma_f32_16x16x32_bf16 v[20:23], a[212:215], a[76:79], v[20:23]
    ds_read_b128 a[92:95], v231 offset:9216
    v_add_u32 v231, 32768, v231
    v_mfma_f32_16x16x32_bf16 v[24:27], a[200:203], a[72:75], v[24:27]
    v_mfma_f32_16x16x32_bf16 v[24:27], a[216:219], a[76:79], v[24:27]
    buffer_load_dwordx4 v245, s[56:59], s90 offen offset:2048 sc1 lds
    v_mfma_f32_16x16x32_bf16 v[28:31], a[204:207], a[72:75], v[28:31]
    v_mfma_f32_16x16x32_bf16 v[28:31], a[220:223], a[76:79], v[28:31]
    s_waitcnt lgkmcnt(8)
    v_mfma_f32_16x16x32_bf16 v[32:35], a[192:195], a[80:83], v[32:35]
    v_mfma_f32_16x16x32_bf16 v[32:35], a[208:211], a[84:87], v[32:35]
    ds_read_b128 a[64:67], v232 offset:0
    buffer_load_dwordx4 v245, s[56:59], s90 offen offset:3072 sc1 lds
    v_mfma_f32_16x16x32_bf16 v[36:39], a[196:199], a[80:83], v[36:39]
    s_add_u32 s91, s77, 1179648
    s_add_u32 m0, s79, 32768
    v_mfma_f32_16x16x32_bf16 v[36:39], a[212:215], a[84:87], v[36:39]
    ds_read_b128 a[68:71], v232 offset:8192
    s_waitcnt lgkmcnt(3)
    buffer_load_dwordx4 v246, s[44:47], s91 offen offset:0 lds
    v_mfma_f32_16x16x32_bf16 v[40:43], a[200:203], a[80:83], v[40:43]
    v_mfma_f32_16x16x32_bf16 v[40:43], a[216:219], a[84:87], v[40:43]
    buffer_load_dwordx4 v247, s[44:47], s91 offen offset:1024 lds
    v_mfma_f32_16x16x32_bf16 v[44:47], a[204:207], a[80:83], v[44:47]
    v_mfma_f32_16x16x32_bf16 v[44:47], a[220:223], a[84:87], v[44:47]
    s_waitcnt lgkmcnt(2)
    buffer_load_dwordx4 v248, s[44:47], s91 offen offset:2048 lds
    v_mfma_f32_16x16x32_bf16 v[48:51], a[192:195], a[88:91], v[48:51]
    v_cvt_pk_bf16_f32 v108, v108, v109
    v_mfma_f32_16x16x32_bf16 v[48:51], a[208:211], a[92:95], v[48:51]
    ds_read_b128 a[72:75], v232 offset:1024
    buffer_load_dwordx4 v249, s[44:47], s91 offen offset:3072 lds
    v_mfma_f32_16x16x32_bf16 v[52:55], a[196:199], a[88:91], v[52:55]
    v_cvt_pk_bf16_f32 v109, v110, v111
    v_mfma_f32_16x16x32_bf16 v[52:55], a[212:215], a[92:95], v[52:55]
    ds_read_b128 a[76:79], v232 offset:9216
    v_add_u32 v232, 32768, v232
    v_mfma_f32_16x16x32_bf16 v[56:59], a[200:203], a[88:91], v[56:59]
    buffer_store_dwordx2 v[108:109], v128, s[52:55], s74 offen offset:1536 sc1
    v_mfma_f32_16x16x32_bf16 v[56:59], a[216:219], a[92:95], v[56:59]
    v_mfma_f32_16x16x32_bf16 v[60:63], a[204:207], a[88:91], v[60:63]
    v_mfma_f32_16x16x32_bf16 v[60:63], a[220:223], a[92:95], v[60:63]
    s_waitcnt lgkmcnt(2)
    v_mfma_f32_16x16x32_bf16 a[0:3], a[192:195], a[64:67], a[0:3]
    v_mfma_f32_16x16x32_bf16 a[0:3], a[208:211], a[68:71], a[0:3]
    ds_read_b128 a[80:83], v233 offset:0
    v_mfma_f32_16x16x32_bf16 a[4:7], a[196:199], a[64:67], a[4:7]
    v_mfma_f32_16x16x32_bf16 a[4:7], a[212:215], a[68:71], a[4:7]
    ds_read_b128 a[84:87], v233 offset:8192
    v_mfma_f32_16x16x32_bf16 a[8:11], a[200:203], a[64:67], a[8:11]
    v_mfma_f32_16x16x32_bf16 a[8:11], a[216:219], a[68:71], a[8:11]
    ds_read_b128 a[88:91], v233 offset:1024
    v_mfma_f32_16x16x32_bf16 a[12:15], a[204:207], a[64:67], a[12:15]
    v_mfma_f32_16x16x32_bf16 a[12:15], a[220:223], a[68:71], a[12:15]
    s_waitcnt lgkmcnt(3)
    ds_read_b128 a[92:95], v233 offset:9216
    v_add_u32 v233, 32768, v233
    v_mfma_f32_16x16x32_bf16 a[16:19], a[192:195], a[72:75], a[16:19]
    v_mfma_f32_16x16x32_bf16 a[16:19], a[208:211], a[76:79], a[16:19]
    v_mfma_f32_16x16x32_bf16 a[20:23], a[196:199], a[72:75], a[20:23]
    v_mfma_f32_16x16x32_bf16 a[20:23], a[212:215], a[76:79], a[20:23]
    v_mfma_f32_16x16x32_bf16 a[24:27], a[200:203], a[72:75], a[24:27]
    v_mfma_f32_16x16x32_bf16 a[24:27], a[216:219], a[76:79], a[24:27]
    v_mfma_f32_16x16x32_bf16 a[28:31], a[204:207], a[72:75], a[28:31]
    v_mfma_f32_16x16x32_bf16 a[28:31], a[220:223], a[76:79], a[28:31]
    s_waitcnt vmcnt(23) lgkmcnt(0)
    v_mfma_f32_16x16x32_bf16 a[32:35], a[192:195], a[80:83], a[32:35]
    s_barrier
    v_mfma_f32_16x16x32_bf16 a[32:35], a[208:211], a[84:87], a[32:35]
    ds_read_b128 a[64:67], v230 offset:0
    v_mfma_f32_16x16x32_bf16 a[36:39], a[196:199], a[80:83], a[36:39]
    s_add_u32 m0, s85, 32768
    v_mfma_f32_16x16x32_bf16 a[36:39], a[212:215], a[84:87], a[36:39]
    ds_read_b128 a[68:71], v230 offset:8192
    s_add_u32 s90, s84, 65536
    v_mfma_f32_16x16x32_bf16 a[40:43], a[200:203], a[80:83], a[40:43]
    buffer_load_dwordx4 v245, s[56:59], s90 offen offset:0 sc1 lds
    v_mfma_f32_16x16x32_bf16 a[40:43], a[216:219], a[84:87], a[40:43]
    v_mfma_f32_16x16x32_bf16 a[44:47], a[204:207], a[80:83], a[44:47]
    v_mfma_f32_16x16x32_bf16 a[44:47], a[220:223], a[84:87], a[44:47]
    v_mfma_f32_16x16x32_bf16 a[48:51], a[192:195], a[88:91], a[48:51]
    buffer_load_dwordx4 v245, s[56:59], s90 offen offset:1024 sc1 lds
    v_mfma_f32_16x16x32_bf16 a[48:51], a[208:211], a[92:95], a[48:51]
    ds_read_b128 a[72:75], v230 offset:1024
    v_mfma_f32_16x16x32_bf16 a[52:55], a[196:199], a[88:91], a[52:55]
    v_mfma_f32_16x16x32_bf16 a[52:55], a[212:215], a[92:95], a[52:55]
    ds_read_b128 a[76:79], v230 offset:9216
    v_add_u32 v230, 4294901760, v230
    v_mfma_f32_16x16x32_bf16 a[56:59], a[200:203], a[88:91], a[56:59]
    buffer_load_dwordx4 v245, s[56:59], s90 offen offset:2048 sc1 lds
    v_mfma_f32_16x16x32_bf16 a[56:59], a[216:219], a[92:95], a[56:59]
    v_mfma_f32_16x16x32_bf16 a[60:63], a[204:207], a[88:91], a[60:63]
    v_mfma_f32_16x16x32_bf16 a[60:63], a[220:223], a[92:95], a[60:63]
    s_waitcnt lgkmcnt(2)
    v_mfma_f32_16x16x32_bf16 v[0:3], a[224:227], a[64:67], v[0:3]
    ds_read_b64_tr_b16 a[176:177], v250 offset:36864
    v_mfma_f32_16x16x32_bf16 v[0:3], a[240:243], a[68:71], v[0:3]
    ds_read_b128 a[80:83], v231 offset:0
    buffer_load_dwordx4 v245, s[56:59], s90 offen offset:3072 sc1 lds
    v_mfma_f32_16x16x32_bf16 v[4:7], a[228:231], a[64:67], v[4:7]
    ds_read_b64_tr_b16 a[178:179], v250 offset:38912
    v_mfma_f32_16x16x32_bf16 v[4:7], a[244:247], a[68:71], v[4:7]
    ds_read_b128 a[84:87], v231 offset:8192
    s_add_u32 s90, s84, 69632
    v_mfma_f32_16x16x32_bf16 v[8:11], a[232:235], a[64:67], v[8:11]
    ds_read_b64_tr_b16 a[180:181], v251 offset:36864
    v_cvt_pk_bf16_f32 v112, v112, v113
    s_add_u32 m0, s85, 36864
    v_mfma_f32_16x16x32_bf16 v[8:11], a[248:251], a[68:71], v[8:11]
    buffer_load_dwordx4 v245, s[56:59], s90 offen offset:0 sc1 lds
    ds_read_b64_tr_b16 a[182:183], v251 offset:38912
    v_mfma_f32_16x16x32_bf16 v[12:15], a[236:239], a[64:67], v[12:15]
    ds_read_b64_tr_b16 a[184:185], v252 offset:36864
    v_cvt_pk_bf16_f32 v113, v114, v115
    v_mfma_f32_16x16x32_bf16 v[12:15], a[252:255], a[68:71], v[12:15]
    s_waitcnt lgkmcnt(7)
    ds_read_b64_tr_b16 a[186:187], v252 offset:38912
    v_mfma_f32_16x16x32_bf16 v[16:19], a[224:227], a[72:75], v[16:19]
    ds_read_b64_tr_b16 a[188:189], v253 offset:36864
    buffer_store_dwordx2 v[112:113], v128, s[52:55], s74 offen offset:2048 sc1
    v_mfma_f32_16x16x32_bf16 v[16:19], a[240:243], a[76:79], v[16:19]
    ds_read_b128 a[88:91], v231 offset:1024
    buffer_load_dwordx4 v245, s[56:59], s90 offen offset:1024 sc1 lds
    v_mfma_f32_16x16x32_bf16 v[20:23], a[228:231], a[72:75], v[20:23]
    ds_read_b64_tr_b16 a[190:191], v253 offset:38912
    v_mfma_f32_16x16x32_bf16 v[20:23], a[244:247], a[76:79], v[20:23]
    ds_read_b128 a[92:95], v231 offset:9216
    v_add_u32 v231, 4294901760, v231
    v_mfma_f32_16x16x32_bf16 v[24:27], a[232:235], a[72:75], v[24:27]
    v_mfma_f32_16x16x32_bf16 v[24:27], a[248:251], a[76:79], v[24:27]
    buffer_load_dwordx4 v245, s[56:59], s90 offen offset:2048 sc1 lds
    v_mfma_f32_16x16x32_bf16 v[28:31], a[236:239], a[72:75], v[28:31]
    v_mfma_f32_16x16x32_bf16 v[28:31], a[252:255], a[76:79], v[28:31]
    s_waitcnt lgkmcnt(8)
    v_mfma_f32_16x16x32_bf16 v[32:35], a[224:227], a[80:83], v[32:35]
    v_mfma_f32_16x16x32_bf16 v[32:35], a[240:243], a[84:87], v[32:35]
    ds_read_b128 a[64:67], v232 offset:0
    buffer_load_dwordx4 v245, s[56:59], s90 offen offset:3072 sc1 lds
    v_mfma_f32_16x16x32_bf16 v[36:39], a[228:231], a[80:83], v[36:39]
    s_add_u32 s78, s77, 1245184
    s_add_u32 m0, s79, 36864
    v_mfma_f32_16x16x32_bf16 v[36:39], a[244:247], a[84:87], v[36:39]
    ds_read_b128 a[68:71], v232 offset:8192
    s_waitcnt lgkmcnt(3)
    buffer_load_dwordx4 v246, s[44:47], s78 offen offset:0 lds
    v_mfma_f32_16x16x32_bf16 v[40:43], a[232:235], a[80:83], v[40:43]
    v_mfma_f32_16x16x32_bf16 v[40:43], a[248:251], a[84:87], v[40:43]
    buffer_load_dwordx4 v247, s[44:47], s78 offen offset:1024 lds
    v_mfma_f32_16x16x32_bf16 v[44:47], a[236:239], a[80:83], v[44:47]
    v_mfma_f32_16x16x32_bf16 v[44:47], a[252:255], a[84:87], v[44:47]
    s_waitcnt lgkmcnt(2)
    buffer_load_dwordx4 v248, s[44:47], s78 offen offset:2048 lds
    v_mfma_f32_16x16x32_bf16 v[48:51], a[224:227], a[88:91], v[48:51]
    v_cvt_pk_bf16_f32 v116, v116, v117
    v_mfma_f32_16x16x32_bf16 v[48:51], a[240:243], a[92:95], v[48:51]
    ds_read_b128 a[72:75], v232 offset:1024
    buffer_load_dwordx4 v249, s[44:47], s78 offen offset:3072 lds
    v_mfma_f32_16x16x32_bf16 v[52:55], a[228:231], a[88:91], v[52:55]
    v_cvt_pk_bf16_f32 v117, v118, v119
    v_mfma_f32_16x16x32_bf16 v[52:55], a[244:247], a[92:95], v[52:55]
    ds_read_b128 a[76:79], v232 offset:9216
    v_add_u32 v232, 4294901760, v232
    v_mfma_f32_16x16x32_bf16 v[56:59], a[232:235], a[88:91], v[56:59]
    buffer_store_dwordx2 v[116:117], v128, s[52:55], s74 offen offset:2560 sc1
    v_mfma_f32_16x16x32_bf16 v[56:59], a[248:251], a[92:95], v[56:59]
    v_mfma_f32_16x16x32_bf16 v[60:63], a[236:239], a[88:91], v[60:63]
    v_mfma_f32_16x16x32_bf16 v[60:63], a[252:255], a[92:95], v[60:63]
    s_waitcnt lgkmcnt(2)
    v_mfma_f32_16x16x32_bf16 a[0:3], a[224:227], a[64:67], a[0:3]
    v_mfma_f32_16x16x32_bf16 a[0:3], a[240:243], a[68:71], a[0:3]
    ds_read_b128 a[80:83], v233 offset:0
    v_mfma_f32_16x16x32_bf16 a[4:7], a[228:231], a[64:67], a[4:7]
    v_mfma_f32_16x16x32_bf16 a[4:7], a[244:247], a[68:71], a[4:7]
    ds_read_b128 a[84:87], v233 offset:8192
    v_mfma_f32_16x16x32_bf16 a[8:11], a[232:235], a[64:67], a[8:11]
    v_mfma_f32_16x16x32_bf16 a[8:11], a[248:251], a[68:71], a[8:11]
    ds_read_b128 a[88:91], v233 offset:1024
    v_mfma_f32_16x16x32_bf16 a[12:15], a[236:239], a[64:67], a[12:15]
    v_mfma_f32_16x16x32_bf16 a[12:15], a[252:255], a[68:71], a[12:15]
    s_waitcnt lgkmcnt(3)
    ds_read_b128 a[92:95], v233 offset:9216
    v_add_u32 v233, 4294901760, v233
    v_mfma_f32_16x16x32_bf16 a[16:19], a[224:227], a[72:75], a[16:19]
    v_mfma_f32_16x16x32_bf16 a[16:19], a[240:243], a[76:79], a[16:19]
    v_mfma_f32_16x16x32_bf16 a[20:23], a[228:231], a[72:75], a[20:23]
    v_mfma_f32_16x16x32_bf16 a[20:23], a[244:247], a[76:79], a[20:23]
    v_mfma_f32_16x16x32_bf16 a[24:27], a[232:235], a[72:75], a[24:27]
    v_mfma_f32_16x16x32_bf16 a[24:27], a[248:251], a[76:79], a[24:27]
    v_mfma_f32_16x16x32_bf16 a[28:31], a[236:239], a[72:75], a[28:31]
    v_mfma_f32_16x16x32_bf16 a[28:31], a[252:255], a[76:79], a[28:31]
    s_waitcnt vmcnt(19) lgkmcnt(0)
    v_mfma_f32_16x16x32_bf16 a[32:35], a[224:227], a[80:83], a[32:35]
    s_barrier
    v_mfma_f32_16x16x32_bf16 a[32:35], a[240:243], a[84:87], a[32:35]
    ds_read_b128 a[64:67], v230 offset:0
    v_mfma_f32_16x16x32_bf16 a[36:39], a[228:231], a[80:83], a[36:39]
    s_add_u32 m0, s85, 65536
    v_mfma_f32_16x16x32_bf16 a[36:39], a[244:247], a[84:87], a[36:39]
    ds_read_b128 a[68:71], v230 offset:8192
    s_add_u32 s90, s84, 81920
    v_mfma_f32_16x16x32_bf16 a[40:43], a[232:235], a[80:83], a[40:43]
    buffer_load_dwordx4 v245, s[56:59], s90 offen offset:0 sc1 lds
    v_mfma_f32_16x16x32_bf16 a[40:43], a[248:251], a[84:87], a[40:43]
    v_mfma_f32_16x16x32_bf16 a[44:47], a[236:239], a[80:83], a[44:47]
    v_mfma_f32_16x16x32_bf16 a[44:47], a[252:255], a[84:87], a[44:47]
    v_mfma_f32_16x16x32_bf16 a[48:51], a[224:227], a[88:91], a[48:51]
    buffer_load_dwordx4 v245, s[56:59], s90 offen offset:1024 sc1 lds
    v_mfma_f32_16x16x32_bf16 a[48:51], a[240:243], a[92:95], a[48:51]
    ds_read_b128 a[72:75], v230 offset:1024
    v_mfma_f32_16x16x32_bf16 a[52:55], a[228:231], a[88:91], a[52:55]
    v_mfma_f32_16x16x32_bf16 a[52:55], a[244:247], a[92:95], a[52:55]
    ds_read_b128 a[76:79], v230 offset:9216
    v_add_u32 v230, 32768, v230
    v_mfma_f32_16x16x32_bf16 a[56:59], a[232:235], a[88:91], a[56:59]
    buffer_load_dwordx4 v245, s[56:59], s90 offen offset:2048 sc1 lds
    v_mfma_f32_16x16x32_bf16 a[56:59], a[248:251], a[92:95], a[56:59]
    v_mfma_f32_16x16x32_bf16 a[60:63], a[236:239], a[88:91], a[60:63]
    v_mfma_f32_16x16x32_bf16 a[60:63], a[252:255], a[92:95], a[60:63]
    s_waitcnt lgkmcnt(2)
    v_mfma_f32_16x16x32_bf16 v[0:3], a[96:99], a[64:67], v[0:3]
    ds_read_b64_tr_b16 a[192:193], v250 offset:0
    v_mfma_f32_16x16x32_bf16 v[0:3], a[112:115], a[68:71], v[0:3]
    ds_read_b128 a[80:83], v231 offset:0
    buffer_load_dwordx4 v245, s[56:59], s90 offen offset:3072 sc1 lds
    v_mfma_f32_16x16x32_bf16 v[4:7], a[100:103], a[64:67], v[4:7]
    ds_read_b64_tr_b16 a[194:195], v250 offset:2048
    v_mfma_f32_16x16x32_bf16 v[4:7], a[116:119], a[68:71], v[4:7]
    ds_read_b128 a[84:87], v231 offset:8192
    s_add_u32 s90, s84, 86016
    v_mfma_f32_16x16x32_bf16 v[8:11], a[104:107], a[64:67], v[8:11]
    ds_read_b64_tr_b16 a[196:197], v251 offset:0
    v_cvt_pk_bf16_f32 v120, v120, v121
    s_add_u32 m0, s85, 69632
    v_mfma_f32_16x16x32_bf16 v[8:11], a[120:123], a[68:71], v[8:11]
    buffer_load_dwordx4 v245, s[56:59], s90 offen offset:0 sc1 lds
    ds_read_b64_tr_b16 a[198:199], v251 offset:2048
    v_mfma_f32_16x16x32_bf16 v[12:15], a[108:111], a[64:67], v[12:15]
    ds_read_b64_tr_b16 a[200:201], v252 offset:0
    v_cvt_pk_bf16_f32 v121, v122, v123
    v_mfma_f32_16x16x32_bf16 v[12:15], a[124:127], a[68:71], v[12:15]
    s_waitcnt lgkmcnt(7)
    ds_read_b64_tr_b16 a[202:203], v252 offset:2048
    v_mfma_f32_16x16x32_bf16 v[16:19], a[96:99], a[72:75], v[16:19]
    ds_read_b64_tr_b16 a[204:205], v253 offset:0
    buffer_store_dwordx2 v[120:121], v128, s[52:55], s74 offen offset:3072 sc1
    v_mfma_f32_16x16x32_bf16 v[16:19], a[112:115], a[76:79], v[16:19]
    ds_read_b128 a[88:91], v231 offset:1024
    buffer_load_dwordx4 v245, s[56:59], s90 offen offset:1024 sc1 lds
    v_mfma_f32_16x16x32_bf16 v[20:23], a[100:103], a[72:75], v[20:23]
    ds_read_b64_tr_b16 a[206:207], v253 offset:2048
    v_mfma_f32_16x16x32_bf16 v[20:23], a[116:119], a[76:79], v[20:23]
    ds_read_b128 a[92:95], v231 offset:9216
    v_add_u32 v231, 32768, v231
    v_mfma_f32_16x16x32_bf16 v[24:27], a[104:107], a[72:75], v[24:27]
    v_mfma_f32_16x16x32_bf16 v[24:27], a[120:123], a[76:79], v[24:27]
    buffer_load_dwordx4 v245, s[56:59], s90 offen offset:2048 sc1 lds
    v_mfma_f32_16x16x32_bf16 v[28:31], a[108:111], a[72:75], v[28:31]
    v_mfma_f32_16x16x32_bf16 v[28:31], a[124:127], a[76:79], v[28:31]
    s_waitcnt lgkmcnt(8)
    v_mfma_f32_16x16x32_bf16 v[32:35], a[96:99], a[80:83], v[32:35]
    v_mfma_f32_16x16x32_bf16 v[32:35], a[112:115], a[84:87], v[32:35]
    ds_read_b128 a[64:67], v232 offset:0
    buffer_load_dwordx4 v245, s[56:59], s90 offen offset:3072 sc1 lds
    v_mfma_f32_16x16x32_bf16 v[36:39], a[100:103], a[80:83], v[36:39]
    s_add_u32 s91, s77, 1310720
    s_mov_b32 m0, s79
    v_mfma_f32_16x16x32_bf16 v[36:39], a[116:119], a[84:87], v[36:39]
    ds_read_b128 a[68:71], v232 offset:8192
    s_waitcnt lgkmcnt(3)
    buffer_load_dwordx4 v246, s[44:47], s91 offen offset:0 lds
    v_mfma_f32_16x16x32_bf16 v[40:43], a[104:107], a[80:83], v[40:43]
    v_mfma_f32_16x16x32_bf16 v[40:43], a[120:123], a[84:87], v[40:43]
    buffer_load_dwordx4 v247, s[44:47], s91 offen offset:1024 lds
    v_mfma_f32_16x16x32_bf16 v[44:47], a[108:111], a[80:83], v[44:47]
    v_mfma_f32_16x16x32_bf16 v[44:47], a[124:127], a[84:87], v[44:47]
    s_waitcnt lgkmcnt(2)
    buffer_load_dwordx4 v248, s[44:47], s91 offen offset:2048 lds
    v_mfma_f32_16x16x32_bf16 v[48:51], a[96:99], a[88:91], v[48:51]
    v_cvt_pk_bf16_f32 v124, v124, v125
    v_mfma_f32_16x16x32_bf16 v[48:51], a[112:115], a[92:95], v[48:51]
    ds_read_b128 a[72:75], v232 offset:1024
    buffer_load_dwordx4 v249, s[44:47], s91 offen offset:3072 lds
    v_mfma_f32_16x16x32_bf16 v[52:55], a[100:103], a[88:91], v[52:55]
    v_cvt_pk_bf16_f32 v125, v126, v127
    v_mfma_f32_16x16x32_bf16 v[52:55], a[116:119], a[92:95], v[52:55]
    ds_read_b128 a[76:79], v232 offset:9216
    v_add_u32 v232, 32768, v232
    v_mfma_f32_16x16x32_bf16 v[56:59], a[104:107], a[88:91], v[56:59]
    buffer_store_dwordx2 v[124:125], v128, s[52:55], s74 offen offset:3584 sc1
    v_mfma_f32_16x16x32_bf16 v[56:59], a[120:123], a[92:95], v[56:59]
    v_mfma_f32_16x16x32_bf16 v[60:63], a[108:111], a[88:91], v[60:63]
    v_mfma_f32_16x16x32_bf16 v[60:63], a[124:127], a[92:95], v[60:63]
    s_waitcnt lgkmcnt(2)
    v_mfma_f32_16x16x32_bf16 a[0:3], a[96:99], a[64:67], a[0:3]
    v_mfma_f32_16x16x32_bf16 a[0:3], a[112:115], a[68:71], a[0:3]
    ds_read_b128 a[80:83], v233 offset:0
    v_mfma_f32_16x16x32_bf16 a[4:7], a[100:103], a[64:67], a[4:7]
    v_mfma_f32_16x16x32_bf16 a[4:7], a[116:119], a[68:71], a[4:7]
    ds_read_b128 a[84:87], v233 offset:8192
    v_mfma_f32_16x16x32_bf16 a[8:11], a[104:107], a[64:67], a[8:11]
    v_mfma_f32_16x16x32_bf16 a[8:11], a[120:123], a[68:71], a[8:11]
    ds_read_b128 a[88:91], v233 offset:1024
    v_mfma_f32_16x16x32_bf16 a[12:15], a[108:111], a[64:67], a[12:15]
    v_mfma_f32_16x16x32_bf16 a[12:15], a[124:127], a[68:71], a[12:15]
    s_waitcnt lgkmcnt(3)
    ds_read_b128 a[92:95], v233 offset:9216
    v_add_u32 v233, 32768, v233
    v_mfma_f32_16x16x32_bf16 a[16:19], a[96:99], a[72:75], a[16:19]
    v_mfma_f32_16x16x32_bf16 a[16:19], a[112:115], a[76:79], a[16:19]
    v_mfma_f32_16x16x32_bf16 a[20:23], a[100:103], a[72:75], a[20:23]
    v_mfma_f32_16x16x32_bf16 a[20:23], a[116:119], a[76:79], a[20:23]
    v_mfma_f32_16x16x32_bf16 a[24:27], a[104:107], a[72:75], a[24:27]
    v_mfma_f32_16x16x32_bf16 a[24:27], a[120:123], a[76:79], a[24:27]
    v_mfma_f32_16x16x32_bf16 a[28:31], a[108:111], a[72:75], a[28:31]
    v_mfma_f32_16x16x32_bf16 a[28:31], a[124:127], a[76:79], a[28:31]
    s_waitcnt vmcnt(19) lgkmcnt(0)
    v_mfma_f32_16x16x32_bf16 a[32:35], a[96:99], a[80:83], a[32:35]
    s_barrier
    v_mfma_f32_16x16x32_bf16 a[32:35], a[112:115], a[84:87], a[32:35]
    ds_read_b128 a[64:67], v230 offset:0
    v_mfma_f32_16x16x32_bf16 a[36:39], a[100:103], a[80:83], a[36:39]
    s_mov_b32 m0, s85
    v_mfma_f32_16x16x32_bf16 a[36:39], a[116:119], a[84:87], a[36:39]
    ds_read_b128 a[68:71], v230 offset:8192
    s_add_u32 s90, s84, 98304
    v_mfma_f32_16x16x32_bf16 a[40:43], a[104:107], a[80:83], a[40:43]
    buffer_load_dwordx4 v245, s[56:59], s90 offen offset:0 sc1 lds
    v_mfma_f32_16x16x32_bf16 a[40:43], a[120:123], a[84:87], a[40:43]
    v_mfma_f32_16x16x32_bf16 a[44:47], a[108:111], a[80:83], a[44:47]
    v_mfma_f32_16x16x32_bf16 a[44:47], a[124:127], a[84:87], a[44:47]
    v_mfma_f32_16x16x32_bf16 a[48:51], a[96:99], a[88:91], a[48:51]
    buffer_load_dwordx4 v245, s[56:59], s90 offen offset:1024 sc1 lds
    v_mfma_f32_16x16x32_bf16 a[48:51], a[112:115], a[92:95], a[48:51]
    ds_read_b128 a[72:75], v230 offset:1024
    v_mfma_f32_16x16x32_bf16 a[52:55], a[100:103], a[88:91], a[52:55]
    v_mfma_f32_16x16x32_bf16 a[52:55], a[116:119], a[92:95], a[52:55]
    ds_read_b128 a[76:79], v230 offset:9216
    v_add_u32 v230, 32768, v230
    v_mfma_f32_16x16x32_bf16 a[56:59], a[104:107], a[88:91], a[56:59]
    buffer_load_dwordx4 v245, s[56:59], s90 offen offset:2048 sc1 lds
    v_mfma_f32_16x16x32_bf16 a[56:59], a[120:123], a[92:95], a[56:59]
    v_mfma_f32_16x16x32_bf16 a[60:63], a[108:111], a[88:91], a[60:63]
    v_mfma_f32_16x16x32_bf16 a[60:63], a[124:127], a[92:95], a[60:63]
    s_waitcnt lgkmcnt(2)
    v_mfma_f32_16x16x32_bf16 v[0:3], a[128:131], a[64:67], v[0:3]
    ds_read_b64_tr_b16 a[208:209], v250 offset:4096
    v_mfma_f32_16x16x32_bf16 v[0:3], a[144:147], a[68:71], v[0:3]
    ds_read_b128 a[80:83], v231 offset:0
    buffer_load_dwordx4 v245, s[56:59], s90 offen offset:3072 sc1 lds
    v_mfma_f32_16x16x32_bf16 v[4:7], a[132:135], a[64:67], v[4:7]
    ds_read_b64_tr_b16 a[210:211], v250 offset:6144
    v_mfma_f32_16x16x32_bf16 v[4:7], a[148:151], a[68:71], v[4:7]
    ds_read_b128 a[84:87], v231 offset:8192
    v_mfma_f32_16x16x32_bf16 v[8:11], a[136:139], a[64:67], v[8:11]
    ds_read_b64_tr_b16 a[212:213], v251 offset:4096
    s_add_u32 s90, s84, 102400
    s_add_u32 m0, s85, 4096
    v_mfma_f32_16x16x32_bf16 v[8:11], a[152:155], a[68:71], v[8:11]
    buffer_load_dwordx4 v245, s[56:59], s90 offen offset:0 sc1 lds
    ds_read_b64_tr_b16 a[214:215], v251 offset:6144
    v_mfma_f32_16x16x32_bf16 v[12:15], a[140:143], a[64:67], v[12:15]
    ds_read_b64_tr_b16 a[216:217], v252 offset:4096
    v_mfma_f32_16x16x32_bf16 v[12:15], a[156:159], a[68:71], v[12:15]
    s_waitcnt lgkmcnt(7)
    ds_read_b64_tr_b16 a[218:219], v252 offset:6144
    v_mfma_f32_16x16x32_bf16 v[16:19], a[128:131], a[72:75], v[16:19]
    ds_read_b64_tr_b16 a[220:221], v253 offset:4096
    v_mfma_f32_16x16x32_bf16 v[16:19], a[144:147], a[76:79], v[16:19]
    ds_read_b128 a[88:91], v231 offset:1024
    buffer_load_dwordx4 v245, s[56:59], s90 offen offset:1024 sc1 lds
    v_mfma_f32_16x16x32_bf16 v[20:23], a[132:135], a[72:75], v[20:23]
    ds_read_b64_tr_b16 a[222:223], v253 offset:6144
    v_mfma_f32_16x16x32_bf16 v[20:23], a[148:151], a[76:79], v[20:23]
    ds_read_b128 a[92:95], v231 offset:9216
    v_add_u32 v231, 32768, v231
    v_mfma_f32_16x16x32_bf16 v[24:27], a[136:139], a[72:75], v[24:27]
    v_mfma_f32_16x16x32_bf16 v[24:27], a[152:155], a[76:79], v[24:27]
    buffer_load_dwordx4 v245, s[56:59], s90 offen offset:2048 sc1 lds
    v_mfma_f32_16x16x32_bf16 v[28:31], a[140:143], a[72:75], v[28:31]
    v_mfma_f32_16x16x32_bf16 v[28:31], a[156:159], a[76:79], v[28:31]
    s_waitcnt lgkmcnt(8)
    v_mfma_f32_16x16x32_bf16 v[32:35], a[128:131], a[80:83], v[32:35]
    v_mfma_f32_16x16x32_bf16 v[32:35], a[144:147], a[84:87], v[32:35]
    ds_read_b128 a[64:67], v232 offset:0
    buffer_load_dwordx4 v245, s[56:59], s90 offen offset:3072 sc1 lds
    v_mfma_f32_16x16x32_bf16 v[36:39], a[132:135], a[80:83], v[36:39]
    s_add_u32 s78, s77, 1376256
    s_add_u32 m0, s79, 4096
    v_mfma_f32_16x16x32_bf16 v[36:39], a[148:151], a[84:87], v[36:39]
    ds_read_b128 a[68:71], v232 offset:8192
    s_waitcnt lgkmcnt(3)
    buffer_load_dwordx4 v246, s[44:47], s78 offen offset:0 lds
    v_mfma_f32_16x16x32_bf16 v[40:43], a[136:139], a[80:83], v[40:43]
    v_mfma_f32_16x16x32_bf16 v[40:43], a[152:155], a[84:87], v[40:43]
    buffer_load_dwordx4 v247, s[44:47], s78 offen offset:1024 lds
    v_mfma_f32_16x16x32_bf16 v[44:47], a[140:143], a[80:83], v[44:47]
    v_mfma_f32_16x16x32_bf16 v[44:47], a[156:159], a[84:87], v[44:47]
    s_waitcnt lgkmcnt(2)
    buffer_load_dwordx4 v248, s[44:47], s78 offen offset:2048 lds
    v_mfma_f32_16x16x32_bf16 v[48:51], a[128:131], a[88:91], v[48:51]
    v_mfma_f32_16x16x32_bf16 v[48:51], a[144:147], a[92:95], v[48:51]
    ds_read_b128 a[72:75], v232 offset:1024
    buffer_load_dwordx4 v249, s[44:47], s78 offen offset:3072 lds
    v_mfma_f32_16x16x32_bf16 v[52:55], a[132:135], a[88:91], v[52:55]
    v_mfma_f32_16x16x32_bf16 v[52:55], a[148:151], a[92:95], v[52:55]
    ds_read_b128 a[76:79], v232 offset:9216
    v_add_u32 v232, 32768, v232
    v_mfma_f32_16x16x32_bf16 v[56:59], a[136:139], a[88:91], v[56:59]
    v_mfma_f32_16x16x32_bf16 v[56:59], a[152:155], a[92:95], v[56:59]
    v_mfma_f32_16x16x32_bf16 v[60:63], a[140:143], a[88:91], v[60:63]
    v_mfma_f32_16x16x32_bf16 v[60:63], a[156:159], a[92:95], v[60:63]
    s_waitcnt lgkmcnt(2)
    v_mfma_f32_16x16x32_bf16 a[0:3], a[128:131], a[64:67], a[0:3]
    v_mfma_f32_16x16x32_bf16 a[0:3], a[144:147], a[68:71], a[0:3]
    ds_read_b128 a[80:83], v233 offset:0
    v_mfma_f32_16x16x32_bf16 a[4:7], a[132:135], a[64:67], a[4:7]
    v_mfma_f32_16x16x32_bf16 a[4:7], a[148:151], a[68:71], a[4:7]
    ds_read_b128 a[84:87], v233 offset:8192
    v_mfma_f32_16x16x32_bf16 a[8:11], a[136:139], a[64:67], a[8:11]
    v_mfma_f32_16x16x32_bf16 a[8:11], a[152:155], a[68:71], a[8:11]
    ds_read_b128 a[88:91], v233 offset:1024
    v_mfma_f32_16x16x32_bf16 a[12:15], a[140:143], a[64:67], a[12:15]
    v_mfma_f32_16x16x32_bf16 a[12:15], a[156:159], a[68:71], a[12:15]
    s_waitcnt lgkmcnt(3)
    ds_read_b128 a[92:95], v233 offset:9216
    v_add_u32 v233, 32768, v233
    v_mfma_f32_16x16x32_bf16 a[16:19], a[128:131], a[72:75], a[16:19]
    v_mfma_f32_16x16x32_bf16 a[16:19], a[144:147], a[76:79], a[16:19]
    v_mfma_f32_16x16x32_bf16 a[20:23], a[132:135], a[72:75], a[20:23]
    v_mfma_f32_16x16x32_bf16 a[20:23], a[148:151], a[76:79], a[20:23]
    v_mfma_f32_16x16x32_bf16 a[24:27], a[136:139], a[72:75], a[24:27]
    v_mfma_f32_16x16x32_bf16 a[24:27], a[152:155], a[76:79], a[24:27]
    v_mfma_f32_16x16x32_bf16 a[28:31], a[140:143], a[72:75], a[28:31]
    v_mfma_f32_16x16x32_bf16 a[28:31], a[156:159], a[76:79], a[28:31]
    s_waitcnt vmcnt(17) lgkmcnt(0)
    v_mfma_f32_16x16x32_bf16 a[32:35], a[128:131], a[80:83], a[32:35]
    s_barrier
    v_mfma_f32_16x16x32_bf16 a[32:35], a[144:147], a[84:87], a[32:35]
    ds_read_b128 a[64:67], v230 offset:0
    v_mfma_f32_16x16x32_bf16 a[36:39], a[132:135], a[80:83], a[36:39]
    s_add_u32 m0, s85, 32768
    v_mfma_f32_16x16x32_bf16 a[36:39], a[148:151], a[84:87], a[36:39]
    ds_read_b128 a[68:71], v230 offset:8192
    s_add_u32 s90, s84, 114688
    v_mfma_f32_16x16x32_bf16 a[40:43], a[136:139], a[80:83], a[40:43]
    buffer_load_dwordx4 v245, s[56:59], s90 offen offset:0 sc1 lds
    v_mfma_f32_16x16x32_bf16 a[40:43], a[152:155], a[84:87], a[40:43]
    v_mfma_f32_16x16x32_bf16 a[44:47], a[140:143], a[80:83], a[44:47]
    v_mfma_f32_16x16x32_bf16 a[44:47], a[156:159], a[84:87], a[44:47]
    v_mfma_f32_16x16x32_bf16 a[48:51], a[128:131], a[88:91], a[48:51]
    buffer_load_dwordx4 v245, s[56:59], s90 offen offset:1024 sc1 lds
    v_mfma_f32_16x16x32_bf16 a[48:51], a[144:147], a[92:95], a[48:51]
    ds_read_b128 a[72:75], v230 offset:1024
    v_mfma_f32_16x16x32_bf16 a[52:55], a[132:135], a[88:91], a[52:55]
    v_mfma_f32_16x16x32_bf16 a[52:55], a[148:151], a[92:95], a[52:55]
    ds_read_b128 a[76:79], v230 offset:9216
    v_add_u32 v230, 4294901760, v230
    v_mfma_f32_16x16x32_bf16 a[56:59], a[136:139], a[88:91], a[56:59]
    buffer_load_dwordx4 v245, s[56:59], s90 offen offset:2048 sc1 lds
    v_mfma_f32_16x16x32_bf16 a[56:59], a[152:155], a[92:95], a[56:59]
    v_mfma_f32_16x16x32_bf16 a[60:63], a[140:143], a[88:91], a[60:63]
    v_mfma_f32_16x16x32_bf16 a[60:63], a[156:159], a[92:95], a[60:63]
    s_waitcnt lgkmcnt(2)
    v_mfma_f32_16x16x32_bf16 v[0:3], v[160:163], a[64:67], v[0:3]
    ds_read_b64_tr_b16 a[224:225], v250 offset:32768
    v_mfma_f32_16x16x32_bf16 v[0:3], v[176:179], a[68:71], v[0:3]
    ds_read_b128 a[80:83], v231 offset:0
    buffer_load_dwordx4 v245, s[56:59], s90 offen offset:3072 sc1 lds
    v_mfma_f32_16x16x32_bf16 v[4:7], v[164:167], a[64:67], v[4:7]
    ds_read_b64_tr_b16 a[226:227], v250 offset:34816
    v_mfma_f32_16x16x32_bf16 v[4:7], v[180:183], a[68:71], v[4:7]
    ds_read_b128 a[84:87], v231 offset:8192
    v_mfma_f32_16x16x32_bf16 v[8:11], v[168:171], a[64:67], v[8:11]
    ds_read_b64_tr_b16 a[228:229], v251 offset:32768
    s_add_u32 s90, s84, 118784
    s_add_u32 m0, s85, 36864
    v_mfma_f32_16x16x32_bf16 v[8:11], v[184:187], a[68:71], v[8:11]
    buffer_load_dwordx4 v245, s[56:59], s90 offen offset:0 sc1 lds
    ds_read_b64_tr_b16 a[230:231], v251 offset:34816
    v_mfma_f32_16x16x32_bf16 v[12:15], v[172:175], a[64:67], v[12:15]
    ds_read_b64_tr_b16 a[232:233], v252 offset:32768
    v_mfma_f32_16x16x32_bf16 v[12:15], v[188:191], a[68:71], v[12:15]
    s_waitcnt lgkmcnt(7)
    ds_read_b64_tr_b16 a[234:235], v252 offset:34816
    v_mfma_f32_16x16x32_bf16 v[16:19], v[160:163], a[72:75], v[16:19]
    ds_read_b64_tr_b16 a[236:237], v253 offset:32768
    v_mfma_f32_16x16x32_bf16 v[16:19], v[176:179], a[76:79], v[16:19]
    ds_read_b128 a[88:91], v231 offset:1024
    buffer_load_dwordx4 v245, s[56:59], s90 offen offset:1024 sc1 lds
    v_mfma_f32_16x16x32_bf16 v[20:23], v[164:167], a[72:75], v[20:23]
    ds_read_b64_tr_b16 a[238:239], v253 offset:34816
    v_mfma_f32_16x16x32_bf16 v[20:23], v[180:183], a[76:79], v[20:23]
    ds_read_b128 a[92:95], v231 offset:9216
    v_add_u32 v231, 4294901760, v231
    v_mfma_f32_16x16x32_bf16 v[24:27], v[168:171], a[72:75], v[24:27]
    ds_read_b64_tr_b16 a[240:241], v250 offset:36864
    v_mfma_f32_16x16x32_bf16 v[24:27], v[184:187], a[76:79], v[24:27]
    buffer_load_dwordx4 v245, s[56:59], s90 offen offset:2048 sc1 lds
    ds_read_b64_tr_b16 a[242:243], v250 offset:38912
    v_mfma_f32_16x16x32_bf16 v[28:31], v[172:175], a[72:75], v[28:31]
    ds_read_b64_tr_b16 a[244:245], v251 offset:36864
    v_mfma_f32_16x16x32_bf16 v[28:31], v[188:191], a[76:79], v[28:31]
    s_waitcnt lgkmcnt(11)
    ds_read_b64_tr_b16 a[246:247], v251 offset:38912
    v_mfma_f32_16x16x32_bf16 v[32:35], v[160:163], a[80:83], v[32:35]
    ds_read_b64_tr_b16 a[248:249], v252 offset:36864
    v_mfma_f32_16x16x32_bf16 v[32:35], v[176:179], a[84:87], v[32:35]
    ds_read_b128 a[64:67], v232 offset:0
    buffer_load_dwordx4 v245, s[56:59], s90 offen offset:3072 sc1 lds
    v_mfma_f32_16x16x32_bf16 v[36:39], v[164:167], a[80:83], v[36:39]
    ds_read_b64_tr_b16 a[250:251], v252 offset:38912
    s_add_u32 s91, s77, 1441792
    s_add_u32 m0, s79, 32768
    v_mfma_f32_16x16x32_bf16 v[36:39], v[180:183], a[84:87], v[36:39]
    ds_read_b128 a[68:71], v232 offset:8192
    s_waitcnt lgkmcnt(9)
    buffer_load_dwordx4 v246, s[44:47], s91 offen offset:0 lds
    v_mfma_f32_16x16x32_bf16 v[40:43], v[168:171], a[80:83], v[40:43]
    ds_read_b64_tr_b16 a[252:253], v253 offset:36864
    s_waitcnt vmcnt(21)
    v_mfma_f32_16x16x32_bf16 v[40:43], v[184:187], a[84:87], v[40:43]
    ds_read_b64_tr_b16 a[254:255], v253 offset:38912
    buffer_load_dwordx4 v247, s[44:47], s91 offen offset:1024 lds
    v_mfma_f32_16x16x32_bf16 v[44:47], v[172:175], a[80:83], v[44:47]
    v_mov_b32 v228, s86
    v_mfma_f32_16x16x32_bf16 v[44:47], v[188:191], a[84:87], v[44:47]
    s_waitcnt lgkmcnt(10)
    buffer_load_dwordx4 v248, s[44:47], s91 offen offset:2048 lds
    v_mfma_f32_16x16x32_bf16 v[48:51], v[160:163], a[88:91], v[48:51]
    v_mov_b32 v229, s87
    v_mfma_f32_16x16x32_bf16 v[48:51], v[176:179], a[92:95], v[48:51]
    ds_read_b128 a[72:75], v232 offset:1024
    buffer_load_dwordx4 v249, s[44:47], s91 offen offset:3072 lds
    v_mfma_f32_16x16x32_bf16 v[52:55], v[164:167], a[88:91], v[52:55]
    buffer_store_dwordx2 v[228:229], v254, s[60:63], 0 offen offset:384 sc1
    v_mfma_f32_16x16x32_bf16 v[52:55], v[180:183], a[92:95], v[52:55]
    ds_read_b128 a[76:79], v232 offset:9216
    v_add_u32 v232, 4294901760, v232
    v_mfma_f32_16x16x32_bf16 v[56:59], v[168:171], a[88:91], v[56:59]
    v_mfma_f32_16x16x32_bf16 v[56:59], v[184:187], a[92:95], v[56:59]
    s_add_u32 s78, s77, 1507328
    s_add_u32 m0, s79, 36864
    v_mfma_f32_16x16x32_bf16 v[60:63], v[172:175], a[88:91], v[60:63]
    s_waitcnt lgkmcnt(2)
    buffer_load_dwordx4 v246, s[44:47], s78 offen offset:0 lds
    v_mfma_f32_16x16x32_bf16 v[60:63], v[188:191], a[92:95], v[60:63]
    v_mfma_f32_16x16x32_bf16 a[0:3], v[160:163], a[64:67], a[0:3]
    buffer_load_dwordx4 v247, s[44:47], s78 offen offset:1024 lds
    v_mfma_f32_16x16x32_bf16 a[0:3], v[176:179], a[68:71], a[0:3]
    ds_read_b128 a[80:83], v233 offset:0
    v_mfma_f32_16x16x32_bf16 a[4:7], v[164:167], a[64:67], a[4:7]
    buffer_load_dwordx4 v248, s[44:47], s78 offen offset:2048 lds
    v_mfma_f32_16x16x32_bf16 a[4:7], v[180:183], a[68:71], a[4:7]
    ds_read_b128 a[84:87], v233 offset:8192
    v_mfma_f32_16x16x32_bf16 a[8:11], v[168:171], a[64:67], a[8:11]
    buffer_load_dwordx4 v249, s[44:47], s78 offen offset:3072 lds
    v_mfma_f32_16x16x32_bf16 a[8:11], v[184:187], a[68:71], a[8:11]
    ds_read_b128 a[88:91], v233 offset:1024
    v_mfma_f32_16x16x32_bf16 a[12:15], v[172:175], a[64:67], a[12:15]
    v_mfma_f32_16x16x32_bf16 a[12:15], v[188:191], a[68:71], a[12:15]
    s_waitcnt lgkmcnt(3)
    ds_read_b128 a[92:95], v233 offset:9216
    v_add_u32 v233, 4294901760, v233
    v_mfma_f32_16x16x32_bf16 a[16:19], v[160:163], a[72:75], a[16:19]
    v_mfma_f32_16x16x32_bf16 a[16:19], v[176:179], a[76:79], a[16:19]
    v_mfma_f32_16x16x32_bf16 a[20:23], v[164:167], a[72:75], a[20:23]
    v_mfma_f32_16x16x32_bf16 a[20:23], v[180:183], a[76:79], a[20:23]
    v_mfma_f32_16x16x32_bf16 a[24:27], v[168:171], a[72:75], a[24:27]
    v_mfma_f32_16x16x32_bf16 a[24:27], v[184:187], a[76:79], a[24:27]
    v_mfma_f32_16x16x32_bf16 a[28:31], v[172:175], a[72:75], a[28:31]
    v_mfma_f32_16x16x32_bf16 a[28:31], v[188:191], a[76:79], a[28:31]
    s_waitcnt vmcnt(21) lgkmcnt(0)
    v_mfma_f32_16x16x32_bf16 a[32:35], v[160:163], a[80:83], a[32:35]
    s_barrier
    v_mfma_f32_16x16x32_bf16 a[32:35], v[176:179], a[84:87], a[32:35]
    ds_read_b128 a[64:67], v230 offset:0
    v_mfma_f32_16x16x32_bf16 a[36:39], v[164:167], a[80:83], a[36:39]
    s_add_u32 m0, s85, 65536
    v_mfma_f32_16x16x32_bf16 a[36:39], v[180:183], a[84:87], a[36:39]
    ds_read_b128 a[68:71], v230 offset:8192
    s_add_u32 s90, s84, 131072
    v_mfma_f32_16x16x32_bf16 a[40:43], v[168:171], a[80:83], a[40:43]
    buffer_load_dwordx4 v245, s[56:59], s90 offen offset:0 sc1 lds
    v_mfma_f32_16x16x32_bf16 a[40:43], v[184:187], a[84:87], a[40:43]
    v_mfma_f32_16x16x32_bf16 a[44:47], v[172:175], a[80:83], a[44:47]
    v_mfma_f32_16x16x32_bf16 a[44:47], v[188:191], a[84:87], a[44:47]
    v_mfma_f32_16x16x32_bf16 a[48:51], v[160:163], a[88:91], a[48:51]
    buffer_load_dwordx4 v245, s[56:59], s90 offen offset:1024 sc1 lds
    v_mfma_f32_16x16x32_bf16 a[48:51], v[176:179], a[92:95], a[48:51]
    ds_read_b128 a[72:75], v230 offset:1024
    v_mfma_f32_16x16x32_bf16 a[52:55], v[164:167], a[88:91], a[52:55]
    v_mfma_f32_16x16x32_bf16 a[52:55], v[180:183], a[92:95], a[52:55]
    ds_read_b128 a[76:79], v230 offset:9216
    v_add_u32 v230, 32768, v230
    v_mfma_f32_16x16x32_bf16 a[56:59], v[168:171], a[88:91], a[56:59]
    buffer_load_dwordx4 v245, s[56:59], s90 offen offset:2048 sc1 lds
    v_mfma_f32_16x16x32_bf16 a[56:59], v[184:187], a[92:95], a[56:59]
    v_mfma_f32_16x16x32_bf16 a[60:63], v[172:175], a[88:91], a[60:63]
    v_mfma_f32_16x16x32_bf16 a[60:63], v[188:191], a[92:95], a[60:63]
    s_waitcnt lgkmcnt(2)
    v_mfma_f32_16x16x32_bf16 v[0:3], v[192:195], a[64:67], v[0:3]
    ds_read_b64_tr_b16 a[96:97], v250 offset:0
    v_mfma_f32_16x16x32_bf16 v[0:3], v[208:211], a[68:71], v[0:3]
    ds_read_b128 a[80:83], v231 offset:0
    buffer_load_dwordx4 v245, s[56:59], s90 offen offset:3072 sc1 lds
    v_mfma_f32_16x16x32_bf16 v[4:7], v[196:199], a[64:67], v[4:7]
    ds_read_b64_tr_b16 a[98:99], v250 offset:2048
    v_mfma_f32_16x16x32_bf16 v[4:7], v[212:215], a[68:71], v[4:7]
    ds_read_b128 a[84:87], v231 offset:8192
    v_mfma_f32_16x16x32_bf16 v[8:11], v[200:203], a[64:67], v[8:11]
    ds_read_b64_tr_b16 a[100:101], v251 offset:0
    s_add_u32 s90, s84, 135168
    s_add_u32 m0, s85, 69632
    v_mfma_f32_16x16x32_bf16 v[8:11], v[216:219], a[68:71], v[8:11]
    buffer_load_dwordx4 v245, s[56:59], s90 offen offset:0 sc1 lds
    ds_read_b64_tr_b16 a[102:103], v251 offset:2048
    v_mfma_f32_16x16x32_bf16 v[12:15], v[204:207], a[64:67], v[12:15]
    ds_read_b64_tr_b16 a[104:105], v252 offset:0
    v_mfma_f32_16x16x32_bf16 v[12:15], v[220:223], a[68:71], v[12:15]
    s_waitcnt lgkmcnt(7)
    ds_read_b64_tr_b16 a[106:107], v252 offset:2048
    v_mfma_f32_16x16x32_bf16 v[16:19], v[192:195], a[72:75], v[16:19]
    ds_read_b64_tr_b16 a[108:109], v253 offset:0
    v_mfma_f32_16x16x32_bf16 v[16:19], v[208:211], a[76:79], v[16:19]
    ds_read_b128 a[88:91], v231 offset:1024
    buffer_load_dwordx4 v245, s[56:59], s90 offen offset:1024 sc1 lds
    v_mfma_f32_16x16x32_bf16 v[20:23], v[196:199], a[72:75], v[20:23]
    ds_read_b64_tr_b16 a[110:111], v253 offset:2048
    s_lshl_b32 s92, s81, 16
    v_mfma_f32_16x16x32_bf16 v[20:23], v[212:215], a[76:79], v[20:23]
    ds_read_b128 a[92:95], v231 offset:9216
    v_add_u32 v231, 32768, v231
    v_mfma_f32_16x16x32_bf16 v[24:27], v[200:203], a[72:75], v[24:27]
    v_mfma_f32_16x16x32_bf16 v[24:27], v[216:219], a[76:79], v[24:27]
    buffer_load_dwordx4 v245, s[56:59], s90 offen offset:2048 sc1 lds
    v_mfma_f32_16x16x32_bf16 v[28:31], v[204:207], a[72:75], v[28:31]
    s_add_u32 s92, s92, 384
    v_mfma_f32_16x16x32_bf16 v[28:31], v[220:223], a[76:79], v[28:31]
    s_waitcnt lgkmcnt(8)
    v_mfma_f32_16x16x32_bf16 v[32:35], v[192:195], a[80:83], v[32:35]
    v_mfma_f32_16x16x32_bf16 v[32:35], v[208:211], a[84:87], v[32:35]
    ds_read_b128 a[64:67], v232 offset:0
    buffer_load_dwordx4 v245, s[56:59], s90 offen offset:3072 sc1 lds
    v_mfma_f32_16x16x32_bf16 v[36:39], v[196:199], a[80:83], v[36:39]
    v_lshlrev_b32 v224, 10, v244
    s_add_u32 s91, s77, 1572864
    s_mov_b32 m0, s79
    v_mfma_f32_16x16x32_bf16 v[36:39], v[212:215], a[84:87], v[36:39]
    ds_read_b128 a[68:71], v232 offset:8192
    s_waitcnt lgkmcnt(3)
    buffer_load_dwordx4 v246, s[44:47], s91 offen offset:0 lds
    v_mfma_f32_16x16x32_bf16 v[40:43], v[200:203], a[80:83], v[40:43]
    v_mfma_f32_16x16x32_bf16 v[40:43], v[216:219], a[84:87], v[40:43]
    buffer_load_dwordx4 v247, s[44:47], s91 offen offset:1024 lds
    v_mfma_f32_16x16x32_bf16 v[44:47], v[204:207], a[80:83], v[44:47]
    v_add_u32 v224, s92, v224
    v_mfma_f32_16x16x32_bf16 v[44:47], v[220:223], a[84:87], v[44:47]
    s_waitcnt lgkmcnt(2)
    buffer_load_dwordx4 v248, s[44:47], s91 offen offset:2048 lds
    v_mfma_f32_16x16x32_bf16 v[48:51], v[192:195], a[88:91], v[48:51]
    v_mfma_f32_16x16x32_bf16 v[48:51], v[208:211], a[92:95], v[48:51]
    ds_read_b128 a[72:75], v232 offset:1024
    buffer_load_dwordx4 v249, s[44:47], s91 offen offset:3072 lds
    v_mfma_f32_16x16x32_bf16 v[52:55], v[196:199], a[88:91], v[52:55]
    v_mfma_f32_16x16x32_bf16 v[52:55], v[212:215], a[92:95], v[52:55]
    ds_read_b128 a[76:79], v232 offset:9216
    v_add_u32 v232, 32768, v232
    v_mfma_f32_16x16x32_bf16 v[56:59], v[200:203], a[88:91], v[56:59]
    s_lshl2_add_u32 s93, s80, s82
    v_mfma_f32_16x16x32_bf16 v[56:59], v[216:219], a[92:95], v[56:59]
    v_mfma_f32_16x16x32_bf16 v[60:63], v[204:207], a[88:91], v[60:63]
    v_mfma_f32_16x16x32_bf16 v[60:63], v[220:223], a[92:95], v[60:63]
    s_waitcnt lgkmcnt(2)
    v_mfma_f32_16x16x32_bf16 a[0:3], v[192:195], a[64:67], a[0:3]
    s_lshl1_add_u32 s93, s93, 896
    v_mfma_f32_16x16x32_bf16 a[0:3], v[208:211], a[68:71], a[0:3]
    ds_read_b128 a[80:83], v233 offset:0
    v_mfma_f32_16x16x32_bf16 a[4:7], v[196:199], a[64:67], a[4:7]
    v_mfma_f32_16x16x32_bf16 a[4:7], v[212:215], a[68:71], a[4:7]
    ds_read_b128 a[84:87], v233 offset:8192
    v_mfma_f32_16x16x32_bf16 a[8:11], v[200:203], a[64:67], a[8:11]
    v_mfma_f32_16x16x32_bf16 a[8:11], v[216:219], a[68:71], a[8:11]
    ds_read_b128 a[88:91], v233 offset:1024
    s_lshl_b32 s93, s93, 10
    v_mfma_f32_16x16x32_bf16 a[12:15], v[204:207], a[64:67], a[12:15]
    v_mfma_f32_16x16x32_bf16 a[12:15], v[220:223], a[68:71], a[12:15]
    s_waitcnt lgkmcnt(3)
    ds_read_b128 a[92:95], v233 offset:9216
    v_add_u32 v233, 32768, v233
    v_mfma_f32_16x16x32_bf16 a[16:19], v[192:195], a[72:75], a[16:19]
    v_mfma_f32_16x16x32_bf16 a[16:19], v[208:211], a[76:79], a[16:19]
    s_add_u32 s93, s93, 640
    v_mfma_f32_16x16x32_bf16 a[20:23], v[196:199], a[72:75], a[20:23]
    v_mfma_f32_16x16x32_bf16 a[20:23], v[212:215], a[76:79], a[20:23]
    v_mfma_f32_16x16x32_bf16 a[24:27], v[200:203], a[72:75], a[24:27]
    v_mfma_f32_16x16x32_bf16 a[24:27], v[216:219], a[76:79], a[24:27]
    v_mfma_f32_16x16x32_bf16 a[28:31], v[204:207], a[72:75], a[28:31]
    v_and_b32 v225, 1, v244
    v_mfma_f32_16x16x32_bf16 a[28:31], v[220:223], a[76:79], a[28:31]
    s_waitcnt vmcnt(21) lgkmcnt(0)
    v_mfma_f32_16x16x32_bf16 a[32:35], v[192:195], a[80:83], a[32:35]
    s_barrier
    v_mfma_f32_16x16x32_bf16 a[32:35], v[208:211], a[84:87], a[32:35]
    ds_read_b128 a[64:67], v230 offset:0
    v_mfma_f32_16x16x32_bf16 a[36:39], v[196:199], a[80:83], a[36:39]
    v_lshlrev_b32 v225, 10, v225
    s_mov_b32 m0, s85
    v_mfma_f32_16x16x32_bf16 a[36:39], v[212:215], a[84:87], a[36:39]
    ds_read_b128 a[68:71], v230 offset:8192
    s_add_u32 s90, s84, 147456
    v_mfma_f32_16x16x32_bf16 a[40:43], v[200:203], a[80:83], a[40:43]
    buffer_load_dwordx4 v245, s[56:59], s90 offen offset:0 sc1 lds
    v_mfma_f32_16x16x32_bf16 a[40:43], v[216:219], a[84:87], a[40:43]
    v_mfma_f32_16x16x32_bf16 a[44:47], v[204:207], a[80:83], a[44:47]
    v_mfma_f32_16x16x32_bf16 a[44:47], v[220:223], a[84:87], a[44:47]
    v_add_u32 v225, s93, v225
    v_mfma_f32_16x16x32_bf16 a[48:51], v[192:195], a[88:91], a[48:51]
    buffer_load_dwordx4 v245, s[56:59], s90 offen offset:1024 sc1 lds
    v_mfma_f32_16x16x32_bf16 a[48:51], v[208:211], a[92:95], a[48:51]
    ds_read_b128 a[72:75], v230 offset:1024
    v_mfma_f32_16x16x32_bf16 a[52:55], v[196:199], a[88:91], a[52:55]
    v_mfma_f32_16x16x32_bf16 a[52:55], v[212:215], a[92:95], a[52:55]
    ds_read_b128 a[76:79], v230 offset:9216
    v_add_u32 v230, 32768, v230
    v_mfma_f32_16x16x32_bf16 a[56:59], v[200:203], a[88:91], a[56:59]
    buffer_load_dwordx4 v245, s[56:59], s90 offen offset:2048 sc1 lds
    v_mfma_f32_16x16x32_bf16 a[56:59], v[216:219], a[92:95], a[56:59]
    v_mfma_f32_16x16x32_bf16 a[60:63], v[204:207], a[88:91], a[60:63]
    v_mfma_f32_16x16x32_bf16 a[60:63], v[220:223], a[92:95], a[60:63]
    s_waitcnt lgkmcnt(2)
    buffer_load_dwordx2 v[226:227], v225, s[60:63], 0 offen sc1
    v_mfma_f32_16x16x32_bf16 v[0:3], a[160:163], a[64:67], v[0:3]
    ds_read_b64_tr_b16 a[112:113], v250 offset:4096
    v_mfma_f32_16x16x32_bf16 v[0:3], a[176:179], a[68:71], v[0:3]
    ds_read_b128 a[80:83], v231 offset:0
    buffer_load_dwordx4 v245, s[56:59], s90 offen offset:3072 sc1 lds
    v_mfma_f32_16x16x32_bf16 v[4:7], a[164:167], a[64:67], v[4:7]
    ds_read_b64_tr_b16 a[114:115], v250 offset:6144
    v_mfma_f32_16x16x32_bf16 v[4:7], a[180:183], a[68:71], v[4:7]
    ds_read_b128 a[84:87], v231 offset:8192
    v_mfma_f32_16x16x32_bf16 v[8:11], a[168:171], a[64:67], v[8:11]
    ds_read_b64_tr_b16 a[116:117], v251 offset:4096
    s_add_u32 s90, s84, 151552
    s_add_u32 m0, s85, 4096
    v_mfma_f32_16x16x32_bf16 v[8:11], a[184:187], a[68:71], v[8:11]
    buffer_load_dwordx4 v245, s[56:59], s90 offen offset:0 sc1 lds
    ds_read_b64_tr_b16 a[118:119], v251 offset:6144
    v_mfma_f32_16x16x32_bf16 v[12:15], a[172:175], a[64:67], v[12:15]
    ds_read_b64_tr_b16 a[120:121], v252 offset:4096
    v_mfma_f32_16x16x32_bf16 v[12:15], a[188:191], a[68:71], v[12:15]
    s_waitcnt lgkmcnt(7)
    ds_read_b64_tr_b16 a[122:123], v252 offset:6144
    v_mfma_f32_16x16x32_bf16 v[16:19], a[160:163], a[72:75], v[16:19]
    ds_read_b64_tr_b16 a[124:125], v253 offset:4096
    v_mfma_f32_16x16x32_bf16 v[16:19], a[176:179], a[76:79], v[16:19]
    ds_read_b128 a[88:91], v231 offset:1024
    buffer_load_dwordx4 v245, s[56:59], s90 offen offset:1024 sc1 lds
    v_mfma_f32_16x16x32_bf16 v[20:23], a[164:167], a[72:75], v[20:23]
    ds_read_b64_tr_b16 a[126:127], v253 offset:6144
    v_mfma_f32_16x16x32_bf16 v[20:23], a[180:183], a[76:79], v[20:23]
    ds_read_b128 a[92:95], v231 offset:9216
    v_add_u32 v231, 32768, v231
    v_mfma_f32_16x16x32_bf16 v[24:27], a[168:171], a[72:75], v[24:27]
    v_mfma_f32_16x16x32_bf16 v[24:27], a[184:187], a[76:79], v[24:27]
    buffer_load_dwordx4 v245, s[56:59], s90 offen offset:2048 sc1 lds
    v_mfma_f32_16x16x32_bf16 v[28:31], a[172:175], a[72:75], v[28:31]
    v_mfma_f32_16x16x32_bf16 v[28:31], a[188:191], a[76:79], v[28:31]
    s_waitcnt lgkmcnt(8)
    v_mfma_f32_16x16x32_bf16 v[32:35], a[160:163], a[80:83], v[32:35]
    v_mfma_f32_16x16x32_bf16 v[32:35], a[176:179], a[84:87], v[32:35]
    ds_read_b128 a[64:67], v232 offset:0
    buffer_load_dwordx4 v245, s[56:59], s90 offen offset:3072 sc1 lds
    v_mfma_f32_16x16x32_bf16 v[36:39], a[164:167], a[80:83], v[36:39]
    s_add_u32 s78, s77, 1638400
    s_add_u32 m0, s79, 4096
    v_mfma_f32_16x16x32_bf16 v[36:39], a[180:183], a[84:87], v[36:39]
    ds_read_b128 a[68:71], v232 offset:8192
    s_waitcnt lgkmcnt(3)
    buffer_load_dwordx4 v246, s[44:47], s78 offen offset:0 lds
    v_mfma_f32_16x16x32_bf16 v[40:43], a[168:171], a[80:83], v[40:43]
    v_mfma_f32_16x16x32_bf16 v[40:43], a[184:187], a[84:87], v[40:43]
    buffer_load_dwordx4 v247, s[44:47], s78 offen offset:1024 lds
    v_mfma_f32_16x16x32_bf16 v[44:47], a[172:175], a[80:83], v[44:47]
    v_mfma_f32_16x16x32_bf16 v[44:47], a[188:191], a[84:87], v[44:47]
    s_waitcnt lgkmcnt(2)
    buffer_load_dwordx4 v248, s[44:47], s78 offen offset:2048 lds
    v_mfma_f32_16x16x32_bf16 v[48:51], a[160:163], a[88:91], v[48:51]
    v_mfma_f32_16x16x32_bf16 v[48:51], a[176:179], a[92:95], v[48:51]
    ds_read_b128 a[72:75], v232 offset:1024
    buffer_load_dwordx4 v249, s[44:47], s78 offen offset:3072 lds
    v_mfma_f32_16x16x32_bf16 v[52:55], a[164:167], a[88:91], v[52:55]
    v_mfma_f32_16x16x32_bf16 v[52:55], a[180:183], a[92:95], v[52:55]
    ds_read_b128 a[76:79], v232 offset:9216
    v_add_u32 v232, 32768, v232
    v_mfma_f32_16x16x32_bf16 v[56:59], a[168:171], a[88:91], v[56:59]
    v_mfma_f32_16x16x32_bf16 v[56:59], a[184:187], a[92:95], v[56:59]
    v_mfma_f32_16x16x32_bf16 v[60:63], a[172:175], a[88:91], v[60:63]
    v_mfma_f32_16x16x32_bf16 v[60:63], a[188:191], a[92:95], v[60:63]
    s_waitcnt lgkmcnt(2)
    v_mfma_f32_16x16x32_bf16 a[0:3], a[160:163], a[64:67], a[0:3]
    v_mfma_f32_16x16x32_bf16 a[0:3], a[176:179], a[68:71], a[0:3]
    ds_read_b128 a[80:83], v233 offset:0
    v_mfma_f32_16x16x32_bf16 a[4:7], a[164:167], a[64:67], a[4:7]
    v_mfma_f32_16x16x32_bf16 a[4:7], a[180:183], a[68:71], a[4:7]
    ds_read_b128 a[84:87], v233 offset:8192
    v_mfma_f32_16x16x32_bf16 a[8:11], a[168:171], a[64:67], a[8:11]
    v_mfma_f32_16x16x32_bf16 a[8:11], a[184:187], a[68:71], a[8:11]
    ds_read_b128 a[88:91], v233 offset:1024
    v_mfma_f32_16x16x32_bf16 a[12:15], a[172:175], a[64:67], a[12:15]
    v_mfma_f32_16x16x32_bf16 a[12:15], a[188:191], a[68:71], a[12:15]
    s_waitcnt lgkmcnt(3)
    ds_read_b128 a[92:95], v233 offset:9216
    v_add_u32 v233, 32768, v233
    v_mfma_f32_16x16x32_bf16 a[16:19], a[160:163], a[72:75], a[16:19]
    v_mfma_f32_16x16x32_bf16 a[16:19], a[176:179], a[76:79], a[16:19]
    v_mfma_f32_16x16x32_bf16 a[20:23], a[164:167], a[72:75], a[20:23]
    v_mfma_f32_16x16x32_bf16 a[20:23], a[180:183], a[76:79], a[20:23]
    v_mfma_f32_16x16x32_bf16 a[24:27], a[168:171], a[72:75], a[24:27]
    v_mfma_f32_16x16x32_bf16 a[24:27], a[184:187], a[76:79], a[24:27]
    v_mfma_f32_16x16x32_bf16 a[28:31], a[172:175], a[72:75], a[28:31]
    v_mfma_f32_16x16x32_bf16 a[28:31], a[188:191], a[76:79], a[28:31]
    s_waitcnt vmcnt(17) lgkmcnt(0)
    v_mfma_f32_16x16x32_bf16 a[32:35], a[160:163], a[80:83], a[32:35]
    s_barrier
    v_mfma_f32_16x16x32_bf16 a[32:35], a[176:179], a[84:87], a[32:35]
    ds_read_b128 a[64:67], v230 offset:0
    v_mfma_f32_16x16x32_bf16 a[36:39], a[164:167], a[80:83], a[36:39]
    s_waitcnt vmcnt(9)
    v_cmp_eq_u64 vcc, s[86:87], v[226:227]
    s_nop 1
    s_cmp_eq_u64 vcc, -1
    s_cbranch_scc0 L_slow_g
L_ok_g:
    v_mfma_f32_16x16x32_bf16 a[36:39], a[180:183], a[84:87], a[36:39]
    ds_read_b128 a[68:71], v230 offset:8192
    s_add_u32 s90, s84, 163840
    v_mfma_f32_16x16x32_bf16 a[40:43], a[168:171], a[80:83], a[40:43]
    s_add_u32 m0, s85, 32768
    s_nop 0
    buffer_load_dwordx4 v245, s[56:59], s90 offen offset:0 sc1 lds
    v_mfma_f32_16x16x32_bf16 a[40:43], a[184:187], a[84:87], a[40:43]
    v_mfma_f32_16x16x32_bf16 a[44:47], a[172:175], a[80:83], a[44:47]
    v_mfma_f32_16x16x32_bf16 a[44:47], a[188:191], a[84:87], a[44:47]
    v_mfma_f32_16x16x32_bf16 a[48:51], a[160:163], a[88:91], a[48:51]
    buffer_load_dwordx4 v245, s[56:59], s90 offen offset:1024 sc1 lds
    v_mfma_f32_16x16x32_bf16 a[48:51], a[176:179], a[92:95], a[48:51]
    ds_read_b128 a[72:75], v230 offset:1024
    v_mfma_f32_16x16x32_bf16 a[52:55], a[164:167], a[88:91], a[52:55]
    v_mfma_f32_16x16x32_bf16 a[52:55], a[180:183], a[92:95], a[52:55]
    ds_read_b128 a[76:79], v230 offset:9216
    v_add_u32 v230, 4294901760, v230
    v_mfma_f32_16x16x32_bf16 a[56:59], a[168:171], a[88:91], a[56:59]
    buffer_load_dwordx4 v245, s[56:59], s90 offen offset:2048 sc1 lds
    v_mfma_f32_16x16x32_bf16 a[56:59], a[184:187], a[92:95], a[56:59]
    v_mfma_f32_16x16x32_bf16 a[60:63], a[172:175], a[88:91], a[60:63]
    v_mfma_f32_16x16x32_bf16 a[60:63], a[188:191], a[92:95], a[60:63]
    s_waitcnt lgkmcnt(2)
    v_mfma_f32_16x16x32_bf16 v[0:3], a[192:195], a[64:67], v[0:3]
    ds_read_b64_tr_b16 a[128:129], v250 offset:32768
    v_mfma_f32_16x16x32_bf16 v[0:3], a[208:211], a[68:71], v[0:3]
    ds_read_b128 a[80:83], v231 offset:0
    buffer_load_dwordx4 v245, s[56:59], s90 offen offset:3072 sc1 lds
    v_mfma_f32_16x16x32_bf16 v[4:7], a[196:199], a[64:67], v[4:7]
    ds_read_b64_tr_b16 a[130:131], v250 offset:34816
    v_mfma_f32_16x16x32_bf16 v[4:7], a[212:215], a[68:71], v[4:7]
    ds_read_b128 a[84:87], v231 offset:8192
    v_mfma_f32_16x16x32_bf16 v[8:11], a[200:203], a[64:67], v[8:11]
    ds_read_b64_tr_b16 a[132:133], v251 offset:32768
    s_add_u32 s90, s84, 167936
    s_add_u32 m0, s85, 36864
    v_mfma_f32_16x16x32_bf16 v[8:11], a[216:219], a[68:71], v[8:11]
    buffer_load_dwordx4 v245, s[56:59], s90 offen offset:0 sc1 lds
    ds_read_b64_tr_b16 a[134:135], v251 offset:34816
    v_mfma_f32_16x16x32_bf16 v[12:15], a[204:207], a[64:67], v[12:15]
    ds_read_b64_tr_b16 a[136:137], v252 offset:32768
    v_mfma_f32_16x16x32_bf16 v[12:15], a[220:223], a[68:71], v[12:15]
    s_waitcnt lgkmcnt(7)
    ds_read_b64_tr_b16 a[138:139], v252 offset:34816
    v_mfma_f32_16x16x32_bf16 v[16:19], a[192:195], a[72:75], v[16:19]
    ds_read_b64_tr_b16 a[140:141], v253 offset:32768
    v_mfma_f32_16x16x32_bf16 v[16:19], a[208:211], a[76:79], v[16:19]
    ds_read_b128 a[88:91], v231 offset:1024
    buffer_load_dwordx4 v245, s[56:59], s90 offen offset:1024 sc1 lds
    v_mfma_f32_16x16x32_bf16 v[20:23], a[196:199], a[72:75], v[20:23]
    ds_read_b64_tr_b16 a[142:143], v253 offset:34816
    v_mfma_f32_16x16x32_bf16 v[20:23], a[212:215], a[76:79], v[20:23]
    ds_read_b128 a[92:95], v231 offset:9216
    v_add_u32 v231, 4294901760, v231
    v_mfma_f32_16x16x32_bf16 v[24:27], a[200:203], a[72:75], v[24:27]
    ds_read_b64_tr_b16 a[144:145], v250 offset:36864
    v_mfma_f32_16x16x32_bf16 v[24:27], a[216:219], a[76:79], v[24:27]
    buffer_load_dwordx4 v245, s[56:59], s90 offen offset:2048 sc1 lds
    ds_read_b64_tr_b16 a[146:147], v250 offset:38912
    v_mfma_f32_16x16x32_bf16 v[28:31], a[204:207], a[72:75], v[28:31]
    ds_read_b64_tr_b16 a[148:149], v251 offset:36864
    v_mfma_f32_16x16x32_bf16 v[28:31], a[220:223], a[76:79], v[28:31]
    s_waitcnt lgkmcnt(11)
    ds_read_b64_tr_b16 a[150:151], v251 offset:38912
    v_mfma_f32_16x16x32_bf16 v[32:35], a[192:195], a[80:83], v[32:35]
    ds_read_b64_tr_b16 a[152:153], v252 offset:36864
    v_mfma_f32_16x16x32_bf16 v[32:35], a[208:211], a[84:87], v[32:35]
    ds_read_b128 a[64:67], v232 offset:0
    buffer_load_dwordx4 v245, s[56:59], s90 offen offset:3072 sc1 lds
    v_mfma_f32_16x16x32_bf16 v[36:39], a[196:199], a[80:83], v[36:39]
    ds_read_b64_tr_b16 a[154:155], v252 offset:38912
    s_add_u32 s91, s77, 1703936
    s_add_u32 m0, s79, 32768
    v_mfma_f32_16x16x32_bf16 v[36:39], a[212:215], a[84:87], v[36:39]
    ds_read_b128 a[68:71], v232 offset:8192
    s_waitcnt lgkmcnt(9)
    buffer_load_dwordx4 v246, s[44:47], s91 offen offset:0 lds
    v_mfma_f32_16x16x32_bf16 v[40:43], a[200:203], a[80:83], v[40:43]
    ds_read_b64_tr_b16 a[156:157], v253 offset:36864
    v_mfma_f32_16x16x32_bf16 v[40:43], a[216:219], a[84:87], v[40:43]
    ds_read_b64_tr_b16 a[158:159], v253 offset:38912
    buffer_load_dwordx4 v247, s[44:47], s91 offen offset:1024 lds
    v_mfma_f32_16x16x32_bf16 v[44:47], a[204:207], a[80:83], v[44:47]
    v_mfma_f32_16x16x32_bf16 v[44:47], a[220:223], a[84:87], v[44:47]
    s_waitcnt lgkmcnt(10)
    buffer_load_dwordx4 v248, s[44:47], s91 offen offset:2048 lds
    v_mfma_f32_16x16x32_bf16 v[48:51], a[192:195], a[88:91], v[48:51]
    v_mfma_f32_16x16x32_bf16 v[48:51], a[208:211], a[92:95], v[48:51]
    ds_read_b128 a[72:75], v232 offset:1024
    buffer_load_dwordx4 v249, s[44:47], s91 offen offset:3072 lds
    v_mfma_f32_16x16x32_bf16 v[52:55], a[196:199], a[88:91], v[52:55]
    v_mfma_f32_16x16x32_bf16 v[52:55], a[212:215], a[92:95], v[52:55]
    ds_read_b128 a[76:79], v232 offset:9216
    v_add_u32 v232, 4294901760, v232
    v_mfma_f32_16x16x32_bf16 v[56:59], a[200:203], a[88:91], v[56:59]
    v_mfma_f32_16x16x32_bf16 v[56:59], a[216:219], a[92:95], v[56:59]
    s_add_u32 s78, s77, 1769472
    s_add_u32 m0, s79, 36864
    v_mfma_f32_16x16x32_bf16 v[60:63], a[204:207], a[88:91], v[60:63]
    s_waitcnt lgkmcnt(2)
    buffer_load_dwordx4 v246, s[44:47], s78 offen offset:0 lds
    v_mfma_f32_16x16x32_bf16 v[60:63], a[220:223], a[92:95], v[60:63]
    v_mfma_f32_16x16x32_bf16 a[0:3], a[192:195], a[64:67], a[0:3]
    buffer_load_dwordx4 v247, s[44:47], s78 offen offset:1024 lds
    v_mfma_f32_16x16x32_bf16 a[0:3], a[208:211], a[68:71], a[0:3]
    ds_read_b128 a[80:83], v233 offset:0
    v_mfma_f32_16x16x32_bf16 a[4:7], a[196:199], a[64:67], a[4:7]
    buffer_load_dwordx4 v248, s[44:47], s78 offen offset:2048 lds
    v_mfma_f32_16x16x32_bf16 a[4:7], a[212:215], a[68:71], a[4:7]
    ds_read_b128 a[84:87], v233 offset:8192
    v_mfma_f32_16x16x32_bf16 a[8:11], a[200:203], a[64:67], a[8:11]
    buffer_load_dwordx4 v249, s[44:47], s78 offen offset:3072 lds
    v_mfma_f32_16x16x32_bf16 a[8:11], a[216:219], a[68:71], a[8:11]
    ds_read_b128 a[88:91], v233 offset:1024
    v_mfma_f32_16x16x32_bf16 a[12:15], a[204:207], a[64:67], a[12:15]
    v_mfma_f32_16x16x32_bf16 a[12:15], a[220:223], a[68:71], a[12:15]
    s_waitcnt lgkmcnt(3)
    ds_read_b128 a[92:95], v233 offset:9216
    v_add_u32 v233, 4294901760, v233
    v_mfma_f32_16x16x32_bf16 a[16:19], a[192:195], a[72:75], a[16:19]
    v_mfma_f32_16x16x32_bf16 a[16:19], a[208:211], a[76:79], a[16:19]
    v_mfma_f32_16x16x32_bf16 a[20:23], a[196:199], a[72:75], a[20:23]
    v_mfma_f32_16x16x32_bf16 a[20:23], a[212:215], a[76:79], a[20:23]
    v_mfma_f32_16x16x32_bf16 a[24:27], a[200:203], a[72:75], a[24:27]
    v_mfma_f32_16x16x32_bf16 a[24:27], a[216:219], a[76:79], a[24:27]
    v_mfma_f32_16x16x32_bf16 a[28:31], a[204:207], a[72:75], a[28:31]
    v_mfma_f32_16x16x32_bf16 a[28:31], a[220:223], a[76:79], a[28:31]
    s_waitcnt vmcnt(20) lgkmcnt(0)
    v_mfma_f32_16x16x32_bf16 a[32:35], a[192:195], a[80:83], a[32:35]
    s_barrier
    v_mfma_f32_16x16x32_bf16 a[32:35], a[208:211], a[84:87], a[32:35]
    ds_read_b128 a[64:67], v230 offset:0
    v_mfma_f32_16x16x32_bf16 a[36:39], a[196:199], a[80:83], a[36:39]
    buffer_load_dwordx2 v[226:227], v224, s[60:63], 0 offen sc1
    s_add_u32 m0, s85, 65536
    v_mfma_f32_16x16x32_bf16 a[36:39], a[212:215], a[84:87], a[36:39]
    ds_read_b128 a[68:71], v230 offset:8192
    s_add_u32 s90, s84, 180224
    v_mfma_f32_16x16x32_bf16 a[40:43], a[200:203], a[80:83], a[40:43]
    buffer_load_dwordx4 v245, s[56:59], s90 offen offset:0 sc1 lds
    v_mfma_f32_16x16x32_bf16 a[40:43], a[216:219], a[84:87], a[40:43]
    v_mfma_f32_16x16x32_bf16 a[44:47], a[204:207], a[80:83], a[44:47]
    v_mfma_f32_16x16x32_bf16 a[44:47], a[220:223], a[84:87], a[44:47]
    v_mfma_f32_16x16x32_bf16 a[48:51], a[192:195], a[88:91], a[48:51]
    buffer_load_dwordx4 v245, s[56:59], s90 offen offset:1024 sc1 lds
    v_mfma_f32_16x16x32_bf16 a[48:51], a[208:211], a[92:95], a[48:51]
    ds_read_b128 a[72:75], v230 offset:1024
    v_mfma_f32_16x16x32_bf16 a[52:55], a[196:199], a[88:91], a[52:55]
    v_mfma_f32_16x16x32_bf16 a[52:55], a[212:215], a[92:95], a[52:55]
    ds_read_b128 a[76:79], v230 offset:9216
    v_add_u32 v230, 32768, v230
    v_mfma_f32_16x16x32_bf16 a[56:59], a[200:203], a[88:91], a[56:59]
    buffer_load_dwordx4 v245, s[56:59], s90 offen offset:2048 sc1 lds
    v_mfma_f32_16x16x32_bf16 a[56:59], a[216:219], a[92:95], a[56:59]
    v_mfma_f32_16x16x32_bf16 a[60:63], a[204:207], a[88:91], a[60:63]
    v_mfma_f32_16x16x32_bf16 a[60:63], a[220:223], a[92:95], a[60:63]
    s_waitcnt lgkmcnt(2)
    v_mfma_f32_16x16x32_bf16 v[0:3], a[224:227], a[64:67], v[0:3]
    ds_read_b64_tr_b16 v[160:161], v250 offset:0
    v_mfma_f32_16x16x32_bf16 v[0:3], a[240:243], a[68:71], v[0:3]
    ds_read_b128 a[80:83], v231 offset:0
    buffer_load_dwordx4 v245, s[56:59], s90 offen offset:3072 sc1 lds
    v_mfma_f32_16x16x32_bf16 v[4:7], a[228:231], a[64:67], v[4:7]
    ds_read_b64_tr_b16 v[162:163], v250 offset:2048
    v_mfma_f32_16x16x32_bf16 v[4:7], a[244:247], a[68:71], v[4:7]
    ds_read_b128 a[84:87], v231 offset:8192
    v_mfma_f32_16x16x32_bf16 v[8:11], a[232:235], a[64:67], v[8:11]
    ds_read_b64_tr_b16 v[164:165], v251 offset:0
    s_add_u32 s90, s84, 184320
    s_add_u32 m0, s85, 69632
    v_mfma_f32_16x16x32_bf16 v[8:11], a[248:251], a[68:71], v[8:11]
    buffer_load_dwordx4 v245, s[56:59], s90 offen offset:0 sc1 lds
    ds_read_b64_tr_b16 v[166:167], v251 offset:2048
    v_mfma_f32_16x16x32_bf16 v[12:15], a[236:239], a[64:67], v[12:15]
    ds_read_b64_tr_b16 v[168:169], v252 offset:0
    v_mfma_f32_16x16x32_bf16 v[12:15], a[252:255], a[68:71], v[12:15]
    s_waitcnt lgkmcnt(7)
    ds_read_b64_tr_b16 v[170:171], v252 offset:2048
    v_mfma_f32_16x16x32_bf16 v[16:19], a[224:227], a[72:75], v[16:19]
    ds_read_b64_tr_b16 v[172:173], v253 offset:0
    v_mfma_f32_16x16x32_bf16 v[16:19], a[240:243], a[76:79], v[16:19]
    ds_read_b128 a[88:91], v231 offset:1024
    buffer_load_dwordx4 v245, s[56:59], s90 offen offset:1024 sc1 lds
    v_mfma_f32_16x16x32_bf16 v[20:23], a[228:231], a[72:75], v[20:23]
    ds_read_b64_tr_b16 v[174:175], v253 offset:2048
    v_mfma_f32_16x16x32_bf16 v[20:23], a[244:247], a[76:79], v[20:23]
    ds_read_b128 a[92:95], v231 offset:9216
    v_add_u32 v231, 32768, v231
    v_mfma_f32_16x16x32_bf16 v[24:27], a[232:235], a[72:75], v[24:27]
    v_mfma_f32_16x16x32_bf16 v[24:27], a[248:251], a[76:79], v[24:27]
    buffer_load_dwordx4 v245, s[56:59], s90 offen offset:2048 sc1 lds
    v_mfma_f32_16x16x32_bf16 v[28:31], a[236:239], a[72:75], v[28:31]
    v_mfma_f32_16x16x32_bf16 v[28:31], a[252:255], a[76:79], v[28:31]
    s_waitcnt lgkmcnt(8)
    v_mfma_f32_16x16x32_bf16 v[32:35], a[224:227], a[80:83], v[32:35]
    v_mfma_f32_16x16x32_bf16 v[32:35], a[240:243], a[84:87], v[32:35]
    ds_read_b128 a[64:67], v232 offset:0
    buffer_load_dwordx4 v245, s[56:59], s90 offen offset:3072 sc1 lds
    v_mfma_f32_16x16x32_bf16 v[36:39], a[228:231], a[80:83], v[36:39]
    v_mfma_f32_16x16x32_bf16 v[36:39], a[244:247], a[84:87], v[36:39]
    ds_read_b128 a[68:71], v232 offset:8192
    v_mfma_f32_16x16x32_bf16 v[40:43], a[232:235], a[80:83], v[40:43]
    v_mfma_f32_16x16x32_bf16 v[40:43], a[248:251], a[84:87], v[40:43]
    v_mfma_f32_16x16x32_bf16 v[44:47], a[236:239], a[80:83], v[44:47]
    v_mfma_f32_16x16x32_bf16 v[44:47], a[252:255], a[84:87], v[44:47]
    s_waitcnt lgkmcnt(2)
    v_mfma_f32_16x16x32_bf16 v[48:51], a[224:227], a[88:91], v[48:51]
    v_mfma_f32_16x16x32_bf16 v[48:51], a[240:243], a[92:95], v[48:51]
    ds_read_b128 a[72:75], v232 offset:1024
    v_mfma_f32_16x16x32_bf16 v[52:55], a[228:231], a[88:91], v[52:55]
    v_mfma_f32_16x16x32_bf16 v[52:55], a[244:247], a[92:95], v[52:55]
    ds_read_b128 a[76:79], v232 offset:9216
    v_add_u32 v232, 32768, v232
    v_mfma_f32_16x16x32_bf16 v[56:59], a[232:235], a[88:91], v[56:59]
    v_mfma_f32_16x16x32_bf16 v[56:59], a[248:251], a[92:95], v[56:59]
    v_mfma_f32_16x16x32_bf16 v[60:63], a[236:239], a[88:91], v[60:63]
    v_mfma_f32_16x16x32_bf16 v[60:63], a[252:255], a[92:95], v[60:63]
    s_waitcnt lgkmcnt(2)
    v_mfma_f32_16x16x32_bf16 a[0:3], a[224:227], a[64:67], a[0:3]
    v_mfma_f32_16x16x32_bf16 a[0:3], a[240:243], a[68:71], a[0:3]
    ds_read_b128 a[80:83], v233 offset:0
    v_mfma_f32_16x16x32_bf16 a[4:7], a[228:231], a[64:67], a[4:7]
    v_mfma_f32_16x16x32_bf16 a[4:7], a[244:247], a[68:71], a[4:7]
    ds_read_b128 a[84:87], v233 offset:8192
    v_mfma_f32_16x16x32_bf16 a[8:11], a[232:235], a[64:67], a[8:11]
    v_mfma_f32_16x16x32_bf16 a[8:11], a[248:251], a[68:71], a[8:11]
    ds_read_b128 a[88:91], v233 offset:1024
    v_mfma_f32_16x16x32_bf16 a[12:15], a[236:239], a[64:67], a[12:15]
    v_mfma_f32_16x16x32_bf16 a[12:15], a[252:255], a[68:71], a[12:15]
    s_waitcnt lgkmcnt(3)
    ds_read_b128 a[92:95], v233 offset:9216
    v_add_u32 v233, 32768, v233
    v_mfma_f32_16x16x32_bf16 a[16:19], a[224:227], a[72:75], a[16:19]
    v_mfma_f32_16x16x32_bf16 a[16:19], a[240:243], a[76:79], a[16:19]
    v_mfma_f32_16x16x32_bf16 a[20:23], a[228:231], a[72:75], a[20:23]
    v_mfma_f32_16x16x32_bf16 a[20:23], a[244:247], a[76:79], a[20:23]
    v_mfma_f32_16x16x32_bf16 a[24:27], a[232:235], a[72:75], a[24:27]
    v_mfma_f32_16x16x32_bf16 a[24:27], a[248:251], a[76:79], a[24:27]
    v_mfma_f32_16x16x32_bf16 a[28:31], a[236:239], a[72:75], a[28:31]
    v_mfma_f32_16x16x32_bf16 a[28:31], a[252:255], a[76:79], a[28:31]
    s_waitcnt vmcnt(17) lgkmcnt(0)
    v_mfma_f32_16x16x32_bf16 a[32:35], a[224:227], a[80:83], a[32:35]
    s_barrier
    v_mfma_f32_16x16x32_bf16 a[32:35], a[240:243], a[84:87], a[32:35]
    ds_read_b128 a[64:67], v230 offset:0
    v_mfma_f32_16x16x32_bf16 a[36:39], a[228:231], a[80:83], a[36:39]
    s_waitcnt vmcnt(8)
    v_cmp_eq_u64 vcc, s[86:87], v[226:227]
    s_nop 1
    s_cmp_eq_u64 vcc, -1
    s_cbranch_scc0 L_slow_y2
L_ok_y2:
    v_mfma_f32_16x16x32_bf16 a[36:39], a[244:247], a[84:87], a[36:39]
    ds_read_b128 a[68:71], v230 offset:8192
    s_add_u32 s90, s84, 196608
    v_mfma_f32_16x16x32_bf16 a[40:43], a[232:235], a[80:83], a[40:43]
    s_mov_b32 m0, s85
    s_nop 0
    buffer_load_dwordx4 v245, s[56:59], s90 offen offset:0 sc1 lds
    v_mfma_f32_16x16x32_bf16 a[40:43], a[248:251], a[84:87], a[40:43]
    buffer_load_dwordx4 v245, s[56:59], s90 offen offset:1024 sc1 lds
    v_mfma_f32_16x16x32_bf16 a[44:47], a[236:239], a[80:83], a[44:47]
    v_mfma_f32_16x16x32_bf16 a[44:47], a[252:255], a[84:87], a[44:47]
    buffer_load_dwordx4 v245, s[56:59], s90 offen offset:2048 sc1 lds
    v_mfma_f32_16x16x32_bf16 a[48:51], a[224:227], a[88:91], a[48:51]
    buffer_load_dwordx4 v245, s[56:59], s90 offen offset:3072 sc1 lds
    s_add_u32 m0, s85, 4096
    v_mfma_f32_16x16x32_bf16 a[48:51], a[240:243], a[92:95], a[48:51]
    ds_read_b128 a[72:75], v230 offset:1024
    s_add_u32 s90, s84, 200704
    v_mfma_f32_16x16x32_bf16 a[52:55], a[228:231], a[88:91], a[52:55]
    buffer_load_dwordx4 v245, s[56:59], s90 offen offset:0 sc1 lds
    v_mfma_f32_16x16x32_bf16 a[52:55], a[244:247], a[92:95], a[52:55]
    ds_read_b128 a[76:79], v230 offset:9216
    v_add_u32 v230, 32768, v230
    buffer_load_dwordx4 v245, s[56:59], s90 offen offset:1024 sc1 lds
    v_mfma_f32_16x16x32_bf16 a[56:59], a[232:235], a[88:91], a[56:59]
    v_mfma_f32_16x16x32_bf16 a[56:59], a[248:251], a[92:95], a[56:59]
    buffer_load_dwordx4 v245, s[56:59], s90 offen offset:2048 sc1 lds
    v_mfma_f32_16x16x32_bf16 a[60:63], a[236:239], a[88:91], a[60:63]
    buffer_load_dwordx4 v245, s[56:59], s90 offen offset:3072 sc1 lds
    v_mfma_f32_16x16x32_bf16 a[60:63], a[252:255], a[92:95], a[60:63]
    s_waitcnt lgkmcnt(2)
    s_mov_b32 s51, 0x20000
    v_mfma_f32_16x16x32_bf16 v[0:3], a[96:99], a[64:67], v[0:3]
    ds_read_b64_tr_b16 v[176:177], v250 offset:4096
    s_mov_b32 s36, s24
    v_mfma_f32_16x16x32_bf16 v[0:3], a[112:115], a[68:71], v[0:3]
    ds_read_b128 a[80:83], v231 offset:0
    s_and_b32 s37, s25, 0xffff
    v_mfma_f32_16x16x32_bf16 v[4:7], a[100:103], a[64:67], v[4:7]
    ds_read_b64_tr_b16 v[178:179], v250 offset:6144
    s_mov_b32 s38, 4194304
    v_mfma_f32_16x16x32_bf16 v[4:7], a[116:119], a[68:71], v[4:7]
    ds_read_b128 a[84:87], v231 offset:8192
    s_mov_b32 s39, 0x20000
    v_mfma_f32_16x16x32_bf16 v[8:11], a[104:107], a[64:67], v[8:11]
    ds_read_b64_tr_b16 v[180:181], v251 offset:4096
    s_mov_b32 s50, 16384
    v_mfma_f32_16x16x32_bf16 v[8:11], a[120:123], a[68:71], v[8:11]
    ds_read_b64_tr_b16 v[182:183], v251 offset:6144
    s_add_u32 s48, s28, 20971520
    s_addc_u32 s49, s29, 0
    s_and_b32 s49, s49, 0xffff
    v_mfma_f32_16x16x32_bf16 v[12:15], a[108:111], a[64:67], v[12:15]
    ds_read_b64_tr_b16 v[184:185], v252 offset:4096
    v_and_b32 v134, 15, v244
    v_mfma_f32_16x16x32_bf16 v[12:15], a[124:127], a[68:71], v[12:15]
    s_waitcnt lgkmcnt(7)
    ds_read_b64_tr_b16 v[186:187], v252 offset:6144
    v_mfma_f32_16x16x32_bf16 v[16:19], a[96:99], a[72:75], v[16:19]
    ds_read_b64_tr_b16 v[188:189], v253 offset:4096
    v_bfe_u32 v133, v244, 4, 1
    v_mfma_f32_16x16x32_bf16 v[16:19], a[112:115], a[76:79], v[16:19]
    ds_read_b128 a[88:91], v231 offset:1024
    v_lshrrev_b32 v135, 5, v244
    v_mfma_f32_16x16x32_bf16 v[20:23], a[100:103], a[72:75], v[20:23]
    ds_read_b64_tr_b16 v[190:191], v253 offset:6144
    v_lshl_add_u32 v135, v133, 1, v135
    v_mfma_f32_16x16x32_bf16 v[20:23], a[116:119], a[76:79], v[20:23]
    ds_read_b128 a[92:95], v231 offset:9216
    v_add_u32 v231, 32768, v231
    v_mfma_f32_16x16x32_bf16 v[24:27], a[104:107], a[72:75], v[24:27]
    ds_read_b64_tr_b16 v[192:193], v250 offset:32768
    v_lshlrev_b32 v132, 11, v134
    v_mfma_f32_16x16x32_bf16 v[24:27], a[120:123], a[76:79], v[24:27]
    ds_read_b64_tr_b16 v[194:195], v250 offset:34816
    v_lshl_add_u32 v132, v135, 4, v132
    v_mfma_f32_16x16x32_bf16 v[28:31], a[108:111], a[72:75], v[28:31]
    ds_read_b64_tr_b16 v[196:197], v251 offset:32768
    v_lshlrev_b32 v134, 3, v134
    v_mfma_f32_16x16x32_bf16 v[28:31], a[124:127], a[76:79], v[28:31]
    s_waitcnt lgkmcnt(11)
    ds_read_b64_tr_b16 v[198:199], v251 offset:34816
    v_mfma_f32_16x16x32_bf16 v[32:35], a[96:99], a[80:83], v[32:35]
    ds_read_b64_tr_b16 v[200:201], v252 offset:32768
    v_bfe_u32 v133, v244, 2, 2
    v_mfma_f32_16x16x32_bf16 v[32:35], a[112:115], a[84:87], v[32:35]
    ds_read_b128 a[64:67], v232 offset:0
    v_lshl_add_u32 v135, v135, 3, v133
    v_mfma_f32_16x16x32_bf16 v[36:39], a[100:103], a[80:83], v[36:39]
    ds_read_b64_tr_b16 v[202:203], v252 offset:34816
    v_and_b32 v133, 3, v244
    v_mfma_f32_16x16x32_bf16 v[36:39], a[116:119], a[84:87], v[36:39]
    ds_read_b128 a[68:71], v232 offset:8192
    v_lshlrev_b32 v138, 3, v133
    v_mfma_f32_16x16x32_bf16 v[40:43], a[104:107], a[80:83], v[40:43]
    ds_read_b64_tr_b16 v[204:205], v253 offset:32768
    v_lshl_add_u32 v135, v135, 6, v138
    v_mfma_f32_16x16x32_bf16 v[40:43], a[120:123], a[84:87], v[40:43]
    ds_read_b64_tr_b16 v[206:207], v253 offset:34816
    v_add_u32 v135, s79, v135
    v_mfma_f32_16x16x32_bf16 v[44:47], a[108:111], a[80:83], v[44:47]
    v_mfma_f32_16x16x32_bf16 v[44:47], a[124:127], a[84:87], v[44:47]
    s_waitcnt lgkmcnt(10)
    v_lshrrev_b32 v138, 2, v244
    v_mfma_f32_16x16x32_bf16 v[48:51], a[96:99], a[88:91], v[48:51]
    v_lshlrev_b32 v138, 12, v138
    v_mfma_f32_16x16x32_bf16 v[48:51], a[112:115], a[92:95], v[48:51]
    ds_read_b128 a[72:75], v232 offset:1024
    v_lshl_add_u32 v133, v133, 4, v138
    v_mfma_f32_16x16x32_bf16 v[52:55], a[100:103], a[88:91], v[52:55]
    s_lshl2_add_u32 s92, s80, s82
    v_mfma_f32_16x16x32_bf16 v[52:55], a[116:119], a[92:95], v[52:55]
    ds_read_b128 a[76:79], v232 offset:9216
    v_add_u32 v232, 32768, v232
    v_mfma_f32_16x16x32_bf16 v[56:59], a[104:107], a[88:91], v[56:59]
    s_lshl_b32 s93, s92, 6
    v_mfma_f32_16x16x32_bf16 v[56:59], a[120:123], a[92:95], v[56:59]
    s_lshl_b32 s94, s81, 18
    v_mfma_f32_16x16x32_bf16 v[60:63], a[108:111], a[88:91], v[60:63]
    s_add_u32 s94, s94, s93
    s_mov_b32 s42, 8388608
    s_mov_b32 s43, 0x20000
    v_mfma_f32_16x16x32_bf16 v[60:63], a[124:127], a[92:95], v[60:63]
    s_waitcnt lgkmcnt(4)
    s_lshl_b32 s93, s92, 8
    v_mfma_f32_16x16x32_bf16 a[0:3], a[96:99], a[64:67], a[0:3]
    s_add_u32 s40, s28, 41943040
    s_addc_u32 s41, s29, 0
    s_and_b32 s41, s41, 0xffff
    v_mfma_f32_16x16x32_bf16 a[0:3], a[112:115], a[68:71], a[0:3]
    ds_read_b128 a[80:83], v233 offset:0
    v_mfma_f32_16x16x32_bf16 a[4:7], a[100:103], a[64:67], a[4:7]
    s_lshl2_add_u32 s73, s2, s30
    v_mfma_f32_16x16x32_bf16 a[4:7], a[116:119], a[68:71], a[4:7]
    ds_read_b128 a[84:87], v233 offset:8192
    s_xor_b32 s74, s73, 4
    v_mfma_f32_16x16x32_bf16 a[8:11], a[104:107], a[64:67], a[8:11]
    v_mfma_f32_16x16x32_bf16 a[8:11], a[120:123], a[68:71], a[8:11]
    ds_read_b128 a[88:91], v233 offset:1024
    s_lshl_b32 s75, s74, 10
    v_mfma_f32_16x16x32_bf16 a[12:15], a[108:111], a[64:67], a[12:15]
    s_add_u32 s75, s75, 512
    v_mov_b32 v224, s75
    v_mfma_f32_16x16x32_bf16 a[12:15], a[124:127], a[68:71], a[12:15]
    s_waitcnt lgkmcnt(3)
    ds_read_b128 a[92:95], v233 offset:9216
    v_add_u32 v233, 32768, v233
    v_mfma_f32_16x16x32_bf16 a[16:19], a[96:99], a[72:75], a[16:19]
    s_lshl_b32 s73, s73, 13
    v_mfma_f32_16x16x32_bf16 a[16:19], a[112:115], a[76:79], a[16:19]
    v_mfma_f32_16x16x32_bf16 a[20:23], a[100:103], a[72:75], a[20:23]
    s_lshl_b32 s74, s74, 13
    v_mfma_f32_16x16x32_bf16 a[20:23], a[116:119], a[76:79], a[20:23]
    v_add_u32 v225, s79, v245
    v_mfma_f32_16x16x32_bf16 a[24:27], a[104:107], a[72:75], a[24:27]
    v_xor_b32 v229, 8192, v225
    v_mfma_f32_16x16x32_bf16 a[24:27], a[120:123], a[76:79], a[24:27]
    v_mfma_f32_16x16x32_bf16 a[28:31], a[108:111], a[72:75], a[28:31]
    v_mfma_f32_16x16x32_bf16 a[28:31], a[124:127], a[76:79], a[28:31]
    s_waitcnt vmcnt(0) lgkmcnt(0)
    v_mfma_f32_16x16x32_bf16 a[32:35], a[96:99], a[80:83], a[32:35]
    s_barrier
    v_mfma_f32_16x16x32_bf16 a[32:35], a[112:115], a[84:87], a[32:35]
    ds_read_b128 a[64:67], v231 offset:0
    v_mfma_f32_16x16x32_bf16 a[36:39], a[100:103], a[80:83], a[36:39]
    s_add_u32 m0, s85, 32768
    v_mfma_f32_16x16x32_bf16 a[36:39], a[116:119], a[84:87], a[36:39]
    ds_read_b128 a[68:71], v231 offset:8192
    s_add_u32 s90, s84, 212992
    v_mfma_f32_16x16x32_bf16 a[40:43], a[104:107], a[80:83], a[40:43]
    buffer_load_dwordx4 v245, s[56:59], s90 offen offset:0 sc1 lds
    v_mfma_f32_16x16x32_bf16 a[40:43], a[120:123], a[84:87], a[40:43]
    buffer_load_dwordx4 v245, s[56:59], s90 offen offset:1024 sc1 lds
    v_mfma_f32_16x16x32_bf16 a[44:47], a[108:111], a[80:83], a[44:47]
    v_mfma_f32_16x16x32_bf16 a[44:47], a[124:127], a[84:87], a[44:47]
    buffer_load_dwordx4 v245, s[56:59], s90 offen offset:2048 sc1 lds
    v_mfma_f32_16x16x32_bf16 a[48:51], a[96:99], a[88:91], a[48:51]
    buffer_load_dwordx4 v245, s[56:59], s90 offen offset:3072 sc1 lds
    s_add_u32 m0, s85, 36864
    v_mfma_f32_16x16x32_bf16 a[48:51], a[112:115], a[92:95], a[48:51]
    ds_read_b128 a[72:75], v231 offset:1024
    s_add_u32 s90, s84, 217088
    v_mfma_f32_16x16x32_bf16 a[52:55], a[100:103], a[88:91], a[52:55]
    buffer_load_dwordx4 v245, s[56:59], s90 offen offset:0 sc1 lds
    v_mfma_f32_16x16x32_bf16 a[52:55], a[116:119], a[92:95], a[52:55]
    ds_read_b128 a[76:79], v231 offset:9216
    v_add_u32 v231, 4294901760, v231
    buffer_load_dwordx4 v245, s[56:59], s90 offen offset:1024 sc1 lds
    v_mfma_f32_16x16x32_bf16 a[56:59], a[104:107], a[88:91], a[56:59]
    v_mfma_f32_16x16x32_bf16 a[56:59], a[120:123], a[92:95], a[56:59]
    buffer_load_dwordx4 v245, s[56:59], s90 offen offset:2048 sc1 lds
    v_mfma_f32_16x16x32_bf16 a[60:63], a[108:111], a[88:91], a[60:63]
    buffer_load_dwordx4 v245, s[56:59], s90 offen offset:3072 sc1 lds
    v_mfma_f32_16x16x32_bf16 a[60:63], a[124:127], a[92:95], a[60:63]
    s_waitcnt lgkmcnt(2)
    s_mov_b32 m0, s79
    v_mfma_f32_16x16x32_bf16 v[32:35], a[128:131], a[64:67], v[32:35]
    ds_read_b64_tr_b16 v[208:209], v250 offset:36864
    buffer_load_dwordx4 v133, s[52:55], s94 offen offset:0 sc1 lds
    s_add_u32 s94, s94, 64512
    v_mfma_f32_16x16x32_bf16 v[32:35], a[144:147], a[68:71], v[32:35]
    ds_read_b128 a[80:83], v233 offset:0
    v_mfma_f32_16x16x32_bf16 v[36:39], a[132:135], a[64:67], v[36:39]
    ds_read_b64_tr_b16 v[210:211], v250 offset:38912
    buffer_load_dwordx4 v133, s[52:55], s94 offen offset:1024 sc1 lds
    s_add_u32 s94, s94, 64512
    v_mfma_f32_16x16x32_bf16 v[36:39], a[148:151], a[68:71], v[36:39]
    ds_read_b128 a[84:87], v233 offset:8192
    v_mfma_f32_16x16x32_bf16 v[40:43], a[136:139], a[64:67], v[40:43]
    ds_read_b64_tr_b16 v[212:213], v251 offset:36864
    v_mfma_f32_16x16x32_bf16 v[40:43], a[152:155], a[68:71], v[40:43]
    ds_read_b64_tr_b16 v[214:215], v251 offset:38912
    buffer_load_dwordx4 v133, s[52:55], s94 offen offset:2048 sc1 lds
    s_add_u32 s94, s94, 64512
    v_mfma_f32_16x16x32_bf16 v[44:47], a[140:143], a[64:67], v[44:47]
    ds_read_b64_tr_b16 v[216:217], v252 offset:36864
    buffer_load_dwordx4 v133, s[52:55], s94 offen offset:3072 sc1 lds
    v_mfma_f32_16x16x32_bf16 v[44:47], a[156:159], a[68:71], v[44:47]
    s_waitcnt lgkmcnt(7)
    ds_read_b64_tr_b16 v[218:219], v252 offset:38912
    v_mfma_f32_16x16x32_bf16 v[48:51], a[128:131], a[72:75], v[48:51]
    ds_read_b64_tr_b16 v[220:221], v253 offset:36864
    v_mfma_f32_16x16x32_bf16 v[48:51], a[144:147], a[76:79], v[48:51]
    ds_read_b128 a[88:91], v233 offset:1024
    v_mfma_f32_16x16x32_bf16 v[52:55], a[132:135], a[72:75], v[52:55]
    ds_read_b64_tr_b16 v[222:223], v253 offset:38912
    buffer_load_dwordx2 v[128:129], v134, s[48:51], s93 offen sc1
    v_mfma_f32_16x16x32_bf16 v[52:55], a[148:151], a[76:79], v[52:55]
    ds_read_b128 a[92:95], v233 offset:9216
    v_add_u32 v233, 4294901760, v233
    v_mfma_f32_16x16x32_bf16 v[56:59], a[136:139], a[72:75], v[56:59]
    buffer_load_dwordx2 v[130:131], v134, s[48:51], s93 offen offset:128 sc1
    v_mfma_f32_16x16x32_bf16 v[56:59], a[152:155], a[76:79], v[56:59]
    v_mfma_f32_16x16x32_bf16 v[60:63], a[140:143], a[72:75], v[60:63]
    v_mfma_f32_16x16x32_bf16 v[60:63], a[156:159], a[76:79], v[60:63]
    s_waitcnt lgkmcnt(8)
    s_lshl_b32 s92, s92, 16
    v_mfma_f32_16x16x32_bf16 a[32:35], a[128:131], a[80:83], a[32:35]
    v_mfma_f32_16x16x32_bf16 a[32:35], a[144:147], a[84:87], a[32:35]
    ds_read_b128 a[64:67], v231 offset:0
    v_mfma_f32_16x16x32_bf16 a[36:39], a[132:135], a[80:83], a[36:39]
    s_lshl_b32 s94, s81, 7
    v_mfma_f32_16x16x32_bf16 a[36:39], a[148:151], a[84:87], a[36:39]
    ds_read_b128 a[68:71], v231 offset:8192
    v_mfma_f32_16x16x32_bf16 a[40:43], a[136:139], a[80:83], a[40:43]
    s_add_u32 s92, s92, s94
    v_mfma_f32_16x16x32_bf16 a[40:43], a[152:155], a[84:87], a[40:43]
    v_mfma_f32_16x16x32_bf16 a[44:47], a[140:143], a[80:83], a[44:47]
    v_mfma_f32_16x16x32_bf16 a[44:47], a[156:159], a[84:87], a[44:47]
    s_waitcnt lgkmcnt(2)
    s_add_u32 s93, s92, 32768
    v_mfma_f32_16x16x32_bf16 a[48:51], a[128:131], a[88:91], a[48:51]
    v_mfma_f32_16x16x32_bf16 a[48:51], a[144:147], a[92:95], a[48:51]
    ds_read_b128 a[72:75], v231 offset:1024
    buffer_load_dwordx4 v[96:99], v132, s[32:35], s92 offen offset:0
    v_mfma_f32_16x16x32_bf16 a[52:55], a[132:135], a[88:91], a[52:55]
    v_mfma_f32_16x16x32_bf16 a[52:55], a[148:151], a[92:95], a[52:55]
    ds_read_b128 a[76:79], v231 offset:9216
    v_add_u32 v231, 32768, v231
    v_mfma_f32_16x16x32_bf16 a[56:59], a[136:139], a[88:91], a[56:59]
    buffer_load_dwordx4 v[100:103], v132, s[32:35], s92 offen offset:64
    v_mfma_f32_16x16x32_bf16 a[56:59], a[152:155], a[92:95], a[56:59]
    v_mfma_f32_16x16x32_bf16 a[60:63], a[140:143], a[88:91], a[60:63]
    buffer_load_dwordx4 v[104:107], v132, s[32:35], s93 offen offset:0
    v_mfma_f32_16x16x32_bf16 a[60:63], a[156:159], a[92:95], a[60:63]
    s_waitcnt lgkmcnt(2)
    v_mfma_f32_16x16x32_bf16 v[32:35], v[160:163], a[64:67], v[32:35]
    v_mfma_f32_16x16x32_bf16 v[32:35], v[176:179], a[68:71], v[32:35]
    ds_read_b128 a[80:83], v233 offset:0
    buffer_load_dwordx4 v[108:111], v132, s[32:35], s93 offen offset:64
    v_mfma_f32_16x16x32_bf16 v[36:39], v[164:167], a[64:67], v[36:39]
    v_mfma_f32_16x16x32_bf16 v[36:39], v[180:183], a[68:71], v[36:39]
    ds_read_b128 a[84:87], v233 offset:8192
    v_mfma_f32_16x16x32_bf16 v[40:43], v[168:171], a[64:67], v[40:43]
    v_mfma_f32_16x16x32_bf16 v[40:43], v[184:187], a[68:71], v[40:43]
    v_mfma_f32_16x16x32_bf16 v[44:47], v[172:175], a[64:67], v[44:47]
    v_mfma_f32_16x16x32_bf16 v[44:47], v[188:191], a[68:71], v[44:47]
    s_waitcnt lgkmcnt(2)
    v_mfma_f32_16x16x32_bf16 v[48:51], v[160:163], a[72:75], v[48:51]
    v_mfma_f32_16x16x32_bf16 v[48:51], v[176:179], a[76:79], v[48:51]
    ds_read_b128 a[88:91], v233 offset:1024
    v_mfma_f32_16x16x32_bf16 v[52:55], v[164:167], a[72:75], v[52:55]
    v_mfma_f32_16x16x32_bf16 v[52:55], v[180:183], a[76:79], v[52:55]
    ds_read_b128 a[92:95], v233 offset:9216
    v_add_u32 v233, 32768, v233
    v_mfma_f32_16x16x32_bf16 v[56:59], v[168:171], a[72:75], v[56:59]
    v_mfma_f32_16x16x32_bf16 v[56:59], v[184:187], a[76:79], v[56:59]
    v_mfma_f32_16x16x32_bf16 v[60:63], v[172:175], a[72:75], v[60:63]
    v_mfma_f32_16x16x32_bf16 v[60:63], v[188:191], a[76:79], v[60:63]
    s_waitcnt vmcnt(10) lgkmcnt(2)
    v_mfma_f32_16x16x32_bf16 a[32:35], v[160:163], a[80:83], a[32:35]
    s_barrier
    v_mfma_f32_16x16x32_bf16 a[32:35], v[176:179], a[84:87], a[32:35]
    ds_read_b128 a[64:67], v231 offset:0
    v_mfma_f32_16x16x32_bf16 a[36:39], v[164:167], a[80:83], a[36:39]
    v_mfma_f32_16x16x32_bf16 a[36:39], v[180:183], a[84:87], a[36:39]
    ds_read_b128 a[68:71], v231 offset:8192
    v_mfma_f32_16x16x32_bf16 a[40:43], v[168:171], a[80:83], a[40:43]
    s_waitcnt vmcnt(6)
    v_mfma_f32_16x16x32_bf16 a[40:43], v[184:187], a[84:87], a[40:43]
    ds_read_b64_tr_b16 v[112:113], v135 offset:0
    v_mfma_f32_16x16x32_bf16 a[44:47], v[172:175], a[80:83], a[44:47]
    ds_read_b64_tr_b16 v[114:115], v135 offset:32
    v_mfma_f32_16x16x32_bf16 a[44:47], v[188:191], a[84:87], a[44:47]
    s_waitcnt lgkmcnt(4)
    v_mfma_f32_16x16x32_bf16 a[48:51], v[160:163], a[88:91], a[48:51]
    ds_read_b64_tr_b16 v[116:117], v135 offset:256
    v_mfma_f32_16x16x32_bf16 a[48:51], v[176:179], a[92:95], a[48:51]
    ds_read_b128 a[72:75], v231 offset:1024
    v_mfma_f32_16x16x32_bf16 a[52:55], v[164:167], a[88:91], a[52:55]
    ds_read_b64_tr_b16 v[118:119], v135 offset:288
    v_mfma_f32_16x16x32_bf16 a[52:55], v[180:183], a[92:95], a[52:55]
    ds_read_b128 a[76:79], v231 offset:9216
    v_mfma_f32_16x16x32_bf16 a[56:59], v[168:171], a[88:91], a[56:59]
    ds_read_b64_tr_b16 v[120:121], v135 offset:2048
    v_mfma_f32_16x16x32_bf16 a[56:59], v[184:187], a[92:95], a[56:59]
    ds_read_b64_tr_b16 v[122:123], v135 offset:2080
    v_mfma_f32_16x16x32_bf16 a[60:63], v[172:175], a[88:91], a[60:63]
    ds_read_b64_tr_b16 v[124:125], v135 offset:2304
    v_mfma_f32_16x16x32_bf16 a[60:63], v[188:191], a[92:95], a[60:63]
    s_waitcnt lgkmcnt(9)
    ds_read_b64_tr_b16 v[126:127], v135 offset:2336
    v_mfma_f32_16x16x32_bf16 v[32:35], v[192:195], a[64:67], v[32:35]
    v_mfma_f32_16x16x32_bf16 v[32:35], v[208:211], a[68:71], v[32:35]
    ds_read_b128 a[80:83], v233 offset:0
    v_mfma_f32_16x16x32_bf16 v[36:39], v[196:199], a[64:67], v[36:39]
    v_mfma_f32_16x16x32_bf16 v[36:39], v[212:215], a[68:71], v[36:39]
    ds_read_b128 a[84:87], v233 offset:8192
    v_mfma_f32_16x16x32_bf16 v[40:43], v[200:203], a[64:67], v[40:43]
    v_mfma_f32_16x16x32_bf16 v[40:43], v[216:219], a[68:71], v[40:43]
    v_mfma_f32_16x16x32_bf16 v[44:47], v[204:207], a[64:67], v[44:47]
    s_waitcnt vmcnt(3)
    v_lshlrev_b32 v64, 16, v96
    v_mfma_f32_16x16x32_bf16 v[44:47], v[220:223], a[68:71], v[44:47]
    s_waitcnt lgkmcnt(6)
    v_and_b32 v65, 0xffff0000, v96
    v_mfma_f32_16x16x32_bf16 v[48:51], v[192:195], a[72:75], v[48:51]
    v_lshlrev_b32 v136, 16, v112
    v_mfma_f32_16x16x32_bf16 v[48:51], v[208:211], a[76:79], v[48:51]
    ds_read_b128 a[88:91], v233 offset:1024
    v_and_b32 v137, 0xffff0000, v112
    v_mfma_f32_16x16x32_bf16 v[52:55], v[196:199], a[72:75], v[52:55]
    v_mul_f32 v64, v64, v128
    v_mfma_f32_16x16x32_bf16 v[52:55], v[212:215], a[76:79], v[52:55]
    ds_read_b128 a[92:95], v233 offset:9216
    v_mul_f32 v65, v65, v128
    v_mfma_f32_16x16x32_bf16 v[56:59], v[200:203], a[72:75], v[56:59]
    v_mul_f32 v64, v64, v136
    v_mfma_f32_16x16x32_bf16 v[56:59], v[216:219], a[76:79], v[56:59]
    v_mul_f32 v65, v65, v137
    v_lshlrev_b32 v66, 16, v97
    v_mfma_f32_16x16x32_bf16 v[60:63], v[204:207], a[72:75], v[60:63]
    v_and_b32 v67, 0xffff0000, v97
    v_mfma_f32_16x16x32_bf16 v[60:63], v[220:223], a[76:79], v[60:63]
    s_waitcnt lgkmcnt(2)
    v_lshlrev_b32 v136, 16, v113
    v_and_b32 v137, 0xffff0000, v113
    v_mfma_f32_16x16x32_bf16 a[32:35], v[192:195], a[80:83], a[32:35]
    v_mul_f32 v66, v66, v128
    v_mfma_f32_16x16x32_bf16 a[32:35], v[208:211], a[84:87], a[32:35]
    ds_read_b128 a[64:67], v230 offset:0
    v_mul_f32 v67, v67, v128
    v_mul_f32 v66, v66, v136
    v_mfma_f32_16x16x32_bf16 a[36:39], v[196:199], a[80:83], a[36:39]
    v_mul_f32 v67, v67, v137
    v_mfma_f32_16x16x32_bf16 a[36:39], v[212:215], a[84:87], a[36:39]
    ds_read_b128 a[68:71], v230 offset:8192
    v_lshlrev_b32 v68, 16, v98
    v_and_b32 v69, 0xffff0000, v98
    v_mfma_f32_16x16x32_bf16 a[40:43], v[200:203], a[80:83], a[40:43]
    v_lshlrev_b32 v136, 16, v116
    v_mfma_f32_16x16x32_bf16 a[40:43], v[216:219], a[84:87], a[40:43]
    v_and_b32 v137, 0xffff0000, v116
    v_mul_f32 v68, v68, v128
    v_mfma_f32_16x16x32_bf16 a[44:47], v[204:207], a[80:83], a[44:47]
    v_mul_f32 v69, v69, v128
    v_mul_f32 v68, v68, v136
    v_mfma_f32_16x16x32_bf16 a[44:47], v[220:223], a[84:87], a[44:47]
    s_waitcnt lgkmcnt(2)
    v_mul_f32 v69, v69, v137
    v_mfma_f32_16x16x32_bf16 a[48:51], v[192:195], a[88:91], a[48:51]
    v_lshlrev_b32 v70, 16, v99
    v_and_b32 v71, 0xffff0000, v99
    v_mfma_f32_16x16x32_bf16 a[48:51], v[208:211], a[92:95], a[48:51]
    ds_read_b128 a[72:75], v230 offset:1024
    v_lshlrev_b32 v136, 16, v117
    v_mfma_f32_16x16x32_bf16 a[52:55], v[196:199], a[88:91], a[52:55]
    v_and_b32 v137, 0xffff0000, v117
    v_mul_f32 v70, v70, v128
    v_mul_f32 v71, v71, v128
    v_mfma_f32_16x16x32_bf16 a[52:55], v[212:215], a[92:95], a[52:55]
    ds_read_b128 a[76:79], v230 offset:9216
    v_add_u32 v230, 4294901760, v230
    v_mfma_f32_16x16x32_bf16 a[56:59], v[200:203], a[88:91], a[56:59]
    v_mul_f32 v70, v70, v136
    v_mul_f32 v71, v71, v137
    v_mfma_f32_16x16x32_bf16 a[56:59], v[216:219], a[92:95], a[56:59]
    s_waitcnt vmcnt(2)
    v_lshlrev_b32 v72, 16, v100
    v_mfma_f32_16x16x32_bf16 a[60:63], v[204:207], a[88:91], a[60:63]
    v_and_b32 v73, 0xffff0000, v100
    v_lshlrev_b32 v136, 16, v120
    v_mfma_f32_16x16x32_bf16 a[60:63], v[220:223], a[92:95], a[60:63]
    s_waitcnt lgkmcnt(2)
    v_and_b32 v137, 0xffff0000, v120
    v_mul_f32 v72, v72, v128
    v_mul_f32 v73, v73, v128
    v_mul_f32 v72, v72, v136
    v_mul_f32 v73, v73, v137
    v_mfma_f32_16x16x32_bf16 v[0:3], a[128:131], a[64:67], v[0:3]
    v_mfma_f32_16x16x32_bf16 v[0:3], a[144:147], a[68:71], v[0:3]
    ds_read_b128 a[80:83], v232 offset:0
    v_mfma_f32_16x16x32_bf16 v[4:7], a[132:135], a[64:67], v[4:7]
    ds_write_b128 v225, a[32:35] offset:0
    v_mfma_f32_16x16x32_bf16 v[4:7], a[148:151], a[68:71], v[4:7]
    ds_read_b128 a[84:87], v232 offset:8192
    v_mfma_f32_16x16x32_bf16 v[8:11], a[136:139], a[64:67], v[8:11]
    ds_write_b128 v225, a[36:39] offset:1024
    v_mfma_f32_16x16x32_bf16 v[8:11], a[152:155], a[68:71], v[8:11]
    ds_write_b128 v225, a[40:43] offset:2048
    v_mfma_f32_16x16x32_bf16 v[12:15], a[140:143], a[64:67], v[12:15]
    ds_write_b128 v225, a[44:47] offset:3072
    v_mfma_f32_16x16x32_bf16 v[12:15], a[156:159], a[68:71], v[12:15]
    s_waitcnt lgkmcnt(6)
    ds_write_b128 v225, a[48:51] offset:4096
    v_mfma_f32_16x16x32_bf16 v[16:19], a[128:131], a[72:75], v[16:19]
    ds_write_b128 v225, a[52:55] offset:5120
    v_mfma_f32_16x16x32_bf16 v[16:19], a[144:147], a[76:79], v[16:19]
    ds_read_b128 a[88:91], v232 offset:1024
    v_mfma_f32_16x16x32_bf16 v[20:23], a[132:135], a[72:75], v[20:23]
    ds_write_b128 v225, a[56:59] offset:6144
    v_mfma_f32_16x16x32_bf16 v[20:23], a[148:151], a[76:79], v[20:23]
    ds_read_b128 a[92:95], v232 offset:9216
    v_add_u32 v232, 4294901760, v232
    v_mfma_f32_16x16x32_bf16 v[24:27], a[136:139], a[72:75], v[24:27]
    ds_write_b128 v225, a[60:63] offset:7168
    v_mfma_f32_16x16x32_bf16 v[24:27], a[152:155], a[76:79], v[24:27]
    v_mfma_f32_16x16x32_bf16 v[28:31], a[140:143], a[72:75], v[28:31]
    v_mfma_f32_16x16x32_bf16 v[28:31], a[156:159], a[76:79], v[28:31]
    s_waitcnt lgkmcnt(9)
    v_mfma_f32_16x16x32_bf16 a[0:3], a[128:131], a[80:83], a[0:3]
    v_mfma_f32_16x16x32_bf16 a[0:3], a[144:147], a[84:87], a[0:3]
    ds_read_b128 a[64:67], v230 offset:0
    v_mfma_f32_16x16x32_bf16 a[4:7], a[132:135], a[80:83], a[4:7]
    s_waitcnt lgkmcnt(1)
    v_mfma_f32_16x16x32_bf16 a[4:7], a[148:151], a[84:87], a[4:7]
    s_barrier
    ds_read_b128 a[68:71], v230 offset:8192
    v_mfma_f32_16x16x32_bf16 a[8:11], a[136:139], a[80:83], a[8:11]
    ds_read_b128 v[140:143], v229 offset:0
    v_mfma_f32_16x16x32_bf16 a[8:11], a[152:155], a[84:87], a[8:11]
    ds_read_b128 v[144:147], v229 offset:1024
    v_mfma_f32_16x16x32_bf16 a[12:15], a[140:143], a[80:83], a[12:15]
    ds_read_b128 v[148:151], v229 offset:2048
    v_mfma_f32_16x16x32_bf16 a[12:15], a[156:159], a[84:87], a[12:15]
    ds_read_b128 v[152:155], v229 offset:3072
    v_mfma_f32_16x16x32_bf16 a[16:19], a[128:131], a[88:91], a[16:19]
    ds_read_b128 v[156:159], v229 offset:4096
    v_mfma_f32_16x16x32_bf16 a[16:19], a[144:147], a[92:95], a[16:19]
    ds_read_b128 a[72:75], v230 offset:1024
    v_mfma_f32_16x16x32_bf16 a[20:23], a[132:135], a[88:91], a[20:23]
    v_mfma_f32_16x16x32_bf16 a[20:23], a[148:151], a[92:95], a[20:23]
    ds_read_b128 a[76:79], v230 offset:9216
    v_add_u32 v230, 32768, v230
    v_mfma_f32_16x16x32_bf16 a[24:27], a[136:139], a[88:91], a[24:27]
    s_waitcnt lgkmcnt(6)
    v_add_f32 v32, v32, v140
    v_mfma_f32_16x16x32_bf16 a[24:27], a[152:155], a[92:95], a[24:27]
    v_add_f32 v33, v33, v141
    v_mfma_f32_16x16x32_bf16 a[28:31], a[140:143], a[88:91], a[28:31]
    v_add_f32 v34, v34, v142
    v_mfma_f32_16x16x32_bf16 a[28:31], a[156:159], a[92:95], a[28:31]
    v_add_f32 v35, v35, v143
    v_mfma_f32_16x16x32_bf16 v[0:3], v[160:163], a[64:67], v[0:3]
    ds_read_b128 v[140:143], v229 offset:5120
    buffer_store_dwordx4 v[32:35], v245, s[40:43], s73 offen offset:0 sc1
    v_mfma_f32_16x16x32_bf16 v[0:3], v[176:179], a[68:71], v[0:3]
    ds_read_b128 a[80:83], v232 offset:0
    s_waitcnt lgkmcnt(7)
    v_add_f32 v36, v36, v144
    v_mfma_f32_16x16x32_bf16 v[4:7], v[164:167], a[64:67], v[4:7]
    v_add_f32 v37, v37, v145
    v_mfma_f32_16x16x32_bf16 v[4:7], v[180:183], a[68:71], v[4:7]
    ds_read_b128 a[84:87], v232 offset:8192
    v_add_f32 v38, v38, v146
    v_add_f32 v39, v39, v147
    v_mfma_f32_16x16x32_bf16 v[8:11], v[168:171], a[64:67], v[8:11]
    ds_read_b128 v[144:147], v229 offset:6144
    buffer_store_dwordx4 v[36:39], v245, s[40:43], s73 offen offset:1024 sc1
    v_mfma_f32_16x16x32_bf16 v[8:11], v[184:187], a[68:71], v[8:11]
    s_waitcnt lgkmcnt(8)
    v_add_f32 v40, v40, v148
    v_mfma_f32_16x16x32_bf16 v[12:15], v[172:175], a[64:67], v[12:15]
    v_add_f32 v41, v41, v149
    v_add_f32 v42, v42, v150
    v_mfma_f32_16x16x32_bf16 v[12:15], v[188:191], a[68:71], v[12:15]
    s_waitcnt lgkmcnt(4)
    v_add_f32 v43, v43, v151
    v_mfma_f32_16x16x32_bf16 v[16:19], v[160:163], a[72:75], v[16:19]
    ds_read_b128 v[148:151], v229 offset:7168
    buffer_store_dwordx4 v[40:43], v245, s[40:43], s73 offen offset:2048 sc1
    v_mfma_f32_16x16x32_bf16 v[16:19], v[176:179], a[76:79], v[16:19]
    ds_read_b128 a[88:91], v232 offset:1024
    v_add_f32 v44, v44, v152
    v_add_f32 v45, v45, v153
    v_mfma_f32_16x16x32_bf16 v[20:23], v[164:167], a[72:75], v[20:23]
    v_add_f32 v46, v46, v154
    v_add_f32 v47, v47, v155
    buffer_store_dwordx4 v[44:47], v245, s[40:43], s73 offen offset:3072 sc1
    v_mfma_f32_16x16x32_bf16 v[20:23], v[180:183], a[76:79], v[20:23]
    ds_read_b128 a[92:95], v232 offset:9216
    v_add_u32 v232, 32768, v232
    v_mfma_f32_16x16x32_bf16 v[24:27], v[168:171], a[72:75], v[24:27]
    v_add_f32 v48, v48, v156
    v_add_f32 v49, v49, v157
    v_mfma_f32_16x16x32_bf16 v[24:27], v[184:187], a[76:79], v[24:27]
    v_add_f32 v50, v50, v158
    v_add_f32 v51, v51, v159
    v_mfma_f32_16x16x32_bf16 v[28:31], v[172:175], a[72:75], v[28:31]
    s_add_u32 s73, s73, 4096
    buffer_store_dwordx4 v[48:51], v245, s[40:43], s73 offen offset:0 sc1
    v_mfma_f32_16x16x32_bf16 v[28:31], v[188:191], a[76:79], v[28:31]
    s_waitcnt lgkmcnt(4)
    v_add_f32 v52, v52, v140
    v_mfma_f32_16x16x32_bf16 a[0:3], v[160:163], a[80:83], a[0:3]
    v_add_f32 v53, v53, v141
    v_add_f32 v54, v54, v142
    v_mfma_f32_16x16x32_bf16 a[0:3], v[176:179], a[84:87], a[0:3]
    ds_read_b128 a[64:67], v230 offset:0
    v_add_f32 v55, v55, v143
    v_mfma_f32_16x16x32_bf16 a[4:7], v[164:167], a[80:83], a[4:7]
    buffer_store_dwordx4 v[52:55], v245, s[40:43], s73 offen offset:1024 sc1
    s_waitcnt lgkmcnt(4)
    v_add_f32 v56, v56, v144
    v_mfma_f32_16x16x32_bf16 a[4:7], v[180:183], a[84:87], a[4:7]
    ds_read_b128 a[68:71], v230 offset:8192
    v_add_f32 v57, v57, v145
    v_add_f32 v58, v58, v146
    v_mfma_f32_16x16x32_bf16 a[8:11], v[168:171], a[80:83], a[8:11]
    v_add_f32 v59, v59, v147
    buffer_store_dwordx4 v[56:59], v245, s[40:43], s73 offen offset:2048 sc1
    v_mfma_f32_16x16x32_bf16 a[8:11], v[184:187], a[84:87], a[8:11]
    s_waitcnt lgkmcnt(4)
    v_add_f32 v60, v60, v148
    v_add_f32 v61, v61, v149
    v_add_f32 v62, v62, v150
    v_add_f32 v63, v63, v151
    buffer_store_dwordx4 v[60:63], v245, s[40:43], s73 offen offset:3072 sc1
    v_mfma_f32_16x16x32_bf16 a[12:15], v[172:175], a[80:83], a[12:15]
    v_lshlrev_b32 v74, 16, v101
    v_mfma_f32_16x16x32_bf16 a[12:15], v[188:191], a[84:87], a[12:15]
    s_waitcnt lgkmcnt(2)
    v_and_b32 v75, 0xffff0000, v101
    v_mfma_f32_16x16x32_bf16 a[16:19], v[160:163], a[88:91], a[16:19]
    v_lshlrev_b32 v136, 16, v121
    v_mfma_f32_16x16x32_bf16 a[16:19], v[176:179], a[92:95], a[16:19]
    ds_read_b128 a[72:75], v230 offset:1024
    v_and_b32 v137, 0xffff0000, v121
    v_mfma_f32_16x16x32_bf16 a[20:23], v[164:167], a[88:91], a[20:23]
    v_mul_f32 v74, v74, v128
    v_mul_f32 v75, v75, v128
    v_mfma_f32_16x16x32_bf16 a[20:23], v[180:183], a[92:95], a[20:23]
    ds_read_b128 a[76:79], v230 offset:9216
    v_mul_f32 v74, v74, v136
    v_mul_f32 v75, v75, v137
    v_mfma_f32_16x16x32_bf16 a[24:27], v[168:171], a[88:91], a[24:27]
    v_lshlrev_b32 v76, 16, v102
    v_and_b32 v77, 0xffff0000, v102
    v_mfma_f32_16x16x32_bf16 a[24:27], v[184:187], a[92:95], a[24:27]
    v_lshlrev_b32 v136, 16, v124
    v_and_b32 v137, 0xffff0000, v124
    v_mfma_f32_16x16x32_bf16 a[28:31], v[172:175], a[88:91], a[28:31]
    v_mul_f32 v76, v76, v128
    v_mul_f32 v77, v77, v128
    v_mul_f32 v76, v76, v136
    v_mfma_f32_16x16x32_bf16 a[28:31], v[188:191], a[92:95], a[28:31]
    s_waitcnt lgkmcnt(2)
    v_mul_f32 v77, v77, v137
    v_lshlrev_b32 v78, 16, v103
    v_mfma_f32_16x16x32_bf16 v[0:3], v[192:195], a[64:67], v[0:3]
    v_and_b32 v79, 0xffff0000, v103
    v_lshlrev_b32 v136, 16, v125
    v_mfma_f32_16x16x32_bf16 v[0:3], v[208:211], a[68:71], v[0:3]
    ds_read_b128 a[80:83], v232 offset:0
    v_and_b32 v137, 0xffff0000, v125
    v_mul_f32 v78, v78, v128
    v_mfma_f32_16x16x32_bf16 v[4:7], v[196:199], a[64:67], v[4:7]
    v_mul_f32 v79, v79, v128
    v_mul_f32 v78, v78, v136
    v_mfma_f32_16x16x32_bf16 v[4:7], v[212:215], a[68:71], v[4:7]
    ds_read_b128 a[84:87], v232 offset:8192
    v_mul_f32 v79, v79, v137
    s_waitcnt vmcnt(9)
    v_lshlrev_b32 v80, 16, v104
    v_mfma_f32_16x16x32_bf16 v[8:11], v[200:203], a[64:67], v[8:11]
    v_and_b32 v81, 0xffff0000, v104
    v_lshlrev_b32 v136, 16, v114
    v_mfma_f32_16x16x32_bf16 v[8:11], v[216:219], a[68:71], v[8:11]
    v_and_b32 v137, 0xffff0000, v114
    v_mul_f32 v80, v80, v130
    v_mul_f32 v81, v81, v130
    v_mfma_f32_16x16x32_bf16 v[12:15], v[204:207], a[64:67], v[12:15]
    v_mul_f32 v80, v80, v136
    v_mul_f32 v81, v81, v137
    v_mfma_f32_16x16x32_bf16 v[12:15], v[220:223], a[68:71], v[12:15]
    s_waitcnt lgkmcnt(2)
    v_lshlrev_b32 v82, 16, v105
    v_and_b32 v83, 0xffff0000, v105
    v_mfma_f32_16x16x32_bf16 v[16:19], v[192:195], a[72:75], v[16:19]
    v_lshlrev_b32 v136, 16, v115
    v_and_b32 v137, 0xffff0000, v115
    v_mfma_f32_16x16x32_bf16 v[16:19], v[208:211], a[76:79], v[16:19]
    ds_read_b128 a[88:91], v232 offset:1024
    v_mul_f32 v82, v82, v130
    v_mul_f32 v83, v83, v130
    v_mfma_f32_16x16x32_bf16 v[20:23], v[196:199], a[72:75], v[20:23]
    v_mul_f32 v82, v82, v136
    v_mul_f32 v83, v83, v137
    v_mfma_f32_16x16x32_bf16 v[20:23], v[212:215], a[76:79], v[20:23]
    ds_read_b128 a[92:95], v232 offset:9216
    v_lshlrev_b32 v84, 16, v106
    v_and_b32 v85, 0xffff0000, v106
    v_mfma_f32_16x16x32_bf16 v[24:27], v[200:203], a[72:75], v[24:27]
    v_lshlrev_b32 v136, 16, v118
    v_and_b32 v137, 0xffff0000, v118
    v_mul_f32 v84, v84, v130
    v_mfma_f32_16x16x32_bf16 v[24:27], v[216:219], a[76:79], v[24:27]
    v_mul_f32 v85, v85, v130
    v_mul_f32 v84, v84, v136
    v_mfma_f32_16x16x32_bf16 v[28:31], v[204:207], a[72:75], v[28:31]
    v_mul_f32 v85, v85, v137
    v_lshlrev_b32 v86, 16, v107
    v_mfma_f32_16x16x32_bf16 v[28:31], v[220:223], a[76:79], v[28:31]
    s_waitcnt lgkmcnt(2)
    v_and_b32 v87, 0xffff0000, v107
    v_lshlrev_b32 v136, 16, v119
    v_mfma_f32_16x16x32_bf16 a[0:3], v[192:195], a[80:83], a[0:3]
    v_and_b32 v137, 0xffff0000, v119
    v_mul_f32 v86, v86, v130
    v_mfma_f32_16x16x32_bf16 a[0:3], v[208:211], a[84:87], a[0:3]
    v_mul_f32 v87, v87, v130
    v_mul_f32 v86, v86, v136
    v_mfma_f32_16x16x32_bf16 a[4:7], v[196:199], a[80:83], a[4:7]
    v_mul_f32 v87, v87, v137
    s_waitcnt vmcnt(8)
    v_lshlrev_b32 v88, 16, v108
    v_mfma_f32_16x16x32_bf16 a[4:7], v[212:215], a[84:87], a[4:7]
    v_and_b32 v89, 0xffff0000, v108
    v_lshlrev_b32 v136, 16, v122
    v_and_b32 v137, 0xffff0000, v122
    v_mfma_f32_16x16x32_bf16 a[8:11], v[200:203], a[80:83], a[8:11]
    v_mul_f32 v88, v88, v130
    v_mul_f32 v89, v89, v130
    v_mfma_f32_16x16x32_bf16 a[8:11], v[216:219], a[84:87], a[8:11]
    v_mul_f32 v88, v88, v136
    v_mul_f32 v89, v89, v137
    v_mfma_f32_16x16x32_bf16 a[12:15], v[204:207], a[80:83], a[12:15]
    v_lshlrev_b32 v90, 16, v109
    v_and_b32 v91, 0xffff0000, v109
    v_mfma_f32_16x16x32_bf16 a[12:15], v[220:223], a[84:87], a[12:15]
    s_waitcnt lgkmcnt(0)
    v_lshlrev_b32 v136, 16, v123
    v_and_b32 v137, 0xffff0000, v123
    v_mfma_f32_16x16x32_bf16 a[16:19], v[192:195], a[88:91], a[16:19]
    v_mul_f32 v90, v90, v130
    v_mul_f32 v91, v91, v130
    v_mfma_f32_16x16x32_bf16 a[16:19], v[208:211], a[92:95], a[16:19]
    v_mul_f32 v90, v90, v136
    v_mul_f32 v91, v91, v137
    v_mfma_f32_16x16x32_bf16 a[20:23], v[196:199], a[88:91], a[20:23]
    v_lshlrev_b32 v92, 16, v110
    v_and_b32 v93, 0xffff0000, v110
    v_lshlrev_b32 v136, 16, v126
    v_mfma_f32_16x16x32_bf16 a[20:23], v[212:215], a[92:95], a[20:23]
    v_and_b32 v137, 0xffff0000, v126
    v_mul_f32 v92, v92, v130
    v_mfma_f32_16x16x32_bf16 a[24:27], v[200:203], a[88:91], a[24:27]
    v_mul_f32 v93, v93, v130
    v_mul_f32 v92, v92, v136
    v_mfma_f32_16x16x32_bf16 a[24:27], v[216:219], a[92:95], a[24:27]
    v_mul_f32 v93, v93, v137
    v_lshlrev_b32 v94, 16, v111
    v_mfma_f32_16x16x32_bf16 a[28:31], v[204:207], a[88:91], a[28:31]
    v_and_b32 v95, 0xffff0000, v111
    v_lshlrev_b32 v136, 16, v127
    v_and_b32 v137, 0xffff0000, v127
    v_mul_f32 v94, v94, v130
    v_mul_f32 v95, v95, v130
    v_mul_f32 v94, v94, v136
    v_mul_f32 v95, v95, v137
    v_mfma_f32_16x16x32_bf16 a[28:31], v[220:223], a[92:95], a[28:31]
    ds_write_b128 v225, a[0:3] offset:32768
    ds_write_b128 v225, a[4:7] offset:33792
    ds_write_b128 v225, a[8:11] offset:34816
    ds_write_b128 v225, a[12:15] offset:35840
    ds_write_b128 v225, a[16:19] offset:36864
    ds_write_b128 v225, a[20:23] offset:37888
    ds_write_b128 v225, a[24:27] offset:38912
    s_nop 0
    ds_write_b128 v225, a[28:31] offset:39936
    s_waitcnt vmcnt(0)
    v_mov_b32 v226, s86
    v_mov_b32 v227, s87
    buffer_store_dwordx2 v[226:227], v254, s[60:63], 0 offen offset:512 sc1
    buffer_load_dwordx2 v[226:227], v224, s[60:63], 0 offen sc1
    s_waitcnt lgkmcnt(0)
    s_barrier
    ds_read_b128 v[192:195], v229 offset:32768
    ds_read_b128 v[196:199], v229 offset:33792
    ds_read_b128 v[200:203], v229 offset:34816
    ds_read_b128 v[204:207], v229 offset:35840
    ds_read_b128 v[208:211], v229 offset:36864
    ds_read_b128 v[212:215], v229 offset:37888
    ds_read_b128 v[216:219], v229 offset:38912
    ds_read_b128 v[220:223], v229 offset:39936
    s_waitcnt vmcnt(0)
    v_cmp_eq_u64 vcc, s[86:87], v[226:227]
    s_nop 1
    s_cmp_eq_u64 vcc, -1
    s_cbranch_scc0 L_slow_x
L_ok_x:
    buffer_load_dwordx4 v[160:163], v245, s[40:43], s74 offen offset:0 sc1
    buffer_load_dwordx4 v[164:167], v245, s[40:43], s74 offen offset:1024 sc1
    buffer_load_dwordx4 v[168:171], v245, s[40:43], s74 offen offset:2048 sc1
    buffer_load_dwordx4 v[172:175], v245, s[40:43], s74 offen offset:3072 sc1
    s_add_u32 s74, s74, 4096
    buffer_load_dwordx4 v[176:179], v245, s[40:43], s74 offen offset:0 sc1
    buffer_load_dwordx4 v[180:183], v245, s[40:43], s74 offen offset:1024 sc1
    buffer_load_dwordx4 v[184:187], v245, s[40:43], s74 offen offset:2048 sc1
    buffer_load_dwordx4 v[188:191], v245, s[40:43], s74 offen offset:3072 sc1
    s_waitcnt lgkmcnt(7)
    v_pk_add_f32 v[0:1], v[0:1], v[192:193]
    v_pk_add_f32 v[2:3], v[2:3], v[194:195]
    s_waitcnt lgkmcnt(6)
    v_pk_add_f32 v[4:5], v[4:5], v[196:197]
    v_pk_add_f32 v[6:7], v[6:7], v[198:199]
    s_waitcnt lgkmcnt(5)
    v_pk_add_f32 v[8:9], v[8:9], v[200:201]
    v_pk_add_f32 v[10:11], v[10:11], v[202:203]
    s_waitcnt lgkmcnt(4)
    v_pk_add_f32 v[12:13], v[12:13], v[204:205]
    v_pk_add_f32 v[14:15], v[14:15], v[206:207]
    s_waitcnt lgkmcnt(3)
    v_pk_add_f32 v[16:17], v[16:17], v[208:209]
    v_pk_add_f32 v[18:19], v[18:19], v[210:211]
    s_waitcnt lgkmcnt(2)
    v_pk_add_f32 v[20:21], v[20:21], v[212:213]
    v_pk_add_f32 v[22:23], v[22:23], v[214:215]
    s_waitcnt lgkmcnt(1)
    v_pk_add_f32 v[24:25], v[24:25], v[216:217]
    v_pk_add_f32 v[26:27], v[26:27], v[218:219]
    s_waitcnt lgkmcnt(0)
    v_pk_add_f32 v[28:29], v[28:29], v[220:221]
    v_pk_add_f32 v[30:31], v[30:31], v[222:223]
    s_waitcnt vmcnt(7)
    v_pk_add_f32 v[0:1], v[0:1], v[160:161]
    v_pk_add_f32 v[2:3], v[2:3], v[162:163]
    s_waitcnt vmcnt(6)
    v_pk_add_f32 v[4:5], v[4:5], v[164:165]
    v_pk_add_f32 v[6:7], v[6:7], v[166:167]
    s_nop 0
    v_permlane16_swap_b32 v0, v4
    v_permlane16_swap_b32 v1, v5
    v_permlane16_swap_b32 v2, v6
    v_permlane16_swap_b32 v3, v7
    v_pk_fma_f32 v[0:1], v[0:1], v[128:129], v[64:65] op_sel:[0,1,0] op_sel_hi:[1,1,1]
    v_pk_fma_f32 v[2:3], v[2:3], v[128:129], v[66:67] op_sel:[0,1,0] op_sel_hi:[1,1,1]
    v_pk_fma_f32 v[4:5], v[4:5], v[128:129], v[68:69] op_sel:[0,1,0] op_sel_hi:[1,1,1]
    v_pk_fma_f32 v[6:7], v[6:7], v[128:129], v[70:71] op_sel:[0,1,0] op_sel_hi:[1,1,1]
    v_cvt_pk_bf16_f32 v136, v0, v1
    v_cvt_pk_bf16_f32 v137, v2, v3
    v_cvt_pk_bf16_f32 v138, v4, v5
    v_cvt_pk_bf16_f32 v139, v6, v7
    buffer_store_dwordx4 v[136:139], v132, s[36:39], s92 offen offset:0
    s_waitcnt vmcnt(6)
    v_pk_add_f32 v[8:9], v[8:9], v[168:169]
    v_pk_add_f32 v[10:11], v[10:11], v[170:171]
    s_waitcnt vmcnt(5)
    v_pk_add_f32 v[12:13], v[12:13], v[172:173]
    v_pk_add_f32 v[14:15], v[14:15], v[174:175]
    s_nop 0
    v_permlane16_swap_b32 v8, v12
    v_permlane16_swap_b32 v9, v13
    v_permlane16_swap_b32 v10, v14
    v_permlane16_swap_b32 v11, v15
    v_pk_fma_f32 v[8:9], v[8:9], v[128:129], v[72:73] op_sel:[0,1,0] op_sel_hi:[1,1,1]
    v_pk_fma_f32 v[10:11], v[10:11], v[128:129], v[74:75] op_sel:[0,1,0] op_sel_hi:[1,1,1]
    v_pk_fma_f32 v[12:13], v[12:13], v[128:129], v[76:77] op_sel:[0,1,0] op_sel_hi:[1,1,1]
    v_pk_fma_f32 v[14:15], v[14:15], v[128:129], v[78:79] op_sel:[0,1,0] op_sel_hi:[1,1,1]
    v_cvt_pk_bf16_f32 v140, v8, v9
    v_cvt_pk_bf16_f32 v141, v10, v11
    v_cvt_pk_bf16_f32 v142, v12, v13
    v_cvt_pk_bf16_f32 v143, v14, v15
    buffer_store_dwordx4 v[140:143], v132, s[36:39], s92 offen offset:64
    s_waitcnt vmcnt(5)
    v_pk_add_f32 v[16:17], v[16:17], v[176:177]
    v_pk_add_f32 v[18:19], v[18:19], v[178:179]
    s_waitcnt vmcnt(4)
    v_pk_add_f32 v[20:21], v[20:21], v[180:181]
    v_pk_add_f32 v[22:23], v[22:23], v[182:183]
    s_nop 0
    v_permlane16_swap_b32 v16, v20
    v_permlane16_swap_b32 v17, v21
    v_permlane16_swap_b32 v18, v22
    v_permlane16_swap_b32 v19, v23
    v_pk_fma_f32 v[16:17], v[16:17], v[130:131], v[80:81] op_sel:[0,1,0] op_sel_hi:[1,1,1]
    v_pk_fma_f32 v[18:19], v[18:19], v[130:131], v[82:83] op_sel:[0,1,0] op_sel_hi:[1,1,1]
    v_pk_fma_f32 v[20:21], v[20:21], v[130:131], v[84:85] op_sel:[0,1,0] op_sel_hi:[1,1,1]
    v_pk_fma_f32 v[22:23], v[22:23], v[130:131], v[86:87] op_sel:[0,1,0] op_sel_hi:[1,1,1]
    v_cvt_pk_bf16_f32 v144, v16, v17
    v_cvt_pk_bf16_f32 v145, v18, v19
    v_cvt_pk_bf16_f32 v146, v20, v21
    v_cvt_pk_bf16_f32 v147, v22, v23
    buffer_store_dwordx4 v[144:147], v132, s[36:39], s93 offen offset:0
    s_waitcnt vmcnt(4)
    v_pk_add_f32 v[24:25], v[24:25], v[184:185]
    v_pk_add_f32 v[26:27], v[26:27], v[186:187]
    s_waitcnt vmcnt(3)
    v_pk_add_f32 v[28:29], v[28:29], v[188:189]
    v_pk_add_f32 v[30:31], v[30:31], v[190:191]
    s_nop 0
    v_permlane16_swap_b32 v24, v28
    v_permlane16_swap_b32 v25, v29
    v_permlane16_swap_b32 v26, v30
    v_permlane16_swap_b32 v27, v31
    v_pk_fma_f32 v[24:25], v[24:25], v[130:131], v[88:89] op_sel:[0,1,0] op_sel_hi:[1,1,1]
    v_pk_fma_f32 v[26:27], v[26:27], v[130:131], v[90:91] op_sel:[0,1,0] op_sel_hi:[1,1,1]
    v_pk_fma_f32 v[28:29], v[28:29], v[130:131], v[92:93] op_sel:[0,1,0] op_sel_hi:[1,1,1]
    v_pk_fma_f32 v[30:31], v[30:31], v[130:131], v[94:95] op_sel:[0,1,0] op_sel_hi:[1,1,1]
    v_cvt_pk_bf16_f32 v148, v24, v25
    v_cvt_pk_bf16_f32 v149, v26, v27
    v_cvt_pk_bf16_f32 v150, v28, v29
    v_cvt_pk_bf16_f32 v151, v30, v31
    buffer_store_dwordx4 v[148:151], v132, s[36:39], s93 offen offset:64
    s_endpgm
L_helper:
    s_sub_u32 s73, s2, 224
    s_lshl2_add_u32 s74, s73, s30
    s_mul_i32 s64, s74, 3584
    s_add_u32 s64, s64, 458752
    s_lshl_b32 s88, s74, 15
    s_add_u32 s88, s88, 128
    v_cmp_le_u32 vcc, 28, v244
    v_subrev_u32 v3, 28, v244
    s_nop 0
    v_cndmask_b32 v3, v244, v3, vcc
    v_mov_b32 v4, 458752
    v_cndmask_b32 v4, 0, v4, vcc
    v_lshl_add_u32 v4, v3, 7, v4
    v_cmp_le_u32 vcc, 28, v3
    v_mov_b32 v5, 0x80000000
    s_nop 0
    v_cndmask_b32 v8, v4, v5, vcc
    v_and_b32 v3, 15, v244
    v_lshrrev_b32 v4, 4, v244
    v_lshlrev_b32 v5, 11, v3
    v_lshl_add_u32 v9, v4, 7, v5
    s_waitcnt lgkmcnt(0)
    s_mov_b32 s36, s16
    s_and_b32 s37, s17, 0xffff
    s_mov_b32 s38, 7340032
    s_mov_b32 s39, 0x20000
    s_mov_b32 s32, s4
    s_and_b32 s33, s5, 0xffff
    s_mov_b32 s34, 4194304
    s_mov_b32 s35, 0x20000
    buffer_load_dword v240, v8, s[36:39], s64 offen
    s_add_u32 s64, s64, 917504
    buffer_load_dword v241, v8, s[36:39], s64 offen
    s_add_u32 s64, s64, 917504
    s_lshl2_add_u32 s73, s2, s30
    s_lshl_b32 s75, s73, 12
    s_load_dword s96, s[12:13], s75
    s_lshr_b32 s75, s73, 1
    s_lshl_b32 s75, s75, 2
    s_load_dword s31, s[14:15], s75
    v_lshlrev_b32 v245, 4, v244
    s_mov_b32 s60, s26
    s_and_b32 s61, s27, 0xffff
    s_mov_b32 s62, 256
    s_mov_b32 s63, 0x20000
    s_lshl2_add_u32 s75, s2, s30
    s_cmp_lg_u32 s75, 896
    s_cbranch_scc1 L_notag
    s_memrealtime s[86:87]
    v_lshlrev_b32 v14, 31, v244
    v_min_u32 v14, 1, v244
    v_lshlrev_b32 v14, 31, v14
    s_waitcnt lgkmcnt(0)
    v_mov_b32 v16, s86
    v_mov_b32 v17, s87
    buffer_store_dwordx2 v[16:17], v14, s[60:63], 0 offen sc1
L_notag:
    s_sub_u32 s73, s2, 224
    v_and_b32 v3, 15, v244
    buffer_load_dword v242, v8, s[36:39], s64 offen
    s_add_u32 s64, s64, 917504
    s_mov_b32 s48, s6
    s_and_b32 s49, s7, 0xffff
    s_mov_b32 s50, 4194304
    s_mov_b32 s51, 0x20000
    s_mov_b32 s52, s8
    s_and_b32 s53, s9, 0xffff
    s_mov_b32 s54, 4194304
    s_mov_b32 s55, 0x20000
    s_mov_b32 s56, s10
    s_and_b32 s57, s11, 0xffff
    s_mov_b32 s58, 8192
    s_mov_b32 s59, 0x20000
    s_lshr_b32 s74, s73, 1
    s_and_b32 s73, s73, 1
    s_lshl2_add_u32 s75, s73, s30
    s_lshl_b32 s76, s75, 19
    v_lshlrev_b32 v10, 14, v4
    v_lshl_add_u32 v10, v3, 3, v10
    v_add_u32 v10, s76, v10
    s_lshl_b32 s76, s74, 7
    v_add_u32 v10, s76, v10
    s_lshl_b32 s76, s74, 9
    v_lshlrev_b32 v11, 5, v3
    buffer_load_dwordx4 v[16:19], v11, s[56:59], s76 offen
    buffer_load_dwordx4 v[20:23], v11, s[56:59], s76 offen offset:16
    s_lshl_b32 s76, s30, 5
    s_sub_u32 s76, 127, s76
    v_sub_u32 v12, s76, v4
    v_lshlrev_b32 v13, 13, v3
    v_and_b32 v7, 7, v3
    v_subrev_u32 v11, 6144, v10
    v_min_u32 v11, 0x80000000, v11
    buffer_load_dwordx2 v[40:41], v11, s[48:51], 0 offen nt
    v_subrev_u32 v11, 4096, v10
    v_min_u32 v11, 0x80000000, v11
    buffer_load_dwordx2 v[42:43], v11, s[48:51], 0 offen nt
    v_subrev_u32 v11, 2048, v10
    v_min_u32 v11, 0x80000000, v11
    buffer_load_dwordx2 v[44:45], v11, s[48:51], 0 offen nt
    s_movk_i32 s76, 0
    buffer_load_dwordx2 v[46:47], v10, s[48:51], s76 offen offset:0 nt
    buffer_load_dwordx2 v[62:63], v10, s[52:55], s76 offen offset:0 nt
    buffer_load_dwordx2 v[48:49], v10, s[48:51], s76 offen offset:2048 nt
    buffer_load_dwordx2 v[64:65], v10, s[52:55], s76 offen offset:2048 nt
    s_movk_i32 s76, 4096
    buffer_load_dwordx2 v[50:51], v10, s[48:51], s76 offen offset:0 nt
    buffer_load_dwordx2 v[66:67], v10, s[52:55], s76 offen offset:0 nt
    buffer_load_dwordx2 v[52:53], v10, s[48:51], s76 offen offset:2048 nt
    buffer_load_dwordx2 v[68:69], v10, s[52:55], s76 offen offset:2048 nt
    s_movk_i32 s76, 8192
    buffer_load_dwordx2 v[54:55], v10, s[48:51], s76 offen offset:0 nt
    buffer_load_dwordx2 v[70:71], v10, s[52:55], s76 offen offset:0 nt
    buffer_load_dwordx2 v[56:57], v10, s[48:51], s76 offen offset:2048 nt
    buffer_load_dwordx2 v[72:73], v10, s[52:55], s76 offen offset:2048 nt
    s_movk_i32 s76, 12288
    buffer_load_dwordx2 v[58:59], v10, s[48:51], s76 offen offset:0 nt
    buffer_load_dwordx2 v[74:75], v10, s[52:55], s76 offen offset:0 nt
    buffer_load_dwordx2 v[60:61], v10, s[48:51], s76 offen offset:2048 nt
    buffer_load_dwordx2 v[76:77], v10, s[52:55], s76 offen offset:2048 nt
    v_add_u32 v10, 65536, v10
    buffer_load_dword v243, v8, s[36:39], s64 offen
    s_add_u32 s64, s64, 917504
    s_waitcnt vmcnt(21)
    v_lshlrev_b32 v24, 16, v16
    v_and_b32 v28, 0xffff0000, v16
    v_lshlrev_b32 v32, 16, v17
    v_and_b32 v36, 0xffff0000, v17
    v_lshlrev_b32 v25, 16, v18
    v_and_b32 v29, 0xffff0000, v18
    v_lshlrev_b32 v33, 16, v19
    v_and_b32 v37, 0xffff0000, v19
    s_waitcnt vmcnt(20)
    v_lshlrev_b32 v26, 16, v20
    v_and_b32 v30, 0xffff0000, v20
    v_lshlrev_b32 v34, 16, v21
    v_and_b32 v38, 0xffff0000, v21
    v_lshlrev_b32 v27, 16, v22
    v_and_b32 v31, 0xffff0000, v22
    v_lshlrev_b32 v35, 16, v23
    v_and_b32 v39, 0xffff0000, v23
    s_mov_b32 s70, 4
L_hloop:
    buffer_load_dword v236, v8, s[36:39], s64 offen
    s_add_u32 s64, s64, 917504
    s_waitcnt vmcnt(19)
    v_lshlrev_b32 v120, 16, v40
    v_and_b32 v121, 0xffff0000, v40
    v_lshlrev_b32 v122, 16, v41
    v_and_b32 v123, 0xffff0000, v41
    v_pk_mul_f32 v[128:129], v[120:121], v[36:37]
    v_pk_mul_f32 v[130:131], v[122:123], v[38:39]
    s_waitcnt vmcnt(18)
    v_lshlrev_b32 v120, 16, v42
    v_and_b32 v121, 0xffff0000, v42
    v_lshlrev_b32 v122, 16, v43
    v_subrev_u32 v11, 6144, v10
    v_min_u32 v11, 0x80000000, v11
    buffer_load_dwordx2 v[80:81], v11, s[48:51], 0 offen nt
    v_and_b32 v123, 0xffff0000, v43
    v_pk_mul_f32 v[132:133], v[120:121], v[36:37]
    v_pk_mul_f32 v[134:135], v[122:123], v[38:39]
    v_pk_fma_f32 v[128:129], v[120:121], v[32:33], v[128:129]
    v_pk_fma_f32 v[130:131], v[122:123], v[34:35], v[130:131]
    s_waitcnt vmcnt(18)
    v_lshlrev_b32 v120, 16, v44
    v_and_b32 v121, 0xffff0000, v44
    v_lshlrev_b32 v122, 16, v45
    v_subrev_u32 v11, 4096, v10
    v_min_u32 v11, 0x80000000, v11
    buffer_load_dwordx2 v[82:83], v11, s[48:51], 0 offen nt
    v_and_b32 v123, 0xffff0000, v45
    v_pk_mul_f32 v[136:137], v[120:121], v[36:37]
    v_pk_mul_f32 v[138:139], v[122:123], v[38:39]
    v_pk_fma_f32 v[132:133], v[120:121], v[32:33], v[132:133]
    v_pk_fma_f32 v[134:135], v[122:123], v[34:35], v[134:135]
    v_pk_fma_f32 v[128:129], v[120:121], v[28:29], v[128:129]
    v_pk_fma_f32 v[130:131], v[122:123], v[30:31], v[130:131]
    s_waitcnt vmcnt(18)
    v_lshlrev_b32 v120, 16, v46
    v_subrev_u32 v11, 2048, v10
    v_min_u32 v11, 0x80000000, v11
    buffer_load_dwordx2 v[84:85], v11, s[48:51], 0 offen nt
    v_and_b32 v121, 0xffff0000, v46
    v_lshlrev_b32 v122, 16, v47
    v_and_b32 v123, 0xffff0000, v47
    v_pk_mul_f32 v[140:141], v[120:121], v[36:37]
    v_pk_mul_f32 v[142:143], v[122:123], v[38:39]
    v_pk_fma_f32 v[136:137], v[120:121], v[32:33], v[136:137]
    v_pk_fma_f32 v[138:139], v[122:123], v[34:35], v[138:139]
    v_pk_fma_f32 v[132:133], v[120:121], v[28:29], v[132:133]
    s_movk_i32 s76, 0
    buffer_load_dwordx2 v[86:87], v10, s[48:51], s76 offen offset:0 nt
    v_pk_fma_f32 v[134:135], v[122:123], v[30:31], v[134:135]
    v_pk_fma_f32 v[128:129], v[120:121], v[24:25], v[128:129]
    v_pk_fma_f32 v[130:131], v[122:123], v[26:27], v[130:131]
    s_waitcnt vmcnt(19)
    v_lshlrev_b32 v124, 16, v62
    v_and_b32 v125, 0xffff0000, v62
    v_lshlrev_b32 v126, 16, v63
    v_and_b32 v127, 0xffff0000, v63
    v_pk_mul_f32 v[128:129], v[128:129], v[124:125]
    buffer_load_dwordx2 v[102:103], v10, s[52:55], s76 offen offset:0 nt
    v_pk_mul_f32 v[130:131], v[130:131], v[126:127]
    s_waitcnt vmcnt(19)
    v_lshlrev_b32 v120, 16, v48
    v_and_b32 v121, 0xffff0000, v48
    v_lshlrev_b32 v122, 16, v49
    v_and_b32 v123, 0xffff0000, v49
    v_pk_mul_f32 v[144:145], v[120:121], v[36:37]
    v_pk_mul_f32 v[146:147], v[122:123], v[38:39]
    v_pk_fma_f32 v[140:141], v[120:121], v[32:33], v[140:141]
    v_pk_fma_f32 v[142:143], v[122:123], v[34:35], v[142:143]
    buffer_load_dwordx2 v[88:89], v10, s[48:51], s76 offen offset:2048 nt
    v_pk_fma_f32 v[136:137], v[120:121], v[28:29], v[136:137]
    v_pk_fma_f32 v[138:139], v[122:123], v[30:31], v[138:139]
    v_pk_fma_f32 v[132:133], v[120:121], v[24:25], v[132:133]
    v_pk_fma_f32 v[134:135], v[122:123], v[26:27], v[134:135]
    s_waitcnt vmcnt(19)
    v_lshlrev_b32 v124, 16, v64
    v_and_b32 v125, 0xffff0000, v64
    v_lshlrev_b32 v126, 16, v65
    v_and_b32 v127, 0xffff0000, v65
    buffer_load_dwordx2 v[104:105], v10, s[52:55], s76 offen offset:2048 nt
    v_pk_mul_f32 v[132:133], v[132:133], v[124:125]
    v_pk_mul_f32 v[134:135], v[134:135], v[126:127]
    s_waitcnt vmcnt(19)
    v_lshlrev_b32 v120, 16, v50
    v_and_b32 v121, 0xffff0000, v50
    v_lshlrev_b32 v122, 16, v51
    v_and_b32 v123, 0xffff0000, v51
    v_pk_mul_f32 v[148:149], v[120:121], v[36:37]
    v_pk_mul_f32 v[150:151], v[122:123], v[38:39]
    s_movk_i32 s76, 4096
    buffer_load_dwordx2 v[90:91], v10, s[48:51], s76 offen offset:0 nt
    v_pk_fma_f32 v[144:145], v[120:121], v[32:33], v[144:145]
    v_pk_fma_f32 v[146:147], v[122:123], v[34:35], v[146:147]
    v_pk_fma_f32 v[140:141], v[120:121], v[28:29], v[140:141]
    v_pk_fma_f32 v[142:143], v[122:123], v[30:31], v[142:143]
    v_pk_fma_f32 v[136:137], v[120:121], v[24:25], v[136:137]
    v_pk_fma_f32 v[138:139], v[122:123], v[26:27], v[138:139]
    s_waitcnt vmcnt(19)
    v_lshlrev_b32 v124, 16, v66
    v_and_b32 v125, 0xffff0000, v66
    buffer_load_dwordx2 v[106:107], v10, s[52:55], s76 offen offset:0 nt
    v_lshlrev_b32 v126, 16, v67
    v_and_b32 v127, 0xffff0000, v67
    v_pk_mul_f32 v[136:137], v[136:137], v[124:125]
    v_pk_mul_f32 v[138:139], v[138:139], v[126:127]
    s_waitcnt vmcnt(19)
    v_lshlrev_b32 v120, 16, v52
    v_and_b32 v121, 0xffff0000, v52
    v_lshlrev_b32 v122, 16, v53
    v_and_b32 v123, 0xffff0000, v53
    buffer_load_dwordx2 v[92:93], v10, s[48:51], s76 offen offset:2048 nt
    v_pk_mul_f32 v[152:153], v[120:121], v[36:37]
    v_pk_mul_f32 v[154:155], v[122:123], v[38:39]
    v_pk_fma_f32 v[148:149], v[120:121], v[32:33], v[148:149]
    v_pk_fma_f32 v[150:151], v[122:123], v[34:35], v[150:151]
    v_pk_fma_f32 v[144:145], v[120:121], v[28:29], v[144:145]
    v_pk_fma_f32 v[146:147], v[122:123], v[30:31], v[146:147]
    v_pk_fma_f32 v[140:141], v[120:121], v[24:25], v[140:141]
    v_pk_fma_f32 v[142:143], v[122:123], v[26:27], v[142:143]
    buffer_load_dwordx2 v[108:109], v10, s[52:55], s76 offen offset:2048 nt
    s_waitcnt vmcnt(20)
    v_lshlrev_b32 v124, 16, v68
    v_and_b32 v125, 0xffff0000, v68
    v_lshlrev_b32 v126, 16, v69
    v_and_b32 v127, 0xffff0000, v69
    v_pk_mul_f32 v[140:141], v[140:141], v[124:125]
    v_pk_mul_f32 v[142:143], v[142:143], v[126:127]
    s_waitcnt vmcnt(19)
    v_lshlrev_b32 v120, 16, v54
    v_and_b32 v121, 0xffff0000, v54
    v_lshlrev_b32 v122, 16, v55
    s_movk_i32 s76, 8192
    buffer_load_dwordx2 v[94:95], v10, s[48:51], s76 offen offset:0 nt
    v_and_b32 v123, 0xffff0000, v55
    v_pk_mul_f32 v[156:157], v[120:121], v[36:37]
    v_pk_mul_f32 v[158:159], v[122:123], v[38:39]
    v_pk_fma_f32 v[152:153], v[120:121], v[32:33], v[152:153]
    v_pk_fma_f32 v[154:155], v[122:123], v[34:35], v[154:155]
    v_pk_fma_f32 v[148:149], v[120:121], v[28:29], v[148:149]
    v_pk_fma_f32 v[150:151], v[122:123], v[30:31], v[150:151]
    v_pk_fma_f32 v[144:145], v[120:121], v[24:25], v[144:145]
    buffer_load_dwordx2 v[110:111], v10, s[52:55], s76 offen offset:0 nt
    v_pk_fma_f32 v[146:147], v[122:123], v[26:27], v[146:147]
    s_waitcnt vmcnt(20)
    v_lshlrev_b32 v124, 16, v70
    v_and_b32 v125, 0xffff0000, v70
    v_lshlrev_b32 v126, 16, v71
    v_and_b32 v127, 0xffff0000, v71
    v_pk_mul_f32 v[144:145], v[144:145], v[124:125]
    v_pk_mul_f32 v[146:147], v[146:147], v[126:127]
    s_waitcnt vmcnt(19)
    v_lshlrev_b32 v120, 16, v56
    buffer_load_dwordx2 v[96:97], v10, s[48:51], s76 offen offset:2048 nt
    v_and_b32 v121, 0xffff0000, v56
    v_lshlrev_b32 v122, 16, v57
    v_and_b32 v123, 0xffff0000, v57
    v_pk_fma_f32 v[156:157], v[120:121], v[32:33], v[156:157]
    v_pk_fma_f32 v[158:159], v[122:123], v[34:35], v[158:159]
    v_pk_fma_f32 v[152:153], v[120:121], v[28:29], v[152:153]
    v_pk_fma_f32 v[154:155], v[122:123], v[30:31], v[154:155]
    v_pk_fma_f32 v[148:149], v[120:121], v[24:25], v[148:149]
    buffer_load_dwordx2 v[112:113], v10, s[52:55], s76 offen offset:2048 nt
    v_pk_fma_f32 v[150:151], v[122:123], v[26:27], v[150:151]
    s_waitcnt vmcnt(20)
    v_lshlrev_b32 v124, 16, v72
    v_and_b32 v125, 0xffff0000, v72
    v_lshlrev_b32 v126, 16, v73
    v_and_b32 v127, 0xffff0000, v73
    v_pk_mul_f32 v[148:149], v[148:149], v[124:125]
    v_pk_mul_f32 v[150:151], v[150:151], v[126:127]
    s_waitcnt vmcnt(19)
    v_lshlrev_b32 v120, 16, v58
    s_movk_i32 s76, 12288
    buffer_load_dwordx2 v[98:99], v10, s[48:51], s76 offen offset:0 nt
    v_and_b32 v121, 0xffff0000, v58
    v_lshlrev_b32 v122, 16, v59
    v_and_b32 v123, 0xffff0000, v59
    v_pk_fma_f32 v[156:157], v[120:121], v[28:29], v[156:157]
    v_pk_fma_f32 v[158:159], v[122:123], v[30:31], v[158:159]
    v_pk_fma_f32 v[152:153], v[120:121], v[24:25], v[152:153]
    v_pk_fma_f32 v[154:155], v[122:123], v[26:27], v[154:155]
    s_waitcnt vmcnt(19)
    v_lshlrev_b32 v124, 16, v74
    v_and_b32 v125, 0xffff0000, v74
    buffer_load_dwordx2 v[114:115], v10, s[52:55], s76 offen offset:0 nt
    v_lshlrev_b32 v126, 16, v75
    v_and_b32 v127, 0xffff0000, v75
    v_pk_mul_f32 v[152:153], v[152:153], v[124:125]
    v_pk_mul_f32 v[154:155], v[154:155], v[126:127]
    s_waitcnt vmcnt(19)
    v_lshlrev_b32 v120, 16, v60
    v_and_b32 v121, 0xffff0000, v60
    v_lshlrev_b32 v122, 16, v61
    v_and_b32 v123, 0xffff0000, v61
    buffer_load_dwordx2 v[100:101], v10, s[48:51], s76 offen offset:2048 nt
    v_pk_fma_f32 v[156:157], v[120:121], v[24:25], v[156:157]
    v_pk_fma_f32 v[158:159], v[122:123], v[26:27], v[158:159]
    s_waitcnt vmcnt(19)
    v_lshlrev_b32 v124, 16, v76
    v_and_b32 v125, 0xffff0000, v76
    v_lshlrev_b32 v126, 16, v77
    v_and_b32 v127, 0xffff0000, v77
    v_pk_mul_f32 v[156:157], v[156:157], v[124:125]
    v_pk_mul_f32 v[158:159], v[158:159], v[126:127]
    buffer_load_dwordx2 v[116:117], v10, s[52:55], s76 offen offset:2048 nt
    v_add_u32 v10, 65536, v10
    s_waitcnt lgkmcnt(0)
    v_xor_b32 v6, v12, v7
    v_lshl_add_u32 v6, v6, 4, v13
    v_subrev_u32 v12, 4, v12
    v_cvt_pk_bf16_f32 v160, v156, v152
    v_cvt_pk_bf16_f32 v161, v148, v144
    v_cvt_pk_bf16_f32 v162, v140, v136
    v_cvt_pk_bf16_f32 v163, v132, v128
    buffer_load_dword v237, v8, s[36:39], s64 offen
    s_add_u32 s64, s64, 917504
    ds_write_b128 v6, v[160:163] offset:0
    v_cvt_pk_bf16_f32 v164, v157, v153
    v_cvt_pk_bf16_f32 v165, v149, v145
    v_cvt_pk_bf16_f32 v166, v141, v137
    v_cvt_pk_bf16_f32 v167, v133, v129
    ds_write_b128 v6, v[164:167] offset:2048
    v_cvt_pk_bf16_f32 v168, v158, v154
    v_cvt_pk_bf16_f32 v169, v150, v146
    v_cvt_pk_bf16_f32 v170, v142, v138
    v_cvt_pk_bf16_f32 v171, v134, v130
    ds_write_b128 v6, v[168:171] offset:4096
    v_cvt_pk_bf16_f32 v172, v159, v155
    v_cvt_pk_bf16_f32 v173, v151, v147
    v_cvt_pk_bf16_f32 v174, v143, v139
    v_cvt_pk_bf16_f32 v175, v135, v131
    ds_write_b128 v6, v[172:175] offset:6144
    s_mov_b32 s88, 0x80000000
    s_cmp_eq_u32 s70, 1
    s_cselect_b32 s76, 0x80000000, 0
    v_or_b32 v10, s76, v10
    s_waitcnt vmcnt(19)
    v_lshlrev_b32 v120, 16, v80
    v_and_b32 v121, 0xffff0000, v80
    v_lshlrev_b32 v122, 16, v81
    v_and_b32 v123, 0xffff0000, v81
    v_pk_mul_f32 v[128:129], v[120:121], v[36:37]
    v_pk_mul_f32 v[130:131], v[122:123], v[38:39]
    s_waitcnt vmcnt(18)
    v_lshlrev_b32 v120, 16, v82
    v_and_b32 v121, 0xffff0000, v82
    v_lshlrev_b32 v122, 16, v83
    v_subrev_u32 v11, 6144, v10
    v_min_u32 v11, 0x80000000, v11
    buffer_load_dwordx2 v[40:41], v11, s[48:51], 0 offen nt
    v_and_b32 v123, 0xffff0000, v83
    v_pk_mul_f32 v[132:133], v[120:121], v[36:37]
    v_pk_mul_f32 v[134:135], v[122:123], v[38:39]
    v_pk_fma_f32 v[128:129], v[120:121], v[32:33], v[128:129]
    v_pk_fma_f32 v[130:131], v[122:123], v[34:35], v[130:131]
    s_waitcnt vmcnt(18)
    v_lshlrev_b32 v120, 16, v84
    v_and_b32 v121, 0xffff0000, v84
    v_lshlrev_b32 v122, 16, v85
    v_and_b32 v123, 0xffff0000, v85
    v_subrev_u32 v11, 4096, v10
    v_min_u32 v11, 0x80000000, v11
    buffer_load_dwordx2 v[42:43], v11, s[48:51], 0 offen nt
    v_pk_mul_f32 v[136:137], v[120:121], v[36:37]
    v_pk_mul_f32 v[138:139], v[122:123], v[38:39]
    v_pk_fma_f32 v[132:133], v[120:121], v[32:33], v[132:133]
    v_pk_fma_f32 v[134:135], v[122:123], v[34:35], v[134:135]
    v_pk_fma_f32 v[128:129], v[120:121], v[28:29], v[128:129]
    v_pk_fma_f32 v[130:131], v[122:123], v[30:31], v[130:131]
    s_waitcnt vmcnt(18)
    v_lshlrev_b32 v120, 16, v86
    v_and_b32 v121, 0xffff0000, v86
    v_subrev_u32 v11, 2048, v10
    v_min_u32 v11, 0x80000000, v11
    buffer_load_dwordx2 v[44:45], v11, s[48:51], 0 offen nt
    v_lshlrev_b32 v122, 16, v87
    v_and_b32 v123, 0xffff0000, v87
    v_pk_mul_f32 v[140:141], v[120:121], v[36:37]
    v_pk_mul_f32 v[142:143], v[122:123], v[38:39]
    v_pk_fma_f32 v[136:137], v[120:121], v[32:33], v[136:137]
    v_pk_fma_f32 v[138:139], v[122:123], v[34:35], v[138:139]
    v_pk_fma_f32 v[132:133], v[120:121], v[28:29], v[132:133]
    v_pk_fma_f32 v[134:135], v[122:123], v[30:31], v[134:135]
    v_pk_fma_f32 v[128:129], v[120:121], v[24:25], v[128:129]
    s_movk_i32 s76, 0
    buffer_load_dwordx2 v[46:47], v10, s[48:51], s76 offen offset:0 nt
    v_pk_fma_f32 v[130:131], v[122:123], v[26:27], v[130:131]
    s_waitcnt vmcnt(19)
    v_lshlrev_b32 v124, 16, v102
    v_and_b32 v125, 0xffff0000, v102
    v_lshlrev_b32 v126, 16, v103
    v_and_b32 v127, 0xffff0000, v103
    v_pk_mul_f32 v[128:129], v[128:129], v[124:125]
    v_pk_mul_f32 v[130:131], v[130:131], v[126:127]
    s_waitcnt vmcnt(18)
    v_lshlrev_b32 v120, 16, v88
    buffer_load_dwordx2 v[62:63], v10, s[52:55], s76 offen offset:0 nt
    v_and_b32 v121, 0xffff0000, v88
    v_lshlrev_b32 v122, 16, v89
    v_and_b32 v123, 0xffff0000, v89
    v_pk_mul_f32 v[144:145], v[120:121], v[36:37]
    v_pk_mul_f32 v[146:147], v[122:123], v[38:39]
    v_pk_fma_f32 v[140:141], v[120:121], v[32:33], v[140:141]
    v_pk_fma_f32 v[142:143], v[122:123], v[34:35], v[142:143]
    v_pk_fma_f32 v[136:137], v[120:121], v[28:29], v[136:137]
    v_pk_fma_f32 v[138:139], v[122:123], v[30:31], v[138:139]
    buffer_load_dwordx2 v[48:49], v10, s[48:51], s76 offen offset:2048 nt
    v_pk_fma_f32 v[132:133], v[120:121], v[24:25], v[132:133]
    v_pk_fma_f32 v[134:135], v[122:123], v[26:27], v[134:135]
    s_waitcnt vmcnt(19)
    v_lshlrev_b32 v124, 16, v104
    v_and_b32 v125, 0xffff0000, v104
    v_lshlrev_b32 v126, 16, v105
    v_and_b32 v127, 0xffff0000, v105
    v_pk_mul_f32 v[132:133], v[132:133], v[124:125]
    v_pk_mul_f32 v[134:135], v[134:135], v[126:127]
    buffer_load_dwordx2 v[64:65], v10, s[52:55], s76 offen offset:2048 nt
    s_waitcnt vmcnt(19)
    v_lshlrev_b32 v120, 16, v90
    v_and_b32 v121, 0xffff0000, v90
    v_lshlrev_b32 v122, 16, v91
    v_and_b32 v123, 0xffff0000, v91
    v_pk_mul_f32 v[148:149], v[120:121], v[36:37]
    v_pk_mul_f32 v[150:151], v[122:123], v[38:39]
    v_pk_fma_f32 v[144:145], v[120:121], v[32:33], v[144:145]
    v_pk_fma_f32 v[146:147], v[122:123], v[34:35], v[146:147]
    v_pk_fma_f32 v[140:141], v[120:121], v[28:29], v[140:141]
    s_movk_i32 s76, 4096
    buffer_load_dwordx2 v[50:51], v10, s[48:51], s76 offen offset:0 nt
    v_pk_fma_f32 v[142:143], v[122:123], v[30:31], v[142:143]
    v_pk_fma_f32 v[136:137], v[120:121], v[24:25], v[136:137]
    v_pk_fma_f32 v[138:139], v[122:123], v[26:27], v[138:139]
    s_waitcnt vmcnt(19)
    v_lshlrev_b32 v124, 16, v106
    v_and_b32 v125, 0xffff0000, v106
    v_lshlrev_b32 v126, 16, v107
    v_and_b32 v127, 0xffff0000, v107
    v_pk_mul_f32 v[136:137], v[136:137], v[124:125]
    v_pk_mul_f32 v[138:139], v[138:139], v[126:127]
    buffer_load_dwordx2 v[66:67], v10, s[52:55], s76 offen offset:0 nt
    s_waitcnt vmcnt(19)
    v_lshlrev_b32 v120, 16, v92
    v_and_b32 v121, 0xffff0000, v92
    v_lshlrev_b32 v122, 16, v93
    v_and_b32 v123, 0xffff0000, v93
    v_pk_mul_f32 v[152:153], v[120:121], v[36:37]
    v_pk_mul_f32 v[154:155], v[122:123], v[38:39]
    v_pk_fma_f32 v[148:149], v[120:121], v[32:33], v[148:149]
    v_pk_fma_f32 v[150:151], v[122:123], v[34:35], v[150:151]
    buffer_load_dwordx2 v[52:53], v10, s[48:51], s76 offen offset:2048 nt
    v_pk_fma_f32 v[144:145], v[120:121], v[28:29], v[144:145]
    v_pk_fma_f32 v[146:147], v[122:123], v[30:31], v[146:147]
    v_pk_fma_f32 v[140:141], v[120:121], v[24:25], v[140:141]
    v_pk_fma_f32 v[142:143], v[122:123], v[26:27], v[142:143]
    s_waitcnt vmcnt(19)
    v_lshlrev_b32 v124, 16, v108
    v_and_b32 v125, 0xffff0000, v108
    v_lshlrev_b32 v126, 16, v109
    v_and_b32 v127, 0xffff0000, v109
    v_pk_mul_f32 v[140:141], v[140:141], v[124:125]
    buffer_load_dwordx2 v[68:69], v10, s[52:55], s76 offen offset:2048 nt
    v_pk_mul_f32 v[142:143], v[142:143], v[126:127]
    s_waitcnt vmcnt(19)
    v_lshlrev_b32 v120, 16, v94
    v_and_b32 v121, 0xffff0000, v94
    v_lshlrev_b32 v122, 16, v95
    v_and_b32 v123, 0xffff0000, v95
    v_pk_mul_f32 v[156:157], v[120:121], v[36:37]
    v_pk_mul_f32 v[158:159], v[122:123], v[38:39]
    v_pk_fma_f32 v[152:153], v[120:121], v[32:33], v[152:153]
    s_movk_i32 s76, 8192
    buffer_load_dwordx2 v[54:55], v10, s[48:51], s76 offen offset:0 nt
    v_pk_fma_f32 v[154:155], v[122:123], v[34:35], v[154:155]
    v_pk_fma_f32 v[148:149], v[120:121], v[28:29], v[148:149]
    v_pk_fma_f32 v[150:151], v[122:123], v[30:31], v[150:151]
    v_pk_fma_f32 v[144:145], v[120:121], v[24:25], v[144:145]
    v_pk_fma_f32 v[146:147], v[122:123], v[26:27], v[146:147]
    s_waitcnt vmcnt(19)
    v_lshlrev_b32 v124, 16, v110
    v_and_b32 v125, 0xffff0000, v110
    v_lshlrev_b32 v126, 16, v111
    v_and_b32 v127, 0xffff0000, v111
    buffer_load_dwordx2 v[70:71], v10, s[52:55], s76 offen offset:0 nt
    v_pk_mul_f32 v[144:145], v[144:145], v[124:125]
    v_pk_mul_f32 v[146:147], v[146:147], v[126:127]
    s_waitcnt vmcnt(19)
    v_lshlrev_b32 v120, 16, v96
    v_and_b32 v121, 0xffff0000, v96
    v_lshlrev_b32 v122, 16, v97
    v_and_b32 v123, 0xffff0000, v97
    v_pk_fma_f32 v[156:157], v[120:121], v[32:33], v[156:157]
    v_pk_fma_f32 v[158:159], v[122:123], v[34:35], v[158:159]
    buffer_load_dwordx2 v[56:57], v10, s[48:51], s76 offen offset:2048 nt
    v_pk_fma_f32 v[152:153], v[120:121], v[28:29], v[152:153]
    v_pk_fma_f32 v[154:155], v[122:123], v[30:31], v[154:155]
    v_pk_fma_f32 v[148:149], v[120:121], v[24:25], v[148:149]
    v_pk_fma_f32 v[150:151], v[122:123], v[26:27], v[150:151]
    s_waitcnt vmcnt(19)
    v_lshlrev_b32 v124, 16, v112
    v_and_b32 v125, 0xffff0000, v112
    v_lshlrev_b32 v126, 16, v113
    v_and_b32 v127, 0xffff0000, v113
    v_pk_mul_f32 v[148:149], v[148:149], v[124:125]
    buffer_load_dwordx2 v[72:73], v10, s[52:55], s76 offen offset:2048 nt
    v_pk_mul_f32 v[150:151], v[150:151], v[126:127]
    s_waitcnt vmcnt(19)
    v_lshlrev_b32 v120, 16, v98
    v_and_b32 v121, 0xffff0000, v98
    v_lshlrev_b32 v122, 16, v99
    v_and_b32 v123, 0xffff0000, v99
    v_pk_fma_f32 v[156:157], v[120:121], v[28:29], v[156:157]
    v_pk_fma_f32 v[158:159], v[122:123], v[30:31], v[158:159]
    v_pk_fma_f32 v[152:153], v[120:121], v[24:25], v[152:153]
    v_pk_fma_f32 v[154:155], v[122:123], v[26:27], v[154:155]
    s_movk_i32 s76, 12288
    buffer_load_dwordx2 v[58:59], v10, s[48:51], s76 offen offset:0 nt
    s_waitcnt vmcnt(19)
    v_lshlrev_b32 v124, 16, v114
    v_and_b32 v125, 0xffff0000, v114
    v_lshlrev_b32 v126, 16, v115
    v_and_b32 v127, 0xffff0000, v115
    v_pk_mul_f32 v[152:153], v[152:153], v[124:125]
    v_pk_mul_f32 v[154:155], v[154:155], v[126:127]
    s_waitcnt vmcnt(18)
    v_lshlrev_b32 v120, 16, v100
    v_and_b32 v121, 0xffff0000, v100
    buffer_load_dwordx2 v[74:75], v10, s[52:55], s76 offen offset:0 nt
    v_lshlrev_b32 v122, 16, v101
    v_and_b32 v123, 0xffff0000, v101
    v_pk_fma_f32 v[156:157], v[120:121], v[24:25], v[156:157]
    v_pk_fma_f32 v[158:159], v[122:123], v[26:27], v[158:159]
    s_waitcnt vmcnt(18)
    v_lshlrev_b32 v124, 16, v116
    v_and_b32 v125, 0xffff0000, v116
    v_lshlrev_b32 v126, 16, v117
    v_and_b32 v127, 0xffff0000, v117
    v_pk_mul_f32 v[156:157], v[156:157], v[124:125]
    buffer_load_dwordx2 v[60:61], v10, s[48:51], s76 offen offset:2048 nt
    v_pk_mul_f32 v[158:159], v[158:159], v[126:127]
    s_waitcnt lgkmcnt(0)
    v_xor_b32 v6, v12, v7
    v_lshl_add_u32 v6, v6, 4, v13
    v_subrev_u32 v12, 4, v12
    v_cvt_pk_bf16_f32 v160, v156, v152
    v_cvt_pk_bf16_f32 v161, v148, v144
    v_cvt_pk_bf16_f32 v162, v140, v136
    buffer_load_dwordx2 v[76:77], v10, s[52:55], s76 offen offset:2048 nt
    v_add_u32 v10, 65536, v10
    v_cvt_pk_bf16_f32 v163, v132, v128
    ds_write_b128 v6, v[160:163] offset:0
    v_cvt_pk_bf16_f32 v164, v157, v153
    v_cvt_pk_bf16_f32 v165, v149, v145
    v_cvt_pk_bf16_f32 v166, v141, v137
    v_cvt_pk_bf16_f32 v167, v133, v129
    ds_write_b128 v6, v[164:167] offset:2048
    v_cvt_pk_bf16_f32 v168, v158, v154
    v_cvt_pk_bf16_f32 v169, v150, v146
    v_cvt_pk_bf16_f32 v170, v142, v138
    v_cvt_pk_bf16_f32 v171, v134, v130
    ds_write_b128 v6, v[168:171] offset:4096
    v_cvt_pk_bf16_f32 v172, v159, v155
    v_cvt_pk_bf16_f32 v173, v151, v147
    v_cvt_pk_bf16_f32 v174, v143, v139
    v_cvt_pk_bf16_f32 v175, v135, v131
    ds_write_b128 v6, v[172:175] offset:6144
    s_sub_u32 s70, s70, 1
    s_cmp_lg_u32 s70, 0
    s_cbranch_scc1 L_hloop
    s_bfe_u32 s80, s2, 0x30003
    s_bfe_u32 s94, s2, 0x10001
    s_lshl3_add_u32 s80, s94, s80
    s_lshr_b32 s81, s2, 6
    s_bfe_u32 s94, s2, 0x10002
    s_lshl2_add_u32 s81, s94, s81
    s_lshr_b32 s94, s30, 1
    s_lshl1_add_u32 s81, s81, s94
    s_and_b32 s92, s2, 1
    s_and_b32 s93, s30, 1
    s_lshl1_add_u32 s82, s92, s93
    s_mov_b32 s44, s20
    s_and_b32 s45, s21, 0xffff
    s_mov_b32 s46, 7340032
    s_mov_b32 s47, 0x20000
    s_lshl2_add_u32 s92, s80, s82
    s_mul_i32 s84, s92, 229376
    s_lshl_b32 s92, s94, 13
    s_add_u32 s84, s84, s92
    s_lshl_b32 s85, s93, 14
    s_add_u32 s85, s85, s92
    s_mul_i32 s69, s30, 1835008
    s_lshl_b32 s92, s2, 11
    s_add_u32 s69, s69, s92
    s_mul_i32 s77, s82, 1835008
    s_lshl_b32 s92, s81, 7
    s_add_u32 s77, s77, s92
    s_lshl_b32 s79, s30, 13
    s_add_u32 s79, s79, 98304
    v_lshrrev_b32 v192, 2, v244
    v_min_u32 v192, 1, v192
    v_lshlrev_b32 v192, 31, v192
    v_lshl_add_u32 v235, v244, 7, v192
    v_lshrrev_b32 v192, 3, v244
    v_and_b32 v193, 6, v192
    v_and_b32 v194, 7, v244
    v_xor_b32 v193, v193, v194
    v_lshlrev_b32 v192, 11, v192
    v_lshl_add_u32 v246, v193, 4, v192
    v_add_u32 v247, 15360, v246
    v_add_u32 v248, 30720, v246
    v_add_u32 v249, 46080, v246
    v_lshrrev_b32 v192, 2, v244
    v_bfe_u32 v193, v244, 3, 2
    v_and_b32 v194, 3, v244
    v_lshlrev_b32 v192, 7, v192
    v_lshl_add_u32 v192, v194, 3, v192
    v_add_u32 v192, s79, v192
    v_xor_b32 v194, 0, v193
    v_lshl_add_u32 v250, v194, 5, v192
    v_xor_b32 v194, 1, v193
    v_lshl_add_u32 v251, v194, 5, v192
    v_xor_b32 v194, 2, v193
    v_lshl_add_u32 v252, v194, 5, v192
    v_xor_b32 v194, 3, v193
    v_lshl_add_u32 v253, v194, 5, v192
    s_add_u32 s91, s77, 0
    s_add_u32 m0, s79, 32768
    s_nop 0
    buffer_load_dwordx4 v246, s[44:47], s91 offen offset:0 lds
    buffer_load_dwordx4 v247, s[44:47], s91 offen offset:1024 lds
    buffer_load_dwordx4 v248, s[44:47], s91 offen offset:2048 lds
    buffer_load_dwordx4 v249, s[44:47], s91 offen offset:3072 lds
    s_add_u32 s78, s77, 65536
    s_add_u32 m0, s79, 36864
    s_nop 0
    buffer_load_dwordx4 v246, s[44:47], s78 offen offset:0 lds
    buffer_load_dwordx4 v247, s[44:47], s78 offen offset:1024 lds
    buffer_load_dwordx4 v248, s[44:47], s78 offen offset:2048 lds
    buffer_load_dwordx4 v249, s[44:47], s78 offen offset:3072 lds
    s_add_u32 s40, s28, 16777216
    s_addc_u32 s41, s29, 0
    s_and_b32 s41, s41, 0xffff
    s_mov_b32 s42, 4194304
    s_mov_b32 s43, 0x20000
    s_lshl2_add_u32 s75, s74, s30
    s_lshl_b32 s75, s75, 16
    s_xor_b32 s73, s73, 1
    s_lshl_b32 s73, s73, 11
    s_add_u32 s75, s75, s73
    s_and_b32 s73, s30, 1
    s_lshl_b32 s73, s73, 2
    s_lshl_b32 s76, s30, 15
    s_add_u32 s74, s73, 0
    v_xor_b32 v10, s74, v244
    v_lshlrev_b32 v10, 4, v10
    v_add_u32 v10, s76, v10
    s_add_u32 s74, s73, 1
    v_xor_b32 v11, s74, v244
    v_lshlrev_b32 v11, 4, v11
    v_add_u32 v11, s76, v11
    s_add_u32 s74, s73, 2
    v_xor_b32 v12, s74, v244
    v_lshlrev_b32 v12, 4, v12
    v_add_u32 v12, s76, v12
    s_add_u32 s74, s73, 3
    v_xor_b32 v13, s74, v244
    v_lshlrev_b32 v13, 4, v13
    v_add_u32 v13, s76, v13
    s_waitcnt lgkmcnt(0)
    s_barrier
    ds_read_b128 v[16:19], v10 offset:0
    ds_read_b128 v[20:23], v10 offset:1024
    ds_read_b128 v[24:27], v10 offset:2048
    ds_read_b128 v[28:31], v10 offset:3072
    ds_read_b128 v[32:35], v10 offset:4096
    ds_read_b128 v[36:39], v10 offset:5120
    s_waitcnt vmcnt(25)
    ds_read_b128 v[40:43], v10 offset:6144
    s_waitcnt vmcnt(23)
    ds_read_b128 v[44:47], v10 offset:7168
    s_waitcnt vmcnt(19)
    ds_read_b128 v[48:51], v11 offset:8192
    s_waitcnt vmcnt(15)
    ds_read_b128 v[52:55], v11 offset:9216
    s_waitcnt vmcnt(11)
    ds_read_b128 v[56:59], v11 offset:10240
    s_waitcnt vmcnt(9)
    ds_read_b128 v[60:63], v11 offset:11264
    ds_read_b128 v[64:67], v11 offset:12288
    ds_read_b128 v[68:71], v11 offset:13312
    ds_read_b128 v[72:75], v11 offset:14336
    s_waitcnt vmcnt(8)
    ds_read_b128 v[76:79], v11 offset:15360
    ds_read_b128 v[80:83], v12 offset:16384
    ds_read_b128 v[84:87], v12 offset:17408
    ds_read_b128 v[88:91], v12 offset:18432
    ds_read_b128 v[92:95], v12 offset:19456
    ds_read_b128 v[96:99], v12 offset:20480
    ds_read_b128 v[100:103], v12 offset:21504
    ds_read_b128 v[104:107], v12 offset:22528
    ds_read_b128 v[108:111], v12 offset:23552
    ds_read_b128 v[112:115], v13 offset:24576
    ds_read_b128 v[116:119], v13 offset:25600
    ds_read_b128 v[120:123], v13 offset:26624
    ds_read_b128 v[124:127], v13 offset:27648
    ds_read_b128 v[128:131], v13 offset:28672
    ds_read_b128 v[132:135], v13 offset:29696
    ds_read_b128 v[136:139], v13 offset:30720
    ds_read_b128 v[140:143], v13 offset:31744
    s_waitcnt lgkmcnt(14)
    buffer_store_dwordx4 v[16:19], v245, s[40:43], s75 offen offset:0 sc1
    buffer_store_dwordx4 v[20:23], v245, s[40:43], s75 offen offset:1024 sc1
    s_add_u32 s75, s75, 4096
    buffer_store_dwordx4 v[24:27], v245, s[40:43], s75 offen offset:0 sc1
    buffer_store_dwordx4 v[28:31], v245, s[40:43], s75 offen offset:1024 sc1
    s_add_u32 s75, s75, 4096
    buffer_store_dwordx4 v[32:35], v245, s[40:43], s75 offen offset:0 sc1
    buffer_store_dwordx4 v[36:39], v245, s[40:43], s75 offen offset:1024 sc1
    s_add_u32 s75, s75, 4096
    buffer_store_dwordx4 v[40:43], v245, s[40:43], s75 offen offset:0 sc1
    buffer_store_dwordx4 v[44:47], v245, s[40:43], s75 offen offset:1024 sc1
    s_add_u32 s75, s75, 4096
    buffer_store_dwordx4 v[48:51], v245, s[40:43], s75 offen offset:0 sc1
    buffer_store_dwordx4 v[52:55], v245, s[40:43], s75 offen offset:1024 sc1
    s_add_u32 s75, s75, 4096
    buffer_store_dwordx4 v[56:59], v245, s[40:43], s75 offen offset:0 sc1
    buffer_store_dwordx4 v[60:63], v245, s[40:43], s75 offen offset:1024 sc1
    s_add_u32 s75, s75, 4096
    buffer_store_dwordx4 v[64:67], v245, s[40:43], s75 offen offset:0 sc1
    buffer_store_dwordx4 v[68:71], v245, s[40:43], s75 offen offset:1024 sc1
    s_add_u32 s75, s75, 4096
    buffer_store_dwordx4 v[72:75], v245, s[40:43], s75 offen offset:0 sc1
    buffer_store_dwordx4 v[76:79], v245, s[40:43], s75 offen offset:1024 sc1
    s_add_u32 s75, s75, 4096
    buffer_store_dwordx4 v[80:83], v245, s[40:43], s75 offen offset:0 sc1
    buffer_store_dwordx4 v[84:87], v245, s[40:43], s75 offen offset:1024 sc1
    s_add_u32 s75, s75, 4096
    s_waitcnt lgkmcnt(13)
    buffer_store_dwordx4 v[88:91], v245, s[40:43], s75 offen offset:0 sc1
    s_waitcnt lgkmcnt(12)
    buffer_store_dwordx4 v[92:95], v245, s[40:43], s75 offen offset:1024 sc1
    s_add_u32 s75, s75, 4096
    s_waitcnt lgkmcnt(11)
    buffer_store_dwordx4 v[96:99], v245, s[40:43], s75 offen offset:0 sc1
    s_waitcnt lgkmcnt(10)
    buffer_store_dwordx4 v[100:103], v245, s[40:43], s75 offen offset:1024 sc1
    s_add_u32 s75, s75, 4096
    s_waitcnt lgkmcnt(9)
    buffer_store_dwordx4 v[104:107], v245, s[40:43], s75 offen offset:0 sc1
    s_waitcnt lgkmcnt(8)
    buffer_store_dwordx4 v[108:111], v245, s[40:43], s75 offen offset:1024 sc1
    s_add_u32 s75, s75, 4096
    s_waitcnt lgkmcnt(7)
    buffer_store_dwordx4 v[112:115], v245, s[40:43], s75 offen offset:0 sc1
    s_waitcnt lgkmcnt(6)
    buffer_store_dwordx4 v[116:119], v245, s[40:43], s75 offen offset:1024 sc1
    s_add_u32 s75, s75, 4096
    s_waitcnt lgkmcnt(5)
    buffer_store_dwordx4 v[120:123], v245, s[40:43], s75 offen offset:0 sc1
    s_waitcnt lgkmcnt(4)
    buffer_store_dwordx4 v[124:127], v245, s[40:43], s75 offen offset:1024 sc1
    s_add_u32 s75, s75, 4096
    s_waitcnt lgkmcnt(3)
    buffer_store_dwordx4 v[128:131], v245, s[40:43], s75 offen offset:0 sc1
    s_waitcnt lgkmcnt(2)
    buffer_store_dwordx4 v[132:135], v245, s[40:43], s75 offen offset:1024 sc1
    s_add_u32 s75, s75, 4096
    s_waitcnt lgkmcnt(1)
    buffer_store_dwordx4 v[136:139], v245, s[40:43], s75 offen offset:0 sc1
    s_waitcnt lgkmcnt(0)
    buffer_store_dwordx4 v[140:143], v245, s[40:43], s75 offen offset:1024 sc1
    s_add_u32 s75, s75, 4096
    s_barrier
    s_mov_b32 s52, s12
    s_and_b32 s53, s13, 0xffff
    s_mov_b32 s54, 4194304
    s_mov_b32 s55, 0x20000
    s_lshl2_add_u32 s73, s2, s30
    s_mul_i32 s95, s30, 8288
    s_add_u32 s95, s95, 65536
    s_mul_i32 s89, s30, 4576
    s_add_u32 s89, s89, 98688
    s_lshl_b32 s74, s73, 12
    v_lshrrev_b32 v196, 5, v244
    v_lshlrev_b32 v196, 31, v196
    v_lshl_add_u32 v196, v244, 7, v196
    buffer_load_dword v238, v196, s[52:55], s74 offen nt
    v_mov_b32 v192, 0
    buffer_load_dwordx2 v[194:195], v192, s[60:63], 0 offen sc1
    s_add_u32 s91, s77, 131072
    s_mov_b32 m0, s79
    s_nop 0
    buffer_load_dwordx4 v246, s[44:47], s91 offen offset:0 lds
    buffer_load_dwordx4 v247, s[44:47], s91 offen offset:1024 lds
    buffer_load_dwordx4 v248, s[44:47], s91 offen offset:2048 lds
    buffer_load_dwordx4 v249, s[44:47], s91 offen offset:3072 lds
    s_add_u32 s78, s77, 196608
    s_add_u32 m0, s79, 4096
    s_nop 0
    buffer_load_dwordx4 v246, s[44:47], s78 offen offset:0 lds
    buffer_load_dwordx4 v247, s[44:47], s78 offen offset:1024 lds
    buffer_load_dwordx4 v248, s[44:47], s78 offen offset:2048 lds
    buffer_load_dwordx4 v249, s[44:47], s78 offen offset:3072 lds
    s_waitcnt vmcnt(8)
    v_cmp_ne_u64 vcc, 0, v[194:195]
    s_nop 1
    s_cmp_eq_u64 vcc, -1
    s_cbranch_scc0 L_slow_nch
L_ok_nch:
    v_readfirstlane_b32 s86, v194
    v_readfirstlane_b32 s87, v195
    s_add_u32 s60, s28, 27262976
    s_addc_u32 s61, s29, 0
    s_and_b32 s61, s61, 0xffff
    s_mov_b32 s62, 1048576
    s_mov_b32 s63, 0x20000
    s_lshl2_add_u32 s75, s2, s30
    s_lshl_b32 s75, s75, 10
    v_lshrrev_b32 v254, 4, v244
    v_min_u32 v254, 1, v254
    v_lshlrev_b32 v254, 31, v254
    v_lshl_add_u32 v254, v244, 3, v254
    v_add_u32 v254, s75, v254
    v_mov_b32 v192, s86
    v_mov_b32 v193, s87
    buffer_store_dwordx2 v[192:193], v254, s[60:63], 0 offen offset:256 sc1
    s_mov_b32 s48, s22
    s_and_b32 s49, s23, 0xffff
    s_mov_b32 s50, 2048
    s_mov_b32 s51, 0x20000
    s_sub_u32 s92, s2, 224
    s_lshl2_add_u32 s92, s92, s30
    s_lshl_b32 s93, s92, 15
    buffer_load_dwordx4 v[8:11], v245, s[48:51], 0 offen offset:0
    buffer_load_dwordx4 v[12:15], v245, s[48:51], 0 offen offset:1024
    buffer_load_dwordx4 v[16:19], v245, s[32:35], s93 offen offset:0
    buffer_load_dwordx4 v[20:23], v245, s[32:35], s93 offen offset:1024
    buffer_load_dwordx4 v[24:27], v245, s[32:35], s93 offen offset:2048
    buffer_load_dwordx4 v[28:31], v245, s[32:35], s93 offen offset:3072
    s_add_u32 s93, s93, 4096
    buffer_load_dwordx4 v[32:35], v245, s[32:35], s93 offen offset:0
    buffer_load_dwordx4 v[36:39], v245, s[32:35], s93 offen offset:1024
    buffer_load_dwordx4 v[40:43], v245, s[32:35], s93 offen offset:2048
    buffer_load_dwordx4 v[44:47], v245, s[32:35], s93 offen offset:3072
    s_add_u32 s93, s93, 4096
    buffer_load_dwordx4 v[48:51], v245, s[32:35], s93 offen offset:0
    buffer_load_dwordx4 v[52:55], v245, s[32:35], s93 offen offset:1024
    buffer_load_dwordx4 v[56:59], v245, s[32:35], s93 offen offset:2048
    buffer_load_dwordx4 v[60:63], v245, s[32:35], s93 offen offset:3072
    s_add_u32 s93, s93, 4096
    buffer_load_dwordx4 v[64:67], v245, s[32:35], s93 offen offset:0
    buffer_load_dwordx4 v[68:71], v245, s[32:35], s93 offen offset:1024
    buffer_load_dwordx4 v[72:75], v245, s[32:35], s93 offen offset:2048
    buffer_load_dwordx4 v[76:79], v245, s[32:35], s93 offen offset:3072
    s_add_u32 s93, s93, 4096
    buffer_load_dwordx4 v[80:83], v245, s[32:35], s93 offen offset:0
    buffer_load_dwordx4 v[84:87], v245, s[32:35], s93 offen offset:1024
    buffer_load_dwordx4 v[88:91], v245, s[32:35], s93 offen offset:2048
    buffer_load_dwordx4 v[92:95], v245, s[32:35], s93 offen offset:3072
    s_add_u32 s93, s93, 4096
    buffer_load_dwordx4 v[96:99], v245, s[32:35], s93 offen offset:0
    buffer_load_dwordx4 v[100:103], v245, s[32:35], s93 offen offset:1024
    buffer_load_dwordx4 v[104:107], v245, s[32:35], s93 offen offset:2048
    buffer_load_dwordx4 v[108:111], v245, s[32:35], s93 offen offset:3072
    s_add_u32 s93, s93, 4096
    buffer_load_dwordx4 v[112:115], v245, s[32:35], s93 offen offset:0
    buffer_load_dwordx4 v[116:119], v245, s[32:35], s93 offen offset:1024
    buffer_load_dwordx4 v[120:123], v245, s[32:35], s93 offen offset:2048
    buffer_load_dwordx4 v[124:127], v245, s[32:35], s93 offen offset:3072
    s_add_u32 s93, s93, 4096
    buffer_load_dwordx4 v[128:131], v245, s[32:35], s93 offen offset:0
    buffer_load_dwordx4 v[132:135], v245, s[32:35], s93 offen offset:1024
    buffer_load_dwordx4 v[136:139], v245, s[32:35], s93 offen offset:2048
    buffer_load_dwordx4 v[140:143], v245, s[32:35], s93 offen offset:3072
    s_add_u32 s93, s93, 4096
    ds_read_b64_tr_b16 a[160:161], v250 offset:32768
    ds_read_b64_tr_b16 a[162:163], v250 offset:34816
    ds_read_b64_tr_b16 a[164:165], v251 offset:32768
    ds_read_b64_tr_b16 a[166:167], v251 offset:34816
    ds_read_b64_tr_b16 a[168:169], v252 offset:32768
    ds_read_b64_tr_b16 a[170:171], v252 offset:34816
    ds_read_b64_tr_b16 a[172:173], v253 offset:32768
    ds_read_b64_tr_b16 a[174:175], v253 offset:34816
    ds_read_b64_tr_b16 a[176:177], v250 offset:36864
    ds_read_b64_tr_b16 a[178:179], v250 offset:38912
    ds_read_b64_tr_b16 a[180:181], v251 offset:36864
    ds_read_b64_tr_b16 a[182:183], v251 offset:38912
    ds_read_b64_tr_b16 a[184:185], v252 offset:36864
    ds_read_b64_tr_b16 a[186:187], v252 offset:38912
    ds_read_b64_tr_b16 a[188:189], v253 offset:36864
    ds_read_b64_tr_b16 a[190:191], v253 offset:38912
    s_waitcnt vmcnt(39)
    ds_read_b64_tr_b16 a[192:193], v250 offset:0
    ds_read_b64_tr_b16 a[194:195], v250 offset:2048
    ds_read_b64_tr_b16 a[196:197], v251 offset:0
    ds_read_b64_tr_b16 a[198:199], v251 offset:2048
    ds_read_b64_tr_b16 a[200:201], v252 offset:0
    ds_read_b64_tr_b16 a[202:203], v252 offset:2048
    ds_read_b64_tr_b16 a[204:205], v253 offset:0
    ds_read_b64_tr_b16 a[206:207], v253 offset:2048
    s_waitcnt vmcnt(35)
    ds_read_b64_tr_b16 a[208:209], v250 offset:4096
    ds_read_b64_tr_b16 a[210:211], v250 offset:6144
    ds_read_b64_tr_b16 a[212:213], v251 offset:4096
    ds_read_b64_tr_b16 a[214:215], v251 offset:6144
    ds_read_b64_tr_b16 a[216:217], v252 offset:4096
    ds_read_b64_tr_b16 a[218:219], v252 offset:6144
    ds_read_b64_tr_b16 a[220:221], v253 offset:4096
    ds_read_b64_tr_b16 a[222:223], v253 offset:6144
    s_waitcnt lgkmcnt(0)
    s_add_u32 s91, s77, 262144
    s_mov_b32 m0, s79
    s_nop 0
    buffer_load_dwordx4 v246, s[44:47], s91 offen offset:0 lds
    buffer_load_dwordx4 v247, s[44:47], s91 offen offset:1024 lds
    buffer_load_dwordx4 v248, s[44:47], s91 offen offset:2048 lds
    buffer_load_dwordx4 v249, s[44:47], s91 offen offset:3072 lds
    s_add_u32 s78, s77, 327680
    s_add_u32 m0, s79, 4096
    s_nop 0
    buffer_load_dwordx4 v246, s[44:47], s78 offen offset:0 lds
    buffer_load_dwordx4 v247, s[44:47], s78 offen offset:1024 lds
    buffer_load_dwordx4 v248, s[44:47], s78 offen offset:2048 lds
    buffer_load_dwordx4 v249, s[44:47], s78 offen offset:3072 lds
    s_add_u32 s91, s77, 393216
    s_add_u32 m0, s79, 32768
    s_nop 0
    buffer_load_dwordx4 v246, s[44:47], s91 offen offset:0 lds
    buffer_load_dwordx4 v247, s[44:47], s91 offen offset:1024 lds
    buffer_load_dwordx4 v248, s[44:47], s91 offen offset:2048 lds
    buffer_load_dwordx4 v249, s[44:47], s91 offen offset:3072 lds
    s_add_u32 s78, s77, 458752
    s_add_u32 m0, s79, 36864
    s_nop 0
    buffer_load_dwordx4 v246, s[44:47], s78 offen offset:0 lds
    buffer_load_dwordx4 v247, s[44:47], s78 offen offset:1024 lds
    buffer_load_dwordx4 v248, s[44:47], s78 offen offset:2048 lds
    buffer_load_dwordx4 v249, s[44:47], s78 offen offset:3072 lds
    s_add_u32 s48, s28, 20971520
    s_addc_u32 s49, s29, 0
    s_and_b32 s49, s49, 0xffff
    s_mov_b32 s50, 16384
    s_mov_b32 s51, 0x20000
    v_mov_b32 v144, 0
    v_mov_b32 v145, 0
    v_mov_b32 v146, 0
    v_mov_b32 v147, 0
    v_mov_b32 v148, 0
    v_mov_b32 v149, 0
    v_mov_b32 v150, 0
    v_mov_b32 v151, 0
    v_mov_b32 v152, 0
    v_mov_b32 v153, 0
    v_mov_b32 v154, 0
    v_mov_b32 v155, 0
    v_mov_b32 v156, 0
    v_mov_b32 v157, 0
    v_mov_b32 v158, 0
    v_mov_b32 v159, 0
    s_waitcnt vmcnt(47)
    v_dot2c_f32_bf16 v144, v16, v8
    s_waitcnt vmcnt(45)
    v_dot2c_f32_bf16 v145, v24, v8
    s_waitcnt vmcnt(43)
    v_dot2c_f32_bf16 v146, v32, v8
    s_waitcnt vmcnt(41)
    v_dot2c_f32_bf16 v147, v40, v8
    v_dot2c_f32_bf16 v144, v17, v9
    v_dot2c_f32_bf16 v145, v25, v9
    v_dot2c_f32_bf16 v146, v33, v9
    v_dot2c_f32_bf16 v147, v41, v9
    v_dot2c_f32_bf16 v144, v18, v10
    v_dot2c_f32_bf16 v145, v26, v10
    v_dot2c_f32_bf16 v146, v34, v10
    v_dot2c_f32_bf16 v147, v42, v10
    v_dot2c_f32_bf16 v144, v19, v11
    v_dot2c_f32_bf16 v145, v27, v11
    v_dot2c_f32_bf16 v146, v35, v11
    v_dot2c_f32_bf16 v147, v43, v11
    v_dot2c_f32_bf16 v144, v20, v12
    v_dot2c_f32_bf16 v145, v28, v12
    v_dot2c_f32_bf16 v146, v36, v12
    s_waitcnt vmcnt(40)
    v_dot2c_f32_bf16 v147, v44, v12
    v_dot2c_f32_bf16 v144, v21, v13
    v_dot2c_f32_bf16 v145, v29, v13
    v_dot2c_f32_bf16 v146, v37, v13
    v_dot2c_f32_bf16 v147, v45, v13
    v_dot2c_f32_bf16 v144, v22, v14
    v_dot2c_f32_bf16 v145, v30, v14
    v_dot2c_f32_bf16 v146, v38, v14
    v_dot2c_f32_bf16 v147, v46, v14
    v_dot2c_f32_bf16 v144, v23, v15
    v_dot2c_f32_bf16 v145, v31, v15
    v_dot2c_f32_bf16 v146, v39, v15
    v_dot2c_f32_bf16 v147, v47, v15
    s_waitcnt vmcnt(39)
    v_dot2c_f32_bf16 v148, v48, v8
    s_waitcnt vmcnt(37)
    v_dot2c_f32_bf16 v149, v56, v8
    s_waitcnt vmcnt(35)
    v_dot2c_f32_bf16 v150, v64, v8
    s_waitcnt vmcnt(33)
    v_dot2c_f32_bf16 v151, v72, v8
    v_dot2c_f32_bf16 v148, v49, v9
    v_dot2c_f32_bf16 v149, v57, v9
    v_dot2c_f32_bf16 v150, v65, v9
    v_dot2c_f32_bf16 v151, v73, v9
    v_dot2c_f32_bf16 v148, v50, v10
    v_dot2c_f32_bf16 v149, v58, v10
    v_dot2c_f32_bf16 v150, v66, v10
    v_dot2c_f32_bf16 v151, v74, v10
    v_dot2c_f32_bf16 v148, v51, v11
    v_dot2c_f32_bf16 v149, v59, v11
    v_dot2c_f32_bf16 v150, v67, v11
    v_dot2c_f32_bf16 v151, v75, v11
    v_dot2c_f32_bf16 v148, v52, v12
    v_dot2c_f32_bf16 v149, v60, v12
    v_dot2c_f32_bf16 v150, v68, v12
    s_waitcnt vmcnt(32)
    v_dot2c_f32_bf16 v151, v76, v12
    v_dot2c_f32_bf16 v148, v53, v13
    v_dot2c_f32_bf16 v149, v61, v13
    v_dot2c_f32_bf16 v150, v69, v13
    v_dot2c_f32_bf16 v151, v77, v13
    v_dot2c_f32_bf16 v148, v54, v14
    v_dot2c_f32_bf16 v149, v62, v14
    v_dot2c_f32_bf16 v150, v70, v14
    v_dot2c_f32_bf16 v151, v78, v14
    v_dot2c_f32_bf16 v148, v55, v15
    v_dot2c_f32_bf16 v149, v63, v15
    v_dot2c_f32_bf16 v150, v71, v15
    v_dot2c_f32_bf16 v151, v79, v15
    s_waitcnt vmcnt(31)
    v_dot2c_f32_bf16 v152, v80, v8
    s_waitcnt vmcnt(29)
    v_dot2c_f32_bf16 v153, v88, v8
    s_waitcnt vmcnt(27)
    v_dot2c_f32_bf16 v154, v96, v8
    s_waitcnt vmcnt(25)
    v_dot2c_f32_bf16 v155, v104, v8
    v_dot2c_f32_bf16 v152, v81, v9
    v_dot2c_f32_bf16 v153, v89, v9
    v_dot2c_f32_bf16 v154, v97, v9
    v_dot2c_f32_bf16 v155, v105, v9
    v_dot2c_f32_bf16 v152, v82, v10
    v_dot2c_f32_bf16 v153, v90, v10
    v_dot2c_f32_bf16 v154, v98, v10
    v_dot2c_f32_bf16 v155, v106, v10
    v_dot2c_f32_bf16 v152, v83, v11
    v_dot2c_f32_bf16 v153, v91, v11
    v_dot2c_f32_bf16 v154, v99, v11
    v_dot2c_f32_bf16 v155, v107, v11
    v_dot2c_f32_bf16 v152, v84, v12
    v_dot2c_f32_bf16 v153, v92, v12
    v_dot2c_f32_bf16 v154, v100, v12
    s_waitcnt vmcnt(24)
    v_dot2c_f32_bf16 v155, v108, v12
    v_dot2c_f32_bf16 v152, v85, v13
    v_dot2c_f32_bf16 v153, v93, v13
    v_dot2c_f32_bf16 v154, v101, v13
    v_dot2c_f32_bf16 v155, v109, v13
    v_dot2c_f32_bf16 v152, v86, v14
    v_dot2c_f32_bf16 v153, v94, v14
    v_dot2c_f32_bf16 v154, v102, v14
    v_dot2c_f32_bf16 v155, v110, v14
    v_dot2c_f32_bf16 v152, v87, v15
    v_dot2c_f32_bf16 v153, v95, v15
    v_dot2c_f32_bf16 v154, v103, v15
    v_dot2c_f32_bf16 v155, v111, v15
    s_waitcnt vmcnt(23)
    v_dot2c_f32_bf16 v156, v112, v8
    s_waitcnt vmcnt(21)
    v_dot2c_f32_bf16 v157, v120, v8
    s_waitcnt vmcnt(19)
    v_dot2c_f32_bf16 v158, v128, v8
    s_waitcnt vmcnt(17)
    v_dot2c_f32_bf16 v159, v136, v8
    v_dot2c_f32_bf16 v156, v113, v9
    v_dot2c_f32_bf16 v157, v121, v9
    v_dot2c_f32_bf16 v158, v129, v9
    v_dot2c_f32_bf16 v159, v137, v9
    v_dot2c_f32_bf16 v156, v114, v10
    v_dot2c_f32_bf16 v157, v122, v10
    v_dot2c_f32_bf16 v158, v130, v10
    v_dot2c_f32_bf16 v159, v138, v10
    v_dot2c_f32_bf16 v156, v115, v11
    v_dot2c_f32_bf16 v157, v123, v11
    v_dot2c_f32_bf16 v158, v131, v11
    v_dot2c_f32_bf16 v159, v139, v11
    v_dot2c_f32_bf16 v156, v116, v12
    v_dot2c_f32_bf16 v157, v124, v12
    v_dot2c_f32_bf16 v158, v132, v12
    s_waitcnt vmcnt(16)
    v_dot2c_f32_bf16 v159, v140, v12
    v_dot2c_f32_bf16 v156, v117, v13
    v_dot2c_f32_bf16 v157, v125, v13
    v_dot2c_f32_bf16 v158, v133, v13
    v_dot2c_f32_bf16 v159, v141, v13
    v_dot2c_f32_bf16 v156, v118, v14
    v_dot2c_f32_bf16 v157, v126, v14
    v_dot2c_f32_bf16 v158, v134, v14
    v_dot2c_f32_bf16 v159, v142, v14
    v_dot2c_f32_bf16 v156, v119, v15
    v_dot2c_f32_bf16 v157, v127, v15
    v_dot2c_f32_bf16 v158, v135, v15
    v_dot2c_f32_bf16 v159, v143, v15
    s_nop 2
    v_add_f32_dpp v144, v144, v144 row_shr:1 bound_ctrl:0
    v_add_f32_dpp v145, v145, v145 row_shr:1 bound_ctrl:0
    v_add_f32_dpp v146, v146, v146 row_shr:1 bound_ctrl:0
    v_add_f32_dpp v147, v147, v147 row_shr:1 bound_ctrl:0
    v_add_f32_dpp v148, v148, v148 row_shr:1 bound_ctrl:0
    v_add_f32_dpp v149, v149, v149 row_shr:1 bound_ctrl:0
    v_add_f32_dpp v150, v150, v150 row_shr:1 bound_ctrl:0
    v_add_f32_dpp v151, v151, v151 row_shr:1 bound_ctrl:0
    v_add_f32_dpp v152, v152, v152 row_shr:1 bound_ctrl:0
    v_add_f32_dpp v153, v153, v153 row_shr:1 bound_ctrl:0
    v_add_f32_dpp v154, v154, v154 row_shr:1 bound_ctrl:0
    v_add_f32_dpp v155, v155, v155 row_shr:1 bound_ctrl:0
    v_add_f32_dpp v156, v156, v156 row_shr:1 bound_ctrl:0
    v_add_f32_dpp v157, v157, v157 row_shr:1 bound_ctrl:0
    v_add_f32_dpp v158, v158, v158 row_shr:1 bound_ctrl:0
    v_add_f32_dpp v159, v159, v159 row_shr:1 bound_ctrl:0
    v_add_f32_dpp v144, v144, v144 row_shr:2 bound_ctrl:0
    v_add_f32_dpp v145, v145, v145 row_shr:2 bound_ctrl:0
    v_add_f32_dpp v146, v146, v146 row_shr:2 bound_ctrl:0
    v_add_f32_dpp v147, v147, v147 row_shr:2 bound_ctrl:0
    v_add_f32_dpp v148, v148, v148 row_shr:2 bound_ctrl:0
    v_add_f32_dpp v149, v149, v149 row_shr:2 bound_ctrl:0
    v_add_f32_dpp v150, v150, v150 row_shr:2 bound_ctrl:0
    v_add_f32_dpp v151, v151, v151 row_shr:2 bound_ctrl:0
    v_add_f32_dpp v152, v152, v152 row_shr:2 bound_ctrl:0
    v_add_f32_dpp v153, v153, v153 row_shr:2 bound_ctrl:0
    v_add_f32_dpp v154, v154, v154 row_shr:2 bound_ctrl:0
    v_add_f32_dpp v155, v155, v155 row_shr:2 bound_ctrl:0
    v_add_f32_dpp v156, v156, v156 row_shr:2 bound_ctrl:0
    v_add_f32_dpp v157, v157, v157 row_shr:2 bound_ctrl:0
    v_add_f32_dpp v158, v158, v158 row_shr:2 bound_ctrl:0
    v_add_f32_dpp v159, v159, v159 row_shr:2 bound_ctrl:0
    v_add_f32_dpp v144, v144, v144 row_shr:4 bound_ctrl:0
    v_add_f32_dpp v145, v145, v145 row_shr:4 bound_ctrl:0
    v_add_f32_dpp v146, v146, v146 row_shr:4 bound_ctrl:0
    v_add_f32_dpp v147, v147, v147 row_shr:4 bound_ctrl:0
    v_add_f32_dpp v148, v148, v148 row_shr:4 bound_ctrl:0
    v_add_f32_dpp v149, v149, v149 row_shr:4 bound_ctrl:0
    v_add_f32_dpp v150, v150, v150 row_shr:4 bound_ctrl:0
    v_add_f32_dpp v151, v151, v151 row_shr:4 bound_ctrl:0
    v_add_f32_dpp v152, v152, v152 row_shr:4 bound_ctrl:0
    v_add_f32_dpp v153, v153, v153 row_shr:4 bound_ctrl:0
    v_add_f32_dpp v154, v154, v154 row_shr:4 bound_ctrl:0
    v_add_f32_dpp v155, v155, v155 row_shr:4 bound_ctrl:0
    v_add_f32_dpp v156, v156, v156 row_shr:4 bound_ctrl:0
    v_add_f32_dpp v157, v157, v157 row_shr:4 bound_ctrl:0
    v_add_f32_dpp v158, v158, v158 row_shr:4 bound_ctrl:0
    v_add_f32_dpp v159, v159, v159 row_shr:4 bound_ctrl:0
    v_add_f32_dpp v144, v144, v144 row_shr:8 bound_ctrl:0
    v_add_f32_dpp v145, v145, v145 row_shr:8 bound_ctrl:0
    v_add_f32_dpp v146, v146, v146 row_shr:8 bound_ctrl:0
    v_add_f32_dpp v147, v147, v147 row_shr:8 bound_ctrl:0
    v_add_f32_dpp v148, v148, v148 row_shr:8 bound_ctrl:0
    v_add_f32_dpp v149, v149, v149 row_shr:8 bound_ctrl:0
    v_add_f32_dpp v150, v150, v150 row_shr:8 bound_ctrl:0
    v_add_f32_dpp v151, v151, v151 row_shr:8 bound_ctrl:0
    v_add_f32_dpp v152, v152, v152 row_shr:8 bound_ctrl:0
    v_add_f32_dpp v153, v153, v153 row_shr:8 bound_ctrl:0
    v_add_f32_dpp v154, v154, v154 row_shr:8 bound_ctrl:0
    v_add_f32_dpp v155, v155, v155 row_shr:8 bound_ctrl:0
    v_add_f32_dpp v156, v156, v156 row_shr:8 bound_ctrl:0
    v_add_f32_dpp v157, v157, v157 row_shr:8 bound_ctrl:0
    v_add_f32_dpp v158, v158, v158 row_shr:8 bound_ctrl:0
    v_add_f32_dpp v159, v159, v159 row_shr:8 bound_ctrl:0
    v_add_f32_dpp v144, v144, v144 row_bcast:15 row_mask:0xa
    v_add_f32_dpp v145, v145, v145 row_bcast:15 row_mask:0xa
    v_add_f32_dpp v146, v146, v146 row_bcast:15 row_mask:0xa
    v_add_f32_dpp v147, v147, v147 row_bcast:15 row_mask:0xa
    v_add_f32_dpp v148, v148, v148 row_bcast:15 row_mask:0xa
    v_add_f32_dpp v149, v149, v149 row_bcast:15 row_mask:0xa
    v_add_f32_dpp v150, v150, v150 row_bcast:15 row_mask:0xa
    v_add_f32_dpp v151, v151, v151 row_bcast:15 row_mask:0xa
    v_add_f32_dpp v152, v152, v152 row_bcast:15 row_mask:0xa
    v_add_f32_dpp v153, v153, v153 row_bcast:15 row_mask:0xa
    v_add_f32_dpp v154, v154, v154 row_bcast:15 row_mask:0xa
    v_add_f32_dpp v155, v155, v155 row_bcast:15 row_mask:0xa
    v_add_f32_dpp v156, v156, v156 row_bcast:15 row_mask:0xa
    v_add_f32_dpp v157, v157, v157 row_bcast:15 row_mask:0xa
    v_add_f32_dpp v158, v158, v158 row_bcast:15 row_mask:0xa
    v_add_f32_dpp v159, v159, v159 row_bcast:15 row_mask:0xa
    v_add_f32_dpp v144, v144, v144 row_bcast:31 row_mask:0xc
    v_add_f32_dpp v145, v145, v145 row_bcast:31 row_mask:0xc
    v_add_f32_dpp v146, v146, v146 row_bcast:31 row_mask:0xc
    v_add_f32_dpp v147, v147, v147 row_bcast:31 row_mask:0xc
    v_add_f32_dpp v148, v148, v148 row_bcast:31 row_mask:0xc
    v_add_f32_dpp v149, v149, v149 row_bcast:31 row_mask:0xc
    v_add_f32_dpp v150, v150, v150 row_bcast:31 row_mask:0xc
    v_add_f32_dpp v151, v151, v151 row_bcast:31 row_mask:0xc
    v_add_f32_dpp v152, v152, v152 row_bcast:31 row_mask:0xc
    v_add_f32_dpp v153, v153, v153 row_bcast:31 row_mask:0xc
    v_add_f32_dpp v154, v154, v154 row_bcast:31 row_mask:0xc
    v_add_f32_dpp v155, v155, v155 row_bcast:31 row_mask:0xc
    v_add_f32_dpp v156, v156, v156 row_bcast:31 row_mask:0xc
    v_add_f32_dpp v157, v157, v157 row_bcast:31 row_mask:0xc
    v_add_f32_dpp v158, v158, v158 row_bcast:31 row_mask:0xc
    v_add_f32_dpp v159, v159, v159 row_bcast:31 row_mask:0xc
    v_mov_b32 v160, 0
    v_readlane_b32 s3, v144, 63
    s_nop 3
    v_writelane_b32 v160, s3, 0
    v_readlane_b32 s3, v145, 63
    s_nop 3
    v_writelane_b32 v160, s3, 1
    v_readlane_b32 s3, v146, 63
    s_nop 3
    v_writelane_b32 v160, s3, 2
    v_readlane_b32 s3, v147, 63
    s_nop 3
    v_writelane_b32 v160, s3, 3
    v_readlane_b32 s3, v148, 63
    s_nop 3
    v_writelane_b32 v160, s3, 4
    v_readlane_b32 s3, v149, 63
    s_nop 3
    v_writelane_b32 v160, s3, 5
    v_readlane_b32 s3, v150, 63
    s_nop 3
    v_writelane_b32 v160, s3, 6
    v_readlane_b32 s3, v151, 63
    s_nop 3
    v_writelane_b32 v160, s3, 7
    v_readlane_b32 s3, v152, 63
    s_nop 3
    v_writelane_b32 v160, s3, 8
    v_readlane_b32 s3, v153, 63
    s_nop 3
    v_writelane_b32 v160, s3, 9
    v_readlane_b32 s3, v154, 63
    s_nop 3
    v_writelane_b32 v160, s3, 10
    v_readlane_b32 s3, v155, 63
    s_nop 3
    v_writelane_b32 v160, s3, 11
    v_readlane_b32 s3, v156, 63
    s_nop 3
    v_writelane_b32 v160, s3, 12
    v_readlane_b32 s3, v157, 63
    s_nop 3
    v_writelane_b32 v160, s3, 13
    v_readlane_b32 s3, v158, 63
    s_nop 3
    v_writelane_b32 v160, s3, 14
    v_readlane_b32 s3, v159, 63
    s_nop 3
    v_writelane_b32 v160, s3, 15
    v_cvt_pk_bf16_f32 v160, v160, v160
    v_lshlrev_b32 v160, 16, v160
    v_mul_f32 v160, 0xbfb8aa3b, v160
    v_exp_f32 v160, v160
    s_nop 0
    v_add_f32 v160, 1.0, v160
    v_rcp_f32 v160, v160
    s_nop 0
    v_cvt_pk_bf16_f32 v160, v160, v160
    v_lshlrev_b32 v160, 16, v160
    v_sub_f32 v161, 1.0, v160
    v_cvt_pk_bf16_f32 v161, v161, v161
    v_lshlrev_b32 v161, 16, v161
    v_lshrrev_b32 v162, 4, v244
    v_min_u32 v162, 1, v162
    v_lshlrev_b32 v162, 31, v162
    v_lshl_add_u32 v162, v244, 3, v162
    s_lshl_b32 s92, s92, 7
    buffer_store_dwordx2 v[160:161], v162, s[48:51], s92 offen sc1
    s_lshr_b32 s75, s2, 4
    s_lshl3_add_u32 s75, s75, 896
    s_bfe_u32 s76, s2, 0x20002
    s_add_u32 s75, s75, s76
    s_lshl_b32 s75, s75, 10
    s_add_u32 s75, s75, 256
    v_and_b32 v192, 1, v244
    v_lshlrev_b32 v192, 12, v192
    v_add_u32 v192, s75, v192
    buffer_load_dwordx2 v[194:195], v192, s[60:63], 0 offen sc1
    s_waitcnt vmcnt(14)
    ds_read_b64_tr_b16 a[224:225], v250 offset:0
    ds_read_b64_tr_b16 a[226:227], v250 offset:2048
    ds_read_b64_tr_b16 a[228:229], v251 offset:0
    ds_read_b64_tr_b16 a[230:231], v251 offset:2048
    ds_read_b64_tr_b16 a[232:233], v252 offset:0
    ds_read_b64_tr_b16 a[234:235], v252 offset:2048
    ds_read_b64_tr_b16 a[236:237], v253 offset:0
    ds_read_b64_tr_b16 a[238:239], v253 offset:2048
    s_waitcnt vmcnt(10)
    ds_read_b64_tr_b16 a[240:241], v250 offset:4096
    ds_read_b64_tr_b16 a[242:243], v250 offset:6144
    ds_read_b64_tr_b16 a[244:245], v251 offset:4096
    ds_read_b64_tr_b16 a[246:247], v251 offset:6144
    ds_read_b64_tr_b16 a[248:249], v252 offset:4096
    ds_read_b64_tr_b16 a[250:251], v252 offset:6144
    ds_read_b64_tr_b16 a[252:253], v253 offset:4096
    ds_read_b64_tr_b16 a[254:255], v253 offset:6144
    s_waitcnt lgkmcnt(0)
    s_barrier
    s_add_u32 m0, s95, 32
    v_add_u32 v196, 0, v245
    buffer_load_dwordx4 v196, s[52:55], s74 offen offset:0 lds
    buffer_load_dwordx4 v196, s[52:55], s74 offen offset:1024 lds
    buffer_load_dwordx4 v196, s[52:55], s74 offen offset:2048 lds
    buffer_load_dwordx4 v196, s[52:55], s74 offen offset:3072 lds
    s_add_u32 m0, s95, 4192
    v_add_u32 v196, 2, v245
    buffer_load_dwordx4 v196, s[52:55], s74 offen offset:0 lds
    buffer_load_dwordx4 v196, s[52:55], s74 offen offset:1024 lds
    buffer_load_dwordx4 v196, s[52:55], s74 offen offset:2048 lds
    buffer_load_dwordx4 v196, s[52:55], s74 offen offset:3072 lds
    s_waitcnt vmcnt(8)
    v_cmp_eq_u64 vcc, s[86:87], v[194:195]
    s_nop 1
    s_cmp_eq_u64 vcc, -1
    s_cbranch_scc0 L_slow_urh
L_ok_urh:
    s_add_u32 s48, s28, 16777216
    s_addc_u32 s49, s29, 0
    s_and_b32 s49, s49, 0xffff
    s_mov_b32 s50, 4194304
    s_mov_b32 s51, 0x20000
    s_mov_b32 m0, s89
    s_nop 0
    buffer_load_dwordx4 v245, s[48:51], s74 offen offset:0 sc1 lds
    buffer_load_dwordx4 v245, s[48:51], s74 offen offset:1024 sc1 lds
    buffer_load_dwordx4 v245, s[48:51], s74 offen offset:2048 sc1 lds
    buffer_load_dwordx4 v245, s[48:51], s74 offen offset:3072 sc1 lds
    s_mov_b32 s56, s28
    s_and_b32 s57, s29, 0xffff
    s_mov_b32 s58, 14680064
    s_mov_b32 s59, 0x20000
    s_waitcnt vmcnt(0) lgkmcnt(0)
    v_mov_b32 v192, s86
    v_mov_b32 v193, s87
    buffer_store_dwordx2 v[192:193], v254, s[60:63], 0 offen offset:640 sc1
    s_branch L_join
L_slow_nc:
    s_mov_b32 s3, 0x100000
L_spin_nc:
    s_sleep 2
    buffer_load_dwordx2 v[194:195], v192, s[60:63], 0 offen sc1
    s_sub_u32 s3, s3, 1
    s_cbranch_scc1 L_ok_nc
    s_waitcnt vmcnt(0)
    v_cmp_ne_u64 vcc, 0, v[194:195]
    s_nop 1
    s_cmp_eq_u64 vcc, -1
    s_cbranch_scc0 L_spin_nc
    s_branch L_ok_nc
L_slow_ur:
    s_mov_b32 s3, 0x100000
L_spin_ur:
    s_sleep 2
    buffer_load_dwordx2 v[194:195], v192, s[60:63], 0 offen sc1
    s_sub_u32 s3, s3, 1
    s_cbranch_scc1 L_ok_ur
    s_waitcnt vmcnt(0)
    v_cmp_eq_u64 vcc, s[86:87], v[194:195]
    s_nop 1
    s_cmp_eq_u64 vcc, -1
    s_cbranch_scc0 L_spin_ur
    s_branch L_ok_ur
L_slow_h0:
    s_mov_b32 s70, 0x100000
L_spin_h0:
    s_sleep 2
    buffer_load_dwordx2 v[236:237], v235, s[60:63], 0 offen sc1
    s_sub_u32 s70, s70, 1
    s_cbranch_scc1 L_ok_h0
    s_waitcnt vmcnt(0)
    v_cmp_eq_u64 vcc, s[86:87], v[236:237]
    s_nop 1
    s_and_b32 s3, vcc_lo, 3
    s_cmp_eq_u32 s3, 3
    s_cbranch_scc0 L_spin_h0
    s_branch L_ok_h0
L_slow_h1:
    s_mov_b32 s70, 0x100000
L_spin_h1:
    s_sleep 2
    buffer_load_dwordx2 v[236:237], v235, s[60:63], 0 offen sc1
    s_sub_u32 s70, s70, 1
    s_cbranch_scc1 L_ok_h1
    s_waitcnt vmcnt(0)
    v_cmp_eq_u64 vcc, s[86:87], v[236:237]
    s_nop 1
    s_and_b32 s3, vcc_lo, 63
    s_cmp_eq_u32 s3, 63
    s_cbranch_scc0 L_spin_h1
    s_branch L_ok_h1
L_slow_hall:
    s_mov_b32 s70, 0x100000
L_spin_hall:
    s_sleep 2
    buffer_load_dwordx2 v[236:237], v234, s[60:63], 0 offen sc1
    s_sub_u32 s70, s70, 1
    s_cbranch_scc1 L_ok_hall
    s_waitcnt vmcnt(0)
    v_cmp_eq_u64 vcc, s[86:87], v[236:237]
    s_nop 1
    s_and_b32 s3, vcc_lo, 268435455
    s_cmp_eq_u32 s3, 268435455
    s_cbranch_scc0 L_spin_hall
    s_branch L_ok_hall
L_slow_g:
    s_mov_b32 s3, 0x100000
L_spin_g:
    s_sleep 2
    buffer_load_dwordx2 v[226:227], v225, s[60:63], 0 offen sc1
    s_sub_u32 s3, s3, 1
    s_cbranch_scc1 L_ok_g
    s_waitcnt vmcnt(0)
    v_cmp_eq_u64 vcc, s[86:87], v[226:227]
    s_nop 1
    s_cmp_eq_u64 vcc, -1
    s_cbranch_scc0 L_spin_g
    s_branch L_ok_g
L_slow_y2:
    s_mov_b32 s3, 0x100000
L_spin_y2:
    s_sleep 2
    buffer_load_dwordx2 v[226:227], v224, s[60:63], 0 offen sc1
    s_sub_u32 s3, s3, 1
    s_cbranch_scc1 L_ok_y2
    s_waitcnt vmcnt(0)
    v_cmp_eq_u64 vcc, s[86:87], v[226:227]
    s_nop 1
    s_cmp_eq_u64 vcc, -1
    s_cbranch_scc0 L_spin_y2
    s_branch L_ok_y2
L_slow_x:
    s_mov_b32 s3, 0x100000
L_spin_x:
    s_sleep 2
    buffer_load_dwordx2 v[226:227], v224, s[60:63], 0 offen sc1
    s_sub_u32 s3, s3, 1
    s_cbranch_scc1 L_ok_x
    s_waitcnt vmcnt(0)
    v_cmp_eq_u64 vcc, s[86:87], v[226:227]
    s_nop 1
    s_cmp_eq_u64 vcc, -1
    s_cbranch_scc0 L_spin_x
    s_branch L_ok_x
L_slow_nch:
    s_mov_b32 s3, 0x100000
L_spin_nch:
    s_sleep 2
    buffer_load_dwordx2 v[194:195], v192, s[60:63], 0 offen sc1
    s_sub_u32 s3, s3, 1
    s_cbranch_scc1 L_ok_nch
    s_waitcnt vmcnt(0)
    v_cmp_ne_u64 vcc, 0, v[194:195]
    s_nop 1
    s_cmp_eq_u64 vcc, -1
    s_cbranch_scc0 L_spin_nch
    s_branch L_ok_nch
L_slow_urh:
    s_mov_b32 s3, 0x100000
L_spin_urh:
    s_sleep 2
    buffer_load_dwordx2 v[194:195], v192, s[60:63], 0 offen sc1
    s_sub_u32 s3, s3, 1
    s_cbranch_scc1 L_ok_urh
    s_waitcnt vmcnt(0)
    v_cmp_eq_u64 vcc, s[86:87], v[194:195]
    s_nop 1
    s_cmp_eq_u64 vcc, -1
    s_cbranch_scc0 L_spin_urh
    s_branch L_ok_urh
L_done:
    s_endpgm

.section .rodata,"a"
.p2align 6
.amdhsa_kernel gated_mix__ssm_conv_h3__swiglu_ffn__prompt_kernel
  .amdhsa_next_free_vgpr 512
  .amdhsa_next_free_sgpr 102
  .amdhsa_accum_offset 256
  .amdhsa_group_segment_fixed_size 0
  .amdhsa_kernarg_size 112
  .amdhsa_user_sgpr_count 2
  .amdhsa_user_sgpr_kernarg_segment_ptr 1
  .amdhsa_system_sgpr_workgroup_id_x 1
  .amdhsa_float_denorm_mode_32 3
  .amdhsa_float_denorm_mode_16_64 3
.end_amdhsa_kernel
```
